```python
import torch

def _softmax(x, axis=-1):
    return torch.softmax(x, dim=axis)

def _gelu(x):
    return torch.nn.functional.gelu(x, approximate='tanh')

def _silu(x):
    return torch.nn.functional.silu(x)

def _sigmoid(x):
    return torch.sigmoid(x)

def _layernorm(x, axis=-1, eps=1e-05):
    m = x.mean(dim=axis, keepdim=True)
    v = x.var(dim=axis, keepdim=True, unbiased=False)
    return (x - m) / torch.sqrt(v + eps)

def _scatter_add(tgt, idx, src, axis=0):
    return tgt.clone().index_add_(axis, idx, src)

def _segment_sum(src, seg, n):
    out = torch.zeros((n,) + src.shape[1:], dtype=src.dtype)
    return out.index_add_(0, seg, src)

def _pad(x, pw):
    flat = tuple((v for pair in reversed(pw) for v in pair))
    return torch.nn.functional.pad(x, flat)
kernel_name = 'parallel_sum__compressed_kv_cla__mixer_gmlp__prompt'

def setup_inputs():

    _w = lambda a: (lambda t: t.to(torch.bfloat16) if t.is_floating_point() else t)(torch.as_tensor(a))

    def _A_setup():
        B, H, Sq, Sk, D, M = (1, 32, 2048, 2048, 128, 576)
        Dc = 4 * D
        return {'x': _w((lambda *s: torch.randn(*s, dtype=torch.bfloat16) * 0.05)(B, Sq, M)), 'c_kv': _w((lambda *s: torch.randn(*s, dtype=torch.bfloat16) * 1.6)(B, Sk, Dc)), 'w_q': _w((lambda *s: torch.randn(*s, dtype=torch.bfloat16) * 1.6)(M, H, D) * M ** (-0.5)), 'w_uk': _w((lambda *s: torch.randn(*s, dtype=torch.bfloat16) * 1.6)(Dc, H, D) * Dc ** (-0.5)), 'w_uv': _w((lambda *s: torch.randn(*s, dtype=torch.bfloat16) * 1.6)(Dc, H, D) * Dc ** (-0.5)), 'w_o': _w((lambda *s: torch.randn(*s, dtype=torch.bfloat16) * 1.6)(H, D, M) * (H * D) ** (-0.5))}
    _A_in = _A_setup()

    def _B_setup():
        B, S, D, F = (1, 2048, 576, 4608)
        Fh = F // 2
        return {'x': _w((lambda *s: torch.randn(*s, dtype=torch.bfloat16) * 0.05)(B, S, D)), 'w_in': _w((lambda *s: torch.randn(*s, dtype=torch.bfloat16) * 0.4)(D, 2 * Fh)), 'w_sp': _w(0.01 * (lambda *s: torch.randn(*s, dtype=torch.bfloat16) * 0.4)(S, S)), 'b_sp': _w(1.0 + 0.01 * (lambda *s: torch.randn(*s, dtype=torch.bfloat16) * 0.05)(S)), 'w_out': _w((lambda *s: torch.randn(*s, dtype=torch.bfloat16) * 0.05)(Fh, D))}
    _B_in = _B_setup()
    return {'A_x': _A_in['x'], 'A_c_kv': _A_in['c_kv'], 'A_w_q': _A_in['w_q'], 'A_w_uk': _A_in['w_uk'], 'A_w_uv': _A_in['w_uv'], 'A_w_o': _A_in['w_o'], 'B_x': _B_in['x'], 'B_w_in': _B_in['w_in'], 'B_w_sp': _B_in['w_sp'], 'B_b_sp': _B_in['b_sp'], 'B_w_out': _B_in['w_out']}

def reference(A_x, A_c_kv, A_w_q, A_w_uk, A_w_uv, A_w_o, B_x, B_w_in, B_w_sp, B_b_sp, B_w_out):

    def _A_ref(x, c_kv, w_q, w_uk, w_uv, w_o):
        B, Sq, M = (x.shape[0], x.shape[1], x.shape[2])
        Sk = c_kv.shape[1]
        H, D = (w_q.shape[1], w_q.shape[2])
        q = torch.einsum('bqm,mhd->bhqd', x, w_q)
        k = torch.einsum('bkc,chd->bhkd', c_kv, w_uk)
        v = torch.einsum('bkc,chd->bhkd', c_kv, w_uv)
        scores = torch.einsum('bhqd,bhkd->bhqk', q, k) * D ** (-0.5)
        off = Sk - Sq
        qi = torch.arange(Sq)[:, None]
        kj = torch.arange(Sk)[None, :]
        cmask = kj <= qi + off
        scores = torch.where(cmask[None, None], scores, -1000000000.0)
        p = _softmax(scores, axis=-1)
        ctx = torch.einsum('bhqk,bhkd->bhqd', p, v)
        return torch.einsum('bhqd,hdm->bqm', ctx, w_o)

    def _B_ref(x, w_in, w_sp, b_sp, w_out):
        B, S, D = x.shape
        F = w_in.shape[-1]
        Fh = F // 2
        z = _gelu(torch.einsum('bsd,df->bsf', x, w_in))
        z1 = z[..., :Fh].clone()
        z2 = _layernorm(z[..., Fh:], axis=-1)
        g = torch.einsum('ts,bsf->btf', w_sp, z2) + b_sp[None, :, None]
        return torch.einsum('bsf,fd->bsd', z1 * g, w_out)
    x = A_x
    xn = _layernorm(x, axis=-1)
    return x + _A_ref(xn, A_c_kv, A_w_q, A_w_uk, A_w_uv, A_w_o) + _B_ref(xn, B_w_in, B_w_sp, B_b_sp, B_w_out)
```

```asm
; @launch grid=(256,1,1) block=(256,1,1) lds=163840
.amdgcn_target "amdgcn-amd-amdhsa--gfx950"
.macro MF d,x,y,c
v_mfma_f32_16x16x32_bf16 \d,\x,\y,\c
.endm
.macro TR d,x,o
ds_read_b64_tr_b16 \d,\x offset:\o
.endm
.macro RD d,x,o
ds_read_b128 \d,\x offset:\o
.endm
.macro CV d,x,y
v_cvt_pk_bf16_f32 \d,\x,\y
.endm
.macro AR d,x
v_accvgpr_read_b32 \d,\x
.endm
.macro AW d,x
v_accvgpr_write_b32 \d,\x
.endm
.macro LW n
s_waitcnt lgkmcnt(\n)
.endm
.text
.globl parallel_sum__compressed_kv_cla__mixer_gmlp__prompt_kernel
.p2align 8
.type parallel_sum__compressed_kv_cla__mixer_gmlp__prompt_kernel,@function
parallel_sum__compressed_kv_cla__mixer_gmlp__prompt_kernel:
s_load_dwordx2 s[4:5],s[0:1],104
s_load_dwordx16 s[64:79],s[0:1],0
s_load_dwordx8 s[80:87],s[0:1],64
s_cmp_lt_u32 s2,256
s_cbranch_scc1 Lm_go
s_endpgm
Lm_go:
v_lshrrev_b32 v1,6,v0
s_and_b32 s40,s2,7
s_lshr_b32 s41,s2,3
v_readfirstlane_b32 s32,v1
s_lshr_b32 s54,s41,2
s_and_b32 s55,s41,1
s_lshl_b32 s42,s40,1
s_add_u32 s55,s55,s42
s_bfe_u32 s58,s41,0x10001
s_lshr_b32 s33,s40,2
s_lshl_b32 s33,s33,3
s_and_b32 s42,s41,7
s_add_u32 s33,s33,s42
s_and_b32 s34,s40,3
s_lshl_b32 s34,s34,2
s_lshr_b32 s42,s41,3
s_add_u32 s34,s34,s42
s_lshl_b32 s35,s40,2
s_and_b32 s42,s41,3
s_add_u32 s35,s35,s42
s_lshr_b32 s36,s2,5
v_and_b32 v1,63,v0
v_lshlrev_b32 v2,4,v1
v_lshrrev_b32 v28,3,v1
s_lshl_b32 s40,s54,8
s_lshr_b32 s41,s32,1
s_lshl_b32 s42,s41,7
s_add_u32 s40,s40,s42
s_and_b32 s42,s32,1
s_lshl_b32 s43,s42,3
s_add_u32 s40,s40,s43
v_add_u32 v28,s40,v28
v_lshlrev_b32 v28,10,v28
v_and_b32 v29,7,v1
v_lshrrev_b32 v30,4,v1
s_lshl_b32 s43,s42,2
v_or_b32 v30,s43,v30
v_xor_b32 v29,v29,v30
v_lshl_add_u32 v14,v29,4,v28
s_lshl_b32 s48,s41,14
s_lshl_b32 s43,s42,10
s_add_u32 s48,s48,s43
v_lshrrev_b32 v28,5,v1
s_lshl_b32 s43,s42,1
s_lshl_b32 s41,s41,3
s_add_u32 s43,s43,s41
v_add_u32 v29,s43,v28
v_lshlrev_b32 v29,13,v29
s_lshl_b32 s40,s55,9
v_add_u32 v29,s40,v29
s_lshl_b32 s40,s32,1
v_or_b32 v28,s40,v28
v_lshlrev_b32 v28,1,v28
v_and_b32 v30,31,v1
v_xor_b32 v28,v28,v30
v_lshl_add_u32 v15,v28,4,v29
s_lshl_b32 s49,s32,12
s_add_u32 s49,s49,98304
LW 0
s_getpc_b64 s[0:1]
Lm_pc:
s_add_u32 s60,s4,0x8380000
s_addc_u32 s61,s5,0
s_load_dword s3,s[60:61],0
s_cmp_eq_u32 s58,0
s_cselect_b32 s42,s70,s72
s_cselect_b32 s43,s71,s73
s_mov_b32 s12,s66
s_mov_b32 s13,s67
s_mov_b32 s14,0x200000
s_mov_b32 s15,0x20000
s_mov_b32 s16,s42
s_mov_b32 s17,s43
s_mov_b32 s18,0x400000
s_mov_b32 s19,0x20000
s_add_u32 m0,s48,65536
s_mov_b32 s46,0
buffer_load_dwordx4 v14,s[12:15],s46 offen lds
s_mov_b32 s46,14336
buffer_load_dwordx4 v14,s[12:15],s46 offen offset:2048 lds
s_add_u32 m0,s48,69632
s_mov_b32 s46,32768
buffer_load_dwordx4 v14,s[12:15],s46 offen lds
s_mov_b32 s46,47104
buffer_load_dwordx4 v14,s[12:15],s46 offen offset:2048 lds
s_add_u32 m0,s48,73728
s_mov_b32 s46,65536
buffer_load_dwordx4 v14,s[12:15],s46 offen lds
s_mov_b32 s46,79872
buffer_load_dwordx4 v14,s[12:15],s46 offen offset:2048 lds
s_add_u32 m0,s48,77824
s_mov_b32 s46,98304
buffer_load_dwordx4 v14,s[12:15],s46 offen lds
s_mov_b32 s46,112640
buffer_load_dwordx4 v14,s[12:15],s46 offen offset:2048 lds
s_add_u32 m0,s49,0
s_mov_b32 s47,0
buffer_load_dwordx4 v15,s[16:19],s47 offen lds
s_mov_b32 s47,31744
buffer_load_dwordx4 v15,s[16:19],s47 offen offset:1024 lds
s_mov_b32 s47,129024
buffer_load_dwordx4 v15,s[16:19],s47 offen offset:2048 lds
s_mov_b32 s47,160768
buffer_load_dwordx4 v15,s[16:19],s47 offen offset:3072 lds
s_mov_b32 s24,s64
s_mov_b32 s25,s65
s_mov_b32 s26,0x240000
s_mov_b32 s27,0x20000
v_lshrrev_b32 v16,5,v0
v_and_b32 v17,31,v0
s_and_b32 s40,s2,1
s_lshl_b32 s40,s40,3
v_add_u32 v16,s40,v16
s_lshr_b32 s42,s2,2
s_lshl_b32 s42,s42,5
s_bfe_u32 s43,s2,0x10001
s_lshl_b32 s43,s43,2
s_add_u32 s42,s42,s43
v_lshrrev_b32 v18,2,v16
v_lshlrev_b32 v18,3,v18
v_and_b32 v19,3,v16
v_add3_u32 v18,v18,v19,s42
v_mul_u32_u24 v18,1152,v18
v_lshl_add_u32 v18,v17,4,v18
v_cmp_gt_u32 s[44:45],8,v17
v_mov_b32 v20,0x80000000
buffer_load_dwordx4 a[128:131],v18,s[24:27],0 offen
buffer_load_dwordx4 a[132:135],v18,s[24:27],0 offen offset:512
v_cndmask_b32 v19,v20,v18,s[44:45]
buffer_load_dwordx4 a[136:139],v19,s[24:27],0 offen offset:1024
s_add_u32 s40,s0,Lm_kv-Lm_pc
s_addc_u32 s41,s1,0
s_lshr_b32 s7,s2,3
s_lshl_b32 s7,s7,2
s_add_u32 s7,s7,s32
s_lshl_b32 s7,s7,9
v_and_b32 v28,3,v1
v_lshl_add_u32 v28,v28,7,s7
v_min_u32 v28,Lm_codeend-Lm_kv-4,v28
global_load_dword a141,v28,s[40:41]
s_lshl_b32 s40,s2,7
s_add_u32 s40,s40,0x8300000
v_and_b32 v28,1,v1
v_lshl_add_u32 v28,v28,15,s40
global_load_dword a142,v28,s[4:5] sc1
s_add_u32 m0,s49,16384
s_mov_b32 s47,262144
buffer_load_dwordx4 v15,s[16:19],s47 offen lds
s_mov_b32 s47,293888
buffer_load_dwordx4 v15,s[16:19],s47 offen offset:1024 lds
s_mov_b32 s47,391168
buffer_load_dwordx4 v15,s[16:19],s47 offen offset:2048 lds
s_mov_b32 s47,422912
buffer_load_dwordx4 v15,s[16:19],s47 offen offset:3072 lds
s_add_u32 m0,s48,0
s_mov_b32 s46,128
buffer_load_dwordx4 v14,s[12:15],s46 offen lds
s_mov_b32 s46,14464
buffer_load_dwordx4 v14,s[12:15],s46 offen offset:2048 lds
s_add_u32 m0,s48,4096
s_mov_b32 s46,32896
buffer_load_dwordx4 v14,s[12:15],s46 offen lds
s_mov_b32 s46,47232
buffer_load_dwordx4 v14,s[12:15],s46 offen offset:2048 lds
s_add_u32 m0,s48,8192
s_mov_b32 s46,65664
buffer_load_dwordx4 v14,s[12:15],s46 offen lds
s_mov_b32 s46,80000
buffer_load_dwordx4 v14,s[12:15],s46 offen offset:2048 lds
s_add_u32 m0,s48,12288
s_mov_b32 s46,98432
buffer_load_dwordx4 v14,s[12:15],s46 offen lds
s_mov_b32 s46,112768
buffer_load_dwordx4 v14,s[12:15],s46 offen offset:2048 lds
v_and_b32 v28,15,v1
v_lshrrev_b32 v29,4,v1
v_lshrrev_b32 v30,1,v28
v_xor_b32 v29,v29,v30
v_lshlrev_b32 v29,4,v29
v_lshl_add_u32 v5,v28,7,v29
s_lshr_b32 s40,s32,1
s_lshl_b32 s40,s40,14
v_add_u32 v5,s40,v5
v_bfe_u32 v28,v1,2,2
v_bfe_u32 v29,v1,4,1
v_lshl_add_u32 v29,v29,2,v28
v_lshrrev_b32 v30,1,v29
v_lshlrev_b32 v30,12,v30
v_and_b32 v28,1,v28
v_lshl_add_u32 v30,v28,9,v30
v_lshrrev_b32 v28,5,v1
v_lshl_add_u32 v30,v28,11,v30
v_and_b32 v28,3,v1
v_lshl_add_u32 v30,v28,3,v30
s_and_b32 s40,s32,1
s_lshl_b32 s40,s40,8
s_add_u32 s40,s40,98304
v_add_u32 v30,s40,v30
v_xor_b32 v28,0,v29
v_lshl_add_u32 v6,v28,5,v30
v_xor_b32 v28,1,v29
v_lshl_add_u32 v7,v28,5,v30
v_xor_b32 v28,2,v29
v_lshl_add_u32 v8,v28,5,v30
v_xor_b32 v28,3,v29
v_lshl_add_u32 v9,v28,5,v30
v_xor_b32 v28,4,v29
v_lshl_add_u32 v10,v28,5,v30
v_xor_b32 v28,5,v29
v_lshl_add_u32 v11,v28,5,v30
v_xor_b32 v28,6,v29
v_lshl_add_u32 v12,v28,5,v30
v_xor_b32 v28,7,v29
v_lshl_add_u32 v13,v28,5,v30
s_add_u32 m0,s49,32768
s_mov_b32 s47,524288
buffer_load_dwordx4 v15,s[16:19],s47 offen lds
s_mov_b32 s47,556032
buffer_load_dwordx4 v15,s[16:19],s47 offen offset:1024 lds
s_mov_b32 s47,653312
buffer_load_dwordx4 v15,s[16:19],s47 offen offset:2048 lds
s_mov_b32 s47,685056
buffer_load_dwordx4 v15,s[16:19],s47 offen offset:3072 lds
s_mov_b32 s8,s4
s_mov_b32 s9,s5
s_mov_b32 s10,0x240000
s_mov_b32 s11,0x20000
s_add_u32 s20,s4,0x400000
s_addc_u32 s21,s5,0
s_mov_b32 s22,0x2000000
s_mov_b32 s23,0x20000
s_and_b32 s40,s32,1
s_lshl_b32 s41,s55,1
s_add_u32 s40,s40,s41
s_lshl_b32 s56,s40,20
s_lshr_b32 s40,s32,1
s_lshl_b32 s40,s40,2
s_lshl_b32 s41,s54,3
s_add_u32 s40,s40,s41
s_lshl_b32 s40,s40,14
s_add_u32 s56,s56,s40
s_lshl_b32 s40,s58,13
s_add_u32 s56,s56,s40
s_lshl_b32 s57,s55,4
s_lshl_b32 s40,s58,3
s_add_u32 s57,s57,s40
s_add_u32 s57,s57,s54
LW 0
s_mul_i32 s3,s3,1664525
s_add_u32 s3,s3,1013904223
s_getreg_b32 s37,hwreg(HW_REG_XCC_ID,0,4)
s_add_u32 s37,s37,s3
s_waitcnt vmcnt(21)
s_barrier
v_add_u32 v3,65536,v5
v_xor_b32 v4,64,v3
RD a[64:67],v3,0
TR a[96:97],v6,0
TR a[98:99],v6,1024
RD a[68:71],v3,2048
TR a[100:101],v7,0
TR a[102:103],v7,1024
RD a[72:75],v3,4096
TR a[104:105],v8,0
TR a[106:107],v8,1024
RD a[76:79],v3,6144
TR a[108:109],v9,0
TR a[110:111],v9,1024
RD a[80:83],v3,8192
TR a[112:113],v10,0
TR a[114:115],v10,1024
RD a[84:87],v3,10240
TR a[116:117],v11,0
TR a[118:119],v11,1024
RD a[88:91],v3,12288
TR a[120:121],v12,0
TR a[122:123],v12,1024
RD a[92:95],v3,14336
TR a[124:125],v13,0
TR a[126:127],v13,1024
Lm_kv:
s_cmp_eq_u32 s58,0
s_cbranch_scc0 Lm_kvV
LW 15
MF v[32:35],a[96:99],a[64:67],0
MF v[36:39],a[100:103],a[64:67],0
MF v[40:43],a[104:107],a[64:67],0
LW 12
MF v[44:47],a[108:111],a[64:67],0
LW 9
MF v[48:51],a[112:115],a[64:67],0
LW 6
MF v[52:55],a[116:119],a[64:67],0
LW 3
MF v[56:59],a[120:123],a[64:67],0
LW 0
MF v[60:63],a[124:127],a[64:67],0
s_waitcnt vmcnt(12)
MF v[64:67],a[96:99],a[68:71],0
s_barrier
MF v[68:71],a[100:103],a[68:71],0
s_add_u32 m0,s49,49152
s_mov_b32 s47,786432
RD a[0:3],v4,0
MF v[72:75],a[104:107],a[68:71],0
buffer_load_dwordx4 v15,s[16:19],s47 offen lds
MF v[76:79],a[108:111],a[68:71],0
TR a[32:33],v6,16384
MF v[80:83],a[112:115],a[68:71],0
s_mov_b32 s47,818176
buffer_load_dwordx4 v15,s[16:19],s47 offen offset:1024 lds
MF v[84:87],a[116:119],a[68:71],0
TR a[34:35],v6,17408
MF v[88:91],a[120:123],a[68:71],0
MF v[92:95],a[124:127],a[68:71],0
s_mov_b32 s47,915456
buffer_load_dwordx4 v15,s[16:19],s47 offen offset:2048 lds
RD a[4:7],v4,2048
MF v[96:99],a[96:99],a[72:75],0
MF v[100:103],a[100:103],a[72:75],0
TR a[36:37],v7,16384
MF v[104:107],a[104:107],a[72:75],0
MF v[108:111],a[108:111],a[72:75],0
s_mov_b32 s47,947200
TR a[38:39],v7,17408
buffer_load_dwordx4 v15,s[16:19],s47 offen offset:3072 lds
MF v[112:115],a[112:115],a[72:75],0
MF v[116:119],a[116:119],a[72:75],0
RD a[8:11],v4,4096
MF v[120:123],a[120:123],a[72:75],0
s_add_u32 m0,s48,32768
s_mov_b32 s46,256
buffer_load_dwordx4 v14,s[12:15],s46 offen lds
MF v[124:127],a[124:127],a[72:75],0
TR a[40:41],v8,16384
MF v[128:131],a[96:99],a[76:79],0
MF v[132:135],a[100:103],a[76:79],0
MF v[136:139],a[104:107],a[76:79],0
s_mov_b32 s46,14592
buffer_load_dwordx4 v14,s[12:15],s46 offen offset:2048 lds
TR a[42:43],v8,17408
MF v[140:143],a[108:111],a[76:79],0
MF v[144:147],a[112:115],a[76:79],0
RD a[12:15],v4,6144
MF v[148:151],a[116:119],a[76:79],0
s_add_u32 m0,s48,36864
s_mov_b32 s46,33024
buffer_load_dwordx4 v14,s[12:15],s46 offen lds
MF v[152:155],a[120:123],a[76:79],0
TR a[44:45],v9,16384
MF v[156:159],a[124:127],a[76:79],0
MF v[160:163],a[96:99],a[80:83],0
TR a[46:47],v9,17408
MF v[164:167],a[100:103],a[80:83],0
s_mov_b32 s46,47360
buffer_load_dwordx4 v14,s[12:15],s46 offen offset:2048 lds
MF v[168:171],a[104:107],a[80:83],0
RD a[16:19],v4,8192
MF v[172:175],a[108:111],a[80:83],0
MF v[176:179],a[112:115],a[80:83],0
s_add_u32 m0,s48,40960
s_mov_b32 s46,65792
buffer_load_dwordx4 v14,s[12:15],s46 offen lds
MF v[180:183],a[116:119],a[80:83],0
TR a[48:49],v10,16384
MF v[184:187],a[120:123],a[80:83],0
TR a[50:51],v10,17408
MF v[188:191],a[124:127],a[80:83],0
s_mov_b32 s46,80128
buffer_load_dwordx4 v14,s[12:15],s46 offen offset:2048 lds
MF v[192:195],a[96:99],a[84:87],0
RD a[20:23],v4,10240
MF v[196:199],a[100:103],a[84:87],0
MF v[200:203],a[104:107],a[84:87],0
MF v[204:207],a[108:111],a[84:87],0
s_add_u32 m0,s48,45056
s_mov_b32 s46,98560
TR a[52:53],v11,16384
MF v[208:211],a[112:115],a[84:87],0
buffer_load_dwordx4 v14,s[12:15],s46 offen lds
MF v[212:215],a[116:119],a[84:87],0
TR a[54:55],v11,17408
MF v[216:219],a[120:123],a[84:87],0
s_mov_b32 s46,112896
buffer_load_dwordx4 v14,s[12:15],s46 offen offset:2048 lds
MF v[220:223],a[124:127],a[84:87],0
RD a[24:27],v4,12288
MF v[224:227],a[96:99],a[88:91],0
MF v[228:231],a[100:103],a[88:91],0
TR a[56:57],v12,16384
MF v[232:235],a[104:107],a[88:91],0
s_add_u32 m0,s49,0
s_mov_b32 s47,1048576
buffer_load_dwordx4 v15,s[16:19],s47 offen lds
MF v[236:239],a[108:111],a[88:91],0
TR a[58:59],v12,17408
MF v[240:243],a[112:115],a[88:91],0
MF v[244:247],a[116:119],a[88:91],0
s_mov_b32 s47,1080320
buffer_load_dwordx4 v15,s[16:19],s47 offen offset:1024 lds
RD a[28:31],v4,14336
MF v[248:251],a[120:123],a[88:91],0
MF v[252:255],a[124:127],a[88:91],0
TR a[60:61],v13,16384
MF a[192:195],a[96:99],a[92:95],0
MF a[196:199],a[100:103],a[92:95],0
s_mov_b32 s47,1177600
TR a[62:63],v13,17408
buffer_load_dwordx4 v15,s[16:19],s47 offen offset:2048 lds
MF a[200:203],a[104:107],a[92:95],0
MF a[204:207],a[108:111],a[92:95],0
MF a[208:211],a[112:115],a[92:95],0
s_mov_b32 s47,1209344
buffer_load_dwordx4 v15,s[16:19],s47 offen offset:3072 lds
MF a[212:215],a[116:119],a[92:95],0
MF a[216:219],a[120:123],a[92:95],0
MF a[220:223],a[124:127],a[92:95],0
LW 15
MF v[32:35],a[32:35],a[0:3],v[32:35]
s_lshr_b32 s41,s2,1
s_mul_i32 s41,s41,18432
MF v[36:39],a[36:39],a[0:3],v[36:39]
v_lshrrev_b32 v18,2,v17
MF v[40:43],a[40:43],a[0:3],v[40:43]
LW 12
v_lshlrev_b32 v18,10,v18
MF v[44:47],a[44:47],a[0:3],v[44:47]
LW 9
v_lshrrev_b32 v19,2,v16
MF v[48:51],a[48:51],a[0:3],v[48:51]
LW 6
v_sub_u32 v19,0,v19
MF v[52:55],a[52:55],a[0:3],v[52:55]
LW 3
v_xor_b32 v19,v19,v17
MF v[56:59],a[56:59],a[0:3],v[56:59]
LW 0
v_and_b32 v19,3,v19
MF v[60:63],a[60:63],a[0:3],v[60:63]
s_waitcnt vmcnt(16)
v_lshlrev_b32 v19,4,v19
v_add3_u32 v18,v18,v19,s41
MF v[64:67],a[32:35],a[4:7],v[64:67]
s_barrier
v_lshl_add_u32 v18,v16,6,v18
MF v[68:71],a[36:39],a[4:7],v[68:71]
s_add_u32 m0,s49,16384
s_mov_b32 s47,1310720
v_add_u32 v3,0,v5
MF v[72:75],a[40:43],a[4:7],v[72:75]
buffer_load_dwordx4 v15,s[16:19],s47 offen lds
v_cndmask_b32 v19,v20,v18,s[44:45]
MF v[76:79],a[44:47],a[4:7],v[76:79]
v_xor_b32 v4,64,v3
AR v22,a128
MF v[80:83],a[48:51],a[4:7],v[80:83]
v_lshlrev_b32 v21,16,v22
v_and_b32 v22,0xffff0000,v22
MF v[84:87],a[52:55],a[4:7],v[84:87]
RD a[64:67],v3,0
v_add_f32 v16,v21,v22
MF v[88:91],a[56:59],a[4:7],v[88:91]
TR a[96:97],v6,32768
AR v22,a129
MF v[92:95],a[60:63],a[4:7],v[92:95]
s_mov_b32 s47,1342464
buffer_load_dwordx4 v15,s[16:19],s47 offen offset:1024 lds
v_lshlrev_b32 v21,16,v22
MF v[96:99],a[32:35],a[8:11],v[96:99]
v_and_b32 v22,0xffff0000,v22
v_add_f32 v16,v16,v21
MF v[100:103],a[36:39],a[8:11],v[100:103]
TR a[98:99],v6,33792
v_add_f32 v16,v16,v22
MF v[104:107],a[40:43],a[8:11],v[104:107]
RD a[68:71],v3,2048
AR v22,a130
MF v[108:111],a[44:47],a[8:11],v[108:111]
v_lshlrev_b32 v21,16,v22
MF v[112:115],a[48:51],a[8:11],v[112:115]
TR a[100:101],v7,32768
v_and_b32 v22,0xffff0000,v22
MF v[116:119],a[52:55],a[8:11],v[116:119]
v_add_f32 v16,v16,v21
MF v[120:123],a[56:59],a[8:11],v[120:123]
s_mov_b32 s47,1439744
TR a[102:103],v7,33792
v_add_f32 v16,v16,v22
MF v[124:127],a[60:63],a[8:11],v[124:127]
buffer_load_dwordx4 v15,s[16:19],s47 offen offset:2048 lds
AR v22,a131
MF v[128:131],a[32:35],a[12:15],v[128:131]
RD a[72:75],v3,4096
v_lshlrev_b32 v21,16,v22
MF v[132:135],a[36:39],a[12:15],v[132:135]
v_and_b32 v22,0xffff0000,v22
v_add_f32 v16,v16,v21
MF v[136:139],a[40:43],a[12:15],v[136:139]
TR a[104:105],v8,32768
v_add_f32 v16,v16,v22
MF v[140:143],a[44:47],a[12:15],v[140:143]
AR v22,a132
MF v[144:147],a[48:51],a[12:15],v[144:147]
TR a[106:107],v8,33792
v_lshlrev_b32 v21,16,v22
MF v[148:151],a[52:55],a[12:15],v[148:151]
s_mov_b32 s47,1471488
buffer_load_dwordx4 v15,s[16:19],s47 offen offset:3072 lds
v_and_b32 v22,0xffff0000,v22
MF v[152:155],a[56:59],a[12:15],v[152:155]
RD a[76:79],v3,6144
v_add_f32 v16,v16,v21
MF v[156:159],a[60:63],a[12:15],v[156:159]
v_add_f32 v16,v16,v22
AR v22,a133
MF v[160:163],a[32:35],a[16:19],v[160:163]
TR a[108:109],v9,32768
v_lshlrev_b32 v21,16,v22
MF v[164:167],a[36:39],a[16:19],v[164:167]
v_and_b32 v22,0xffff0000,v22
MF v[168:171],a[40:43],a[16:19],v[168:171]
TR a[110:111],v9,33792
v_add_f32 v16,v16,v21
MF v[172:175],a[44:47],a[16:19],v[172:175]
v_add_f32 v16,v16,v22
MF v[176:179],a[48:51],a[16:19],v[176:179]
s_add_u32 m0,s48,65536
RD a[80:83],v3,8192
AR v22,a134
MF v[180:183],a[52:55],a[16:19],v[180:183]
s_mov_b32 s46,384
buffer_load_dwordx4 v14,s[12:15],s46 offen lds
v_lshlrev_b32 v21,16,v22
MF v[184:187],a[56:59],a[16:19],v[184:187]
TR a[112:113],v10,32768
v_and_b32 v22,0xffff0000,v22
MF v[188:191],a[60:63],a[16:19],v[188:191]
v_add_f32 v16,v16,v21
v_add_f32 v16,v16,v22
MF v[192:195],a[32:35],a[20:23],v[192:195]
TR a[114:115],v10,33792
AR v22,a135
MF v[196:199],a[36:39],a[20:23],v[196:199]
v_lshlrev_b32 v21,16,v22
MF v[200:203],a[40:43],a[20:23],v[200:203]
RD a[84:87],v3,10240
v_and_b32 v22,0xffff0000,v22
MF v[204:207],a[44:47],a[20:23],v[204:207]
s_mov_b32 s46,14720
buffer_load_dwordx4 v14,s[12:15],s46 offen offset:2048 lds
v_add_f32 v16,v16,v21
MF v[208:211],a[48:51],a[20:23],v[208:211]
TR a[116:117],v11,32768
v_add_f32 v16,v16,v22
MF v[212:215],a[52:55],a[20:23],v[212:215]
AR v22,a136
MF v[216:219],a[56:59],a[20:23],v[216:219]
TR a[118:119],v11,33792
v_lshlrev_b32 v21,16,v22
MF v[220:223],a[60:63],a[20:23],v[220:223]
v_and_b32 v22,0xffff0000,v22
v_add_f32 v16,v16,v21
MF v[224:227],a[32:35],a[24:27],v[224:227]
RD a[88:91],v3,12288
v_add_f32 v16,v16,v22
MF v[228:231],a[36:39],a[24:27],v[228:231]
AR v22,a137
MF v[232:235],a[40:43],a[24:27],v[232:235]
s_add_u32 m0,s48,69632
s_mov_b32 s46,33152
TR a[120:121],v12,32768
MF v[236:239],a[44:47],a[24:27],v[236:239]
buffer_load_dwordx4 v14,s[12:15],s46 offen lds
v_lshlrev_b32 v21,16,v22
MF v[240:243],a[48:51],a[24:27],v[240:243]
TR a[122:123],v12,33792
v_and_b32 v22,0xffff0000,v22
MF v[244:247],a[52:55],a[24:27],v[244:247]
v_add_f32 v16,v16,v21
v_add_f32 v16,v16,v22
MF v[248:251],a[56:59],a[24:27],v[248:251]
RD a[92:95],v3,14336
AR v22,a138
MF v[252:255],a[60:63],a[24:27],v[252:255]
v_lshlrev_b32 v21,16,v22
v_and_b32 v22,0xffff0000,v22
MF a[192:195],a[32:35],a[28:31],a[192:195]
TR a[124:125],v13,32768
v_add_f32 v16,v16,v21
MF a[196:199],a[36:39],a[28:31],a[196:199]
s_mov_b32 s46,47488
buffer_load_dwordx4 v14,s[12:15],s46 offen offset:2048 lds
v_add_f32 v16,v16,v22
MF a[200:203],a[40:43],a[28:31],a[200:203]
TR a[126:127],v13,33792
AR v22,a139
MF a[204:207],a[44:47],a[28:31],a[204:207]
v_lshlrev_b32 v21,16,v22
MF a[208:211],a[48:51],a[28:31],a[208:211]
v_and_b32 v22,0xffff0000,v22
MF a[212:215],a[52:55],a[28:31],a[212:215]
v_add_f32 v16,v16,v21
MF a[216:219],a[56:59],a[28:31],a[216:219]
MF a[220:223],a[60:63],a[28:31],a[220:223]
LW 15
MF v[32:35],a[96:99],a[64:67],v[32:35]
v_add_f32 v16,v16,v22
MF v[36:39],a[100:103],a[64:67],v[36:39]
s_nop 1
MF v[40:43],a[104:107],a[64:67],v[40:43]
LW 12
v_add_f32_dpp v16,v16,v16 row_ror:8 row_mask:0xf bank_mask:0xf
MF v[44:47],a[108:111],a[64:67],v[44:47]
LW 9
s_nop 1
MF v[48:51],a[112:115],a[64:67],v[48:51]
LW 6
v_add_f32_dpp v16,v16,v16 row_ror:4 row_mask:0xf bank_mask:0xf
MF v[52:55],a[116:119],a[64:67],v[52:55]
LW 3
s_nop 1
MF v[56:59],a[120:123],a[64:67],v[56:59]
LW 0
v_add_f32_dpp v16,v16,v16 row_ror:2 row_mask:0xf bank_mask:0xf
MF v[60:63],a[124:127],a[64:67],v[60:63]
s_waitcnt vmcnt(20)
s_nop 1
MF v[64:67],a[96:99],a[68:71],v[64:67]
s_barrier
v_add_f32_dpp v16,v16,v16 row_ror:1 row_mask:0xf bank_mask:0xf
v_mov_b32 v17,v16
MF v[68:71],a[100:103],a[68:71],v[68:71]
s_nop 1
RD a[0:3],v4,0
MF v[72:75],a[104:107],a[68:71],v[72:75]
s_add_u32 m0,s49,32768
s_mov_b32 s47,1572864
buffer_load_dwordx4 v15,s[16:19],s47 offen lds
MF v[76:79],a[108:111],a[68:71],v[76:79]
TR a[32:33],v6,49152
v_permlane16_swap_b32 v16,v17
MF v[80:83],a[112:115],a[68:71],v[80:83]
s_nop 1
v_add_f32 v16,v16,v17
MF v[84:87],a[116:119],a[68:71],v[84:87]
TR a[34:35],v6,50176
v_mul_f32 v16,0x3ae38e39,v16
MF v[88:91],a[120:123],a[68:71],v[88:91]
v_mov_b32 v17,0
v_mov_b32 v20,0
MF v[92:95],a[124:127],a[68:71],v[92:95]
s_mov_b32 s47,1604608
buffer_load_dwordx4 v15,s[16:19],s47 offen offset:1024 lds
AR v22,a128
MF v[96:99],a[96:99],a[72:75],v[96:99]
RD a[4:7],v4,2048
v_lshlrev_b32 v21,16,v22
MF v[100:103],a[100:103],a[72:75],v[100:103]
TR a[36:37],v7,49152
v_and_b32 v22,0xffff0000,v22
MF v[104:107],a[104:107],a[72:75],v[104:107]
v_sub_f32 v21,v21,v16
v_sub_f32 v22,v22,v16
MF v[108:111],a[108:111],a[72:75],v[108:111]
TR a[38:39],v7,50176
v_fmac_f32 v17,v21,v21
MF v[112:115],a[112:115],a[72:75],v[112:115]
v_fmac_f32 v17,v22,v22
MF v[116:119],a[116:119],a[72:75],v[116:119]
s_mov_b32 s47,1701888
buffer_load_dwordx4 v15,s[16:19],s47 offen offset:2048 lds
AR v22,a129
MF v[120:123],a[120:123],a[72:75],v[120:123]
RD a[8:11],v4,4096
v_lshlrev_b32 v21,16,v22
MF v[124:127],a[124:127],a[72:75],v[124:127]
TR a[40:41],v8,49152
v_and_b32 v22,0xffff0000,v22
MF v[128:131],a[96:99],a[76:79],v[128:131]
v_sub_f32 v21,v21,v16
v_sub_f32 v22,v22,v16
MF v[132:135],a[100:103],a[76:79],v[132:135]
v_fmac_f32 v17,v21,v21
MF v[136:139],a[104:107],a[76:79],v[136:139]
TR a[42:43],v8,50176
v_fmac_f32 v17,v22,v22
MF v[140:143],a[108:111],a[76:79],v[140:143]
s_mov_b32 s47,1733632
buffer_load_dwordx4 v15,s[16:19],s47 offen offset:3072 lds
AR v22,a130
MF v[144:147],a[112:115],a[76:79],v[144:147]
RD a[12:15],v4,6144
v_lshlrev_b32 v21,16,v22
MF v[148:151],a[116:119],a[76:79],v[148:151]
v_and_b32 v22,0xffff0000,v22
MF v[152:155],a[120:123],a[76:79],v[152:155]
TR a[44:45],v9,49152
v_sub_f32 v21,v21,v16
MF v[156:159],a[124:127],a[76:79],v[156:159]
v_sub_f32 v22,v22,v16
v_fmac_f32 v17,v21,v21
MF v[160:163],a[96:99],a[80:83],v[160:163]
TR a[46:47],v9,50176
v_fmac_f32 v17,v22,v22
MF v[164:167],a[100:103],a[80:83],v[164:167]
s_add_u32 m0,s48,73728
s_mov_b32 s46,65920
buffer_load_dwordx4 v14,s[12:15],s46 offen lds
MF v[168:171],a[104:107],a[80:83],v[168:171]
RD a[16:19],v4,8192
AR v22,a131
MF v[172:175],a[108:111],a[80:83],v[172:175]
v_lshlrev_b32 v21,16,v22
v_and_b32 v22,0xffff0000,v22
MF v[176:179],a[112:115],a[80:83],v[176:179]
TR a[48:49],v10,49152
v_sub_f32 v21,v21,v16
MF v[180:183],a[116:119],a[80:83],v[180:183]
v_sub_f32 v22,v22,v16
MF v[184:187],a[120:123],a[80:83],v[184:187]
TR a[50:51],v10,50176
v_fmac_f32 v17,v21,v21
MF v[188:191],a[124:127],a[80:83],v[188:191]
s_mov_b32 s46,80256
buffer_load_dwordx4 v14,s[12:15],s46 offen offset:2048 lds
v_fmac_f32 v17,v22,v22
MF v[192:195],a[96:99],a[84:87],v[192:195]
AR v22,a132
v_lshlrev_b32 v21,16,v22
MF v[196:199],a[100:103],a[84:87],v[196:199]
RD a[20:23],v4,10240
v_and_b32 v22,0xffff0000,v22
MF v[200:203],a[104:107],a[84:87],v[200:203]
v_sub_f32 v21,v21,v16
MF v[204:207],a[108:111],a[84:87],v[204:207]
TR a[52:53],v11,49152
v_sub_f32 v22,v22,v16
MF v[208:211],a[112:115],a[84:87],v[208:211]
v_fmac_f32 v17,v21,v21
MF v[212:215],a[116:119],a[84:87],v[212:215]
s_add_u32 m0,s48,77824
TR a[54:55],v11,50176
v_fmac_f32 v17,v22,v22
MF v[216:219],a[120:123],a[84:87],v[216:219]
s_mov_b32 s46,98688
buffer_load_dwordx4 v14,s[12:15],s46 offen lds
AR v22,a133
MF v[220:223],a[124:127],a[84:87],v[220:223]
RD a[24:27],v4,12288
v_lshlrev_b32 v21,16,v22
MF v[224:227],a[96:99],a[88:91],v[224:227]
v_and_b32 v22,0xffff0000,v22
v_sub_f32 v21,v21,v16
MF v[228:231],a[100:103],a[88:91],v[228:231]
TR a[56:57],v12,49152
v_sub_f32 v22,v22,v16
MF v[232:235],a[104:107],a[88:91],v[232:235]
v_fmac_f32 v17,v21,v21
MF v[236:239],a[108:111],a[88:91],v[236:239]
s_mov_b32 s46,113024
TR a[58:59],v12,50176
v_fmac_f32 v17,v22,v22
MF v[240:243],a[112:115],a[88:91],v[240:243]
buffer_load_dwordx4 v14,s[12:15],s46 offen offset:2048 lds
AR v22,a134
MF v[244:247],a[116:119],a[88:91],v[244:247]
RD a[28:31],v4,14336
v_lshlrev_b32 v21,16,v22
MF v[248:251],a[120:123],a[88:91],v[248:251]
v_and_b32 v22,0xffff0000,v22
v_sub_f32 v21,v21,v16
MF v[252:255],a[124:127],a[88:91],v[252:255]
TR a[60:61],v13,49152
v_sub_f32 v22,v22,v16
MF a[192:195],a[96:99],a[92:95],a[192:195]
v_fmac_f32 v17,v21,v21
MF a[196:199],a[100:103],a[92:95],a[196:199]
s_lshl_b32 s7,s2,2
TR a[62:63],v13,50176
v_fmac_f32 v17,v22,v22
MF a[200:203],a[104:107],a[92:95],a[200:203]
s_add_u32 s7,s7,s32
s_mul_i32 s7,s7,1728
s_add_u32 s7,s7,0
MF a[204:207],a[108:111],a[92:95],a[204:207]
v_lshlrev_b32 v0,7,v1
v_min_u32 v0,1724,v0
MF a[208:211],a[112:115],a[92:95],a[208:211]
AR v22,a135
v_add_u32 v0,s7,v0
MF a[212:215],a[116:119],a[92:95],a[212:215]
global_load_dword a180,v0,s[78:79]
v_lshlrev_b32 v21,16,v22
MF a[216:219],a[120:123],a[92:95],a[216:219]
v_and_b32 v22,0xffff0000,v22
v_sub_f32 v21,v21,v16
MF a[220:223],a[124:127],a[92:95],a[220:223]
LW 15
MF v[32:35],a[32:35],a[0:3],v[32:35]
v_sub_f32 v22,v22,v16
v_fmac_f32 v17,v21,v21
MF v[36:39],a[36:39],a[0:3],v[36:39]
v_fmac_f32 v17,v22,v22
MF v[40:43],a[40:43],a[0:3],v[40:43]
LW 12
AR v22,a136
MF v[44:47],a[44:47],a[0:3],v[44:47]
LW 9
v_lshlrev_b32 v21,16,v22
MF v[48:51],a[48:51],a[0:3],v[48:51]
LW 6
v_and_b32 v22,0xffff0000,v22
MF v[52:55],a[52:55],a[0:3],v[52:55]
LW 3
v_sub_f32 v21,v21,v16
MF v[56:59],a[56:59],a[0:3],v[56:59]
LW 0
v_sub_f32 v22,v22,v16
MF v[60:63],a[60:63],a[0:3],v[60:63]
s_waitcnt vmcnt(17)
v_fmac_f32 v20,v21,v21
v_fmac_f32 v20,v22,v22
MF v[64:67],a[32:35],a[4:7],v[64:67]
s_barrier
AR v22,a137
MF v[68:71],a[36:39],a[4:7],v[68:71]
s_add_u32 m0,s49,49152
s_mov_b32 s47,1835008
v_add_u32 v3,32768,v5
MF v[72:75],a[40:43],a[4:7],v[72:75]
buffer_load_dwordx4 v15,s[16:19],s47 offen lds
v_lshlrev_b32 v21,16,v22
MF v[76:79],a[44:47],a[4:7],v[76:79]
v_xor_b32 v4,64,v3
v_and_b32 v22,0xffff0000,v22
MF v[80:83],a[48:51],a[4:7],v[80:83]
v_sub_f32 v21,v21,v16
v_sub_f32 v22,v22,v16
MF v[84:87],a[52:55],a[4:7],v[84:87]
RD a[64:67],v3,0
v_fmac_f32 v20,v21,v21
MF v[88:91],a[56:59],a[4:7],v[88:91]
TR a[96:97],v6,0
v_fmac_f32 v20,v22,v22
MF v[92:95],a[60:63],a[4:7],v[92:95]
s_mov_b32 s47,1866752
buffer_load_dwordx4 v15,s[16:19],s47 offen offset:1024 lds
AR v22,a138
MF v[96:99],a[32:35],a[8:11],v[96:99]
v_lshlrev_b32 v21,16,v22
v_and_b32 v22,0xffff0000,v22
MF v[100:103],a[36:39],a[8:11],v[100:103]
TR a[98:99],v6,1024
v_sub_f32 v21,v21,v16
MF v[104:107],a[40:43],a[8:11],v[104:107]
RD a[68:71],v3,2048
v_sub_f32 v22,v22,v16
MF v[108:111],a[44:47],a[8:11],v[108:111]
v_fmac_f32 v20,v21,v21
MF v[112:115],a[48:51],a[8:11],v[112:115]
TR a[100:101],v7,0
v_fmac_f32 v20,v22,v22
MF v[116:119],a[52:55],a[8:11],v[116:119]
s_mov_b32 s47,1964032
buffer_load_dwordx4 v15,s[16:19],s47 offen offset:2048 lds
AR v22,a139
MF v[120:123],a[56:59],a[8:11],v[120:123]
TR a[102:103],v7,1024
v_lshlrev_b32 v21,16,v22
MF v[124:127],a[60:63],a[8:11],v[124:127]
v_and_b32 v22,0xffff0000,v22
v_sub_f32 v21,v21,v16
MF v[128:131],a[32:35],a[12:15],v[128:131]
RD a[72:75],v3,4096
v_sub_f32 v22,v22,v16
MF v[132:135],a[36:39],a[12:15],v[132:135]
v_fmac_f32 v20,v21,v21
MF v[136:139],a[40:43],a[12:15],v[136:139]
TR a[104:105],v8,0
v_fmac_f32 v20,v22,v22
MF v[140:143],a[44:47],a[12:15],v[140:143]
s_mov_b32 s47,1995776
buffer_load_dwordx4 v15,s[16:19],s47 offen offset:3072 lds
v_cndmask_b32 v20,0,v20,s[44:45]
MF v[144:147],a[48:51],a[12:15],v[144:147]
TR a[106:107],v8,1024
v_add_f32 v17,v17,v20
MF v[148:151],a[52:55],a[12:15],v[148:151]
s_nop 1
MF v[152:155],a[56:59],a[12:15],v[152:155]
RD a[76:79],v3,6144
v_add_f32_dpp v17,v17,v17 row_ror:8 row_mask:0xf bank_mask:0xf
MF v[156:159],a[60:63],a[12:15],v[156:159]
s_nop 1
v_add_f32_dpp v17,v17,v17 row_ror:4 row_mask:0xf bank_mask:0xf
MF v[160:163],a[32:35],a[16:19],v[160:163]
s_nop 1
TR a[108:109],v9,0
MF v[164:167],a[36:39],a[16:19],v[164:167]
s_add_u32 m0,s48,0
s_mov_b32 s46,512
buffer_load_dwordx4 v14,s[12:15],s46 offen lds
MF v[168:171],a[40:43],a[16:19],v[168:171]
TR a[110:111],v9,1024
v_add_f32_dpp v17,v17,v17 row_ror:2 row_mask:0xf bank_mask:0xf
MF v[172:175],a[44:47],a[16:19],v[172:175]
s_nop 1
v_add_f32_dpp v17,v17,v17 row_ror:1 row_mask:0xf bank_mask:0xf
MF v[176:179],a[48:51],a[16:19],v[176:179]
RD a[80:83],v3,8192
v_mov_b32 v20,v17
MF v[180:183],a[52:55],a[16:19],v[180:183]
s_nop 1
MF v[184:187],a[56:59],a[16:19],v[184:187]
TR a[112:113],v10,0
v_permlane16_swap_b32 v17,v20
MF v[188:191],a[60:63],a[16:19],v[188:191]
s_mov_b32 s46,14848
s_nop 1
MF v[192:195],a[32:35],a[20:23],v[192:195]
buffer_load_dwordx4 v14,s[12:15],s46 offen offset:2048 lds
v_add_f32 v17,v17,v20
MF v[196:199],a[36:39],a[20:23],v[196:199]
TR a[114:115],v10,1024
v_mul_f32 v17,0x3ae38e39,v17
MF v[200:203],a[40:43],a[20:23],v[200:203]
RD a[84:87],v3,10240
CV v17,v16,v17
MF v[204:207],a[44:47],a[20:23],v[204:207]
v_lshlrev_b32 v16,16,v17
v_and_b32 v17,0xffff0000,v17
MF v[208:211],a[48:51],a[20:23],v[208:211]
TR a[116:117],v11,0
v_add_f32 v17,0x3727c5ac,v17
MF v[212:215],a[52:55],a[20:23],v[212:215]
s_add_u32 m0,s48,4096
s_mov_b32 s46,33280
CV v17,v17,v17
MF v[216:219],a[56:59],a[20:23],v[216:219]
buffer_load_dwordx4 v14,s[12:15],s46 offen lds
v_and_b32 v17,0xffff0000,v17
MF v[220:223],a[60:63],a[20:23],v[220:223]
TR a[118:119],v11,1024
MF v[224:227],a[32:35],a[24:27],v[224:227]
v_sqrt_f32 v17,v17
MF v[228:231],a[36:39],a[24:27],v[228:231]
s_nop 0
RD a[88:91],v3,12288
CV v17,v17,v17
MF v[232:235],a[40:43],a[24:27],v[232:235]
TR a[120:121],v12,0
v_and_b32 v17,0xffff0000,v17
MF v[236:239],a[44:47],a[24:27],v[236:239]
s_mov_b32 s46,47616
v_rcp_f32 v17,v17
MF v[240:243],a[48:51],a[24:27],v[240:243]
s_nop 0
TR a[122:123],v12,1024
buffer_load_dwordx4 v14,s[12:15],s46 offen offset:2048 lds
MF v[244:247],a[52:55],a[24:27],v[244:247]
v_mul_f32 v16,v16,v17
AR v22,a128
MF v[248:251],a[56:59],a[24:27],v[248:251]
RD a[92:95],v3,14336
v_lshlrev_b32 v21,16,v22
MF v[252:255],a[60:63],a[24:27],v[252:255]
v_and_b32 v22,0xffff0000,v22
v_fma_f32 v21,v21,v17,-v16
MF a[192:195],a[32:35],a[28:31],a[192:195]
TR a[124:125],v13,0
v_fma_f32 v22,v22,v17,-v16
MF a[196:199],a[36:39],a[28:31],a[196:199]
s_lshl_b32 s7,s2,2
s_add_u32 s7,s7,s32
CV v24,v21,v22
MF a[200:203],a[40:43],a[28:31],a[200:203]
s_mul_i32 s7,s7,1728
s_add_u32 s7,s7,1769472
v_lshlrev_b32 v0,7,v1
MF a[204:207],a[44:47],a[28:31],a[204:207]
v_min_u32 v0,1724,v0
v_add_u32 v0,s7,v0
MF a[208:211],a[48:51],a[28:31],a[208:211]
TR a[126:127],v13,1024
global_load_dword a181,v0,s[78:79]
MF a[212:215],a[52:55],a[28:31],a[212:215]
AR v22,a129
v_lshlrev_b32 v21,16,v22
MF a[216:219],a[56:59],a[28:31],a[216:219]
v_and_b32 v22,0xffff0000,v22
v_fma_f32 v21,v21,v17,-v16
MF a[220:223],a[60:63],a[28:31],a[220:223]
LW 15
MF v[32:35],a[96:99],a[64:67],v[32:35]
v_fma_f32 v22,v22,v17,-v16
CV v25,v21,v22
MF v[36:39],a[100:103],a[64:67],v[36:39]
AR v22,a130
MF v[40:43],a[104:107],a[64:67],v[40:43]
LW 12
v_lshlrev_b32 v21,16,v22
MF v[44:47],a[108:111],a[64:67],v[44:47]
LW 9
v_and_b32 v22,0xffff0000,v22
MF v[48:51],a[112:115],a[64:67],v[48:51]
LW 6
v_fma_f32 v21,v21,v17,-v16
MF v[52:55],a[116:119],a[64:67],v[52:55]
LW 3
v_fma_f32 v22,v22,v17,-v16
MF v[56:59],a[120:123],a[64:67],v[56:59]
LW 0
CV v26,v21,v22
AR v22,a131
MF v[60:63],a[124:127],a[64:67],v[60:63]
s_waitcnt vmcnt(22)
v_lshlrev_b32 v21,16,v22
MF v[64:67],a[96:99],a[68:71],v[64:67]
s_barrier
v_and_b32 v22,0xffff0000,v22
MF v[68:71],a[100:103],a[68:71],v[68:71]
s_add_u32 m0,s49,0
s_mov_b32 s47,2097152
RD a[0:3],v4,0
MF v[72:75],a[104:107],a[68:71],v[72:75]
buffer_load_dwordx4 v15,s[16:19],s47 offen lds
v_fma_f32 v21,v21,v17,-v16
MF v[76:79],a[108:111],a[68:71],v[76:79]
TR a[32:33],v6,16384
v_fma_f32 v22,v22,v17,-v16
MF v[80:83],a[112:115],a[68:71],v[80:83]
CV v27,v21,v22
s_movk_i32 s42,0
MF v[84:87],a[116:119],a[68:71],v[84:87]
TR a[34:35],v6,17408
buffer_store_dwordx4 v[24:27],v18,s[8:11],s42 offen sc1
MF v[88:91],a[120:123],a[68:71],v[88:91]
s_nop 1
AR v22,a132
MF v[92:95],a[124:127],a[68:71],v[92:95]
s_mov_b32 s47,2128896
RD a[4:7],v4,2048
buffer_load_dwordx4 v15,s[16:19],s47 offen offset:1024 lds
MF v[96:99],a[96:99],a[72:75],v[96:99]
v_lshlrev_b32 v21,16,v22
v_and_b32 v22,0xffff0000,v22
MF v[100:103],a[100:103],a[72:75],v[100:103]
TR a[36:37],v7,16384
v_fma_f32 v21,v21,v17,-v16
MF v[104:107],a[104:107],a[72:75],v[104:107]
v_fma_f32 v22,v22,v17,-v16
MF v[108:111],a[108:111],a[72:75],v[108:111]
TR a[38:39],v7,17408
CV v24,v21,v22
MF v[112:115],a[112:115],a[72:75],v[112:115]
AR v22,a133
v_lshlrev_b32 v21,16,v22
MF v[116:119],a[116:119],a[72:75],v[116:119]
s_mov_b32 s47,2226176
RD a[8:11],v4,4096
buffer_load_dwordx4 v15,s[16:19],s47 offen offset:2048 lds
MF v[120:123],a[120:123],a[72:75],v[120:123]
v_and_b32 v22,0xffff0000,v22
v_fma_f32 v21,v21,v17,-v16
MF v[124:127],a[124:127],a[72:75],v[124:127]
TR a[40:41],v8,16384
v_fma_f32 v22,v22,v17,-v16
MF v[128:131],a[96:99],a[76:79],v[128:131]
CV v25,v21,v22
MF v[132:135],a[100:103],a[76:79],v[132:135]
AR v22,a134
MF v[136:139],a[104:107],a[76:79],v[136:139]
TR a[42:43],v8,17408
v_lshlrev_b32 v21,16,v22
MF v[140:143],a[108:111],a[76:79],v[140:143]
s_mov_b32 s47,2257920
buffer_load_dwordx4 v15,s[16:19],s47 offen offset:3072 lds
v_and_b32 v22,0xffff0000,v22
MF v[144:147],a[112:115],a[76:79],v[144:147]
RD a[12:15],v4,6144
v_fma_f32 v21,v21,v17,-v16
MF v[148:151],a[116:119],a[76:79],v[148:151]
v_fma_f32 v22,v22,v17,-v16
CV v26,v21,v22
MF v[152:155],a[120:123],a[76:79],v[152:155]
TR a[44:45],v9,16384
AR v22,a135
MF v[156:159],a[124:127],a[76:79],v[156:159]
v_lshlrev_b32 v21,16,v22
MF v[160:163],a[96:99],a[80:83],v[160:163]
TR a[46:47],v9,17408
v_and_b32 v22,0xffff0000,v22
MF v[164:167],a[100:103],a[80:83],v[164:167]
s_add_u32 m0,s48,8192
s_mov_b32 s46,66048
v_fma_f32 v21,v21,v17,-v16
MF v[168:171],a[104:107],a[80:83],v[168:171]
buffer_load_dwordx4 v14,s[12:15],s46 offen lds
v_fma_f32 v22,v22,v17,-v16
MF v[172:175],a[108:111],a[80:83],v[172:175]
RD a[16:19],v4,8192
CV v27,v21,v22
MF v[176:179],a[112:115],a[80:83],v[176:179]
s_movk_i32 s42,8192
buffer_store_dwordx4 v[24:27],v18,s[8:11],s42 offen sc1
TR a[48:49],v10,16384
MF v[180:183],a[116:119],a[80:83],v[180:183]
s_nop 1
MF v[184:187],a[120:123],a[80:83],v[184:187]
TR a[50:51],v10,17408
AR v22,a136
MF v[188:191],a[124:127],a[80:83],v[188:191]
s_mov_b32 s46,80384
buffer_load_dwordx4 v14,s[12:15],s46 offen offset:2048 lds
v_lshlrev_b32 v21,16,v22
MF v[192:195],a[96:99],a[84:87],v[192:195]
RD a[20:23],v4,10240
v_and_b32 v22,0xffff0000,v22
MF v[196:199],a[100:103],a[84:87],v[196:199]
v_fma_f32 v21,v21,v17,-v16
v_fma_f32 v22,v22,v17,-v16
MF v[200:203],a[104:107],a[84:87],v[200:203]
CV v24,v21,v22
MF v[204:207],a[108:111],a[84:87],v[204:207]
TR a[52:53],v11,16384
AR v22,a137
MF v[208:211],a[112:115],a[84:87],v[208:211]
v_lshlrev_b32 v21,16,v22
MF v[212:215],a[116:119],a[84:87],v[212:215]
s_add_u32 m0,s48,12288
TR a[54:55],v11,17408
v_and_b32 v22,0xffff0000,v22
MF v[216:219],a[120:123],a[84:87],v[216:219]
s_mov_b32 s46,98816
buffer_load_dwordx4 v14,s[12:15],s46 offen lds
v_fma_f32 v21,v21,v17,-v16
MF v[220:223],a[124:127],a[84:87],v[220:223]
RD a[24:27],v4,12288
v_fma_f32 v22,v22,v17,-v16
MF v[224:227],a[96:99],a[88:91],v[224:227]
CV v25,v21,v22
AR v22,a138
MF v[228:231],a[100:103],a[88:91],v[228:231]
TR a[56:57],v12,16384
v_lshlrev_b32 v21,16,v22
MF v[232:235],a[104:107],a[88:91],v[232:235]
v_and_b32 v22,0xffff0000,v22
MF v[236:239],a[108:111],a[88:91],v[236:239]
s_mov_b32 s46,113152
TR a[58:59],v12,17408
v_fma_f32 v21,v21,v17,-v16
MF v[240:243],a[112:115],a[88:91],v[240:243]
buffer_load_dwordx4 v14,s[12:15],s46 offen offset:2048 lds
v_fma_f32 v22,v22,v17,-v16
MF v[244:247],a[116:119],a[88:91],v[244:247]
RD a[28:31],v4,14336
CV v26,v21,v22
MF v[248:251],a[120:123],a[88:91],v[248:251]
AR v22,a139
MF v[252:255],a[124:127],a[88:91],v[252:255]
TR a[60:61],v13,16384
v_lshlrev_b32 v21,16,v22
MF a[192:195],a[96:99],a[92:95],a[192:195]
v_and_b32 v22,0xffff0000,v22
v_fma_f32 v21,v21,v17,-v16
MF a[196:199],a[100:103],a[92:95],a[196:199]
s_lshl_b32 s7,s2,2
TR a[62:63],v13,17408
v_fma_f32 v22,v22,v17,-v16
MF a[200:203],a[104:107],a[92:95],a[200:203]
s_add_u32 s7,s7,s32
s_mul_i32 s7,s7,1728
s_add_u32 s7,s7,3538944
MF a[204:207],a[108:111],a[92:95],a[204:207]
v_lshlrev_b32 v0,7,v1
v_min_u32 v0,1724,v0
MF a[208:211],a[112:115],a[92:95],a[208:211]
CV v27,v21,v22
v_add_u32 v0,s7,v0
MF a[212:215],a[116:119],a[92:95],a[212:215]
s_movk_i32 s42,16384
buffer_store_dwordx4 v[24:27],v19,s[8:11],s42 offen sc1
global_load_dword a182,v0,s[78:79]
MF a[216:219],a[120:123],a[92:95],a[216:219]
s_nop 1
MF a[220:223],a[124:127],a[92:95],a[220:223]
LW 15
MF v[32:35],a[32:35],a[0:3],v[32:35]
v_bfe_u32 v27,v1,2,2
MF v[36:39],a[36:39],a[0:3],v[36:39]
v_sub_u32 v27,0,v27
MF v[40:43],a[40:43],a[0:3],v[40:43]
LW 12
v_lshrrev_b32 v29,4,v1
MF v[44:47],a[44:47],a[0:3],v[44:47]
LW 9
v_xor_b32 v27,v27,v29
MF v[48:51],a[48:51],a[0:3],v[48:51]
LW 6
MF v[52:55],a[52:55],a[0:3],v[52:55]
LW 3
v_and_b32 v27,3,v27
MF v[56:59],a[56:59],a[0:3],v[56:59]
LW 0
v_lshlrev_b32 v27,4,v27
MF v[60:63],a[60:63],a[0:3],v[60:63]
s_waitcnt vmcnt(22)
v_and_b32 v29,15,v1
MF v[64:67],a[32:35],a[4:7],v[64:67]
s_barrier
MF v[68:71],a[36:39],a[4:7],v[68:71]
s_add_u32 m0,s49,16384
s_mov_b32 s47,2359296
v_add_u32 v3,65536,v5
MF v[72:75],a[40:43],a[4:7],v[72:75]
buffer_load_dwordx4 v15,s[16:19],s47 offen lds
v_lshl_add_u32 v27,v29,6,v27
MF v[76:79],a[44:47],a[4:7],v[76:79]
s_and_b32 s50,s32,1
s_lshl_b32 s50,s50,13
v_xor_b32 v4,64,v3
MF v[80:83],a[48:51],a[4:7],v[80:83]
RD a[64:67],v3,0
MF v[84:87],a[52:55],a[4:7],v[84:87]
v_add_u32 v27,s50,v27
MF v[88:91],a[56:59],a[4:7],v[88:91]
TR a[96:97],v6,32768
v_lshrrev_b32 v29,4,v1
MF v[92:95],a[60:63],a[4:7],v[92:95]
s_mov_b32 s47,2391040
buffer_load_dwordx4 v15,s[16:19],s47 offen offset:1024 lds
v_bfe_u32 v30,v1,2,2
MF v[96:99],a[32:35],a[8:11],v[96:99]
TR a[98:99],v6,33792
MF v[100:103],a[36:39],a[8:11],v[100:103]
v_and_b32 v31,1,v29
MF v[104:107],a[40:43],a[8:11],v[104:107]
RD a[68:71],v3,2048
v_lshl_add_u32 v30,v31,2,v30
MF v[108:111],a[44:47],a[8:11],v[108:111]
v_lshrrev_b32 v29,1,v29
MF v[112:115],a[48:51],a[8:11],v[112:115]
TR a[100:101],v7,32768
MF v[116:119],a[52:55],a[8:11],v[116:119]
v_lshl_add_u32 v30,v29,4,v30
MF v[120:123],a[56:59],a[8:11],v[120:123]
s_mov_b32 s47,2488320
TR a[102:103],v7,33792
v_mul_u32_u24 v30,288,v30
MF v[124:127],a[60:63],a[8:11],v[124:127]
buffer_load_dwordx4 v15,s[16:19],s47 offen offset:2048 lds
v_and_b32 v29,3,v1
MF v[128:131],a[32:35],a[12:15],v[128:131]
RD a[72:75],v3,4096
MF v[132:135],a[36:39],a[12:15],v[132:135]
v_lshl_add_u32 v30,v29,3,v30
MF v[136:139],a[40:43],a[12:15],v[136:139]
TR a[104:105],v8,32768
v_add_u32 v28,16384,v30
MF v[140:143],a[44:47],a[12:15],v[140:143]
s_lshl_b32 s50,s33,3
MF v[144:147],a[48:51],a[12:15],v[144:147]
TR a[106:107],v8,33792
MF v[148:151],a[52:55],a[12:15],v[148:151]
s_mov_b32 s47,2520064
buffer_load_dwordx4 v15,s[16:19],s47 offen offset:3072 lds
s_lshl_b32 s51,s32,1
MF v[152:155],a[56:59],a[12:15],v[152:155]
s_add_u32 s50,s50,s51
RD a[76:79],v3,6144
MF v[156:159],a[60:63],a[12:15],v[156:159]
s_mul_i32 s50,s50,18432
MF v[160:163],a[32:35],a[16:19],v[160:163]
TR a[108:109],v9,32768
v_add_u32 v25,s50,v2
MF v[164:167],a[36:39],a[16:19],v[164:167]
MF v[168:171],a[40:43],a[16:19],v[168:171]
TR a[110:111],v9,33792
v_add_u32 v26,16384,v25
MF v[172:175],a[44:47],a[16:19],v[172:175]
s_movk_i32 s52,3641
MF v[176:179],a[48:51],a[16:19],v[176:179]
s_add_u32 m0,s48,32768
s_mov_b32 s46,640
RD a[80:83],v3,8192
MF v[180:183],a[52:55],a[16:19],v[180:183]
s_mov_b32 s53,9216
buffer_load_dwordx4 v14,s[12:15],s46 offen lds
MF v[184:187],a[56:59],a[16:19],v[184:187]
TR a[112:113],v10,32768
v_add_u32 v29,0,v1
MF v[188:191],a[60:63],a[16:19],v[188:191]
v_mul_u32_u24 v30,s52,v29
MF v[192:195],a[32:35],a[20:23],v[192:195]
TR a[114:115],v10,33792
v_lshrrev_b32 v30,16,v30
MF v[196:199],a[36:39],a[20:23],v[196:199]
MF v[200:203],a[40:43],a[20:23],v[200:203]
RD a[84:87],v3,10240
v_mul_u32_u24 v31,18,v30
MF v[204:207],a[44:47],a[20:23],v[204:207]
s_mov_b32 s46,14976
buffer_load_dwordx4 v14,s[12:15],s46 offen offset:2048 lds
v_sub_u32 v29,v29,v31
MF v[208:211],a[48:51],a[20:23],v[208:211]
TR a[116:117],v11,32768
v_lshrrev_b32 v31,1,v30
MF v[212:215],a[52:55],a[20:23],v[212:215]
MF v[216:219],a[56:59],a[20:23],v[216:219]
TR a[118:119],v11,33792
v_xor_b32 v31,v31,v30
MF v[220:223],a[60:63],a[20:23],v[220:223]
v_and_b32 v31,4,v31
MF v[224:227],a[32:35],a[24:27],v[224:227]
RD a[88:91],v3,12288
v_mul_u32_u24 v31,3,v31
MF v[228:231],a[36:39],a[24:27],v[228:231]
MF v[232:235],a[40:43],a[24:27],v[232:235]
s_add_u32 m0,s48,36864
TR a[120:121],v12,32768
v_xor_b32 v30,v30,v31
MF v[236:239],a[44:47],a[24:27],v[236:239]
s_mov_b32 s46,33408
buffer_load_dwordx4 v14,s[12:15],s46 offen lds
v_mul_u32_u24 v30,s53,v30
MF v[240:243],a[48:51],a[24:27],v[240:243]
TR a[122:123],v12,33792
v_lshl_add_u32 v16,v29,4,v30
MF v[244:247],a[52:55],a[24:27],v[244:247]
MF v[248:251],a[56:59],a[24:27],v[248:251]
RD a[92:95],v3,14336
v_add_u32 v29,64,v1
MF v[252:255],a[60:63],a[24:27],v[252:255]
v_mul_u32_u24 v30,s52,v29
MF a[192:195],a[32:35],a[28:31],a[192:195]
TR a[124:125],v13,32768
v_lshrrev_b32 v30,16,v30
MF a[196:199],a[36:39],a[28:31],a[196:199]
s_mov_b32 s46,47744
buffer_load_dwordx4 v14,s[12:15],s46 offen offset:2048 lds
MF a[200:203],a[40:43],a[28:31],a[200:203]
TR a[126:127],v13,33792
v_mul_u32_u24 v31,18,v30
MF a[204:207],a[44:47],a[28:31],a[204:207]
v_sub_u32 v29,v29,v31
MF a[208:211],a[48:51],a[28:31],a[208:211]
v_lshrrev_b32 v31,1,v30
MF a[212:215],a[52:55],a[28:31],a[212:215]
MF a[216:219],a[56:59],a[28:31],a[216:219]
MF a[220:223],a[60:63],a[28:31],a[220:223]
LW 15
MF v[32:35],a[96:99],a[64:67],v[32:35]
v_xor_b32 v31,v31,v30
MF v[36:39],a[100:103],a[64:67],v[36:39]
v_and_b32 v31,4,v31
MF v[40:43],a[104:107],a[64:67],v[40:43]
LW 12
v_mul_u32_u24 v31,3,v31
MF v[44:47],a[108:111],a[64:67],v[44:47]
LW 9
v_xor_b32 v30,v30,v31
MF v[48:51],a[112:115],a[64:67],v[48:51]
LW 6
MF v[52:55],a[116:119],a[64:67],v[52:55]
LW 3
v_mul_u32_u24 v30,s53,v30
MF v[56:59],a[120:123],a[64:67],v[56:59]
LW 0
v_lshl_add_u32 v17,v29,4,v30
MF v[60:63],a[124:127],a[64:67],v[60:63]
s_waitcnt vmcnt(25)
v_subrev_u32 v17,1024,v17
MF v[64:67],a[96:99],a[68:71],v[64:67]
s_barrier
MF v[68:71],a[100:103],a[68:71],v[68:71]
s_add_u32 m0,s49,32768
s_mov_b32 s47,2621440
RD a[0:3],v4,0
MF v[72:75],a[104:107],a[68:71],v[72:75]
buffer_load_dwordx4 v15,s[16:19],s47 offen lds
v_add_u32 v29,128,v1
MF v[76:79],a[108:111],a[68:71],v[76:79]
TR a[32:33],v6,49152
v_mul_u32_u24 v30,s52,v29
MF v[80:83],a[112:115],a[68:71],v[80:83]
v_lshrrev_b32 v30,16,v30
v_mul_u32_u24 v31,18,v30
MF v[84:87],a[116:119],a[68:71],v[84:87]
TR a[34:35],v6,50176
MF v[88:91],a[120:123],a[68:71],v[88:91]
v_sub_u32 v29,v29,v31
MF v[92:95],a[124:127],a[68:71],v[92:95]
s_mov_b32 s47,2653184
RD a[4:7],v4,2048
v_lshrrev_b32 v31,1,v30
MF v[96:99],a[96:99],a[72:75],v[96:99]
buffer_load_dwordx4 v15,s[16:19],s47 offen offset:1024 lds
v_xor_b32 v31,v31,v30
MF v[100:103],a[100:103],a[72:75],v[100:103]
TR a[36:37],v7,49152
MF v[104:107],a[104:107],a[72:75],v[104:107]
v_and_b32 v31,4,v31
MF v[108:111],a[108:111],a[72:75],v[108:111]
TR a[38:39],v7,50176
v_mul_u32_u24 v31,3,v31
MF v[112:115],a[112:115],a[72:75],v[112:115]
v_xor_b32 v30,v30,v31
MF v[116:119],a[116:119],a[72:75],v[116:119]
RD a[8:11],v4,4096
v_mul_u32_u24 v30,s53,v30
MF v[120:123],a[120:123],a[72:75],v[120:123]
s_mov_b32 s47,2750464
buffer_load_dwordx4 v15,s[16:19],s47 offen offset:2048 lds
MF v[124:127],a[124:127],a[72:75],v[124:127]
TR a[40:41],v8,49152
v_lshl_add_u32 v18,v29,4,v30
MF v[128:131],a[96:99],a[76:79],v[128:131]
v_subrev_u32 v18,2048,v18
MF v[132:135],a[100:103],a[76:79],v[132:135]
v_add_u32 v29,192,v1
MF v[136:139],a[104:107],a[76:79],v[136:139]
TR a[42:43],v8,50176
MF v[140:143],a[108:111],a[76:79],v[140:143]
v_mul_u32_u24 v30,s52,v29
MF v[144:147],a[112:115],a[76:79],v[144:147]
RD a[12:15],v4,6144
v_lshrrev_b32 v30,16,v30
MF v[148:151],a[116:119],a[76:79],v[148:151]
s_mov_b32 s47,2782208
buffer_load_dwordx4 v15,s[16:19],s47 offen offset:3072 lds
v_mul_u32_u24 v31,18,v30
MF v[152:155],a[120:123],a[76:79],v[152:155]
TR a[44:45],v9,49152
MF v[156:159],a[124:127],a[76:79],v[156:159]
v_sub_u32 v29,v29,v31
MF v[160:163],a[96:99],a[80:83],v[160:163]
TR a[46:47],v9,50176
v_lshrrev_b32 v31,1,v30
MF v[164:167],a[100:103],a[80:83],v[164:167]
v_xor_b32 v31,v31,v30
MF v[168:171],a[104:107],a[80:83],v[168:171]
RD a[16:19],v4,8192
v_and_b32 v31,4,v31
MF v[172:175],a[108:111],a[80:83],v[172:175]
MF v[176:179],a[112:115],a[80:83],v[176:179]
s_add_u32 m0,s48,40960
s_mov_b32 s46,66176
v_mul_u32_u24 v31,3,v31
MF v[180:183],a[116:119],a[80:83],v[180:183]
TR a[48:49],v10,49152
buffer_load_dwordx4 v14,s[12:15],s46 offen lds
MF v[184:187],a[120:123],a[80:83],v[184:187]
TR a[50:51],v10,50176
v_xor_b32 v30,v30,v31
MF v[188:191],a[124:127],a[80:83],v[188:191]
v_mul_u32_u24 v30,s53,v30
MF v[192:195],a[96:99],a[84:87],v[192:195]
RD a[20:23],v4,10240
v_lshl_add_u32 v19,v29,4,v30
MF v[196:199],a[100:103],a[84:87],v[196:199]
v_subrev_u32 v19,3072,v19
MF v[200:203],a[104:107],a[84:87],v[200:203]
v_add_u32 v29,256,v1
MF v[204:207],a[108:111],a[84:87],v[204:207]
s_mov_b32 s46,80512
buffer_load_dwordx4 v14,s[12:15],s46 offen offset:2048 lds
TR a[52:53],v11,49152
MF v[208:211],a[112:115],a[84:87],v[208:211]
v_mul_u32_u24 v30,s52,v29
MF v[212:215],a[116:119],a[84:87],v[212:215]
TR a[54:55],v11,50176
v_lshrrev_b32 v30,16,v30
MF v[216:219],a[120:123],a[84:87],v[216:219]
v_mul_u32_u24 v31,18,v30
MF v[220:223],a[124:127],a[84:87],v[220:223]
RD a[24:27],v4,12288
v_sub_u32 v29,v29,v31
MF v[224:227],a[96:99],a[88:91],v[224:227]
MF v[228:231],a[100:103],a[88:91],v[228:231]
TR a[56:57],v12,49152
v_lshrrev_b32 v31,1,v30
MF v[232:235],a[104:107],a[88:91],v[232:235]
s_add_u32 m0,s48,45056
s_mov_b32 s46,98944
buffer_load_dwordx4 v14,s[12:15],s46 offen lds
MF v[236:239],a[108:111],a[88:91],v[236:239]
TR a[58:59],v12,50176
v_xor_b32 v31,v31,v30
MF v[240:243],a[112:115],a[88:91],v[240:243]
v_and_b32 v31,4,v31
v_mul_u32_u24 v31,3,v31
MF v[244:247],a[116:119],a[88:91],v[244:247]
RD a[28:31],v4,14336
MF v[248:251],a[120:123],a[88:91],v[248:251]
v_xor_b32 v30,v30,v31
MF v[252:255],a[124:127],a[88:91],v[252:255]
TR a[60:61],v13,49152
v_mul_u32_u24 v30,s53,v30
MF a[192:195],a[96:99],a[92:95],a[192:195]
v_lshl_add_u32 v20,v29,4,v30
MF a[196:199],a[100:103],a[92:95],a[196:199]
s_mov_b32 s46,113280
TR a[62:63],v13,50176
buffer_load_dwordx4 v14,s[12:15],s46 offen offset:2048 lds
MF a[200:203],a[104:107],a[92:95],a[200:203]
v_add_u32 v29,320,v1
MF a[204:207],a[108:111],a[92:95],a[204:207]
v_mul_u32_u24 v30,s52,v29
MF a[208:211],a[112:115],a[92:95],a[208:211]
v_lshrrev_b32 v30,16,v30
MF a[212:215],a[116:119],a[92:95],a[212:215]
MF a[216:219],a[120:123],a[92:95],a[216:219]
MF a[220:223],a[124:127],a[92:95],a[220:223]
LW 15
MF v[32:35],a[32:35],a[0:3],v[32:35]
v_mul_u32_u24 v31,18,v30
MF v[36:39],a[36:39],a[0:3],v[36:39]
v_sub_u32 v29,v29,v31
MF v[40:43],a[40:43],a[0:3],v[40:43]
LW 12
v_lshrrev_b32 v31,1,v30
MF v[44:47],a[44:47],a[0:3],v[44:47]
LW 9
v_xor_b32 v31,v31,v30
MF v[48:51],a[48:51],a[0:3],v[48:51]
LW 6
MF v[52:55],a[52:55],a[0:3],v[52:55]
LW 3
v_and_b32 v31,4,v31
MF v[56:59],a[56:59],a[0:3],v[56:59]
LW 0
v_mul_u32_u24 v31,3,v31
MF v[60:63],a[60:63],a[0:3],v[60:63]
s_waitcnt vmcnt(18)
v_xor_b32 v30,v30,v31
MF v[64:67],a[32:35],a[4:7],v[64:67]
s_barrier
MF v[68:71],a[36:39],a[4:7],v[68:71]
s_add_u32 m0,s49,49152
s_mov_b32 s47,2883584
v_add_u32 v3,0,v5
MF v[72:75],a[40:43],a[4:7],v[72:75]
buffer_load_dwordx4 v15,s[16:19],s47 offen lds
v_mul_u32_u24 v30,s53,v30
MF v[76:79],a[44:47],a[4:7],v[76:79]
v_xor_b32 v4,64,v3
v_lshl_add_u32 v21,v29,4,v30
MF v[80:83],a[48:51],a[4:7],v[80:83]
v_subrev_u32 v21,1024,v21
v_add_u32 v29,384,v1
MF v[84:87],a[52:55],a[4:7],v[84:87]
RD a[64:67],v3,0
MF v[88:91],a[56:59],a[4:7],v[88:91]
TR a[96:97],v6,0
v_mul_u32_u24 v30,s52,v29
MF v[92:95],a[60:63],a[4:7],v[92:95]
s_mov_b32 s47,2915328
buffer_load_dwordx4 v15,s[16:19],s47 offen offset:1024 lds
v_lshrrev_b32 v30,16,v30
MF v[96:99],a[32:35],a[8:11],v[96:99]
TR a[98:99],v6,1024
v_mul_u32_u24 v31,18,v30
MF v[100:103],a[36:39],a[8:11],v[100:103]
MF v[104:107],a[40:43],a[8:11],v[104:107]
RD a[68:71],v3,2048
v_sub_u32 v29,v29,v31
MF v[108:111],a[44:47],a[8:11],v[108:111]
v_lshrrev_b32 v31,1,v30
MF v[112:115],a[48:51],a[8:11],v[112:115]
TR a[100:101],v7,0
v_xor_b32 v31,v31,v30
MF v[116:119],a[52:55],a[8:11],v[116:119]
v_and_b32 v31,4,v31
MF v[120:123],a[56:59],a[8:11],v[120:123]
s_mov_b32 s47,3012608
buffer_load_dwordx4 v15,s[16:19],s47 offen offset:2048 lds
TR a[102:103],v7,1024
MF v[124:127],a[60:63],a[8:11],v[124:127]
v_mul_u32_u24 v31,3,v31
MF v[128:131],a[32:35],a[12:15],v[128:131]
RD a[72:75],v3,4096
v_xor_b32 v30,v30,v31
MF v[132:135],a[36:39],a[12:15],v[132:135]
v_mul_u32_u24 v30,s53,v30
MF v[136:139],a[40:43],a[12:15],v[136:139]
TR a[104:105],v8,0
MF v[140:143],a[44:47],a[12:15],v[140:143]
v_lshl_add_u32 v22,v29,4,v30
MF v[144:147],a[48:51],a[12:15],v[144:147]
TR a[106:107],v8,1024
v_subrev_u32 v22,2048,v22
MF v[148:151],a[52:55],a[12:15],v[148:151]
s_mov_b32 s47,3044352
buffer_load_dwordx4 v15,s[16:19],s47 offen offset:3072 lds
v_add_u32 v29,448,v1
MF v[152:155],a[56:59],a[12:15],v[152:155]
RD a[76:79],v3,6144
MF v[156:159],a[60:63],a[12:15],v[156:159]
v_mul_u32_u24 v30,s52,v29
MF v[160:163],a[32:35],a[16:19],v[160:163]
TR a[108:109],v9,0
v_lshrrev_b32 v30,16,v30
MF v[164:167],a[36:39],a[16:19],v[164:167]
v_mul_u32_u24 v31,18,v30
MF v[168:171],a[40:43],a[16:19],v[168:171]
TR a[110:111],v9,1024
v_sub_u32 v29,v29,v31
MF v[172:175],a[44:47],a[16:19],v[172:175]
MF v[176:179],a[48:51],a[16:19],v[176:179]
s_add_u32 m0,s48,65536
RD a[80:83],v3,8192
v_lshrrev_b32 v31,1,v30
MF v[180:183],a[52:55],a[16:19],v[180:183]
s_mov_b32 s46,768
buffer_load_dwordx4 v14,s[12:15],s46 offen lds
v_xor_b32 v31,v31,v30
MF v[184:187],a[56:59],a[16:19],v[184:187]
TR a[112:113],v10,0
v_and_b32 v31,4,v31
MF v[188:191],a[60:63],a[16:19],v[188:191]
MF v[192:195],a[32:35],a[20:23],v[192:195]
TR a[114:115],v10,1024
v_mul_u32_u24 v31,3,v31
MF v[196:199],a[36:39],a[20:23],v[196:199]
v_xor_b32 v30,v30,v31
MF v[200:203],a[40:43],a[20:23],v[200:203]
RD a[84:87],v3,10240
v_mul_u32_u24 v30,s53,v30
MF v[204:207],a[44:47],a[20:23],v[204:207]
s_mov_b32 s46,15104
buffer_load_dwordx4 v14,s[12:15],s46 offen offset:2048 lds
v_lshl_add_u32 v23,v29,4,v30
MF v[208:211],a[48:51],a[20:23],v[208:211]
TR a[116:117],v11,0
MF v[212:215],a[52:55],a[20:23],v[212:215]
v_subrev_u32 v23,3072,v23
MF v[216:219],a[56:59],a[20:23],v[216:219]
TR a[118:119],v11,1024
v_add_u32 v29,512,v1
MF v[220:223],a[60:63],a[20:23],v[220:223]
v_mul_u32_u24 v30,s52,v29
MF v[224:227],a[32:35],a[24:27],v[224:227]
RD a[88:91],v3,12288
MF v[228:231],a[36:39],a[24:27],v[228:231]
v_lshrrev_b32 v30,16,v30
MF v[232:235],a[40:43],a[24:27],v[232:235]
s_add_u32 m0,s48,69632
s_mov_b32 s46,33536
TR a[120:121],v12,0
MF v[236:239],a[44:47],a[24:27],v[236:239]
buffer_load_dwordx4 v14,s[12:15],s46 offen lds
v_mul_u32_u24 v31,18,v30
MF v[240:243],a[48:51],a[24:27],v[240:243]
TR a[122:123],v12,1024
v_sub_u32 v29,v29,v31
MF v[244:247],a[52:55],a[24:27],v[244:247]
v_lshrrev_b32 v31,1,v30
MF v[248:251],a[56:59],a[24:27],v[248:251]
RD a[92:95],v3,14336
v_xor_b32 v31,v31,v30
MF v[252:255],a[60:63],a[24:27],v[252:255]
v_and_b32 v31,4,v31
MF a[192:195],a[32:35],a[28:31],a[192:195]
TR a[124:125],v13,0
v_mul_u32_u24 v31,3,v31
MF a[196:199],a[36:39],a[28:31],a[196:199]
s_mov_b32 s46,47872
buffer_load_dwordx4 v14,s[12:15],s46 offen offset:2048 lds
MF a[200:203],a[40:43],a[28:31],a[200:203]
TR a[126:127],v13,1024
v_xor_b32 v30,v30,v31
MF a[204:207],a[44:47],a[28:31],a[204:207]
v_mul_u32_u24 v30,s53,v30
MF a[208:211],a[48:51],a[28:31],a[208:211]
v_lshl_add_u32 v24,v29,4,v30
MF a[212:215],a[52:55],a[28:31],a[212:215]
MF a[216:219],a[56:59],a[28:31],a[216:219]
MF a[220:223],a[60:63],a[28:31],a[220:223]
LW 15
MF v[32:35],a[96:99],a[64:67],v[32:35]
MF v[36:39],a[100:103],a[64:67],v[36:39]
MF v[40:43],a[104:107],a[64:67],v[40:43]
LW 12
MF v[44:47],a[108:111],a[64:67],v[44:47]
LW 9
MF v[48:51],a[112:115],a[64:67],v[48:51]
LW 6
MF v[52:55],a[116:119],a[64:67],v[52:55]
LW 3
MF v[56:59],a[120:123],a[64:67],v[56:59]
LW 0
MF v[60:63],a[124:127],a[64:67],v[60:63]
s_waitcnt vmcnt(20)
MF v[64:67],a[96:99],a[68:71],v[64:67]
s_barrier
MF v[68:71],a[100:103],a[68:71],v[68:71]
s_add_u32 m0,s49,0
s_mov_b32 s47,3145728
RD a[0:3],v4,0
MF v[72:75],a[104:107],a[68:71],v[72:75]
buffer_load_dwordx4 v15,s[16:19],s47 offen lds
MF v[76:79],a[108:111],a[68:71],v[76:79]
TR a[32:33],v6,16384
MF v[80:83],a[112:115],a[68:71],v[80:83]
MF v[84:87],a[116:119],a[68:71],v[84:87]
TR a[34:35],v6,17408
MF v[88:91],a[120:123],a[68:71],v[88:91]
s_mov_b32 s47,3177472
buffer_load_dwordx4 v15,s[16:19],s47 offen offset:1024 lds
MF v[92:95],a[124:127],a[68:71],v[92:95]
RD a[4:7],v4,2048
MF v[96:99],a[96:99],a[72:75],v[96:99]
MF v[100:103],a[100:103],a[72:75],v[100:103]
TR a[36:37],v7,16384
MF v[104:107],a[104:107],a[72:75],v[104:107]
MF v[108:111],a[108:111],a[72:75],v[108:111]
s_mov_b32 s47,3274752
TR a[38:39],v7,17408
buffer_load_dwordx4 v15,s[16:19],s47 offen offset:2048 lds
MF v[112:115],a[112:115],a[72:75],v[112:115]
MF v[116:119],a[116:119],a[72:75],v[116:119]
RD a[8:11],v4,4096
MF v[120:123],a[120:123],a[72:75],v[120:123]
MF v[124:127],a[124:127],a[72:75],v[124:127]
TR a[40:41],v8,16384
MF v[128:131],a[96:99],a[76:79],v[128:131]
s_mov_b32 s47,3306496
buffer_load_dwordx4 v15,s[16:19],s47 offen offset:3072 lds
MF v[132:135],a[100:103],a[76:79],v[132:135]
MF v[136:139],a[104:107],a[76:79],v[136:139]
TR a[42:43],v8,17408
MF v[140:143],a[108:111],a[76:79],v[140:143]
MF v[144:147],a[112:115],a[76:79],v[144:147]
RD a[12:15],v4,6144
MF v[148:151],a[116:119],a[76:79],v[148:151]
s_add_u32 m0,s48,73728
s_mov_b32 s46,66304
buffer_load_dwordx4 v14,s[12:15],s46 offen lds
MF v[152:155],a[120:123],a[76:79],v[152:155]
TR a[44:45],v9,16384
MF v[156:159],a[124:127],a[76:79],v[156:159]
MF v[160:163],a[96:99],a[80:83],v[160:163]
TR a[46:47],v9,17408
MF v[164:167],a[100:103],a[80:83],v[164:167]
MF v[168:171],a[104:107],a[80:83],v[168:171]
s_mov_b32 s46,80640
RD a[16:19],v4,8192
buffer_load_dwordx4 v14,s[12:15],s46 offen offset:2048 lds
MF v[172:175],a[108:111],a[80:83],v[172:175]
MF v[176:179],a[112:115],a[80:83],v[176:179]
TR a[48:49],v10,16384
MF v[180:183],a[116:119],a[80:83],v[180:183]
MF v[184:187],a[120:123],a[80:83],v[184:187]
TR a[50:51],v10,17408
MF v[188:191],a[124:127],a[80:83],v[188:191]
s_add_u32 m0,s48,77824
s_mov_b32 s46,99072
buffer_load_dwordx4 v14,s[12:15],s46 offen lds
MF v[192:195],a[96:99],a[84:87],v[192:195]
RD a[20:23],v4,10240
MF v[196:199],a[100:103],a[84:87],v[196:199]
MF v[200:203],a[104:107],a[84:87],v[200:203]
MF v[204:207],a[108:111],a[84:87],v[204:207]
TR a[52:53],v11,16384
MF v[208:211],a[112:115],a[84:87],v[208:211]
s_mov_b32 s46,113408
buffer_load_dwordx4 v14,s[12:15],s46 offen offset:2048 lds
MF v[212:215],a[116:119],a[84:87],v[212:215]
TR a[54:55],v11,17408
MF v[216:219],a[120:123],a[84:87],v[216:219]
MF v[220:223],a[124:127],a[84:87],v[220:223]
RD a[24:27],v4,12288
MF v[224:227],a[96:99],a[88:91],v[224:227]
MF v[228:231],a[100:103],a[88:91],v[228:231]
s_lshl_b32 s7,s2,4
s_lshl_b32 s41,s32,2
s_add_u32 s7,s7,s41
MF v[232:235],a[104:107],a[88:91],v[232:235]
s_add_u32 s7,s7,0x8300000
v_mov_b32 v30,s7
v_mov_b32 v31,s3
MF v[236:239],a[108:111],a[88:91],v[236:239]
TR a[56:57],v12,16384
global_store_dword v30,v31,s[4:5] sc1
MF v[240:243],a[112:115],a[88:91],v[240:243]
TR a[58:59],v12,17408
MF v[244:247],a[116:119],a[88:91],v[244:247]
RD a[28:31],v4,14336
MF v[248:251],a[120:123],a[88:91],v[248:251]
s_lshl_b32 s42,s35,3
s_add_u32 s42,s42,s36
s_lshl_b32 s7,s42,4
MF v[252:255],a[124:127],a[88:91],v[252:255]
s_lshl_b32 s41,s32,2
s_add_u32 s7,s7,s41
s_add_u32 s7,s7,0x8307000
MF a[192:195],a[96:99],a[92:95],a[192:195]
v_mov_b32 v30,s7
v_mov_b32 v31,s37
MF a[196:199],a[100:103],a[92:95],a[196:199]
TR a[60:61],v13,16384
global_store_dword v30,v31,s[4:5] sc1
MF a[200:203],a[104:107],a[92:95],a[200:203]
TR a[62:63],v13,17408
MF a[204:207],a[108:111],a[92:95],a[204:207]
s_lshl_b32 s7,s2,2
s_add_u32 s7,s7,s32
s_mul_i32 s7,s7,1536
MF a[208:211],a[112:115],a[92:95],a[208:211]
s_add_u32 s7,s7,0
v_lshlrev_b32 v0,7,v1
v_min_u32 v0,1532,v0
MF a[212:215],a[116:119],a[92:95],a[212:215]
v_add_u32 v0,s7,v0
MF a[216:219],a[120:123],a[92:95],a[216:219]
global_load_dword a177,v0,s[68:69]
MF a[220:223],a[124:127],a[92:95],a[220:223]
LW 15
MF v[32:35],a[32:35],a[0:3],v[32:35]
MF v[36:39],a[36:39],a[0:3],v[36:39]
MF v[40:43],a[40:43],a[0:3],v[40:43]
LW 12
MF v[44:47],a[44:47],a[0:3],v[44:47]
LW 9
MF v[48:51],a[48:51],a[0:3],v[48:51]
LW 6
MF v[52:55],a[52:55],a[0:3],v[52:55]
LW 3
MF v[56:59],a[56:59],a[0:3],v[56:59]
LW 0
MF v[60:63],a[60:63],a[0:3],v[60:63]
s_waitcnt vmcnt(19)
MF v[64:67],a[32:35],a[4:7],v[64:67]
s_barrier
MF v[68:71],a[36:39],a[4:7],v[68:71]
s_add_u32 m0,s49,16384
s_mov_b32 s47,3407872
v_add_u32 v3,32768,v5
MF v[72:75],a[40:43],a[4:7],v[72:75]
buffer_load_dwordx4 v15,s[16:19],s47 offen lds
v_xor_b32 v4,64,v3
MF v[76:79],a[44:47],a[4:7],v[76:79]
MF v[80:83],a[48:51],a[4:7],v[80:83]
RD a[64:67],v3,0
MF v[84:87],a[52:55],a[4:7],v[84:87]
MF v[88:91],a[56:59],a[4:7],v[88:91]
s_mov_b32 s47,3439616
TR a[96:97],v6,32768
buffer_load_dwordx4 v15,s[16:19],s47 offen offset:1024 lds
MF v[92:95],a[60:63],a[4:7],v[92:95]
MF v[96:99],a[32:35],a[8:11],v[96:99]
TR a[98:99],v6,33792
MF v[100:103],a[36:39],a[8:11],v[100:103]
MF v[104:107],a[40:43],a[8:11],v[104:107]
RD a[68:71],v3,2048
MF v[108:111],a[44:47],a[8:11],v[108:111]
MF v[112:115],a[48:51],a[8:11],v[112:115]
s_mov_b32 s47,3536896
TR a[100:101],v7,32768
buffer_load_dwordx4 v15,s[16:19],s47 offen offset:2048 lds
MF v[116:119],a[52:55],a[8:11],v[116:119]
MF v[120:123],a[56:59],a[8:11],v[120:123]
TR a[102:103],v7,33792
MF v[124:127],a[60:63],a[8:11],v[124:127]
MF v[128:131],a[32:35],a[12:15],v[128:131]
RD a[72:75],v3,4096
MF v[132:135],a[36:39],a[12:15],v[132:135]
s_mov_b32 s47,3568640
buffer_load_dwordx4 v15,s[16:19],s47 offen offset:3072 lds
MF v[136:139],a[40:43],a[12:15],v[136:139]
TR a[104:105],v8,32768
MF v[140:143],a[44:47],a[12:15],v[140:143]
MF v[144:147],a[48:51],a[12:15],v[144:147]
TR a[106:107],v8,33792
MF v[148:151],a[52:55],a[12:15],v[148:151]
MF v[152:155],a[56:59],a[12:15],v[152:155]
RD a[76:79],v3,6144
MF v[156:159],a[60:63],a[12:15],v[156:159]
s_add_u32 m0,s48,0
s_mov_b32 s46,896
buffer_load_dwordx4 v14,s[12:15],s46 offen lds
MF v[160:163],a[32:35],a[16:19],v[160:163]
TR a[108:109],v9,32768
MF v[164:167],a[36:39],a[16:19],v[164:167]
MF v[168:171],a[40:43],a[16:19],v[168:171]
TR a[110:111],v9,33792
MF v[172:175],a[44:47],a[16:19],v[172:175]
MF v[176:179],a[48:51],a[16:19],v[176:179]
s_mov_b32 s46,15232
buffer_load_dwordx4 v14,s[12:15],s46 offen offset:2048 lds
RD a[80:83],v3,8192
MF v[180:183],a[52:55],a[16:19],v[180:183]
MF v[184:187],a[56:59],a[16:19],v[184:187]
TR a[112:113],v10,32768
MF v[188:191],a[60:63],a[16:19],v[188:191]
MF v[192:195],a[32:35],a[20:23],v[192:195]
TR a[114:115],v10,33792
MF v[196:199],a[36:39],a[20:23],v[196:199]
MF v[200:203],a[40:43],a[20:23],v[200:203]
s_add_u32 m0,s48,4096
s_mov_b32 s46,33664
buffer_load_dwordx4 v14,s[12:15],s46 offen lds
MF v[204:207],a[44:47],a[20:23],v[204:207]
RD a[84:87],v3,10240
MF v[208:211],a[48:51],a[20:23],v[208:211]
TR a[116:117],v11,32768
MF v[212:215],a[52:55],a[20:23],v[212:215]
MF v[216:219],a[56:59],a[20:23],v[216:219]
TR a[118:119],v11,33792
MF v[220:223],a[60:63],a[20:23],v[220:223]
s_mov_b32 s46,48000
buffer_load_dwordx4 v14,s[12:15],s46 offen offset:2048 lds
MF v[224:227],a[32:35],a[24:27],v[224:227]
RD a[88:91],v3,12288
MF v[228:231],a[36:39],a[24:27],v[228:231]
MF v[232:235],a[40:43],a[24:27],v[232:235]
TR a[120:121],v12,32768
MF v[236:239],a[44:47],a[24:27],v[236:239]
MF v[240:243],a[48:51],a[24:27],v[240:243]
TR a[122:123],v12,33792
MF v[244:247],a[52:55],a[24:27],v[244:247]
s_add_u32 s40,s0,Lm_z-Lm_pc
s_addc_u32 s41,s1,0
s_lshr_b32 s7,s2,3
MF v[248:251],a[56:59],a[24:27],v[248:251]
s_lshl_b32 s7,s7,2
s_add_u32 s7,s7,s32
s_lshl_b32 s7,s7,9
MF v[252:255],a[60:63],a[24:27],v[252:255]
v_and_b32 v30,3,v1
v_lshl_add_u32 v30,v30,7,s7
MF a[192:195],a[32:35],a[28:31],a[192:195]
RD a[92:95],v3,14336
v_min_u32 v30,Lm_codeend-Lm_z-4,v30
MF a[196:199],a[36:39],a[28:31],a[196:199]
TR a[124:125],v13,32768
global_load_dword a141,v30,s[40:41]
MF a[200:203],a[40:43],a[28:31],a[200:203]
s_lshl_b32 s7,s2,2
s_add_u32 s7,s7,s32
TR a[126:127],v13,33792
MF a[204:207],a[44:47],a[28:31],a[204:207]
s_mul_i32 s7,s7,1536
s_add_u32 s7,s7,1572864
v_lshlrev_b32 v0,7,v1
MF a[208:211],a[48:51],a[28:31],a[208:211]
v_min_u32 v0,1532,v0
v_add_u32 v0,s7,v0
MF a[212:215],a[52:55],a[28:31],a[212:215]
global_load_dword a178,v0,s[68:69]
MF a[216:219],a[56:59],a[28:31],a[216:219]
MF a[220:223],a[60:63],a[28:31],a[220:223]
LW 15
MF v[32:35],a[96:99],a[64:67],v[32:35]
MF v[36:39],a[100:103],a[64:67],v[36:39]
MF v[40:43],a[104:107],a[64:67],v[40:43]
LW 12
MF v[44:47],a[108:111],a[64:67],v[44:47]
LW 9
MF v[48:51],a[112:115],a[64:67],v[48:51]
LW 6
MF v[52:55],a[116:119],a[64:67],v[52:55]
LW 3
MF v[56:59],a[120:123],a[64:67],v[56:59]
LW 0
MF v[60:63],a[124:127],a[64:67],v[60:63]
s_waitcnt vmcnt(25)
MF v[64:67],a[96:99],a[68:71],v[64:67]
s_barrier
MF v[68:71],a[100:103],a[68:71],v[68:71]
s_add_u32 m0,s49,32768
s_mov_b32 s47,3670016
RD a[0:3],v4,0
MF v[72:75],a[104:107],a[68:71],v[72:75]
buffer_load_dwordx4 v15,s[16:19],s47 offen lds
MF v[76:79],a[108:111],a[68:71],v[76:79]
TR a[32:33],v6,49152
MF v[80:83],a[112:115],a[68:71],v[80:83]
MF v[84:87],a[116:119],a[68:71],v[84:87]
TR a[34:35],v6,50176
MF v[88:91],a[120:123],a[68:71],v[88:91]
s_mov_b32 s47,3701760
buffer_load_dwordx4 v15,s[16:19],s47 offen offset:1024 lds
MF v[92:95],a[124:127],a[68:71],v[92:95]
RD a[4:7],v4,2048
MF v[96:99],a[96:99],a[72:75],v[96:99]
MF v[100:103],a[100:103],a[72:75],v[100:103]
TR a[36:37],v7,49152
MF v[104:107],a[104:107],a[72:75],v[104:107]
MF v[108:111],a[108:111],a[72:75],v[108:111]
TR a[38:39],v7,50176
MF v[112:115],a[112:115],a[72:75],v[112:115]
s_mov_b32 s47,3799040
buffer_load_dwordx4 v15,s[16:19],s47 offen offset:2048 lds
MF v[116:119],a[116:119],a[72:75],v[116:119]
RD a[8:11],v4,4096
MF v[120:123],a[120:123],a[72:75],v[120:123]
MF v[124:127],a[124:127],a[72:75],v[124:127]
TR a[40:41],v8,49152
MF v[128:131],a[96:99],a[76:79],v[128:131]
MF v[132:135],a[100:103],a[76:79],v[132:135]
s_mov_b32 s47,3830784
buffer_load_dwordx4 v15,s[16:19],s47 offen offset:3072 lds
MF v[136:139],a[104:107],a[76:79],v[136:139]
TR a[42:43],v8,50176
MF v[140:143],a[108:111],a[76:79],v[140:143]
MF v[144:147],a[112:115],a[76:79],v[144:147]
RD a[12:15],v4,6144
MF v[148:151],a[116:119],a[76:79],v[148:151]
MF v[152:155],a[120:123],a[76:79],v[152:155]
TR a[44:45],v9,49152
MF v[156:159],a[124:127],a[76:79],v[156:159]
s_add_u32 m0,s48,8192
s_mov_b32 s46,66432
buffer_load_dwordx4 v14,s[12:15],s46 offen lds
MF v[160:163],a[96:99],a[80:83],v[160:163]
TR a[46:47],v9,50176
MF v[164:167],a[100:103],a[80:83],v[164:167]
MF v[168:171],a[104:107],a[80:83],v[168:171]
RD a[16:19],v4,8192
MF v[172:175],a[108:111],a[80:83],v[172:175]
MF v[176:179],a[112:115],a[80:83],v[176:179]
s_mov_b32 s46,80768
TR a[48:49],v10,49152
buffer_load_dwordx4 v14,s[12:15],s46 offen offset:2048 lds
MF v[180:183],a[116:119],a[80:83],v[180:183]
MF v[184:187],a[120:123],a[80:83],v[184:187]
TR a[50:51],v10,50176
MF v[188:191],a[124:127],a[80:83],v[188:191]
MF v[192:195],a[96:99],a[84:87],v[192:195]
RD a[20:23],v4,10240
MF v[196:199],a[100:103],a[84:87],v[196:199]
MF v[200:203],a[104:107],a[84:87],v[200:203]
s_add_u32 m0,s48,12288
s_mov_b32 s46,99200
buffer_load_dwordx4 v14,s[12:15],s46 offen lds
MF v[204:207],a[108:111],a[84:87],v[204:207]
TR a[52:53],v11,49152
MF v[208:211],a[112:115],a[84:87],v[208:211]
MF v[212:215],a[116:119],a[84:87],v[212:215]
TR a[54:55],v11,50176
MF v[216:219],a[120:123],a[84:87],v[216:219]
MF v[220:223],a[124:127],a[84:87],v[220:223]
s_mov_b32 s46,113536
buffer_load_dwordx4 v14,s[12:15],s46 offen offset:2048 lds
RD a[24:27],v4,12288
MF v[224:227],a[96:99],a[88:91],v[224:227]
MF v[228:231],a[100:103],a[88:91],v[228:231]
TR a[56:57],v12,49152
MF v[232:235],a[104:107],a[88:91],v[232:235]
MF v[236:239],a[108:111],a[88:91],v[236:239]
TR a[58:59],v12,50176
MF v[240:243],a[112:115],a[88:91],v[240:243]
MF v[244:247],a[116:119],a[88:91],v[244:247]
s_lshl_b32 s42,s33,4
s_lshl_b32 s7,s42,4
s_add_u32 s7,s7,0x8300000
MF v[248:251],a[120:123],a[88:91],v[248:251]
RD a[28:31],v4,14336
v_lshl_add_u32 v30,v1,2,s7
MF v[252:255],a[124:127],a[88:91],v[252:255]
TR a[60:61],v13,49152
global_load_dword v31,v30,s[4:5] sc1
MF a[192:195],a[96:99],a[92:95],a[192:195]
MF a[196:199],a[100:103],a[92:95],a[196:199]
TR a[62:63],v13,50176
MF a[200:203],a[104:107],a[92:95],a[200:203]
s_lshl_b32 s7,s2,2
s_add_u32 s7,s7,s32
s_mul_i32 s7,s7,1536
MF a[204:207],a[108:111],a[92:95],a[204:207]
s_add_u32 s7,s7,3145728
v_lshlrev_b32 v0,7,v1
v_min_u32 v0,1532,v0
MF a[208:211],a[112:115],a[92:95],a[208:211]
v_add_u32 v0,s7,v0
MF a[212:215],a[116:119],a[92:95],a[212:215]
global_load_dword a179,v0,s[68:69]
MF a[216:219],a[120:123],a[92:95],a[216:219]
MF a[220:223],a[124:127],a[92:95],a[220:223]
LW 15
MF v[32:35],a[32:35],a[0:3],v[32:35]
s_mov_b32 s28,s80
MF v[36:39],a[36:39],a[0:3],v[36:39]
s_mov_b32 s29,s81
MF v[40:43],a[40:43],a[0:3],v[40:43]
LW 12
MF v[44:47],a[44:47],a[0:3],v[44:47]
LW 9
s_mov_b32 s30,0x800000
MF v[48:51],a[48:51],a[0:3],v[48:51]
LW 6
MF v[52:55],a[52:55],a[0:3],v[52:55]
LW 3
s_mov_b32 s31,0x20000
MF v[56:59],a[56:59],a[0:3],v[56:59]
LW 0
MF v[60:63],a[60:63],a[0:3],v[60:63]
s_waitcnt vmcnt(23)
v_and_b32 v29,7,v1
MF v[64:67],a[32:35],a[4:7],v[64:67]
s_barrier
MF v[68:71],a[36:39],a[4:7],v[68:71]
s_add_u32 m0,s49,49152
s_mov_b32 s47,3932160
v_add_u32 v3,65536,v5
MF v[72:75],a[40:43],a[4:7],v[72:75]
s_and_b32 s40,s34,1
s_lshl_b32 s40,s40,3
buffer_load_dwordx4 v15,s[16:19],s47 offen lds
MF v[76:79],a[44:47],a[4:7],v[76:79]
v_xor_b32 v4,64,v3
MF v[80:83],a[48:51],a[4:7],v[80:83]
RD a[64:67],v3,0
v_add_u32 v29,s40,v29
MF v[84:87],a[52:55],a[4:7],v[84:87]
MF v[88:91],a[56:59],a[4:7],v[88:91]
TR a[96:97],v6,0
v_lshrrev_b32 v0,2,v29
MF v[92:95],a[60:63],a[4:7],v[92:95]
MF v[96:99],a[32:35],a[8:11],v[96:99]
TR a[98:99],v6,1024
v_lshlrev_b32 v0,3,v0
MF v[100:103],a[36:39],a[8:11],v[100:103]
MF v[104:107],a[40:43],a[8:11],v[104:107]
RD a[68:71],v3,2048
v_and_b32 v14,3,v29
MF v[108:111],a[44:47],a[8:11],v[108:111]
MF v[112:115],a[48:51],a[8:11],v[112:115]
s_lshl_b32 s41,s33,7
TR a[100:101],v7,0
MF v[116:119],a[52:55],a[8:11],v[116:119]
s_lshr_b32 s42,s34,2
MF v[120:123],a[56:59],a[8:11],v[120:123]
s_mov_b32 s47,3963904
buffer_load_dwordx4 v15,s[16:19],s47 offen offset:1024 lds
TR a[102:103],v7,1024
MF v[124:127],a[60:63],a[8:11],v[124:127]
s_lshl_b32 s42,s42,5
MF v[128:131],a[32:35],a[12:15],v[128:131]
RD a[72:75],v3,4096
MF v[132:135],a[36:39],a[12:15],v[132:135]
s_add_u32 s41,s41,s42
MF v[136:139],a[40:43],a[12:15],v[136:139]
TR a[104:105],v8,0
MF v[140:143],a[44:47],a[12:15],v[140:143]
s_bfe_u32 s42,s34,0x10001
MF v[144:147],a[48:51],a[12:15],v[144:147]
TR a[106:107],v8,1024
MF v[148:151],a[52:55],a[12:15],v[148:151]
s_lshl_b32 s42,s42,2
MF v[152:155],a[56:59],a[12:15],v[152:155]
RD a[76:79],v3,6144
MF v[156:159],a[60:63],a[12:15],v[156:159]
s_add_u32 s41,s41,s42
MF v[160:163],a[32:35],a[16:19],v[160:163]
TR a[108:109],v9,0
v_add3_u32 v0,v0,v14,s41
MF v[164:167],a[36:39],a[16:19],v[164:167]
MF v[168:171],a[40:43],a[16:19],v[168:171]
TR a[110:111],v9,1024
v_lshlrev_b32 v0,12,v0
MF v[172:175],a[44:47],a[16:19],v[172:175]
MF v[176:179],a[48:51],a[16:19],v[176:179]
s_mov_b32 s47,4061184
RD a[80:83],v3,8192
v_lshrrev_b32 v14,3,v1
MF v[180:183],a[52:55],a[16:19],v[180:183]
buffer_load_dwordx4 v15,s[16:19],s47 offen offset:2048 lds
MF v[184:187],a[56:59],a[16:19],v[184:187]
TR a[112:113],v10,0
v_lshl_add_u32 v0,v14,4,v0
MF v[188:191],a[60:63],a[16:19],v[188:191]
MF v[192:195],a[32:35],a[20:23],v[192:195]
s_lshl_b32 s42,s32,10
TR a[114:115],v10,1024
MF v[196:199],a[36:39],a[20:23],v[196:199]
v_add_u32 v0,s42,v0
MF v[200:203],a[40:43],a[20:23],v[200:203]
RD a[84:87],v3,10240
MF v[204:207],a[44:47],a[20:23],v[204:207]
v_lshlrev_b32 v29,4,v29
MF v[208:211],a[48:51],a[20:23],v[208:211]
TR a[116:117],v11,0
MF v[212:215],a[52:55],a[20:23],v[212:215]
v_lshl_add_u32 v29,v14,8,v29
MF v[216:219],a[56:59],a[20:23],v[216:219]
TR a[118:119],v11,1024
MF v[220:223],a[60:63],a[20:23],v[220:223]
s_lshl_b32 s41,s33,3
MF v[224:227],a[32:35],a[24:27],v[224:227]
RD a[88:91],v3,12288
MF v[228:231],a[36:39],a[24:27],v[228:231]
s_lshr_b32 s42,s34,1
MF v[232:235],a[40:43],a[24:27],v[232:235]
s_mov_b32 s47,4092928
buffer_load_dwordx4 v15,s[16:19],s47 offen offset:3072 lds
TR a[120:121],v12,0
MF v[236:239],a[44:47],a[24:27],v[236:239]
s_add_u32 s41,s41,s42
MF v[240:243],a[48:51],a[24:27],v[240:243]
s_lshl_b32 s41,s41,16
TR a[122:123],v12,1024
MF v[244:247],a[52:55],a[24:27],v[244:247]
MF v[248:251],a[56:59],a[24:27],v[248:251]
s_lshl_b32 s42,s32,14
RD a[92:95],v3,14336
MF v[252:255],a[60:63],a[24:27],v[252:255]
MF a[192:195],a[32:35],a[28:31],a[192:195]
s_add_u32 s41,s41,s42
TR a[124:125],v13,0
MF a[196:199],a[36:39],a[28:31],a[196:199]
MF a[200:203],a[40:43],a[28:31],a[200:203]
TR a[126:127],v13,1024
v_add_u32 v29,s41,v29
MF a[204:207],a[44:47],a[28:31],a[204:207]
MF a[208:211],a[48:51],a[28:31],a[208:211]
AW a176,v29
MF a[212:215],a[52:55],a[28:31],a[212:215]
MF a[216:219],a[56:59],a[28:31],a[216:219]
MF a[220:223],a[60:63],a[28:31],a[220:223]
LW 15
MF v[32:35],a[96:99],a[64:67],v[32:35]
MF v[36:39],a[100:103],a[64:67],v[36:39]
MF v[40:43],a[104:107],a[64:67],v[40:43]
LW 12
MF v[44:47],a[108:111],a[64:67],v[44:47]
LW 9
MF v[48:51],a[112:115],a[64:67],v[48:51]
LW 6
MF v[52:55],a[116:119],a[64:67],v[52:55]
LW 3
MF v[56:59],a[120:123],a[64:67],v[56:59]
LW 0
MF v[60:63],a[124:127],a[64:67],v[60:63]
s_waitcnt vmcnt(20)
MF v[64:67],a[96:99],a[68:71],v[64:67]
s_barrier
s_waitcnt vmcnt(5)
v_cmp_ne_u32 vcc,s3,v31
s_nop 0
s_cbranch_vccnz Lm_pl1
Lm_pl1r:
MF v[68:71],a[100:103],a[68:71],v[68:71]
buffer_load_dwordx4 a[224:227],v0,s[28:31],0 offen nt
RD a[0:3],v4,0
MF v[72:75],a[104:107],a[68:71],v[72:75]
MF v[76:79],a[108:111],a[68:71],v[76:79]
TR a[32:33],v6,16384
MF v[80:83],a[112:115],a[68:71],v[80:83]
MF v[84:87],a[116:119],a[68:71],v[84:87]
TR a[34:35],v6,17408
MF v[88:91],a[120:123],a[68:71],v[88:91]
MF v[92:95],a[124:127],a[68:71],v[92:95]
RD a[4:7],v4,2048
MF v[96:99],a[96:99],a[72:75],v[96:99]
MF v[100:103],a[100:103],a[72:75],v[100:103]
TR a[36:37],v7,16384
MF v[104:107],a[104:107],a[72:75],v[104:107]
MF v[108:111],a[108:111],a[72:75],v[108:111]
TR a[38:39],v7,17408
MF v[112:115],a[112:115],a[72:75],v[112:115]
MF v[116:119],a[116:119],a[72:75],v[116:119]
RD a[8:11],v4,4096
MF v[120:123],a[120:123],a[72:75],v[120:123]
buffer_load_dwordx4 a[228:231],v0,s[28:31],0 offen offset:128 nt
MF v[124:127],a[124:127],a[72:75],v[124:127]
TR a[40:41],v8,16384
MF v[128:131],a[96:99],a[76:79],v[128:131]
MF v[132:135],a[100:103],a[76:79],v[132:135]
MF v[136:139],a[104:107],a[76:79],v[136:139]
TR a[42:43],v8,17408
MF v[140:143],a[108:111],a[76:79],v[140:143]
MF v[144:147],a[112:115],a[76:79],v[144:147]
RD a[12:15],v4,6144
MF v[148:151],a[116:119],a[76:79],v[148:151]
MF v[152:155],a[120:123],a[76:79],v[152:155]
TR a[44:45],v9,16384
MF v[156:159],a[124:127],a[76:79],v[156:159]
MF v[160:163],a[96:99],a[80:83],v[160:163]
TR a[46:47],v9,17408
MF v[164:167],a[100:103],a[80:83],v[164:167]
MF v[168:171],a[104:107],a[80:83],v[168:171]
RD a[16:19],v4,8192
MF v[172:175],a[108:111],a[80:83],v[172:175]
MF v[176:179],a[112:115],a[80:83],v[176:179]
TR a[48:49],v10,16384
buffer_load_dwordx4 a[232:235],v0,s[28:31],0 offen offset:256 nt
MF v[180:183],a[116:119],a[80:83],v[180:183]
MF v[184:187],a[120:123],a[80:83],v[184:187]
TR a[50:51],v10,17408
MF v[188:191],a[124:127],a[80:83],v[188:191]
MF v[192:195],a[96:99],a[84:87],v[192:195]
RD a[20:23],v4,10240
MF v[196:199],a[100:103],a[84:87],v[196:199]
MF v[200:203],a[104:107],a[84:87],v[200:203]
MF v[204:207],a[108:111],a[84:87],v[204:207]
TR a[52:53],v11,16384
MF v[208:211],a[112:115],a[84:87],v[208:211]
MF v[212:215],a[116:119],a[84:87],v[212:215]
TR a[54:55],v11,17408
MF v[216:219],a[120:123],a[84:87],v[216:219]
MF v[220:223],a[124:127],a[84:87],v[220:223]
RD a[24:27],v4,12288
MF v[224:227],a[96:99],a[88:91],v[224:227]
MF v[228:231],a[100:103],a[88:91],v[228:231]
TR a[56:57],v12,16384
MF v[232:235],a[104:107],a[88:91],v[232:235]
buffer_load_dwordx4 a[236:239],v0,s[28:31],0 offen offset:384 nt
MF v[236:239],a[108:111],a[88:91],v[236:239]
TR a[58:59],v12,17408
MF v[240:243],a[112:115],a[88:91],v[240:243]
MF v[244:247],a[116:119],a[88:91],v[244:247]
RD a[28:31],v4,14336
MF v[248:251],a[120:123],a[88:91],v[248:251]
MF v[252:255],a[124:127],a[88:91],v[252:255]
TR a[60:61],v13,16384
MF a[192:195],a[96:99],a[92:95],a[192:195]
MF a[196:199],a[100:103],a[92:95],a[196:199]
TR a[62:63],v13,17408
MF a[200:203],a[104:107],a[92:95],a[200:203]
MF a[204:207],a[108:111],a[92:95],a[204:207]
MF a[208:211],a[112:115],a[92:95],a[208:211]
MF a[212:215],a[116:119],a[92:95],a[212:215]
MF a[216:219],a[120:123],a[92:95],a[216:219]
MF a[220:223],a[124:127],a[92:95],a[220:223]
LW 15
MF v[32:35],a[32:35],a[0:3],v[32:35]
MF v[36:39],a[36:39],a[0:3],v[36:39]
MF v[40:43],a[40:43],a[0:3],v[40:43]
LW 12
MF v[44:47],a[44:47],a[0:3],v[44:47]
LW 9
MF v[48:51],a[48:51],a[0:3],v[48:51]
LW 6
MF v[52:55],a[52:55],a[0:3],v[52:55]
LW 3
MF v[56:59],a[56:59],a[0:3],v[56:59]
LW 0
MF v[60:63],a[60:63],a[0:3],v[60:63]
s_waitcnt vmcnt(9)
MF v[64:67],a[32:35],a[4:7],v[64:67]
s_barrier
MF v[68:71],a[36:39],a[4:7],v[68:71]
s_mov_b32 s12,s78
s_mov_b32 s13,s79
v_add_u32 v3,0,v5
MF v[72:75],a[40:43],a[4:7],v[72:75]
s_mov_b32 s14,0x510000
s_mov_b32 s15,0x20000
s_lshl_b32 s44,s32,12
MF v[76:79],a[44:47],a[4:7],v[76:79]
s_mul_i32 s45,s32,9216
s_add_u32 s45,s45,16384
s_lshr_b32 s40,s32,1
MF v[80:83],a[48:51],a[4:7],v[80:83]
s_mul_i32 s40,s40,294912
s_and_b32 s41,s32,1
s_mul_i32 s41,s41,4608
MF v[84:87],a[52:55],a[4:7],v[84:87]
s_add_u32 s40,s40,s41
s_mul_i32 s41,s34,288
s_add_u32 s46,s40,s41
MF v[88:91],a[56:59],a[4:7],v[88:91]
s_mov_b32 s47,0
s_mov_b32 s48,53248
s_mov_b32 s49,53248
MF v[92:95],a[60:63],a[4:7],v[92:95]
s_add_u32 m0,s44,s48
v_xor_b32 v4,64,v3
MF v[96:99],a[32:35],a[8:11],v[96:99]
buffer_load_dwordx4 v25,s[8:11],s47 offen sc1 lds
RD a[64:67],v3,0
MF v[100:103],a[36:39],a[8:11],v[100:103]
buffer_load_dwordx4 v25,s[8:11],s47 offen offset:1024 sc1 lds
TR a[96:97],v6,32768
MF v[104:107],a[40:43],a[8:11],v[104:107]
TR a[98:99],v6,33792
MF v[108:111],a[44:47],a[8:11],v[108:111]
RD a[68:71],v3,2048
MF v[112:115],a[48:51],a[8:11],v[112:115]
buffer_load_dwordx4 v26,s[8:11],s47 offen offset:2048 sc1 lds
TR a[100:101],v7,32768
MF v[116:119],a[52:55],a[8:11],v[116:119]
MF v[120:123],a[56:59],a[8:11],v[120:123]
TR a[102:103],v7,33792
MF v[124:127],a[60:63],a[8:11],v[124:127]
MF v[128:131],a[32:35],a[12:15],v[128:131]
buffer_load_dwordx4 v26,s[8:11],s47 offen offset:3072 sc1 lds
RD a[72:75],v3,4096
MF v[132:135],a[36:39],a[12:15],v[132:135]
s_add_u32 s47,s47,2048
MF v[136:139],a[40:43],a[12:15],v[136:139]
TR a[104:105],v8,32768
MF v[140:143],a[44:47],a[12:15],v[140:143]
MF v[144:147],a[48:51],a[12:15],v[144:147]
s_add_u32 s43,s45,s48
s_add_u32 m0,s43,0
TR a[106:107],v8,33792
MF v[148:151],a[52:55],a[12:15],v[148:151]
buffer_load_dwordx4 v16,s[12:15],s46 offen lds
MF v[152:155],a[56:59],a[12:15],v[152:155]
RD a[76:79],v3,6144
MF v[156:159],a[60:63],a[12:15],v[156:159]
MF v[160:163],a[32:35],a[16:19],v[160:163]
buffer_load_dwordx4 v17,s[12:15],s46 offen offset:1024 lds
TR a[108:109],v9,32768
MF v[164:167],a[36:39],a[16:19],v[164:167]
MF v[168:171],a[40:43],a[16:19],v[168:171]
TR a[110:111],v9,33792
MF v[172:175],a[44:47],a[16:19],v[172:175]
MF v[176:179],a[48:51],a[16:19],v[176:179]
buffer_load_dwordx4 v18,s[12:15],s46 offen offset:2048 lds
RD a[80:83],v3,8192
MF v[180:183],a[52:55],a[16:19],v[180:183]
MF v[184:187],a[56:59],a[16:19],v[184:187]
TR a[112:113],v10,32768
MF v[188:191],a[60:63],a[16:19],v[188:191]
MF v[192:195],a[32:35],a[20:23],v[192:195]
buffer_load_dwordx4 v19,s[12:15],s46 offen offset:3072 lds
TR a[114:115],v10,33792
MF v[196:199],a[36:39],a[20:23],v[196:199]
MF v[200:203],a[40:43],a[20:23],v[200:203]
RD a[84:87],v3,10240
MF v[204:207],a[44:47],a[20:23],v[204:207]
MF v[208:211],a[48:51],a[20:23],v[208:211]
s_add_u32 m0,s43,4096
TR a[116:117],v11,32768
MF v[212:215],a[52:55],a[20:23],v[212:215]
buffer_load_dwordx4 v20,s[12:15],s46 offen lds
MF v[216:219],a[56:59],a[20:23],v[216:219]
TR a[118:119],v11,33792
MF v[220:223],a[60:63],a[20:23],v[220:223]
MF v[224:227],a[32:35],a[24:27],v[224:227]
buffer_load_dwordx4 v21,s[12:15],s46 offen offset:1024 lds
RD a[88:91],v3,12288
MF v[228:231],a[36:39],a[24:27],v[228:231]
MF v[232:235],a[40:43],a[24:27],v[232:235]
TR a[120:121],v12,32768
MF v[236:239],a[44:47],a[24:27],v[236:239]
MF v[240:243],a[48:51],a[24:27],v[240:243]
buffer_load_dwordx4 v22,s[12:15],s46 offen offset:2048 lds
TR a[122:123],v12,33792
MF v[244:247],a[52:55],a[24:27],v[244:247]
MF v[248:251],a[56:59],a[24:27],v[248:251]
RD a[92:95],v3,14336
MF v[252:255],a[60:63],a[24:27],v[252:255]
MF a[192:195],a[32:35],a[28:31],a[192:195]
buffer_load_dwordx4 v23,s[12:15],s46 offen offset:3072 lds
TR a[124:125],v13,32768
MF a[196:199],a[36:39],a[28:31],a[196:199]
MF a[200:203],a[40:43],a[28:31],a[200:203]
TR a[126:127],v13,33792
MF a[204:207],a[44:47],a[28:31],a[204:207]
MF a[208:211],a[48:51],a[28:31],a[208:211]
s_add_u32 m0,s43,8192
MF a[212:215],a[52:55],a[28:31],a[212:215]
buffer_load_dwordx4 v24,s[12:15],s46 offen lds
s_add_u32 s46,s46,589824
MF a[216:219],a[56:59],a[28:31],a[216:219]
s_add_u32 s48,s48,53248
s_cmp_eq_u32 s48,159744
s_cselect_b32 s48,0,s48
MF a[220:223],a[60:63],a[28:31],a[220:223]
LW 15
MF v[32:35],a[96:99],a[64:67],v[32:35]
MF v[36:39],a[100:103],a[64:67],v[36:39]
MF v[40:43],a[104:107],a[64:67],v[40:43]
LW 12
MF v[44:47],a[108:111],a[64:67],v[44:47]
LW 9
MF v[48:51],a[112:115],a[64:67],v[48:51]
LW 6
MF v[52:55],a[116:119],a[64:67],v[52:55]
LW 3
MF v[56:59],a[120:123],a[64:67],v[56:59]
LW 0
MF v[60:63],a[124:127],a[64:67],v[60:63]
s_waitcnt vmcnt(17)
MF v[64:67],a[96:99],a[68:71],v[64:67]
s_barrier
MF v[68:71],a[100:103],a[68:71],v[68:71]
buffer_load_dwordx4 a[240:243],v0,s[28:31],0 offen offset:512 nt
RD a[24:27],v4,12288
MF v[72:75],a[104:107],a[68:71],v[72:75]
MF v[76:79],a[108:111],a[68:71],v[76:79]
TR a[32:33],v6,49152
MF v[80:83],a[112:115],a[68:71],v[80:83]
MF v[84:87],a[116:119],a[68:71],v[84:87]
TR a[34:35],v6,50176
MF v[88:91],a[120:123],a[68:71],v[88:91]
MF v[92:95],a[124:127],a[68:71],v[92:95]
RD a[28:31],v4,14336
MF v[96:99],a[96:99],a[72:75],v[96:99]
MF v[100:103],a[100:103],a[72:75],v[100:103]
TR a[36:37],v7,49152
MF v[104:107],a[104:107],a[72:75],v[104:107]
MF v[108:111],a[108:111],a[72:75],v[108:111]
TR a[38:39],v7,50176
MF v[112:115],a[112:115],a[72:75],v[112:115]
MF v[116:119],a[116:119],a[72:75],v[116:119]
RD a[20:23],v4,10240
MF v[120:123],a[120:123],a[72:75],v[120:123]
buffer_load_dwordx4 a[244:247],v0,s[28:31],0 offen offset:640 nt
MF v[124:127],a[124:127],a[72:75],v[124:127]
TR a[40:41],v8,49152
MF v[128:131],a[96:99],a[76:79],v[128:131]
MF v[132:135],a[100:103],a[76:79],v[132:135]
MF v[136:139],a[104:107],a[76:79],v[136:139]
TR a[42:43],v8,50176
MF v[140:143],a[108:111],a[76:79],v[140:143]
MF v[144:147],a[112:115],a[76:79],v[144:147]
RD a[16:19],v4,8192
MF v[148:151],a[116:119],a[76:79],v[148:151]
MF v[152:155],a[120:123],a[76:79],v[152:155]
TR a[44:45],v9,49152
MF v[156:159],a[124:127],a[76:79],v[156:159]
MF v[160:163],a[96:99],a[80:83],v[160:163]
TR a[46:47],v9,50176
MF v[164:167],a[100:103],a[80:83],v[164:167]
MF v[168:171],a[104:107],a[80:83],v[168:171]
RD a[4:7],v4,2048
MF v[172:175],a[108:111],a[80:83],v[172:175]
MF v[176:179],a[112:115],a[80:83],v[176:179]
TR a[48:49],v10,49152
buffer_load_dwordx4 a[248:251],v0,s[28:31],0 offen offset:768 nt
MF v[180:183],a[116:119],a[80:83],v[180:183]
MF v[184:187],a[120:123],a[80:83],v[184:187]
TR a[50:51],v10,50176
MF v[188:191],a[124:127],a[80:83],v[188:191]
MF v[192:195],a[96:99],a[84:87],v[192:195]
RD a[0:3],v4,0
MF v[196:199],a[100:103],a[84:87],v[196:199]
MF v[200:203],a[104:107],a[84:87],v[200:203]
MF v[204:207],a[108:111],a[84:87],v[204:207]
TR a[52:53],v11,49152
MF v[208:211],a[112:115],a[84:87],v[208:211]
MF v[212:215],a[116:119],a[84:87],v[212:215]
TR a[54:55],v11,50176
MF v[216:219],a[120:123],a[84:87],v[216:219]
MF v[220:223],a[124:127],a[84:87],v[220:223]
RD a[8:11],v4,4096
MF v[224:227],a[96:99],a[88:91],v[224:227]
MF v[228:231],a[100:103],a[88:91],v[228:231]
TR a[56:57],v12,49152
MF v[232:235],a[104:107],a[88:91],v[232:235]
buffer_load_dwordx4 a[252:255],v0,s[28:31],0 offen offset:896 nt
MF v[236:239],a[108:111],a[88:91],v[236:239]
TR a[58:59],v12,50176
MF v[240:243],a[112:115],a[88:91],v[240:243]
MF v[244:247],a[116:119],a[88:91],v[244:247]
RD a[12:15],v4,6144
MF v[248:251],a[120:123],a[88:91],v[248:251]
MF v[252:255],a[124:127],a[88:91],v[252:255]
TR a[60:61],v13,49152
MF a[192:195],a[96:99],a[92:95],a[192:195]
MF a[196:199],a[100:103],a[92:95],a[196:199]
TR a[62:63],v13,50176
MF a[200:203],a[104:107],a[92:95],a[200:203]
MF a[204:207],a[108:111],a[92:95],a[204:207]
MF a[208:211],a[112:115],a[92:95],a[208:211]
MF a[212:215],a[116:119],a[92:95],a[212:215]
MF a[216:219],a[120:123],a[92:95],a[216:219]
MF a[220:223],a[124:127],a[92:95],a[220:223]
LW 15
MF v[224:227],a[32:35],a[24:27],v[224:227]
s_mov_b32 s66,0x110401c6
MF v[228:231],a[36:39],a[24:27],v[228:231]
s_mov_b32 s67,0x100c24d2
MF v[232:235],a[40:43],a[24:27],v[232:235]
LW 12
s_mov_b32 s70,0x30867826
MF v[236:239],a[44:47],a[24:27],v[236:239]
LW 9
s_mov_b32 s71,0x36cb5c74
MF v[240:243],a[48:51],a[24:27],v[240:243]
LW 6
s_mov_b32 s72,0x22964df3
MF v[244:247],a[52:55],a[24:27],v[244:247]
LW 3
s_mov_b32 s73,0x15505123
MF v[248:251],a[56:59],a[24:27],v[248:251]
LW 0
CV v224,v224,v225
CV v225,v226,v227
MF v[252:255],a[60:63],a[24:27],v[252:255]
s_waitcnt vmcnt(21)
CV v226,v228,v229
CV v227,v230,v231
MF a[192:195],a[32:35],a[28:31],a[192:195]
s_barrier
CV v232,v232,v233
s_mov_b32 s76,0x5d6
MF a[196:199],a[36:39],a[28:31],a[196:199]
s_add_u32 m0,s44,s48
CV v233,v234,v235
CV v234,v236,v237
MF a[200:203],a[40:43],a[28:31],a[200:203]
buffer_load_dwordx4 v25,s[8:11],s47 offen sc1 lds
CV v235,v238,v239
MF a[204:207],a[44:47],a[28:31],a[204:207]
CV v240,v240,v241
CV v241,v242,v243
MF a[208:211],a[48:51],a[28:31],a[208:211]
CV v242,v244,v245
CV v243,v246,v247
MF a[212:215],a[52:55],a[28:31],a[212:215]
CV v248,v248,v249
CV v249,v250,v251
MF a[216:219],a[56:59],a[28:31],a[216:219]
CV v250,v252,v253
CV v251,v254,v255
MF a[220:223],a[60:63],a[28:31],a[220:223]
buffer_load_dwordx4 v25,s[8:11],s47 offen offset:1024 sc1 lds
AR v6,a192
MF v[192:195],a[32:35],a[20:23],v[192:195]
AR v7,a193
AR v8,a194
MF v[196:199],a[36:39],a[20:23],v[196:199]
AR v9,a195
AR v10,a196
MF v[200:203],a[40:43],a[20:23],v[200:203]
AR v11,a197
AR v12,a198
MF v[204:207],a[44:47],a[20:23],v[204:207]
AR v13,a199
CV v228,v6,v7
MF v[208:211],a[48:51],a[20:23],v[208:211]
CV v229,v8,v9
CV v230,v10,v11
MF v[212:215],a[52:55],a[20:23],v[212:215]
CV v231,v12,v13
AR v6,a200
MF v[216:219],a[56:59],a[20:23],v[216:219]
AR v7,a201
AR v8,a202
MF v[220:223],a[60:63],a[20:23],v[220:223]
AR v9,a203
AR v10,a204
MF v[160:163],a[32:35],a[16:19],v[160:163]
AR v11,a205
AR v12,a206
MF v[164:167],a[36:39],a[16:19],v[164:167]
AR v13,a207
CV v236,v6,v7
MF v[168:171],a[40:43],a[16:19],v[168:171]
CV v237,v8,v9
CV v238,v10,v11
MF v[172:175],a[44:47],a[16:19],v[172:175]
buffer_load_dwordx4 v26,s[8:11],s47 offen offset:2048 sc1 lds
CV v239,v12,v13
MF v[176:179],a[48:51],a[16:19],v[176:179]
AR v6,a208
AR v7,a209
MF v[180:183],a[52:55],a[16:19],v[180:183]
AR v8,a210
AR v9,a211
MF v[184:187],a[56:59],a[16:19],v[184:187]
AR v10,a212
AR v11,a213
MF v[188:191],a[60:63],a[16:19],v[188:191]
AR v12,a214
AR v13,a215
MF v[64:67],a[32:35],a[4:7],v[64:67]
CV v244,v6,v7
CV v245,v8,v9
MF v[68:71],a[36:39],a[4:7],v[68:71]
CV v246,v10,v11
CV v247,v12,v13
MF v[72:75],a[40:43],a[4:7],v[72:75]
AR v6,a216
AR v7,a217
MF v[76:79],a[44:47],a[4:7],v[76:79]
AR v8,a218
AR v9,a219
MF v[80:83],a[48:51],a[4:7],v[80:83]
AR v10,a220
AR v11,a221
MF v[84:87],a[52:55],a[4:7],v[84:87]
AR v12,a222
AR v13,a223
MF v[88:91],a[56:59],a[4:7],v[88:91]
CV v252,v6,v7
CV v253,v8,v9
MF v[92:95],a[60:63],a[4:7],v[92:95]
CV v254,v10,v11
CV v255,v12,v13
MF v[32:35],a[32:35],a[0:3],v[32:35]
buffer_load_dwordx4 v26,s[8:11],s47 offen offset:3072 sc1 lds
s_add_u32 s47,s47,2048
MF v[36:39],a[36:39],a[0:3],v[36:39]
s_add_u32 s43,s45,s48
CV v192,v192,v193
CV v193,v194,v195
MF v[40:43],a[40:43],a[0:3],v[40:43]
s_add_u32 m0,s43,0
CV v194,v196,v197
CV v195,v198,v199
MF v[44:47],a[44:47],a[0:3],v[44:47]
AW a104,v192
AW a105,v193
MF v[48:51],a[48:51],a[0:3],v[48:51]
AW a106,v194
AW a107,v195
MF v[52:55],a[52:55],a[0:3],v[52:55]
CV v200,v200,v201
CV v201,v202,v203
MF v[56:59],a[56:59],a[0:3],v[56:59]
CV v202,v204,v205
CV v203,v206,v207
MF v[60:63],a[60:63],a[0:3],v[60:63]
AW a108,v200
AW a109,v201
MF v[96:99],a[32:35],a[8:11],v[96:99]
AW a110,v202
AW a111,v203
MF v[100:103],a[36:39],a[8:11],v[100:103]
buffer_load_dwordx4 v16,s[12:15],s46 offen lds
CV v208,v208,v209
MF v[104:107],a[40:43],a[8:11],v[104:107]
CV v209,v210,v211
CV v210,v212,v213
MF v[108:111],a[44:47],a[8:11],v[108:111]
CV v211,v214,v215
CV v216,v216,v217
MF v[112:115],a[48:51],a[8:11],v[112:115]
CV v217,v218,v219
CV v218,v220,v221
MF v[116:119],a[52:55],a[8:11],v[116:119]
CV v219,v222,v223
CV v212,v160,v161
MF v[120:123],a[56:59],a[8:11],v[120:123]
CV v213,v162,v163
CV v214,v164,v165
MF v[124:127],a[60:63],a[8:11],v[124:127]
buffer_load_dwordx4 v17,s[12:15],s46 offen offset:1024 lds
CV v215,v166,v167
MF v[128:131],a[32:35],a[12:15],v[128:131]
CV v220,v168,v169
CV v221,v170,v171
MF v[132:135],a[36:39],a[12:15],v[132:135]
CV v222,v172,v173
CV v223,v174,v175
MF v[136:139],a[40:43],a[12:15],v[136:139]
CV v176,v176,v177
CV v177,v178,v179
MF v[140:143],a[44:47],a[12:15],v[140:143]
CV v178,v180,v181
CV v179,v182,v183
MF v[144:147],a[48:51],a[12:15],v[144:147]
AW a112,v176
AW a113,v177
MF v[148:151],a[52:55],a[12:15],v[148:151]
AW a114,v178
AW a115,v179
MF v[152:155],a[56:59],a[12:15],v[152:155]
buffer_load_dwordx4 v18,s[12:15],s46 offen offset:2048 lds
CV v184,v184,v185
MF v[156:159],a[60:63],a[12:15],v[156:159]
buffer_load_dwordx4 v19,s[12:15],s46 offen offset:3072 lds
s_add_u32 m0,s43,4096
s_nop 0
buffer_load_dwordx4 v20,s[12:15],s46 offen lds
buffer_load_dwordx4 v21,s[12:15],s46 offen offset:1024 lds
buffer_load_dwordx4 v22,s[12:15],s46 offen offset:2048 lds
buffer_load_dwordx4 v23,s[12:15],s46 offen offset:3072 lds
s_add_u32 m0,s43,8192
s_nop 0
buffer_load_dwordx4 v24,s[12:15],s46 offen lds
s_add_u32 s46,s46,589824
s_add_u32 s48,s48,53248
s_cmp_eq_u32 s48,159744
s_cselect_b32 s48,0,s48
CV v185,v186,v187
CV v186,v188,v189
CV v187,v190,v191
AW a116,v184
AW a117,v185
AW a118,v186
AW a119,v187
CV v64,v64,v65
CV v65,v66,v67
CV v66,v68,v69
CV v67,v70,v71
AW a120,v64
AW a121,v65
AW a122,v66
AW a123,v67
CV v72,v72,v73
CV v73,v74,v75
CV v74,v76,v77
CV v75,v78,v79
AW a124,v72
AW a125,v73
AW a126,v74
AW a127,v75
CV v80,v80,v81
CV v81,v82,v83
CV v82,v84,v85
CV v83,v86,v87
AW a128,v80
AW a129,v81
AW a130,v82
AW a131,v83
CV v88,v88,v89
CV v89,v90,v91
CV v90,v92,v93
CV v91,v94,v95
AW a132,v88
AW a133,v89
AW a134,v90
AW a135,v91
CV v32,v32,v33
CV v33,v34,v35
CV v34,v36,v37
CV v35,v38,v39
AW a136,v32
AW a137,v33
AW a138,v34
AW a139,v35
CV v40,v40,v41
CV v41,v42,v43
CV v42,v44,v45
CV v43,v46,v47
AW a144,v40
AW a145,v41
AW a146,v42
AW a147,v43
CV v55,v54,v55
CV v54,v52,v53
CV v52,v48,v49
CV v53,v50,v51
CV v56,v56,v57
CV v57,v58,v59
CV v58,v60,v61
CV v59,v62,v63
CV v60,v96,v97
CV v61,v98,v99
CV v62,v100,v101
CV v63,v102,v103
CV v104,v104,v105
CV v105,v106,v107
CV v106,v108,v109
CV v107,v110,v111
AW a148,v104
AW a149,v105
AW a150,v106
AW a151,v107
CV v112,v112,v113
CV v113,v114,v115
CV v114,v116,v117
CV v115,v118,v119
AW a152,v112
AW a153,v113
AW a154,v114
AW a155,v115
CV v120,v120,v121
CV v121,v122,v123
CV v122,v124,v125
CV v123,v126,v127
AW a156,v120
AW a157,v121
AW a158,v122
AW a159,v123
CV v128,v128,v129
CV v129,v130,v131
CV v130,v132,v133
CV v131,v134,v135
AW a192,v128
AW a193,v129
AW a194,v130
AW a195,v131
CV v136,v136,v137
CV v137,v138,v139
CV v138,v140,v141
CV v139,v142,v143
AW a196,v136
AW a197,v137
AW a198,v138
AW a199,v139
CV v144,v144,v145
CV v145,v146,v147
CV v146,v148,v149
CV v147,v150,v151
AW a200,v144
AW a201,v145
AW a202,v146
AW a203,v147
CV v152,v152,v153
CV v153,v154,v155
CV v154,v156,v157
CV v155,v158,v159
AW a204,v152
AW a205,v153
AW a206,v154
AW a207,v155
s_branch Lm_z
Lm_kvV:
LW 15
MF v[32:35],a[64:67],a[96:99],0
MF v[36:39],a[64:67],a[100:103],0
MF v[40:43],a[64:67],a[104:107],0
LW 12
MF v[44:47],a[64:67],a[108:111],0
LW 9
MF v[48:51],a[64:67],a[112:115],0
LW 6
MF v[52:55],a[64:67],a[116:119],0
LW 3
MF v[56:59],a[64:67],a[120:123],0
LW 0
MF v[60:63],a[64:67],a[124:127],0
s_waitcnt vmcnt(12)
MF v[64:67],a[68:71],a[96:99],0
s_barrier
MF v[68:71],a[68:71],a[100:103],0
s_add_u32 m0,s49,49152
s_mov_b32 s47,786432
RD a[0:3],v4,0
MF v[72:75],a[68:71],a[104:107],0
buffer_load_dwordx4 v15,s[16:19],s47 offen lds
MF v[76:79],a[68:71],a[108:111],0
TR a[32:33],v6,16384
MF v[80:83],a[68:71],a[112:115],0
s_mov_b32 s47,818176
buffer_load_dwordx4 v15,s[16:19],s47 offen offset:1024 lds
MF v[84:87],a[68:71],a[116:119],0
TR a[34:35],v6,17408
MF v[88:91],a[68:71],a[120:123],0
MF v[92:95],a[68:71],a[124:127],0
s_mov_b32 s47,915456
buffer_load_dwordx4 v15,s[16:19],s47 offen offset:2048 lds
RD a[4:7],v4,2048
MF v[96:99],a[72:75],a[96:99],0
MF v[100:103],a[72:75],a[100:103],0
TR a[36:37],v7,16384
MF v[104:107],a[72:75],a[104:107],0
MF v[108:111],a[72:75],a[108:111],0
s_mov_b32 s47,947200
TR a[38:39],v7,17408
buffer_load_dwordx4 v15,s[16:19],s47 offen offset:3072 lds
MF v[112:115],a[72:75],a[112:115],0
MF v[116:119],a[72:75],a[116:119],0
RD a[8:11],v4,4096
MF v[120:123],a[72:75],a[120:123],0
s_add_u32 m0,s48,32768
s_mov_b32 s46,256
buffer_load_dwordx4 v14,s[12:15],s46 offen lds
MF v[124:127],a[72:75],a[124:127],0
TR a[40:41],v8,16384
MF v[128:131],a[76:79],a[96:99],0
MF v[132:135],a[76:79],a[100:103],0
MF v[136:139],a[76:79],a[104:107],0
s_mov_b32 s46,14592
buffer_load_dwordx4 v14,s[12:15],s46 offen offset:2048 lds
TR a[42:43],v8,17408
MF v[140:143],a[76:79],a[108:111],0
MF v[144:147],a[76:79],a[112:115],0
RD a[12:15],v4,6144
MF v[148:151],a[76:79],a[116:119],0
s_add_u32 m0,s48,36864
s_mov_b32 s46,33024
buffer_load_dwordx4 v14,s[12:15],s46 offen lds
MF v[152:155],a[76:79],a[120:123],0
TR a[44:45],v9,16384
MF v[156:159],a[76:79],a[124:127],0
MF v[160:163],a[80:83],a[96:99],0
TR a[46:47],v9,17408
MF v[164:167],a[80:83],a[100:103],0
s_mov_b32 s46,47360
buffer_load_dwordx4 v14,s[12:15],s46 offen offset:2048 lds
MF v[168:171],a[80:83],a[104:107],0
RD a[16:19],v4,8192
MF v[172:175],a[80:83],a[108:111],0
MF v[176:179],a[80:83],a[112:115],0
s_add_u32 m0,s48,40960
s_mov_b32 s46,65792
buffer_load_dwordx4 v14,s[12:15],s46 offen lds
MF v[180:183],a[80:83],a[116:119],0
TR a[48:49],v10,16384
MF v[184:187],a[80:83],a[120:123],0
TR a[50:51],v10,17408
MF v[188:191],a[80:83],a[124:127],0
s_mov_b32 s46,80128
buffer_load_dwordx4 v14,s[12:15],s46 offen offset:2048 lds
MF v[192:195],a[84:87],a[96:99],0
RD a[20:23],v4,10240
MF v[196:199],a[84:87],a[100:103],0
MF v[200:203],a[84:87],a[104:107],0
MF v[204:207],a[84:87],a[108:111],0
s_add_u32 m0,s48,45056
s_mov_b32 s46,98560
TR a[52:53],v11,16384
MF v[208:211],a[84:87],a[112:115],0
buffer_load_dwordx4 v14,s[12:15],s46 offen lds
MF v[212:215],a[84:87],a[116:119],0
TR a[54:55],v11,17408
MF v[216:219],a[84:87],a[120:123],0
s_mov_b32 s46,112896
buffer_load_dwordx4 v14,s[12:15],s46 offen offset:2048 lds
MF v[220:223],a[84:87],a[124:127],0
RD a[24:27],v4,12288
MF v[224:227],a[88:91],a[96:99],0
MF v[228:231],a[88:91],a[100:103],0
TR a[56:57],v12,16384
MF v[232:235],a[88:91],a[104:107],0
s_add_u32 m0,s49,0
s_mov_b32 s47,1048576
buffer_load_dwordx4 v15,s[16:19],s47 offen lds
MF v[236:239],a[88:91],a[108:111],0
TR a[58:59],v12,17408
MF v[240:243],a[88:91],a[112:115],0
MF v[244:247],a[88:91],a[116:119],0
s_mov_b32 s47,1080320
buffer_load_dwordx4 v15,s[16:19],s47 offen offset:1024 lds
RD a[28:31],v4,14336
MF v[248:251],a[88:91],a[120:123],0
MF v[252:255],a[88:91],a[124:127],0
TR a[60:61],v13,16384
MF a[192:195],a[92:95],a[96:99],0
MF a[196:199],a[92:95],a[100:103],0
s_mov_b32 s47,1177600
TR a[62:63],v13,17408
buffer_load_dwordx4 v15,s[16:19],s47 offen offset:2048 lds
MF a[200:203],a[92:95],a[104:107],0
MF a[204:207],a[92:95],a[108:111],0
MF a[208:211],a[92:95],a[112:115],0
s_mov_b32 s47,1209344
buffer_load_dwordx4 v15,s[16:19],s47 offen offset:3072 lds
MF a[212:215],a[92:95],a[116:119],0
MF a[216:219],a[92:95],a[120:123],0
MF a[220:223],a[92:95],a[124:127],0
LW 15
MF v[32:35],a[0:3],a[32:35],v[32:35]
s_lshr_b32 s41,s2,1
s_mul_i32 s41,s41,18432
MF v[36:39],a[0:3],a[36:39],v[36:39]
v_lshrrev_b32 v18,2,v17
MF v[40:43],a[0:3],a[40:43],v[40:43]
LW 12
v_lshlrev_b32 v18,10,v18
MF v[44:47],a[0:3],a[44:47],v[44:47]
LW 9
v_lshrrev_b32 v19,2,v16
MF v[48:51],a[0:3],a[48:51],v[48:51]
LW 6
v_sub_u32 v19,0,v19
MF v[52:55],a[0:3],a[52:55],v[52:55]
LW 3
v_xor_b32 v19,v19,v17
MF v[56:59],a[0:3],a[56:59],v[56:59]
LW 0
v_and_b32 v19,3,v19
MF v[60:63],a[0:3],a[60:63],v[60:63]
s_waitcnt vmcnt(16)
v_lshlrev_b32 v19,4,v19
v_add3_u32 v18,v18,v19,s41
MF v[64:67],a[4:7],a[32:35],v[64:67]
s_barrier
v_lshl_add_u32 v18,v16,6,v18
MF v[68:71],a[4:7],a[36:39],v[68:71]
s_add_u32 m0,s49,16384
s_mov_b32 s47,1310720
v_add_u32 v3,0,v5
MF v[72:75],a[4:7],a[40:43],v[72:75]
buffer_load_dwordx4 v15,s[16:19],s47 offen lds
v_cndmask_b32 v19,v20,v18,s[44:45]
MF v[76:79],a[4:7],a[44:47],v[76:79]
v_xor_b32 v4,64,v3
AR v22,a128
MF v[80:83],a[4:7],a[48:51],v[80:83]
v_lshlrev_b32 v21,16,v22
v_and_b32 v22,0xffff0000,v22
MF v[84:87],a[4:7],a[52:55],v[84:87]
RD a[64:67],v3,0
v_add_f32 v16,v21,v22
MF v[88:91],a[4:7],a[56:59],v[88:91]
TR a[96:97],v6,32768
AR v22,a129
MF v[92:95],a[4:7],a[60:63],v[92:95]
s_mov_b32 s47,1342464
buffer_load_dwordx4 v15,s[16:19],s47 offen offset:1024 lds
v_lshlrev_b32 v21,16,v22
MF v[96:99],a[8:11],a[32:35],v[96:99]
v_and_b32 v22,0xffff0000,v22
v_add_f32 v16,v16,v21
MF v[100:103],a[8:11],a[36:39],v[100:103]
TR a[98:99],v6,33792
v_add_f32 v16,v16,v22
MF v[104:107],a[8:11],a[40:43],v[104:107]
RD a[68:71],v3,2048
AR v22,a130
MF v[108:111],a[8:11],a[44:47],v[108:111]
v_lshlrev_b32 v21,16,v22
MF v[112:115],a[8:11],a[48:51],v[112:115]
TR a[100:101],v7,32768
v_and_b32 v22,0xffff0000,v22
MF v[116:119],a[8:11],a[52:55],v[116:119]
v_add_f32 v16,v16,v21
MF v[120:123],a[8:11],a[56:59],v[120:123]
s_mov_b32 s47,1439744
TR a[102:103],v7,33792
v_add_f32 v16,v16,v22
MF v[124:127],a[8:11],a[60:63],v[124:127]
buffer_load_dwordx4 v15,s[16:19],s47 offen offset:2048 lds
AR v22,a131
MF v[128:131],a[12:15],a[32:35],v[128:131]
RD a[72:75],v3,4096
v_lshlrev_b32 v21,16,v22
MF v[132:135],a[12:15],a[36:39],v[132:135]
v_and_b32 v22,0xffff0000,v22
v_add_f32 v16,v16,v21
MF v[136:139],a[12:15],a[40:43],v[136:139]
TR a[104:105],v8,32768
v_add_f32 v16,v16,v22
MF v[140:143],a[12:15],a[44:47],v[140:143]
AR v22,a132
MF v[144:147],a[12:15],a[48:51],v[144:147]
TR a[106:107],v8,33792
v_lshlrev_b32 v21,16,v22
MF v[148:151],a[12:15],a[52:55],v[148:151]
s_mov_b32 s47,1471488
buffer_load_dwordx4 v15,s[16:19],s47 offen offset:3072 lds
v_and_b32 v22,0xffff0000,v22
MF v[152:155],a[12:15],a[56:59],v[152:155]
RD a[76:79],v3,6144
v_add_f32 v16,v16,v21
MF v[156:159],a[12:15],a[60:63],v[156:159]
v_add_f32 v16,v16,v22
AR v22,a133
MF v[160:163],a[16:19],a[32:35],v[160:163]
TR a[108:109],v9,32768
v_lshlrev_b32 v21,16,v22
MF v[164:167],a[16:19],a[36:39],v[164:167]
v_and_b32 v22,0xffff0000,v22
MF v[168:171],a[16:19],a[40:43],v[168:171]
TR a[110:111],v9,33792
v_add_f32 v16,v16,v21
MF v[172:175],a[16:19],a[44:47],v[172:175]
v_add_f32 v16,v16,v22
MF v[176:179],a[16:19],a[48:51],v[176:179]
s_add_u32 m0,s48,65536
RD a[80:83],v3,8192
AR v22,a134
MF v[180:183],a[16:19],a[52:55],v[180:183]
s_mov_b32 s46,384
buffer_load_dwordx4 v14,s[12:15],s46 offen lds
v_lshlrev_b32 v21,16,v22
MF v[184:187],a[16:19],a[56:59],v[184:187]
TR a[112:113],v10,32768
v_and_b32 v22,0xffff0000,v22
MF v[188:191],a[16:19],a[60:63],v[188:191]
v_add_f32 v16,v16,v21
v_add_f32 v16,v16,v22
MF v[192:195],a[20:23],a[32:35],v[192:195]
TR a[114:115],v10,33792
AR v22,a135
MF v[196:199],a[20:23],a[36:39],v[196:199]
v_lshlrev_b32 v21,16,v22
MF v[200:203],a[20:23],a[40:43],v[200:203]
RD a[84:87],v3,10240
v_and_b32 v22,0xffff0000,v22
MF v[204:207],a[20:23],a[44:47],v[204:207]
s_mov_b32 s46,14720
buffer_load_dwordx4 v14,s[12:15],s46 offen offset:2048 lds
v_add_f32 v16,v16,v21
MF v[208:211],a[20:23],a[48:51],v[208:211]
TR a[116:117],v11,32768
v_add_f32 v16,v16,v22
MF v[212:215],a[20:23],a[52:55],v[212:215]
AR v22,a136
MF v[216:219],a[20:23],a[56:59],v[216:219]
TR a[118:119],v11,33792
v_lshlrev_b32 v21,16,v22
MF v[220:223],a[20:23],a[60:63],v[220:223]
v_and_b32 v22,0xffff0000,v22
v_add_f32 v16,v16,v21
MF v[224:227],a[24:27],a[32:35],v[224:227]
RD a[88:91],v3,12288
v_add_f32 v16,v16,v22
MF v[228:231],a[24:27],a[36:39],v[228:231]
AR v22,a137
MF v[232:235],a[24:27],a[40:43],v[232:235]
s_add_u32 m0,s48,69632
s_mov_b32 s46,33152
TR a[120:121],v12,32768
MF v[236:239],a[24:27],a[44:47],v[236:239]
buffer_load_dwordx4 v14,s[12:15],s46 offen lds
v_lshlrev_b32 v21,16,v22
MF v[240:243],a[24:27],a[48:51],v[240:243]
TR a[122:123],v12,33792
v_and_b32 v22,0xffff0000,v22
MF v[244:247],a[24:27],a[52:55],v[244:247]
v_add_f32 v16,v16,v21
v_add_f32 v16,v16,v22
MF v[248:251],a[24:27],a[56:59],v[248:251]
RD a[92:95],v3,14336
AR v22,a138
MF v[252:255],a[24:27],a[60:63],v[252:255]
v_lshlrev_b32 v21,16,v22
v_and_b32 v22,0xffff0000,v22
MF a[192:195],a[28:31],a[32:35],a[192:195]
TR a[124:125],v13,32768
v_add_f32 v16,v16,v21
MF a[196:199],a[28:31],a[36:39],a[196:199]
s_mov_b32 s46,47488
buffer_load_dwordx4 v14,s[12:15],s46 offen offset:2048 lds
v_add_f32 v16,v16,v22
MF a[200:203],a[28:31],a[40:43],a[200:203]
TR a[126:127],v13,33792
AR v22,a139
MF a[204:207],a[28:31],a[44:47],a[204:207]
v_lshlrev_b32 v21,16,v22
MF a[208:211],a[28:31],a[48:51],a[208:211]
v_and_b32 v22,0xffff0000,v22
MF a[212:215],a[28:31],a[52:55],a[212:215]
v_add_f32 v16,v16,v21
MF a[216:219],a[28:31],a[56:59],a[216:219]
MF a[220:223],a[28:31],a[60:63],a[220:223]
LW 15
MF v[32:35],a[64:67],a[96:99],v[32:35]
v_add_f32 v16,v16,v22
MF v[36:39],a[64:67],a[100:103],v[36:39]
s_nop 1
MF v[40:43],a[64:67],a[104:107],v[40:43]
LW 12
v_add_f32_dpp v16,v16,v16 row_ror:8 row_mask:0xf bank_mask:0xf
MF v[44:47],a[64:67],a[108:111],v[44:47]
LW 9
s_nop 1
MF v[48:51],a[64:67],a[112:115],v[48:51]
LW 6
v_add_f32_dpp v16,v16,v16 row_ror:4 row_mask:0xf bank_mask:0xf
MF v[52:55],a[64:67],a[116:119],v[52:55]
LW 3
s_nop 1
MF v[56:59],a[64:67],a[120:123],v[56:59]
LW 0
v_add_f32_dpp v16,v16,v16 row_ror:2 row_mask:0xf bank_mask:0xf
MF v[60:63],a[64:67],a[124:127],v[60:63]
s_waitcnt vmcnt(20)
s_nop 1
MF v[64:67],a[68:71],a[96:99],v[64:67]
s_barrier
v_add_f32_dpp v16,v16,v16 row_ror:1 row_mask:0xf bank_mask:0xf
v_mov_b32 v17,v16
MF v[68:71],a[68:71],a[100:103],v[68:71]
s_nop 1
RD a[0:3],v4,0
MF v[72:75],a[68:71],a[104:107],v[72:75]
s_add_u32 m0,s49,32768
s_mov_b32 s47,1572864
buffer_load_dwordx4 v15,s[16:19],s47 offen lds
MF v[76:79],a[68:71],a[108:111],v[76:79]
TR a[32:33],v6,49152
v_permlane16_swap_b32 v16,v17
MF v[80:83],a[68:71],a[112:115],v[80:83]
s_nop 1
v_add_f32 v16,v16,v17
MF v[84:87],a[68:71],a[116:119],v[84:87]
TR a[34:35],v6,50176
v_mul_f32 v16,0x3ae38e39,v16
MF v[88:91],a[68:71],a[120:123],v[88:91]
v_mov_b32 v17,0
v_mov_b32 v20,0
MF v[92:95],a[68:71],a[124:127],v[92:95]
s_mov_b32 s47,1604608
buffer_load_dwordx4 v15,s[16:19],s47 offen offset:1024 lds
AR v22,a128
MF v[96:99],a[72:75],a[96:99],v[96:99]
RD a[4:7],v4,2048
v_lshlrev_b32 v21,16,v22
MF v[100:103],a[72:75],a[100:103],v[100:103]
TR a[36:37],v7,49152
v_and_b32 v22,0xffff0000,v22
MF v[104:107],a[72:75],a[104:107],v[104:107]
v_sub_f32 v21,v21,v16
v_sub_f32 v22,v22,v16
MF v[108:111],a[72:75],a[108:111],v[108:111]
TR a[38:39],v7,50176
v_fmac_f32 v17,v21,v21
MF v[112:115],a[72:75],a[112:115],v[112:115]
v_fmac_f32 v17,v22,v22
MF v[116:119],a[72:75],a[116:119],v[116:119]
s_mov_b32 s47,1701888
buffer_load_dwordx4 v15,s[16:19],s47 offen offset:2048 lds
AR v22,a129
MF v[120:123],a[72:75],a[120:123],v[120:123]
RD a[8:11],v4,4096
v_lshlrev_b32 v21,16,v22
MF v[124:127],a[72:75],a[124:127],v[124:127]
TR a[40:41],v8,49152
v_and_b32 v22,0xffff0000,v22
MF v[128:131],a[76:79],a[96:99],v[128:131]
v_sub_f32 v21,v21,v16
v_sub_f32 v22,v22,v16
MF v[132:135],a[76:79],a[100:103],v[132:135]
v_fmac_f32 v17,v21,v21
MF v[136:139],a[76:79],a[104:107],v[136:139]
TR a[42:43],v8,50176
v_fmac_f32 v17,v22,v22
MF v[140:143],a[76:79],a[108:111],v[140:143]
s_mov_b32 s47,1733632
buffer_load_dwordx4 v15,s[16:19],s47 offen offset:3072 lds
AR v22,a130
MF v[144:147],a[76:79],a[112:115],v[144:147]
RD a[12:15],v4,6144
v_lshlrev_b32 v21,16,v22
MF v[148:151],a[76:79],a[116:119],v[148:151]
v_and_b32 v22,0xffff0000,v22
MF v[152:155],a[76:79],a[120:123],v[152:155]
TR a[44:45],v9,49152
v_sub_f32 v21,v21,v16
MF v[156:159],a[76:79],a[124:127],v[156:159]
v_sub_f32 v22,v22,v16
v_fmac_f32 v17,v21,v21
MF v[160:163],a[80:83],a[96:99],v[160:163]
TR a[46:47],v9,50176
v_fmac_f32 v17,v22,v22
MF v[164:167],a[80:83],a[100:103],v[164:167]
s_add_u32 m0,s48,73728
s_mov_b32 s46,65920
buffer_load_dwordx4 v14,s[12:15],s46 offen lds
MF v[168:171],a[80:83],a[104:107],v[168:171]
RD a[16:19],v4,8192
AR v22,a131
MF v[172:175],a[80:83],a[108:111],v[172:175]
v_lshlrev_b32 v21,16,v22
v_and_b32 v22,0xffff0000,v22
MF v[176:179],a[80:83],a[112:115],v[176:179]
TR a[48:49],v10,49152
v_sub_f32 v21,v21,v16
MF v[180:183],a[80:83],a[116:119],v[180:183]
v_sub_f32 v22,v22,v16
MF v[184:187],a[80:83],a[120:123],v[184:187]
TR a[50:51],v10,50176
v_fmac_f32 v17,v21,v21
MF v[188:191],a[80:83],a[124:127],v[188:191]
s_mov_b32 s46,80256
buffer_load_dwordx4 v14,s[12:15],s46 offen offset:2048 lds
v_fmac_f32 v17,v22,v22
MF v[192:195],a[84:87],a[96:99],v[192:195]
AR v22,a132
v_lshlrev_b32 v21,16,v22
MF v[196:199],a[84:87],a[100:103],v[196:199]
RD a[20:23],v4,10240
v_and_b32 v22,0xffff0000,v22
MF v[200:203],a[84:87],a[104:107],v[200:203]
v_sub_f32 v21,v21,v16
MF v[204:207],a[84:87],a[108:111],v[204:207]
TR a[52:53],v11,49152
v_sub_f32 v22,v22,v16
MF v[208:211],a[84:87],a[112:115],v[208:211]
v_fmac_f32 v17,v21,v21
MF v[212:215],a[84:87],a[116:119],v[212:215]
s_add_u32 m0,s48,77824
TR a[54:55],v11,50176
v_fmac_f32 v17,v22,v22
MF v[216:219],a[84:87],a[120:123],v[216:219]
s_mov_b32 s46,98688
buffer_load_dwordx4 v14,s[12:15],s46 offen lds
AR v22,a133
MF v[220:223],a[84:87],a[124:127],v[220:223]
RD a[24:27],v4,12288
v_lshlrev_b32 v21,16,v22
MF v[224:227],a[88:91],a[96:99],v[224:227]
v_and_b32 v22,0xffff0000,v22
v_sub_f32 v21,v21,v16
MF v[228:231],a[88:91],a[100:103],v[228:231]
TR a[56:57],v12,49152
v_sub_f32 v22,v22,v16
MF v[232:235],a[88:91],a[104:107],v[232:235]
v_fmac_f32 v17,v21,v21
MF v[236:239],a[88:91],a[108:111],v[236:239]
s_mov_b32 s46,113024
TR a[58:59],v12,50176
v_fmac_f32 v17,v22,v22
MF v[240:243],a[88:91],a[112:115],v[240:243]
buffer_load_dwordx4 v14,s[12:15],s46 offen offset:2048 lds
AR v22,a134
MF v[244:247],a[88:91],a[116:119],v[244:247]
RD a[28:31],v4,14336
v_lshlrev_b32 v21,16,v22
MF v[248:251],a[88:91],a[120:123],v[248:251]
v_and_b32 v22,0xffff0000,v22
v_sub_f32 v21,v21,v16
MF v[252:255],a[88:91],a[124:127],v[252:255]
TR a[60:61],v13,49152
v_sub_f32 v22,v22,v16
MF a[192:195],a[92:95],a[96:99],a[192:195]
v_fmac_f32 v17,v21,v21
MF a[196:199],a[92:95],a[100:103],a[196:199]
s_lshl_b32 s7,s2,2
TR a[62:63],v13,50176
v_fmac_f32 v17,v22,v22
MF a[200:203],a[92:95],a[104:107],a[200:203]
s_add_u32 s7,s7,s32
s_mul_i32 s7,s7,1728
s_add_u32 s7,s7,0
MF a[204:207],a[92:95],a[108:111],a[204:207]
v_lshlrev_b32 v0,7,v1
v_min_u32 v0,1724,v0
MF a[208:211],a[92:95],a[112:115],a[208:211]
AR v22,a135
v_add_u32 v0,s7,v0
MF a[212:215],a[92:95],a[116:119],a[212:215]
global_load_dword a180,v0,s[78:79]
v_lshlrev_b32 v21,16,v22
MF a[216:219],a[92:95],a[120:123],a[216:219]
v_and_b32 v22,0xffff0000,v22
v_sub_f32 v21,v21,v16
MF a[220:223],a[92:95],a[124:127],a[220:223]
LW 15
MF v[32:35],a[0:3],a[32:35],v[32:35]
v_sub_f32 v22,v22,v16
v_fmac_f32 v17,v21,v21
MF v[36:39],a[0:3],a[36:39],v[36:39]
v_fmac_f32 v17,v22,v22
MF v[40:43],a[0:3],a[40:43],v[40:43]
LW 12
AR v22,a136
MF v[44:47],a[0:3],a[44:47],v[44:47]
LW 9
v_lshlrev_b32 v21,16,v22
MF v[48:51],a[0:3],a[48:51],v[48:51]
LW 6
v_and_b32 v22,0xffff0000,v22
MF v[52:55],a[0:3],a[52:55],v[52:55]
LW 3
v_sub_f32 v21,v21,v16
MF v[56:59],a[0:3],a[56:59],v[56:59]
LW 0
v_sub_f32 v22,v22,v16
MF v[60:63],a[0:3],a[60:63],v[60:63]
s_waitcnt vmcnt(17)
v_fmac_f32 v20,v21,v21
v_fmac_f32 v20,v22,v22
MF v[64:67],a[4:7],a[32:35],v[64:67]
s_barrier
AR v22,a137
MF v[68:71],a[4:7],a[36:39],v[68:71]
s_add_u32 m0,s49,49152
s_mov_b32 s47,1835008
v_add_u32 v3,32768,v5
MF v[72:75],a[4:7],a[40:43],v[72:75]
buffer_load_dwordx4 v15,s[16:19],s47 offen lds
v_lshlrev_b32 v21,16,v22
MF v[76:79],a[4:7],a[44:47],v[76:79]
v_xor_b32 v4,64,v3
v_and_b32 v22,0xffff0000,v22
MF v[80:83],a[4:7],a[48:51],v[80:83]
v_sub_f32 v21,v21,v16
v_sub_f32 v22,v22,v16
MF v[84:87],a[4:7],a[52:55],v[84:87]
RD a[64:67],v3,0
v_fmac_f32 v20,v21,v21
MF v[88:91],a[4:7],a[56:59],v[88:91]
TR a[96:97],v6,0
v_fmac_f32 v20,v22,v22
MF v[92:95],a[4:7],a[60:63],v[92:95]
s_mov_b32 s47,1866752
buffer_load_dwordx4 v15,s[16:19],s47 offen offset:1024 lds
AR v22,a138
MF v[96:99],a[8:11],a[32:35],v[96:99]
v_lshlrev_b32 v21,16,v22
v_and_b32 v22,0xffff0000,v22
MF v[100:103],a[8:11],a[36:39],v[100:103]
TR a[98:99],v6,1024
v_sub_f32 v21,v21,v16
MF v[104:107],a[8:11],a[40:43],v[104:107]
RD a[68:71],v3,2048
v_sub_f32 v22,v22,v16
MF v[108:111],a[8:11],a[44:47],v[108:111]
v_fmac_f32 v20,v21,v21
MF v[112:115],a[8:11],a[48:51],v[112:115]
TR a[100:101],v7,0
v_fmac_f32 v20,v22,v22
MF v[116:119],a[8:11],a[52:55],v[116:119]
s_mov_b32 s47,1964032
buffer_load_dwordx4 v15,s[16:19],s47 offen offset:2048 lds
AR v22,a139
MF v[120:123],a[8:11],a[56:59],v[120:123]
TR a[102:103],v7,1024
v_lshlrev_b32 v21,16,v22
MF v[124:127],a[8:11],a[60:63],v[124:127]
v_and_b32 v22,0xffff0000,v22
v_sub_f32 v21,v21,v16
MF v[128:131],a[12:15],a[32:35],v[128:131]
RD a[72:75],v3,4096
v_sub_f32 v22,v22,v16
MF v[132:135],a[12:15],a[36:39],v[132:135]
v_fmac_f32 v20,v21,v21
MF v[136:139],a[12:15],a[40:43],v[136:139]
TR a[104:105],v8,0
v_fmac_f32 v20,v22,v22
MF v[140:143],a[12:15],a[44:47],v[140:143]
s_mov_b32 s47,1995776
buffer_load_dwordx4 v15,s[16:19],s47 offen offset:3072 lds
v_cndmask_b32 v20,0,v20,s[44:45]
MF v[144:147],a[12:15],a[48:51],v[144:147]
TR a[106:107],v8,1024
v_add_f32 v17,v17,v20
MF v[148:151],a[12:15],a[52:55],v[148:151]
s_nop 1
MF v[152:155],a[12:15],a[56:59],v[152:155]
RD a[76:79],v3,6144
v_add_f32_dpp v17,v17,v17 row_ror:8 row_mask:0xf bank_mask:0xf
MF v[156:159],a[12:15],a[60:63],v[156:159]
s_nop 1
v_add_f32_dpp v17,v17,v17 row_ror:4 row_mask:0xf bank_mask:0xf
MF v[160:163],a[16:19],a[32:35],v[160:163]
s_nop 1
TR a[108:109],v9,0
MF v[164:167],a[16:19],a[36:39],v[164:167]
s_add_u32 m0,s48,0
s_mov_b32 s46,512
buffer_load_dwordx4 v14,s[12:15],s46 offen lds
MF v[168:171],a[16:19],a[40:43],v[168:171]
TR a[110:111],v9,1024
v_add_f32_dpp v17,v17,v17 row_ror:2 row_mask:0xf bank_mask:0xf
MF v[172:175],a[16:19],a[44:47],v[172:175]
s_nop 1
v_add_f32_dpp v17,v17,v17 row_ror:1 row_mask:0xf bank_mask:0xf
MF v[176:179],a[16:19],a[48:51],v[176:179]
RD a[80:83],v3,8192
v_mov_b32 v20,v17
MF v[180:183],a[16:19],a[52:55],v[180:183]
s_nop 1
MF v[184:187],a[16:19],a[56:59],v[184:187]
TR a[112:113],v10,0
v_permlane16_swap_b32 v17,v20
MF v[188:191],a[16:19],a[60:63],v[188:191]
s_mov_b32 s46,14848
s_nop 1
MF v[192:195],a[20:23],a[32:35],v[192:195]
buffer_load_dwordx4 v14,s[12:15],s46 offen offset:2048 lds
v_add_f32 v17,v17,v20
MF v[196:199],a[20:23],a[36:39],v[196:199]
TR a[114:115],v10,1024
v_mul_f32 v17,0x3ae38e39,v17
MF v[200:203],a[20:23],a[40:43],v[200:203]
RD a[84:87],v3,10240
CV v17,v16,v17
MF v[204:207],a[20:23],a[44:47],v[204:207]
v_lshlrev_b32 v16,16,v17
v_and_b32 v17,0xffff0000,v17
MF v[208:211],a[20:23],a[48:51],v[208:211]
TR a[116:117],v11,0
v_add_f32 v17,0x3727c5ac,v17
MF v[212:215],a[20:23],a[52:55],v[212:215]
s_add_u32 m0,s48,4096
s_mov_b32 s46,33280
CV v17,v17,v17
MF v[216:219],a[20:23],a[56:59],v[216:219]
buffer_load_dwordx4 v14,s[12:15],s46 offen lds
v_and_b32 v17,0xffff0000,v17
MF v[220:223],a[20:23],a[60:63],v[220:223]
TR a[118:119],v11,1024
MF v[224:227],a[24:27],a[32:35],v[224:227]
v_sqrt_f32 v17,v17
MF v[228:231],a[24:27],a[36:39],v[228:231]
s_nop 0
RD a[88:91],v3,12288
CV v17,v17,v17
MF v[232:235],a[24:27],a[40:43],v[232:235]
TR a[120:121],v12,0
v_and_b32 v17,0xffff0000,v17
MF v[236:239],a[24:27],a[44:47],v[236:239]
s_mov_b32 s46,47616
v_rcp_f32 v17,v17
MF v[240:243],a[24:27],a[48:51],v[240:243]
s_nop 0
TR a[122:123],v12,1024
buffer_load_dwordx4 v14,s[12:15],s46 offen offset:2048 lds
MF v[244:247],a[24:27],a[52:55],v[244:247]
v_mul_f32 v16,v16,v17
AR v22,a128
MF v[248:251],a[24:27],a[56:59],v[248:251]
RD a[92:95],v3,14336
v_lshlrev_b32 v21,16,v22
MF v[252:255],a[24:27],a[60:63],v[252:255]
v_and_b32 v22,0xffff0000,v22
v_fma_f32 v21,v21,v17,-v16
MF a[192:195],a[28:31],a[32:35],a[192:195]
TR a[124:125],v13,0
v_fma_f32 v22,v22,v17,-v16
MF a[196:199],a[28:31],a[36:39],a[196:199]
s_lshl_b32 s7,s2,2
s_add_u32 s7,s7,s32
CV v24,v21,v22
MF a[200:203],a[28:31],a[40:43],a[200:203]
s_mul_i32 s7,s7,1728
s_add_u32 s7,s7,1769472
v_lshlrev_b32 v0,7,v1
MF a[204:207],a[28:31],a[44:47],a[204:207]
v_min_u32 v0,1724,v0
v_add_u32 v0,s7,v0
MF a[208:211],a[28:31],a[48:51],a[208:211]
TR a[126:127],v13,1024
global_load_dword a181,v0,s[78:79]
MF a[212:215],a[28:31],a[52:55],a[212:215]
AR v22,a129
v_lshlrev_b32 v21,16,v22
MF a[216:219],a[28:31],a[56:59],a[216:219]
v_and_b32 v22,0xffff0000,v22
v_fma_f32 v21,v21,v17,-v16
MF a[220:223],a[28:31],a[60:63],a[220:223]
LW 15
MF v[32:35],a[64:67],a[96:99],v[32:35]
v_fma_f32 v22,v22,v17,-v16
CV v25,v21,v22
MF v[36:39],a[64:67],a[100:103],v[36:39]
AR v22,a130
MF v[40:43],a[64:67],a[104:107],v[40:43]
LW 12
v_lshlrev_b32 v21,16,v22
MF v[44:47],a[64:67],a[108:111],v[44:47]
LW 9
v_and_b32 v22,0xffff0000,v22
MF v[48:51],a[64:67],a[112:115],v[48:51]
LW 6
v_fma_f32 v21,v21,v17,-v16
MF v[52:55],a[64:67],a[116:119],v[52:55]
LW 3
v_fma_f32 v22,v22,v17,-v16
MF v[56:59],a[64:67],a[120:123],v[56:59]
LW 0
CV v26,v21,v22
AR v22,a131
MF v[60:63],a[64:67],a[124:127],v[60:63]
s_waitcnt vmcnt(22)
v_lshlrev_b32 v21,16,v22
MF v[64:67],a[68:71],a[96:99],v[64:67]
s_barrier
v_and_b32 v22,0xffff0000,v22
MF v[68:71],a[68:71],a[100:103],v[68:71]
s_add_u32 m0,s49,0
s_mov_b32 s47,2097152
RD a[0:3],v4,0
MF v[72:75],a[68:71],a[104:107],v[72:75]
buffer_load_dwordx4 v15,s[16:19],s47 offen lds
v_fma_f32 v21,v21,v17,-v16
MF v[76:79],a[68:71],a[108:111],v[76:79]
TR a[32:33],v6,16384
v_fma_f32 v22,v22,v17,-v16
MF v[80:83],a[68:71],a[112:115],v[80:83]
CV v27,v21,v22
s_movk_i32 s42,0
MF v[84:87],a[68:71],a[116:119],v[84:87]
TR a[34:35],v6,17408
buffer_store_dwordx4 v[24:27],v18,s[8:11],s42 offen sc1
MF v[88:91],a[68:71],a[120:123],v[88:91]
s_nop 1
AR v22,a132
MF v[92:95],a[68:71],a[124:127],v[92:95]
s_mov_b32 s47,2128896
RD a[4:7],v4,2048
buffer_load_dwordx4 v15,s[16:19],s47 offen offset:1024 lds
MF v[96:99],a[72:75],a[96:99],v[96:99]
v_lshlrev_b32 v21,16,v22
v_and_b32 v22,0xffff0000,v22
MF v[100:103],a[72:75],a[100:103],v[100:103]
TR a[36:37],v7,16384
v_fma_f32 v21,v21,v17,-v16
MF v[104:107],a[72:75],a[104:107],v[104:107]
v_fma_f32 v22,v22,v17,-v16
MF v[108:111],a[72:75],a[108:111],v[108:111]
TR a[38:39],v7,17408
CV v24,v21,v22
MF v[112:115],a[72:75],a[112:115],v[112:115]
AR v22,a133
v_lshlrev_b32 v21,16,v22
MF v[116:119],a[72:75],a[116:119],v[116:119]
s_mov_b32 s47,2226176
RD a[8:11],v4,4096
buffer_load_dwordx4 v15,s[16:19],s47 offen offset:2048 lds
MF v[120:123],a[72:75],a[120:123],v[120:123]
v_and_b32 v22,0xffff0000,v22
v_fma_f32 v21,v21,v17,-v16
MF v[124:127],a[72:75],a[124:127],v[124:127]
TR a[40:41],v8,16384
v_fma_f32 v22,v22,v17,-v16
MF v[128:131],a[76:79],a[96:99],v[128:131]
CV v25,v21,v22
MF v[132:135],a[76:79],a[100:103],v[132:135]
AR v22,a134
MF v[136:139],a[76:79],a[104:107],v[136:139]
TR a[42:43],v8,17408
v_lshlrev_b32 v21,16,v22
MF v[140:143],a[76:79],a[108:111],v[140:143]
s_mov_b32 s47,2257920
buffer_load_dwordx4 v15,s[16:19],s47 offen offset:3072 lds
v_and_b32 v22,0xffff0000,v22
MF v[144:147],a[76:79],a[112:115],v[144:147]
RD a[12:15],v4,6144
v_fma_f32 v21,v21,v17,-v16
MF v[148:151],a[76:79],a[116:119],v[148:151]
v_fma_f32 v22,v22,v17,-v16
CV v26,v21,v22
MF v[152:155],a[76:79],a[120:123],v[152:155]
TR a[44:45],v9,16384
AR v22,a135
MF v[156:159],a[76:79],a[124:127],v[156:159]
v_lshlrev_b32 v21,16,v22
MF v[160:163],a[80:83],a[96:99],v[160:163]
TR a[46:47],v9,17408
v_and_b32 v22,0xffff0000,v22
MF v[164:167],a[80:83],a[100:103],v[164:167]
s_add_u32 m0,s48,8192
s_mov_b32 s46,66048
v_fma_f32 v21,v21,v17,-v16
MF v[168:171],a[80:83],a[104:107],v[168:171]
buffer_load_dwordx4 v14,s[12:15],s46 offen lds
v_fma_f32 v22,v22,v17,-v16
MF v[172:175],a[80:83],a[108:111],v[172:175]
RD a[16:19],v4,8192
CV v27,v21,v22
MF v[176:179],a[80:83],a[112:115],v[176:179]
s_movk_i32 s42,8192
buffer_store_dwordx4 v[24:27],v18,s[8:11],s42 offen sc1
TR a[48:49],v10,16384
MF v[180:183],a[80:83],a[116:119],v[180:183]
s_nop 1
MF v[184:187],a[80:83],a[120:123],v[184:187]
TR a[50:51],v10,17408
AR v22,a136
MF v[188:191],a[80:83],a[124:127],v[188:191]
s_mov_b32 s46,80384
buffer_load_dwordx4 v14,s[12:15],s46 offen offset:2048 lds
v_lshlrev_b32 v21,16,v22
MF v[192:195],a[84:87],a[96:99],v[192:195]
RD a[20:23],v4,10240
v_and_b32 v22,0xffff0000,v22
MF v[196:199],a[84:87],a[100:103],v[196:199]
v_fma_f32 v21,v21,v17,-v16
v_fma_f32 v22,v22,v17,-v16
MF v[200:203],a[84:87],a[104:107],v[200:203]
CV v24,v21,v22
MF v[204:207],a[84:87],a[108:111],v[204:207]
TR a[52:53],v11,16384
AR v22,a137
MF v[208:211],a[84:87],a[112:115],v[208:211]
v_lshlrev_b32 v21,16,v22
MF v[212:215],a[84:87],a[116:119],v[212:215]
s_add_u32 m0,s48,12288
TR a[54:55],v11,17408
v_and_b32 v22,0xffff0000,v22
MF v[216:219],a[84:87],a[120:123],v[216:219]
s_mov_b32 s46,98816
buffer_load_dwordx4 v14,s[12:15],s46 offen lds
v_fma_f32 v21,v21,v17,-v16
MF v[220:223],a[84:87],a[124:127],v[220:223]
RD a[24:27],v4,12288
v_fma_f32 v22,v22,v17,-v16
MF v[224:227],a[88:91],a[96:99],v[224:227]
CV v25,v21,v22
AR v22,a138
MF v[228:231],a[88:91],a[100:103],v[228:231]
TR a[56:57],v12,16384
v_lshlrev_b32 v21,16,v22
MF v[232:235],a[88:91],a[104:107],v[232:235]
v_and_b32 v22,0xffff0000,v22
MF v[236:239],a[88:91],a[108:111],v[236:239]
s_mov_b32 s46,113152
TR a[58:59],v12,17408
v_fma_f32 v21,v21,v17,-v16
MF v[240:243],a[88:91],a[112:115],v[240:243]
buffer_load_dwordx4 v14,s[12:15],s46 offen offset:2048 lds
v_fma_f32 v22,v22,v17,-v16
MF v[244:247],a[88:91],a[116:119],v[244:247]
RD a[28:31],v4,14336
CV v26,v21,v22
MF v[248:251],a[88:91],a[120:123],v[248:251]
AR v22,a139
MF v[252:255],a[88:91],a[124:127],v[252:255]
TR a[60:61],v13,16384
v_lshlrev_b32 v21,16,v22
MF a[192:195],a[92:95],a[96:99],a[192:195]
v_and_b32 v22,0xffff0000,v22
v_fma_f32 v21,v21,v17,-v16
MF a[196:199],a[92:95],a[100:103],a[196:199]
s_lshl_b32 s7,s2,2
TR a[62:63],v13,17408
v_fma_f32 v22,v22,v17,-v16
MF a[200:203],a[92:95],a[104:107],a[200:203]
s_add_u32 s7,s7,s32
s_mul_i32 s7,s7,1728
s_add_u32 s7,s7,3538944
MF a[204:207],a[92:95],a[108:111],a[204:207]
v_lshlrev_b32 v0,7,v1
v_min_u32 v0,1724,v0
MF a[208:211],a[92:95],a[112:115],a[208:211]
CV v27,v21,v22
v_add_u32 v0,s7,v0
MF a[212:215],a[92:95],a[116:119],a[212:215]
s_movk_i32 s42,16384
buffer_store_dwordx4 v[24:27],v19,s[8:11],s42 offen sc1
global_load_dword a182,v0,s[78:79]
MF a[216:219],a[92:95],a[120:123],a[216:219]
s_nop 1
MF a[220:223],a[92:95],a[124:127],a[220:223]
LW 15
MF v[32:35],a[0:3],a[32:35],v[32:35]
v_bfe_u32 v27,v1,2,2
MF v[36:39],a[0:3],a[36:39],v[36:39]
v_sub_u32 v27,0,v27
MF v[40:43],a[0:3],a[40:43],v[40:43]
LW 12
v_lshrrev_b32 v29,4,v1
MF v[44:47],a[0:3],a[44:47],v[44:47]
LW 9
v_xor_b32 v27,v27,v29
MF v[48:51],a[0:3],a[48:51],v[48:51]
LW 6
MF v[52:55],a[0:3],a[52:55],v[52:55]
LW 3
v_and_b32 v27,3,v27
MF v[56:59],a[0:3],a[56:59],v[56:59]
LW 0
v_lshlrev_b32 v27,4,v27
MF v[60:63],a[0:3],a[60:63],v[60:63]
s_waitcnt vmcnt(22)
v_and_b32 v29,15,v1
MF v[64:67],a[4:7],a[32:35],v[64:67]
s_barrier
MF v[68:71],a[4:7],a[36:39],v[68:71]
s_add_u32 m0,s49,16384
s_mov_b32 s47,2359296
v_add_u32 v3,65536,v5
MF v[72:75],a[4:7],a[40:43],v[72:75]
buffer_load_dwordx4 v15,s[16:19],s47 offen lds
v_lshl_add_u32 v27,v29,6,v27
MF v[76:79],a[4:7],a[44:47],v[76:79]
s_and_b32 s50,s32,1
s_lshl_b32 s50,s50,13
v_xor_b32 v4,64,v3
MF v[80:83],a[4:7],a[48:51],v[80:83]
RD a[64:67],v3,0
MF v[84:87],a[4:7],a[52:55],v[84:87]
v_add_u32 v27,s50,v27
MF v[88:91],a[4:7],a[56:59],v[88:91]
TR a[96:97],v6,32768
v_lshrrev_b32 v29,4,v1
MF v[92:95],a[4:7],a[60:63],v[92:95]
s_mov_b32 s47,2391040
buffer_load_dwordx4 v15,s[16:19],s47 offen offset:1024 lds
v_bfe_u32 v30,v1,2,2
MF v[96:99],a[8:11],a[32:35],v[96:99]
TR a[98:99],v6,33792
MF v[100:103],a[8:11],a[36:39],v[100:103]
v_and_b32 v31,1,v29
MF v[104:107],a[8:11],a[40:43],v[104:107]
RD a[68:71],v3,2048
v_lshl_add_u32 v30,v31,2,v30
MF v[108:111],a[8:11],a[44:47],v[108:111]
v_lshrrev_b32 v29,1,v29
MF v[112:115],a[8:11],a[48:51],v[112:115]
TR a[100:101],v7,32768
MF v[116:119],a[8:11],a[52:55],v[116:119]
v_lshl_add_u32 v30,v29,4,v30
MF v[120:123],a[8:11],a[56:59],v[120:123]
s_mov_b32 s47,2488320
TR a[102:103],v7,33792
v_mul_u32_u24 v30,288,v30
MF v[124:127],a[8:11],a[60:63],v[124:127]
buffer_load_dwordx4 v15,s[16:19],s47 offen offset:2048 lds
v_and_b32 v29,3,v1
MF v[128:131],a[12:15],a[32:35],v[128:131]
RD a[72:75],v3,4096
MF v[132:135],a[12:15],a[36:39],v[132:135]
v_lshl_add_u32 v30,v29,3,v30
MF v[136:139],a[12:15],a[40:43],v[136:139]
TR a[104:105],v8,32768
v_add_u32 v28,16384,v30
MF v[140:143],a[12:15],a[44:47],v[140:143]
s_lshl_b32 s50,s33,3
MF v[144:147],a[12:15],a[48:51],v[144:147]
TR a[106:107],v8,33792
MF v[148:151],a[12:15],a[52:55],v[148:151]
s_mov_b32 s47,2520064
buffer_load_dwordx4 v15,s[16:19],s47 offen offset:3072 lds
s_lshl_b32 s51,s32,1
MF v[152:155],a[12:15],a[56:59],v[152:155]
s_add_u32 s50,s50,s51
RD a[76:79],v3,6144
MF v[156:159],a[12:15],a[60:63],v[156:159]
s_mul_i32 s50,s50,18432
MF v[160:163],a[16:19],a[32:35],v[160:163]
TR a[108:109],v9,32768
v_add_u32 v25,s50,v2
MF v[164:167],a[16:19],a[36:39],v[164:167]
MF v[168:171],a[16:19],a[40:43],v[168:171]
TR a[110:111],v9,33792
v_add_u32 v26,16384,v25
MF v[172:175],a[16:19],a[44:47],v[172:175]
s_movk_i32 s52,3641
MF v[176:179],a[16:19],a[48:51],v[176:179]
s_add_u32 m0,s48,32768
s_mov_b32 s46,640
RD a[80:83],v3,8192
MF v[180:183],a[16:19],a[52:55],v[180:183]
s_mov_b32 s53,9216
buffer_load_dwordx4 v14,s[12:15],s46 offen lds
MF v[184:187],a[16:19],a[56:59],v[184:187]
TR a[112:113],v10,32768
v_add_u32 v29,0,v1
MF v[188:191],a[16:19],a[60:63],v[188:191]
v_mul_u32_u24 v30,s52,v29
MF v[192:195],a[20:23],a[32:35],v[192:195]
TR a[114:115],v10,33792
v_lshrrev_b32 v30,16,v30
MF v[196:199],a[20:23],a[36:39],v[196:199]
MF v[200:203],a[20:23],a[40:43],v[200:203]
RD a[84:87],v3,10240
v_mul_u32_u24 v31,18,v30
MF v[204:207],a[20:23],a[44:47],v[204:207]
s_mov_b32 s46,14976
buffer_load_dwordx4 v14,s[12:15],s46 offen offset:2048 lds
v_sub_u32 v29,v29,v31
MF v[208:211],a[20:23],a[48:51],v[208:211]
TR a[116:117],v11,32768
v_lshrrev_b32 v31,1,v30
MF v[212:215],a[20:23],a[52:55],v[212:215]
MF v[216:219],a[20:23],a[56:59],v[216:219]
TR a[118:119],v11,33792
v_xor_b32 v31,v31,v30
MF v[220:223],a[20:23],a[60:63],v[220:223]
v_and_b32 v31,4,v31
MF v[224:227],a[24:27],a[32:35],v[224:227]
RD a[88:91],v3,12288
v_mul_u32_u24 v31,3,v31
MF v[228:231],a[24:27],a[36:39],v[228:231]
MF v[232:235],a[24:27],a[40:43],v[232:235]
s_add_u32 m0,s48,36864
TR a[120:121],v12,32768
v_xor_b32 v30,v30,v31
MF v[236:239],a[24:27],a[44:47],v[236:239]
s_mov_b32 s46,33408
buffer_load_dwordx4 v14,s[12:15],s46 offen lds
v_mul_u32_u24 v30,s53,v30
MF v[240:243],a[24:27],a[48:51],v[240:243]
TR a[122:123],v12,33792
v_lshl_add_u32 v16,v29,4,v30
MF v[244:247],a[24:27],a[52:55],v[244:247]
MF v[248:251],a[24:27],a[56:59],v[248:251]
RD a[92:95],v3,14336
v_add_u32 v29,64,v1
MF v[252:255],a[24:27],a[60:63],v[252:255]
v_mul_u32_u24 v30,s52,v29
MF a[192:195],a[28:31],a[32:35],a[192:195]
TR a[124:125],v13,32768
v_lshrrev_b32 v30,16,v30
MF a[196:199],a[28:31],a[36:39],a[196:199]
s_mov_b32 s46,47744
buffer_load_dwordx4 v14,s[12:15],s46 offen offset:2048 lds
MF a[200:203],a[28:31],a[40:43],a[200:203]
TR a[126:127],v13,33792
v_mul_u32_u24 v31,18,v30
MF a[204:207],a[28:31],a[44:47],a[204:207]
v_sub_u32 v29,v29,v31
MF a[208:211],a[28:31],a[48:51],a[208:211]
v_lshrrev_b32 v31,1,v30
MF a[212:215],a[28:31],a[52:55],a[212:215]
MF a[216:219],a[28:31],a[56:59],a[216:219]
MF a[220:223],a[28:31],a[60:63],a[220:223]
LW 15
MF v[32:35],a[64:67],a[96:99],v[32:35]
v_xor_b32 v31,v31,v30
MF v[36:39],a[64:67],a[100:103],v[36:39]
v_and_b32 v31,4,v31
MF v[40:43],a[64:67],a[104:107],v[40:43]
LW 12
v_mul_u32_u24 v31,3,v31
MF v[44:47],a[64:67],a[108:111],v[44:47]
LW 9
v_xor_b32 v30,v30,v31
MF v[48:51],a[64:67],a[112:115],v[48:51]
LW 6
MF v[52:55],a[64:67],a[116:119],v[52:55]
LW 3
v_mul_u32_u24 v30,s53,v30
MF v[56:59],a[64:67],a[120:123],v[56:59]
LW 0
v_lshl_add_u32 v17,v29,4,v30
MF v[60:63],a[64:67],a[124:127],v[60:63]
s_waitcnt vmcnt(25)
v_subrev_u32 v17,1024,v17
MF v[64:67],a[68:71],a[96:99],v[64:67]
s_barrier
MF v[68:71],a[68:71],a[100:103],v[68:71]
s_add_u32 m0,s49,32768
s_mov_b32 s47,2621440
RD a[0:3],v4,0
MF v[72:75],a[68:71],a[104:107],v[72:75]
buffer_load_dwordx4 v15,s[16:19],s47 offen lds
v_add_u32 v29,128,v1
MF v[76:79],a[68:71],a[108:111],v[76:79]
TR a[32:33],v6,49152
v_mul_u32_u24 v30,s52,v29
MF v[80:83],a[68:71],a[112:115],v[80:83]
v_lshrrev_b32 v30,16,v30
v_mul_u32_u24 v31,18,v30
MF v[84:87],a[68:71],a[116:119],v[84:87]
TR a[34:35],v6,50176
MF v[88:91],a[68:71],a[120:123],v[88:91]
v_sub_u32 v29,v29,v31
MF v[92:95],a[68:71],a[124:127],v[92:95]
s_mov_b32 s47,2653184
RD a[4:7],v4,2048
v_lshrrev_b32 v31,1,v30
MF v[96:99],a[72:75],a[96:99],v[96:99]
buffer_load_dwordx4 v15,s[16:19],s47 offen offset:1024 lds
v_xor_b32 v31,v31,v30
MF v[100:103],a[72:75],a[100:103],v[100:103]
TR a[36:37],v7,49152
MF v[104:107],a[72:75],a[104:107],v[104:107]
v_and_b32 v31,4,v31
MF v[108:111],a[72:75],a[108:111],v[108:111]
TR a[38:39],v7,50176
v_mul_u32_u24 v31,3,v31
MF v[112:115],a[72:75],a[112:115],v[112:115]
v_xor_b32 v30,v30,v31
MF v[116:119],a[72:75],a[116:119],v[116:119]
RD a[8:11],v4,4096
v_mul_u32_u24 v30,s53,v30
MF v[120:123],a[72:75],a[120:123],v[120:123]
s_mov_b32 s47,2750464
buffer_load_dwordx4 v15,s[16:19],s47 offen offset:2048 lds
MF v[124:127],a[72:75],a[124:127],v[124:127]
TR a[40:41],v8,49152
v_lshl_add_u32 v18,v29,4,v30
MF v[128:131],a[76:79],a[96:99],v[128:131]
v_subrev_u32 v18,2048,v18
MF v[132:135],a[76:79],a[100:103],v[132:135]
v_add_u32 v29,192,v1
MF v[136:139],a[76:79],a[104:107],v[136:139]
TR a[42:43],v8,50176
MF v[140:143],a[76:79],a[108:111],v[140:143]
v_mul_u32_u24 v30,s52,v29
MF v[144:147],a[76:79],a[112:115],v[144:147]
RD a[12:15],v4,6144
v_lshrrev_b32 v30,16,v30
MF v[148:151],a[76:79],a[116:119],v[148:151]
s_mov_b32 s47,2782208
buffer_load_dwordx4 v15,s[16:19],s47 offen offset:3072 lds
v_mul_u32_u24 v31,18,v30
MF v[152:155],a[76:79],a[120:123],v[152:155]
TR a[44:45],v9,49152
MF v[156:159],a[76:79],a[124:127],v[156:159]
v_sub_u32 v29,v29,v31
MF v[160:163],a[80:83],a[96:99],v[160:163]
TR a[46:47],v9,50176
v_lshrrev_b32 v31,1,v30
MF v[164:167],a[80:83],a[100:103],v[164:167]
v_xor_b32 v31,v31,v30
MF v[168:171],a[80:83],a[104:107],v[168:171]
RD a[16:19],v4,8192
v_and_b32 v31,4,v31
MF v[172:175],a[80:83],a[108:111],v[172:175]
MF v[176:179],a[80:83],a[112:115],v[176:179]
s_add_u32 m0,s48,40960
s_mov_b32 s46,66176
v_mul_u32_u24 v31,3,v31
MF v[180:183],a[80:83],a[116:119],v[180:183]
TR a[48:49],v10,49152
buffer_load_dwordx4 v14,s[12:15],s46 offen lds
MF v[184:187],a[80:83],a[120:123],v[184:187]
TR a[50:51],v10,50176
v_xor_b32 v30,v30,v31
MF v[188:191],a[80:83],a[124:127],v[188:191]
v_mul_u32_u24 v30,s53,v30
MF v[192:195],a[84:87],a[96:99],v[192:195]
RD a[20:23],v4,10240
v_lshl_add_u32 v19,v29,4,v30
MF v[196:199],a[84:87],a[100:103],v[196:199]
v_subrev_u32 v19,3072,v19
MF v[200:203],a[84:87],a[104:107],v[200:203]
v_add_u32 v29,256,v1
MF v[204:207],a[84:87],a[108:111],v[204:207]
s_mov_b32 s46,80512
buffer_load_dwordx4 v14,s[12:15],s46 offen offset:2048 lds
TR a[52:53],v11,49152
MF v[208:211],a[84:87],a[112:115],v[208:211]
v_mul_u32_u24 v30,s52,v29
MF v[212:215],a[84:87],a[116:119],v[212:215]
TR a[54:55],v11,50176
v_lshrrev_b32 v30,16,v30
MF v[216:219],a[84:87],a[120:123],v[216:219]
v_mul_u32_u24 v31,18,v30
MF v[220:223],a[84:87],a[124:127],v[220:223]
RD a[24:27],v4,12288
v_sub_u32 v29,v29,v31
MF v[224:227],a[88:91],a[96:99],v[224:227]
MF v[228:231],a[88:91],a[100:103],v[228:231]
TR a[56:57],v12,49152
v_lshrrev_b32 v31,1,v30
MF v[232:235],a[88:91],a[104:107],v[232:235]
s_add_u32 m0,s48,45056
s_mov_b32 s46,98944
buffer_load_dwordx4 v14,s[12:15],s46 offen lds
MF v[236:239],a[88:91],a[108:111],v[236:239]
TR a[58:59],v12,50176
v_xor_b32 v31,v31,v30
MF v[240:243],a[88:91],a[112:115],v[240:243]
v_and_b32 v31,4,v31
v_mul_u32_u24 v31,3,v31
MF v[244:247],a[88:91],a[116:119],v[244:247]
RD a[28:31],v4,14336
MF v[248:251],a[88:91],a[120:123],v[248:251]
v_xor_b32 v30,v30,v31
MF v[252:255],a[88:91],a[124:127],v[252:255]
TR a[60:61],v13,49152
v_mul_u32_u24 v30,s53,v30
MF a[192:195],a[92:95],a[96:99],a[192:195]
v_lshl_add_u32 v20,v29,4,v30
MF a[196:199],a[92:95],a[100:103],a[196:199]
s_mov_b32 s46,113280
TR a[62:63],v13,50176
buffer_load_dwordx4 v14,s[12:15],s46 offen offset:2048 lds
MF a[200:203],a[92:95],a[104:107],a[200:203]
v_add_u32 v29,320,v1
MF a[204:207],a[92:95],a[108:111],a[204:207]
v_mul_u32_u24 v30,s52,v29
MF a[208:211],a[92:95],a[112:115],a[208:211]
v_lshrrev_b32 v30,16,v30
MF a[212:215],a[92:95],a[116:119],a[212:215]
MF a[216:219],a[92:95],a[120:123],a[216:219]
MF a[220:223],a[92:95],a[124:127],a[220:223]
LW 15
MF v[32:35],a[0:3],a[32:35],v[32:35]
v_mul_u32_u24 v31,18,v30
MF v[36:39],a[0:3],a[36:39],v[36:39]
v_sub_u32 v29,v29,v31
MF v[40:43],a[0:3],a[40:43],v[40:43]
LW 12
v_lshrrev_b32 v31,1,v30
MF v[44:47],a[0:3],a[44:47],v[44:47]
LW 9
v_xor_b32 v31,v31,v30
MF v[48:51],a[0:3],a[48:51],v[48:51]
LW 6
MF v[52:55],a[0:3],a[52:55],v[52:55]
LW 3
v_and_b32 v31,4,v31
MF v[56:59],a[0:3],a[56:59],v[56:59]
LW 0
v_mul_u32_u24 v31,3,v31
MF v[60:63],a[0:3],a[60:63],v[60:63]
s_waitcnt vmcnt(18)
v_xor_b32 v30,v30,v31
MF v[64:67],a[4:7],a[32:35],v[64:67]
s_barrier
MF v[68:71],a[4:7],a[36:39],v[68:71]
s_add_u32 m0,s49,49152
s_mov_b32 s47,2883584
v_add_u32 v3,0,v5
MF v[72:75],a[4:7],a[40:43],v[72:75]
buffer_load_dwordx4 v15,s[16:19],s47 offen lds
v_mul_u32_u24 v30,s53,v30
MF v[76:79],a[4:7],a[44:47],v[76:79]
v_xor_b32 v4,64,v3
v_lshl_add_u32 v21,v29,4,v30
MF v[80:83],a[4:7],a[48:51],v[80:83]
v_subrev_u32 v21,1024,v21
v_add_u32 v29,384,v1
MF v[84:87],a[4:7],a[52:55],v[84:87]
RD a[64:67],v3,0
MF v[88:91],a[4:7],a[56:59],v[88:91]
TR a[96:97],v6,0
v_mul_u32_u24 v30,s52,v29
MF v[92:95],a[4:7],a[60:63],v[92:95]
s_mov_b32 s47,2915328
buffer_load_dwordx4 v15,s[16:19],s47 offen offset:1024 lds
v_lshrrev_b32 v30,16,v30
MF v[96:99],a[8:11],a[32:35],v[96:99]
TR a[98:99],v6,1024
v_mul_u32_u24 v31,18,v30
MF v[100:103],a[8:11],a[36:39],v[100:103]
MF v[104:107],a[8:11],a[40:43],v[104:107]
RD a[68:71],v3,2048
v_sub_u32 v29,v29,v31
MF v[108:111],a[8:11],a[44:47],v[108:111]
v_lshrrev_b32 v31,1,v30
MF v[112:115],a[8:11],a[48:51],v[112:115]
TR a[100:101],v7,0
v_xor_b32 v31,v31,v30
MF v[116:119],a[8:11],a[52:55],v[116:119]
v_and_b32 v31,4,v31
MF v[120:123],a[8:11],a[56:59],v[120:123]
s_mov_b32 s47,3012608
buffer_load_dwordx4 v15,s[16:19],s47 offen offset:2048 lds
TR a[102:103],v7,1024
MF v[124:127],a[8:11],a[60:63],v[124:127]
v_mul_u32_u24 v31,3,v31
MF v[128:131],a[12:15],a[32:35],v[128:131]
RD a[72:75],v3,4096
v_xor_b32 v30,v30,v31
MF v[132:135],a[12:15],a[36:39],v[132:135]
v_mul_u32_u24 v30,s53,v30
MF v[136:139],a[12:15],a[40:43],v[136:139]
TR a[104:105],v8,0
MF v[140:143],a[12:15],a[44:47],v[140:143]
v_lshl_add_u32 v22,v29,4,v30
MF v[144:147],a[12:15],a[48:51],v[144:147]
TR a[106:107],v8,1024
v_subrev_u32 v22,2048,v22
MF v[148:151],a[12:15],a[52:55],v[148:151]
s_mov_b32 s47,3044352
buffer_load_dwordx4 v15,s[16:19],s47 offen offset:3072 lds
v_add_u32 v29,448,v1
MF v[152:155],a[12:15],a[56:59],v[152:155]
RD a[76:79],v3,6144
MF v[156:159],a[12:15],a[60:63],v[156:159]
v_mul_u32_u24 v30,s52,v29
MF v[160:163],a[16:19],a[32:35],v[160:163]
TR a[108:109],v9,0
v_lshrrev_b32 v30,16,v30
MF v[164:167],a[16:19],a[36:39],v[164:167]
v_mul_u32_u24 v31,18,v30
MF v[168:171],a[16:19],a[40:43],v[168:171]
TR a[110:111],v9,1024
v_sub_u32 v29,v29,v31
MF v[172:175],a[16:19],a[44:47],v[172:175]
MF v[176:179],a[16:19],a[48:51],v[176:179]
s_add_u32 m0,s48,65536
RD a[80:83],v3,8192
v_lshrrev_b32 v31,1,v30
MF v[180:183],a[16:19],a[52:55],v[180:183]
s_mov_b32 s46,768
buffer_load_dwordx4 v14,s[12:15],s46 offen lds
v_xor_b32 v31,v31,v30
MF v[184:187],a[16:19],a[56:59],v[184:187]
TR a[112:113],v10,0
v_and_b32 v31,4,v31
MF v[188:191],a[16:19],a[60:63],v[188:191]
MF v[192:195],a[20:23],a[32:35],v[192:195]
TR a[114:115],v10,1024
v_mul_u32_u24 v31,3,v31
MF v[196:199],a[20:23],a[36:39],v[196:199]
v_xor_b32 v30,v30,v31
MF v[200:203],a[20:23],a[40:43],v[200:203]
RD a[84:87],v3,10240
v_mul_u32_u24 v30,s53,v30
MF v[204:207],a[20:23],a[44:47],v[204:207]
s_mov_b32 s46,15104
buffer_load_dwordx4 v14,s[12:15],s46 offen offset:2048 lds
v_lshl_add_u32 v23,v29,4,v30
MF v[208:211],a[20:23],a[48:51],v[208:211]
TR a[116:117],v11,0
MF v[212:215],a[20:23],a[52:55],v[212:215]
v_subrev_u32 v23,3072,v23
MF v[216:219],a[20:23],a[56:59],v[216:219]
TR a[118:119],v11,1024
v_add_u32 v29,512,v1
MF v[220:223],a[20:23],a[60:63],v[220:223]
v_mul_u32_u24 v30,s52,v29
MF v[224:227],a[24:27],a[32:35],v[224:227]
RD a[88:91],v3,12288
MF v[228:231],a[24:27],a[36:39],v[228:231]
v_lshrrev_b32 v30,16,v30
MF v[232:235],a[24:27],a[40:43],v[232:235]
s_add_u32 m0,s48,69632
s_mov_b32 s46,33536
TR a[120:121],v12,0
MF v[236:239],a[24:27],a[44:47],v[236:239]
buffer_load_dwordx4 v14,s[12:15],s46 offen lds
v_mul_u32_u24 v31,18,v30
MF v[240:243],a[24:27],a[48:51],v[240:243]
TR a[122:123],v12,1024
v_sub_u32 v29,v29,v31
MF v[244:247],a[24:27],a[52:55],v[244:247]
v_lshrrev_b32 v31,1,v30
MF v[248:251],a[24:27],a[56:59],v[248:251]
RD a[92:95],v3,14336
v_xor_b32 v31,v31,v30
MF v[252:255],a[24:27],a[60:63],v[252:255]
v_and_b32 v31,4,v31
MF a[192:195],a[28:31],a[32:35],a[192:195]
TR a[124:125],v13,0
v_mul_u32_u24 v31,3,v31
MF a[196:199],a[28:31],a[36:39],a[196:199]
s_mov_b32 s46,47872
buffer_load_dwordx4 v14,s[12:15],s46 offen offset:2048 lds
MF a[200:203],a[28:31],a[40:43],a[200:203]
TR a[126:127],v13,1024
v_xor_b32 v30,v30,v31
MF a[204:207],a[28:31],a[44:47],a[204:207]
v_mul_u32_u24 v30,s53,v30
MF a[208:211],a[28:31],a[48:51],a[208:211]
v_lshl_add_u32 v24,v29,4,v30
MF a[212:215],a[28:31],a[52:55],a[212:215]
MF a[216:219],a[28:31],a[56:59],a[216:219]
MF a[220:223],a[28:31],a[60:63],a[220:223]
LW 15
MF v[32:35],a[64:67],a[96:99],v[32:35]
MF v[36:39],a[64:67],a[100:103],v[36:39]
MF v[40:43],a[64:67],a[104:107],v[40:43]
LW 12
MF v[44:47],a[64:67],a[108:111],v[44:47]
LW 9
MF v[48:51],a[64:67],a[112:115],v[48:51]
LW 6
MF v[52:55],a[64:67],a[116:119],v[52:55]
LW 3
MF v[56:59],a[64:67],a[120:123],v[56:59]
LW 0
MF v[60:63],a[64:67],a[124:127],v[60:63]
s_waitcnt vmcnt(20)
MF v[64:67],a[68:71],a[96:99],v[64:67]
s_barrier
MF v[68:71],a[68:71],a[100:103],v[68:71]
s_add_u32 m0,s49,0
s_mov_b32 s47,3145728
RD a[0:3],v4,0
MF v[72:75],a[68:71],a[104:107],v[72:75]
buffer_load_dwordx4 v15,s[16:19],s47 offen lds
MF v[76:79],a[68:71],a[108:111],v[76:79]
TR a[32:33],v6,16384
MF v[80:83],a[68:71],a[112:115],v[80:83]
MF v[84:87],a[68:71],a[116:119],v[84:87]
TR a[34:35],v6,17408
MF v[88:91],a[68:71],a[120:123],v[88:91]
s_mov_b32 s47,3177472
buffer_load_dwordx4 v15,s[16:19],s47 offen offset:1024 lds
MF v[92:95],a[68:71],a[124:127],v[92:95]
RD a[4:7],v4,2048
MF v[96:99],a[72:75],a[96:99],v[96:99]
MF v[100:103],a[72:75],a[100:103],v[100:103]
TR a[36:37],v7,16384
MF v[104:107],a[72:75],a[104:107],v[104:107]
MF v[108:111],a[72:75],a[108:111],v[108:111]
s_mov_b32 s47,3274752
TR a[38:39],v7,17408
buffer_load_dwordx4 v15,s[16:19],s47 offen offset:2048 lds
MF v[112:115],a[72:75],a[112:115],v[112:115]
MF v[116:119],a[72:75],a[116:119],v[116:119]
RD a[8:11],v4,4096
MF v[120:123],a[72:75],a[120:123],v[120:123]
MF v[124:127],a[72:75],a[124:127],v[124:127]
TR a[40:41],v8,16384
MF v[128:131],a[76:79],a[96:99],v[128:131]
s_mov_b32 s47,3306496
buffer_load_dwordx4 v15,s[16:19],s47 offen offset:3072 lds
MF v[132:135],a[76:79],a[100:103],v[132:135]
MF v[136:139],a[76:79],a[104:107],v[136:139]
TR a[42:43],v8,17408
MF v[140:143],a[76:79],a[108:111],v[140:143]
MF v[144:147],a[76:79],a[112:115],v[144:147]
RD a[12:15],v4,6144
MF v[148:151],a[76:79],a[116:119],v[148:151]
s_add_u32 m0,s48,73728
s_mov_b32 s46,66304
buffer_load_dwordx4 v14,s[12:15],s46 offen lds
MF v[152:155],a[76:79],a[120:123],v[152:155]
TR a[44:45],v9,16384
MF v[156:159],a[76:79],a[124:127],v[156:159]
MF v[160:163],a[80:83],a[96:99],v[160:163]
TR a[46:47],v9,17408
MF v[164:167],a[80:83],a[100:103],v[164:167]
MF v[168:171],a[80:83],a[104:107],v[168:171]
s_mov_b32 s46,80640
RD a[16:19],v4,8192
buffer_load_dwordx4 v14,s[12:15],s46 offen offset:2048 lds
MF v[172:175],a[80:83],a[108:111],v[172:175]
MF v[176:179],a[80:83],a[112:115],v[176:179]
TR a[48:49],v10,16384
MF v[180:183],a[80:83],a[116:119],v[180:183]
MF v[184:187],a[80:83],a[120:123],v[184:187]
TR a[50:51],v10,17408
MF v[188:191],a[80:83],a[124:127],v[188:191]
s_add_u32 m0,s48,77824
s_mov_b32 s46,99072
buffer_load_dwordx4 v14,s[12:15],s46 offen lds
MF v[192:195],a[84:87],a[96:99],v[192:195]
RD a[20:23],v4,10240
MF v[196:199],a[84:87],a[100:103],v[196:199]
MF v[200:203],a[84:87],a[104:107],v[200:203]
MF v[204:207],a[84:87],a[108:111],v[204:207]
TR a[52:53],v11,16384
MF v[208:211],a[84:87],a[112:115],v[208:211]
s_mov_b32 s46,113408
buffer_load_dwordx4 v14,s[12:15],s46 offen offset:2048 lds
MF v[212:215],a[84:87],a[116:119],v[212:215]
TR a[54:55],v11,17408
MF v[216:219],a[84:87],a[120:123],v[216:219]
MF v[220:223],a[84:87],a[124:127],v[220:223]
RD a[24:27],v4,12288
MF v[224:227],a[88:91],a[96:99],v[224:227]
MF v[228:231],a[88:91],a[100:103],v[228:231]
s_lshl_b32 s7,s2,4
s_lshl_b32 s41,s32,2
s_add_u32 s7,s7,s41
MF v[232:235],a[88:91],a[104:107],v[232:235]
s_add_u32 s7,s7,0x8300000
v_mov_b32 v30,s7
v_mov_b32 v31,s3
MF v[236:239],a[88:91],a[108:111],v[236:239]
TR a[56:57],v12,16384
global_store_dword v30,v31,s[4:5] sc1
MF v[240:243],a[88:91],a[112:115],v[240:243]
TR a[58:59],v12,17408
MF v[244:247],a[88:91],a[116:119],v[244:247]
RD a[28:31],v4,14336
MF v[248:251],a[88:91],a[120:123],v[248:251]
s_lshl_b32 s42,s35,3
s_add_u32 s42,s42,s36
s_lshl_b32 s7,s42,4
MF v[252:255],a[88:91],a[124:127],v[252:255]
s_lshl_b32 s41,s32,2
s_add_u32 s7,s7,s41
s_add_u32 s7,s7,0x8307000
MF a[192:195],a[92:95],a[96:99],a[192:195]
v_mov_b32 v30,s7
v_mov_b32 v31,s37
MF a[196:199],a[92:95],a[100:103],a[196:199]
TR a[60:61],v13,16384
global_store_dword v30,v31,s[4:5] sc1
MF a[200:203],a[92:95],a[104:107],a[200:203]
TR a[62:63],v13,17408
MF a[204:207],a[92:95],a[108:111],a[204:207]
s_lshl_b32 s7,s2,2
s_add_u32 s7,s7,s32
s_mul_i32 s7,s7,1536
MF a[208:211],a[92:95],a[112:115],a[208:211]
s_add_u32 s7,s7,0
v_lshlrev_b32 v0,7,v1
v_min_u32 v0,1532,v0
MF a[212:215],a[92:95],a[116:119],a[212:215]
v_add_u32 v0,s7,v0
MF a[216:219],a[92:95],a[120:123],a[216:219]
global_load_dword a177,v0,s[68:69]
MF a[220:223],a[92:95],a[124:127],a[220:223]
LW 15
MF v[32:35],a[0:3],a[32:35],v[32:35]
MF v[36:39],a[0:3],a[36:39],v[36:39]
MF v[40:43],a[0:3],a[40:43],v[40:43]
LW 12
MF v[44:47],a[0:3],a[44:47],v[44:47]
LW 9
MF v[48:51],a[0:3],a[48:51],v[48:51]
LW 6
MF v[52:55],a[0:3],a[52:55],v[52:55]
LW 3
MF v[56:59],a[0:3],a[56:59],v[56:59]
LW 0
MF v[60:63],a[0:3],a[60:63],v[60:63]
s_waitcnt vmcnt(19)
MF v[64:67],a[4:7],a[32:35],v[64:67]
s_barrier
MF v[68:71],a[4:7],a[36:39],v[68:71]
s_add_u32 m0,s49,16384
s_mov_b32 s47,3407872
v_add_u32 v3,32768,v5
MF v[72:75],a[4:7],a[40:43],v[72:75]
buffer_load_dwordx4 v15,s[16:19],s47 offen lds
v_xor_b32 v4,64,v3
MF v[76:79],a[4:7],a[44:47],v[76:79]
MF v[80:83],a[4:7],a[48:51],v[80:83]
RD a[64:67],v3,0
MF v[84:87],a[4:7],a[52:55],v[84:87]
MF v[88:91],a[4:7],a[56:59],v[88:91]
s_mov_b32 s47,3439616
TR a[96:97],v6,32768
buffer_load_dwordx4 v15,s[16:19],s47 offen offset:1024 lds
MF v[92:95],a[4:7],a[60:63],v[92:95]
MF v[96:99],a[8:11],a[32:35],v[96:99]
TR a[98:99],v6,33792
MF v[100:103],a[8:11],a[36:39],v[100:103]
MF v[104:107],a[8:11],a[40:43],v[104:107]
RD a[68:71],v3,2048
MF v[108:111],a[8:11],a[44:47],v[108:111]
MF v[112:115],a[8:11],a[48:51],v[112:115]
s_mov_b32 s47,3536896
TR a[100:101],v7,32768
buffer_load_dwordx4 v15,s[16:19],s47 offen offset:2048 lds
MF v[116:119],a[8:11],a[52:55],v[116:119]
MF v[120:123],a[8:11],a[56:59],v[120:123]
TR a[102:103],v7,33792
MF v[124:127],a[8:11],a[60:63],v[124:127]
MF v[128:131],a[12:15],a[32:35],v[128:131]
RD a[72:75],v3,4096
MF v[132:135],a[12:15],a[36:39],v[132:135]
s_mov_b32 s47,3568640
buffer_load_dwordx4 v15,s[16:19],s47 offen offset:3072 lds
MF v[136:139],a[12:15],a[40:43],v[136:139]
TR a[104:105],v8,32768
MF v[140:143],a[12:15],a[44:47],v[140:143]
MF v[144:147],a[12:15],a[48:51],v[144:147]
TR a[106:107],v8,33792
MF v[148:151],a[12:15],a[52:55],v[148:151]
MF v[152:155],a[12:15],a[56:59],v[152:155]
RD a[76:79],v3,6144
MF v[156:159],a[12:15],a[60:63],v[156:159]
s_add_u32 m0,s48,0
s_mov_b32 s46,896
buffer_load_dwordx4 v14,s[12:15],s46 offen lds
MF v[160:163],a[16:19],a[32:35],v[160:163]
TR a[108:109],v9,32768
MF v[164:167],a[16:19],a[36:39],v[164:167]
MF v[168:171],a[16:19],a[40:43],v[168:171]
TR a[110:111],v9,33792
MF v[172:175],a[16:19],a[44:47],v[172:175]
MF v[176:179],a[16:19],a[48:51],v[176:179]
s_mov_b32 s46,15232
buffer_load_dwordx4 v14,s[12:15],s46 offen offset:2048 lds
RD a[80:83],v3,8192
MF v[180:183],a[16:19],a[52:55],v[180:183]
MF v[184:187],a[16:19],a[56:59],v[184:187]
TR a[112:113],v10,32768
MF v[188:191],a[16:19],a[60:63],v[188:191]
MF v[192:195],a[20:23],a[32:35],v[192:195]
TR a[114:115],v10,33792
MF v[196:199],a[20:23],a[36:39],v[196:199]
MF v[200:203],a[20:23],a[40:43],v[200:203]
s_add_u32 m0,s48,4096
s_mov_b32 s46,33664
buffer_load_dwordx4 v14,s[12:15],s46 offen lds
MF v[204:207],a[20:23],a[44:47],v[204:207]
RD a[84:87],v3,10240
MF v[208:211],a[20:23],a[48:51],v[208:211]
TR a[116:117],v11,32768
MF v[212:215],a[20:23],a[52:55],v[212:215]
MF v[216:219],a[20:23],a[56:59],v[216:219]
TR a[118:119],v11,33792
MF v[220:223],a[20:23],a[60:63],v[220:223]
s_mov_b32 s46,48000
buffer_load_dwordx4 v14,s[12:15],s46 offen offset:2048 lds
MF v[224:227],a[24:27],a[32:35],v[224:227]
RD a[88:91],v3,12288
MF v[228:231],a[24:27],a[36:39],v[228:231]
MF v[232:235],a[24:27],a[40:43],v[232:235]
TR a[120:121],v12,32768
MF v[236:239],a[24:27],a[44:47],v[236:239]
MF v[240:243],a[24:27],a[48:51],v[240:243]
TR a[122:123],v12,33792
MF v[244:247],a[24:27],a[52:55],v[244:247]
s_add_u32 s40,s0,Lm_z-Lm_pc
s_addc_u32 s41,s1,0
s_lshr_b32 s7,s2,3
MF v[248:251],a[24:27],a[56:59],v[248:251]
s_lshl_b32 s7,s7,2
s_add_u32 s7,s7,s32
s_lshl_b32 s7,s7,9
MF v[252:255],a[24:27],a[60:63],v[252:255]
v_and_b32 v30,3,v1
v_lshl_add_u32 v30,v30,7,s7
MF a[192:195],a[28:31],a[32:35],a[192:195]
RD a[92:95],v3,14336
v_min_u32 v30,Lm_codeend-Lm_z-4,v30
MF a[196:199],a[28:31],a[36:39],a[196:199]
TR a[124:125],v13,32768
global_load_dword a141,v30,s[40:41]
MF a[200:203],a[28:31],a[40:43],a[200:203]
s_lshl_b32 s7,s2,2
s_add_u32 s7,s7,s32
TR a[126:127],v13,33792
MF a[204:207],a[28:31],a[44:47],a[204:207]
s_mul_i32 s7,s7,1536
s_add_u32 s7,s7,1572864
v_lshlrev_b32 v0,7,v1
MF a[208:211],a[28:31],a[48:51],a[208:211]
v_min_u32 v0,1532,v0
v_add_u32 v0,s7,v0
MF a[212:215],a[28:31],a[52:55],a[212:215]
global_load_dword a178,v0,s[68:69]
MF a[216:219],a[28:31],a[56:59],a[216:219]
MF a[220:223],a[28:31],a[60:63],a[220:223]
LW 15
MF v[32:35],a[64:67],a[96:99],v[32:35]
MF v[36:39],a[64:67],a[100:103],v[36:39]
MF v[40:43],a[64:67],a[104:107],v[40:43]
LW 12
MF v[44:47],a[64:67],a[108:111],v[44:47]
LW 9
MF v[48:51],a[64:67],a[112:115],v[48:51]
LW 6
MF v[52:55],a[64:67],a[116:119],v[52:55]
LW 3
MF v[56:59],a[64:67],a[120:123],v[56:59]
LW 0
MF v[60:63],a[64:67],a[124:127],v[60:63]
s_waitcnt vmcnt(25)
MF v[64:67],a[68:71],a[96:99],v[64:67]
s_barrier
MF v[68:71],a[68:71],a[100:103],v[68:71]
s_add_u32 m0,s49,32768
s_mov_b32 s47,3670016
RD a[0:3],v4,0
MF v[72:75],a[68:71],a[104:107],v[72:75]
buffer_load_dwordx4 v15,s[16:19],s47 offen lds
MF v[76:79],a[68:71],a[108:111],v[76:79]
TR a[32:33],v6,49152
MF v[80:83],a[68:71],a[112:115],v[80:83]
MF v[84:87],a[68:71],a[116:119],v[84:87]
TR a[34:35],v6,50176
MF v[88:91],a[68:71],a[120:123],v[88:91]
s_mov_b32 s47,3701760
buffer_load_dwordx4 v15,s[16:19],s47 offen offset:1024 lds
MF v[92:95],a[68:71],a[124:127],v[92:95]
RD a[4:7],v4,2048
MF v[96:99],a[72:75],a[96:99],v[96:99]
MF v[100:103],a[72:75],a[100:103],v[100:103]
TR a[36:37],v7,49152
MF v[104:107],a[72:75],a[104:107],v[104:107]
MF v[108:111],a[72:75],a[108:111],v[108:111]
TR a[38:39],v7,50176
MF v[112:115],a[72:75],a[112:115],v[112:115]
s_mov_b32 s47,3799040
buffer_load_dwordx4 v15,s[16:19],s47 offen offset:2048 lds
MF v[116:119],a[72:75],a[116:119],v[116:119]
RD a[8:11],v4,4096
MF v[120:123],a[72:75],a[120:123],v[120:123]
MF v[124:127],a[72:75],a[124:127],v[124:127]
TR a[40:41],v8,49152
MF v[128:131],a[76:79],a[96:99],v[128:131]
MF v[132:135],a[76:79],a[100:103],v[132:135]
s_mov_b32 s47,3830784
buffer_load_dwordx4 v15,s[16:19],s47 offen offset:3072 lds
MF v[136:139],a[76:79],a[104:107],v[136:139]
TR a[42:43],v8,50176
MF v[140:143],a[76:79],a[108:111],v[140:143]
MF v[144:147],a[76:79],a[112:115],v[144:147]
RD a[12:15],v4,6144
MF v[148:151],a[76:79],a[116:119],v[148:151]
MF v[152:155],a[76:79],a[120:123],v[152:155]
TR a[44:45],v9,49152
MF v[156:159],a[76:79],a[124:127],v[156:159]
s_add_u32 m0,s48,8192
s_mov_b32 s46,66432
buffer_load_dwordx4 v14,s[12:15],s46 offen lds
MF v[160:163],a[80:83],a[96:99],v[160:163]
TR a[46:47],v9,50176
MF v[164:167],a[80:83],a[100:103],v[164:167]
MF v[168:171],a[80:83],a[104:107],v[168:171]
RD a[16:19],v4,8192
MF v[172:175],a[80:83],a[108:111],v[172:175]
MF v[176:179],a[80:83],a[112:115],v[176:179]
s_mov_b32 s46,80768
TR a[48:49],v10,49152
buffer_load_dwordx4 v14,s[12:15],s46 offen offset:2048 lds
MF v[180:183],a[80:83],a[116:119],v[180:183]
MF v[184:187],a[80:83],a[120:123],v[184:187]
TR a[50:51],v10,50176
MF v[188:191],a[80:83],a[124:127],v[188:191]
MF v[192:195],a[84:87],a[96:99],v[192:195]
RD a[20:23],v4,10240
MF v[196:199],a[84:87],a[100:103],v[196:199]
MF v[200:203],a[84:87],a[104:107],v[200:203]
s_add_u32 m0,s48,12288
s_mov_b32 s46,99200
buffer_load_dwordx4 v14,s[12:15],s46 offen lds
MF v[204:207],a[84:87],a[108:111],v[204:207]
TR a[52:53],v11,49152
MF v[208:211],a[84:87],a[112:115],v[208:211]
MF v[212:215],a[84:87],a[116:119],v[212:215]
TR a[54:55],v11,50176
MF v[216:219],a[84:87],a[120:123],v[216:219]
MF v[220:223],a[84:87],a[124:127],v[220:223]
s_mov_b32 s46,113536
buffer_load_dwordx4 v14,s[12:15],s46 offen offset:2048 lds
RD a[24:27],v4,12288
MF v[224:227],a[88:91],a[96:99],v[224:227]
MF v[228:231],a[88:91],a[100:103],v[228:231]
TR a[56:57],v12,49152
MF v[232:235],a[88:91],a[104:107],v[232:235]
MF v[236:239],a[88:91],a[108:111],v[236:239]
TR a[58:59],v12,50176
MF v[240:243],a[88:91],a[112:115],v[240:243]
MF v[244:247],a[88:91],a[116:119],v[244:247]
s_lshl_b32 s42,s33,4
s_lshl_b32 s7,s42,4
s_add_u32 s7,s7,0x8300000
MF v[248:251],a[88:91],a[120:123],v[248:251]
RD a[28:31],v4,14336
v_lshl_add_u32 v30,v1,2,s7
MF v[252:255],a[88:91],a[124:127],v[252:255]
TR a[60:61],v13,49152
global_load_dword v31,v30,s[4:5] sc1
MF a[192:195],a[92:95],a[96:99],a[192:195]
MF a[196:199],a[92:95],a[100:103],a[196:199]
TR a[62:63],v13,50176
MF a[200:203],a[92:95],a[104:107],a[200:203]
s_lshl_b32 s7,s2,2
s_add_u32 s7,s7,s32
s_mul_i32 s7,s7,1536
MF a[204:207],a[92:95],a[108:111],a[204:207]
s_add_u32 s7,s7,3145728
v_lshlrev_b32 v0,7,v1
v_min_u32 v0,1532,v0
MF a[208:211],a[92:95],a[112:115],a[208:211]
v_add_u32 v0,s7,v0
MF a[212:215],a[92:95],a[116:119],a[212:215]
global_load_dword a179,v0,s[68:69]
MF a[216:219],a[92:95],a[120:123],a[216:219]
MF a[220:223],a[92:95],a[124:127],a[220:223]
LW 15
MF v[32:35],a[0:3],a[32:35],v[32:35]
s_mov_b32 s28,s80
MF v[36:39],a[0:3],a[36:39],v[36:39]
s_mov_b32 s29,s81
MF v[40:43],a[0:3],a[40:43],v[40:43]
LW 12
MF v[44:47],a[0:3],a[44:47],v[44:47]
LW 9
s_mov_b32 s30,0x800000
MF v[48:51],a[0:3],a[48:51],v[48:51]
LW 6
MF v[52:55],a[0:3],a[52:55],v[52:55]
LW 3
s_mov_b32 s31,0x20000
MF v[56:59],a[0:3],a[56:59],v[56:59]
LW 0
MF v[60:63],a[0:3],a[60:63],v[60:63]
s_waitcnt vmcnt(23)
v_and_b32 v29,7,v1
MF v[64:67],a[4:7],a[32:35],v[64:67]
s_barrier
MF v[68:71],a[4:7],a[36:39],v[68:71]
s_add_u32 m0,s49,49152
s_mov_b32 s47,3932160
v_add_u32 v3,65536,v5
MF v[72:75],a[4:7],a[40:43],v[72:75]
s_and_b32 s40,s34,1
s_lshl_b32 s40,s40,3
buffer_load_dwordx4 v15,s[16:19],s47 offen lds
MF v[76:79],a[4:7],a[44:47],v[76:79]
v_xor_b32 v4,64,v3
MF v[80:83],a[4:7],a[48:51],v[80:83]
RD a[64:67],v3,0
v_add_u32 v29,s40,v29
MF v[84:87],a[4:7],a[52:55],v[84:87]
MF v[88:91],a[4:7],a[56:59],v[88:91]
TR a[96:97],v6,0
v_lshrrev_b32 v0,2,v29
MF v[92:95],a[4:7],a[60:63],v[92:95]
MF v[96:99],a[8:11],a[32:35],v[96:99]
TR a[98:99],v6,1024
v_lshlrev_b32 v0,3,v0
MF v[100:103],a[8:11],a[36:39],v[100:103]
MF v[104:107],a[8:11],a[40:43],v[104:107]
RD a[68:71],v3,2048
v_and_b32 v14,3,v29
MF v[108:111],a[8:11],a[44:47],v[108:111]
MF v[112:115],a[8:11],a[48:51],v[112:115]
s_lshl_b32 s41,s33,7
TR a[100:101],v7,0
MF v[116:119],a[8:11],a[52:55],v[116:119]
s_lshr_b32 s42,s34,2
MF v[120:123],a[8:11],a[56:59],v[120:123]
s_mov_b32 s47,3963904
buffer_load_dwordx4 v15,s[16:19],s47 offen offset:1024 lds
TR a[102:103],v7,1024
MF v[124:127],a[8:11],a[60:63],v[124:127]
s_lshl_b32 s42,s42,5
MF v[128:131],a[12:15],a[32:35],v[128:131]
RD a[72:75],v3,4096
MF v[132:135],a[12:15],a[36:39],v[132:135]
s_add_u32 s41,s41,s42
MF v[136:139],a[12:15],a[40:43],v[136:139]
TR a[104:105],v8,0
MF v[140:143],a[12:15],a[44:47],v[140:143]
s_bfe_u32 s42,s34,0x10001
MF v[144:147],a[12:15],a[48:51],v[144:147]
TR a[106:107],v8,1024
MF v[148:151],a[12:15],a[52:55],v[148:151]
s_lshl_b32 s42,s42,2
MF v[152:155],a[12:15],a[56:59],v[152:155]
RD a[76:79],v3,6144
MF v[156:159],a[12:15],a[60:63],v[156:159]
s_add_u32 s41,s41,s42
MF v[160:163],a[16:19],a[32:35],v[160:163]
TR a[108:109],v9,0
v_add3_u32 v0,v0,v14,s41
MF v[164:167],a[16:19],a[36:39],v[164:167]
MF v[168:171],a[16:19],a[40:43],v[168:171]
TR a[110:111],v9,1024
v_lshlrev_b32 v0,12,v0
MF v[172:175],a[16:19],a[44:47],v[172:175]
MF v[176:179],a[16:19],a[48:51],v[176:179]
s_mov_b32 s47,4061184
RD a[80:83],v3,8192
v_lshrrev_b32 v14,3,v1
MF v[180:183],a[16:19],a[52:55],v[180:183]
buffer_load_dwordx4 v15,s[16:19],s47 offen offset:2048 lds
MF v[184:187],a[16:19],a[56:59],v[184:187]
TR a[112:113],v10,0
v_lshl_add_u32 v0,v14,4,v0
MF v[188:191],a[16:19],a[60:63],v[188:191]
MF v[192:195],a[20:23],a[32:35],v[192:195]
s_lshl_b32 s42,s32,10
TR a[114:115],v10,1024
MF v[196:199],a[20:23],a[36:39],v[196:199]
v_add_u32 v0,s42,v0
MF v[200:203],a[20:23],a[40:43],v[200:203]
RD a[84:87],v3,10240
MF v[204:207],a[20:23],a[44:47],v[204:207]
v_lshlrev_b32 v29,4,v29
MF v[208:211],a[20:23],a[48:51],v[208:211]
TR a[116:117],v11,0
MF v[212:215],a[20:23],a[52:55],v[212:215]
v_lshl_add_u32 v29,v14,8,v29
MF v[216:219],a[20:23],a[56:59],v[216:219]
TR a[118:119],v11,1024
MF v[220:223],a[20:23],a[60:63],v[220:223]
s_lshl_b32 s41,s33,3
MF v[224:227],a[24:27],a[32:35],v[224:227]
RD a[88:91],v3,12288
MF v[228:231],a[24:27],a[36:39],v[228:231]
s_lshr_b32 s42,s34,1
MF v[232:235],a[24:27],a[40:43],v[232:235]
s_mov_b32 s47,4092928
buffer_load_dwordx4 v15,s[16:19],s47 offen offset:3072 lds
TR a[120:121],v12,0
MF v[236:239],a[24:27],a[44:47],v[236:239]
s_add_u32 s41,s41,s42
MF v[240:243],a[24:27],a[48:51],v[240:243]
s_lshl_b32 s41,s41,16
TR a[122:123],v12,1024
MF v[244:247],a[24:27],a[52:55],v[244:247]
MF v[248:251],a[24:27],a[56:59],v[248:251]
s_lshl_b32 s42,s32,14
RD a[92:95],v3,14336
MF v[252:255],a[24:27],a[60:63],v[252:255]
MF a[192:195],a[28:31],a[32:35],a[192:195]
s_add_u32 s41,s41,s42
TR a[124:125],v13,0
MF a[196:199],a[28:31],a[36:39],a[196:199]
MF a[200:203],a[28:31],a[40:43],a[200:203]
TR a[126:127],v13,1024
v_add_u32 v29,s41,v29
MF a[204:207],a[28:31],a[44:47],a[204:207]
MF a[208:211],a[28:31],a[48:51],a[208:211]
AW a176,v29
MF a[212:215],a[28:31],a[52:55],a[212:215]
MF a[216:219],a[28:31],a[56:59],a[216:219]
MF a[220:223],a[28:31],a[60:63],a[220:223]
LW 15
MF v[32:35],a[64:67],a[96:99],v[32:35]
MF v[36:39],a[64:67],a[100:103],v[36:39]
MF v[40:43],a[64:67],a[104:107],v[40:43]
LW 12
MF v[44:47],a[64:67],a[108:111],v[44:47]
LW 9
MF v[48:51],a[64:67],a[112:115],v[48:51]
LW 6
MF v[52:55],a[64:67],a[116:119],v[52:55]
LW 3
MF v[56:59],a[64:67],a[120:123],v[56:59]
LW 0
MF v[60:63],a[64:67],a[124:127],v[60:63]
s_waitcnt vmcnt(20)
MF v[64:67],a[68:71],a[96:99],v[64:67]
s_barrier
s_waitcnt vmcnt(5)
v_cmp_ne_u32 vcc,s3,v31
s_nop 0
s_cbranch_vccnz Lm_pl2
Lm_pl2r:
MF v[68:71],a[68:71],a[100:103],v[68:71]
buffer_load_dwordx4 a[224:227],v0,s[28:31],0 offen nt
RD a[0:3],v4,0
MF v[72:75],a[68:71],a[104:107],v[72:75]
MF v[76:79],a[68:71],a[108:111],v[76:79]
TR a[32:33],v6,16384
MF v[80:83],a[68:71],a[112:115],v[80:83]
MF v[84:87],a[68:71],a[116:119],v[84:87]
TR a[34:35],v6,17408
MF v[88:91],a[68:71],a[120:123],v[88:91]
MF v[92:95],a[68:71],a[124:127],v[92:95]
RD a[4:7],v4,2048
MF v[96:99],a[72:75],a[96:99],v[96:99]
MF v[100:103],a[72:75],a[100:103],v[100:103]
TR a[36:37],v7,16384
MF v[104:107],a[72:75],a[104:107],v[104:107]
MF v[108:111],a[72:75],a[108:111],v[108:111]
TR a[38:39],v7,17408
MF v[112:115],a[72:75],a[112:115],v[112:115]
MF v[116:119],a[72:75],a[116:119],v[116:119]
RD a[8:11],v4,4096
MF v[120:123],a[72:75],a[120:123],v[120:123]
buffer_load_dwordx4 a[228:231],v0,s[28:31],0 offen offset:128 nt
MF v[124:127],a[72:75],a[124:127],v[124:127]
TR a[40:41],v8,16384
MF v[128:131],a[76:79],a[96:99],v[128:131]
MF v[132:135],a[76:79],a[100:103],v[132:135]
MF v[136:139],a[76:79],a[104:107],v[136:139]
TR a[42:43],v8,17408
MF v[140:143],a[76:79],a[108:111],v[140:143]
MF v[144:147],a[76:79],a[112:115],v[144:147]
RD a[12:15],v4,6144
MF v[148:151],a[76:79],a[116:119],v[148:151]
MF v[152:155],a[76:79],a[120:123],v[152:155]
TR a[44:45],v9,16384
MF v[156:159],a[76:79],a[124:127],v[156:159]
MF v[160:163],a[80:83],a[96:99],v[160:163]
TR a[46:47],v9,17408
MF v[164:167],a[80:83],a[100:103],v[164:167]
MF v[168:171],a[80:83],a[104:107],v[168:171]
RD a[16:19],v4,8192
MF v[172:175],a[80:83],a[108:111],v[172:175]
MF v[176:179],a[80:83],a[112:115],v[176:179]
TR a[48:49],v10,16384
buffer_load_dwordx4 a[232:235],v0,s[28:31],0 offen offset:256 nt
MF v[180:183],a[80:83],a[116:119],v[180:183]
MF v[184:187],a[80:83],a[120:123],v[184:187]
TR a[50:51],v10,17408
MF v[188:191],a[80:83],a[124:127],v[188:191]
MF v[192:195],a[84:87],a[96:99],v[192:195]
RD a[20:23],v4,10240
MF v[196:199],a[84:87],a[100:103],v[196:199]
MF v[200:203],a[84:87],a[104:107],v[200:203]
MF v[204:207],a[84:87],a[108:111],v[204:207]
TR a[52:53],v11,16384
MF v[208:211],a[84:87],a[112:115],v[208:211]
MF v[212:215],a[84:87],a[116:119],v[212:215]
TR a[54:55],v11,17408
MF v[216:219],a[84:87],a[120:123],v[216:219]
MF v[220:223],a[84:87],a[124:127],v[220:223]
RD a[24:27],v4,12288
MF v[224:227],a[88:91],a[96:99],v[224:227]
MF v[228:231],a[88:91],a[100:103],v[228:231]
TR a[56:57],v12,16384
MF v[232:235],a[88:91],a[104:107],v[232:235]
buffer_load_dwordx4 a[236:239],v0,s[28:31],0 offen offset:384 nt
MF v[236:239],a[88:91],a[108:111],v[236:239]
TR a[58:59],v12,17408
MF v[240:243],a[88:91],a[112:115],v[240:243]
MF v[244:247],a[88:91],a[116:119],v[244:247]
RD a[28:31],v4,14336
MF v[248:251],a[88:91],a[120:123],v[248:251]
MF v[252:255],a[88:91],a[124:127],v[252:255]
TR a[60:61],v13,16384
MF a[192:195],a[92:95],a[96:99],a[192:195]
MF a[196:199],a[92:95],a[100:103],a[196:199]
TR a[62:63],v13,17408
MF a[200:203],a[92:95],a[104:107],a[200:203]
MF a[204:207],a[92:95],a[108:111],a[204:207]
MF a[208:211],a[92:95],a[112:115],a[208:211]
MF a[212:215],a[92:95],a[116:119],a[212:215]
MF a[216:219],a[92:95],a[120:123],a[216:219]
MF a[220:223],a[92:95],a[124:127],a[220:223]
LW 15
MF v[32:35],a[0:3],a[32:35],v[32:35]
MF v[36:39],a[0:3],a[36:39],v[36:39]
MF v[40:43],a[0:3],a[40:43],v[40:43]
LW 12
MF v[44:47],a[0:3],a[44:47],v[44:47]
LW 9
MF v[48:51],a[0:3],a[48:51],v[48:51]
LW 6
MF v[52:55],a[0:3],a[52:55],v[52:55]
LW 3
MF v[56:59],a[0:3],a[56:59],v[56:59]
LW 0
MF v[60:63],a[0:3],a[60:63],v[60:63]
s_waitcnt vmcnt(9)
MF v[64:67],a[4:7],a[32:35],v[64:67]
s_barrier
MF v[68:71],a[4:7],a[36:39],v[68:71]
s_mov_b32 s12,s78
s_mov_b32 s13,s79
v_add_u32 v3,0,v5
MF v[72:75],a[4:7],a[40:43],v[72:75]
s_mov_b32 s14,0x510000
s_mov_b32 s15,0x20000
s_lshl_b32 s44,s32,12
MF v[76:79],a[4:7],a[44:47],v[76:79]
s_mul_i32 s45,s32,9216
s_add_u32 s45,s45,16384
s_lshr_b32 s40,s32,1
MF v[80:83],a[4:7],a[48:51],v[80:83]
s_mul_i32 s40,s40,294912
s_and_b32 s41,s32,1
s_mul_i32 s41,s41,4608
MF v[84:87],a[4:7],a[52:55],v[84:87]
s_add_u32 s40,s40,s41
s_mul_i32 s41,s34,288
s_add_u32 s46,s40,s41
MF v[88:91],a[4:7],a[56:59],v[88:91]
s_mov_b32 s47,0
s_mov_b32 s48,53248
s_mov_b32 s49,53248
MF v[92:95],a[4:7],a[60:63],v[92:95]
s_add_u32 m0,s44,s48
v_xor_b32 v4,64,v3
MF v[96:99],a[8:11],a[32:35],v[96:99]
buffer_load_dwordx4 v25,s[8:11],s47 offen sc1 lds
RD a[64:67],v3,0
MF v[100:103],a[8:11],a[36:39],v[100:103]
buffer_load_dwordx4 v25,s[8:11],s47 offen offset:1024 sc1 lds
TR a[96:97],v6,32768
MF v[104:107],a[8:11],a[40:43],v[104:107]
TR a[98:99],v6,33792
MF v[108:111],a[8:11],a[44:47],v[108:111]
RD a[68:71],v3,2048
MF v[112:115],a[8:11],a[48:51],v[112:115]
buffer_load_dwordx4 v26,s[8:11],s47 offen offset:2048 sc1 lds
TR a[100:101],v7,32768
MF v[116:119],a[8:11],a[52:55],v[116:119]
MF v[120:123],a[8:11],a[56:59],v[120:123]
TR a[102:103],v7,33792
MF v[124:127],a[8:11],a[60:63],v[124:127]
MF v[128:131],a[12:15],a[32:35],v[128:131]
buffer_load_dwordx4 v26,s[8:11],s47 offen offset:3072 sc1 lds
RD a[72:75],v3,4096
MF v[132:135],a[12:15],a[36:39],v[132:135]
s_add_u32 s47,s47,2048
MF v[136:139],a[12:15],a[40:43],v[136:139]
TR a[104:105],v8,32768
MF v[140:143],a[12:15],a[44:47],v[140:143]
MF v[144:147],a[12:15],a[48:51],v[144:147]
s_add_u32 s43,s45,s48
s_add_u32 m0,s43,0
TR a[106:107],v8,33792
MF v[148:151],a[12:15],a[52:55],v[148:151]
buffer_load_dwordx4 v16,s[12:15],s46 offen lds
MF v[152:155],a[12:15],a[56:59],v[152:155]
RD a[76:79],v3,6144
MF v[156:159],a[12:15],a[60:63],v[156:159]
MF v[160:163],a[16:19],a[32:35],v[160:163]
buffer_load_dwordx4 v17,s[12:15],s46 offen offset:1024 lds
TR a[108:109],v9,32768
MF v[164:167],a[16:19],a[36:39],v[164:167]
MF v[168:171],a[16:19],a[40:43],v[168:171]
TR a[110:111],v9,33792
MF v[172:175],a[16:19],a[44:47],v[172:175]
MF v[176:179],a[16:19],a[48:51],v[176:179]
buffer_load_dwordx4 v18,s[12:15],s46 offen offset:2048 lds
RD a[80:83],v3,8192
MF v[180:183],a[16:19],a[52:55],v[180:183]
MF v[184:187],a[16:19],a[56:59],v[184:187]
TR a[112:113],v10,32768
MF v[188:191],a[16:19],a[60:63],v[188:191]
MF v[192:195],a[20:23],a[32:35],v[192:195]
buffer_load_dwordx4 v19,s[12:15],s46 offen offset:3072 lds
TR a[114:115],v10,33792
MF v[196:199],a[20:23],a[36:39],v[196:199]
MF v[200:203],a[20:23],a[40:43],v[200:203]
RD a[84:87],v3,10240
MF v[204:207],a[20:23],a[44:47],v[204:207]
MF v[208:211],a[20:23],a[48:51],v[208:211]
s_add_u32 m0,s43,4096
TR a[116:117],v11,32768
MF v[212:215],a[20:23],a[52:55],v[212:215]
buffer_load_dwordx4 v20,s[12:15],s46 offen lds
MF v[216:219],a[20:23],a[56:59],v[216:219]
TR a[118:119],v11,33792
MF v[220:223],a[20:23],a[60:63],v[220:223]
MF v[224:227],a[24:27],a[32:35],v[224:227]
buffer_load_dwordx4 v21,s[12:15],s46 offen offset:1024 lds
RD a[88:91],v3,12288
MF v[228:231],a[24:27],a[36:39],v[228:231]
MF v[232:235],a[24:27],a[40:43],v[232:235]
TR a[120:121],v12,32768
MF v[236:239],a[24:27],a[44:47],v[236:239]
MF v[240:243],a[24:27],a[48:51],v[240:243]
buffer_load_dwordx4 v22,s[12:15],s46 offen offset:2048 lds
TR a[122:123],v12,33792
MF v[244:247],a[24:27],a[52:55],v[244:247]
MF v[248:251],a[24:27],a[56:59],v[248:251]
RD a[92:95],v3,14336
MF v[252:255],a[24:27],a[60:63],v[252:255]
MF a[192:195],a[28:31],a[32:35],a[192:195]
buffer_load_dwordx4 v23,s[12:15],s46 offen offset:3072 lds
TR a[124:125],v13,32768
MF a[196:199],a[28:31],a[36:39],a[196:199]
MF a[200:203],a[28:31],a[40:43],a[200:203]
TR a[126:127],v13,33792
MF a[204:207],a[28:31],a[44:47],a[204:207]
MF a[208:211],a[28:31],a[48:51],a[208:211]
s_add_u32 m0,s43,8192
MF a[212:215],a[28:31],a[52:55],a[212:215]
buffer_load_dwordx4 v24,s[12:15],s46 offen lds
s_add_u32 s46,s46,589824
MF a[216:219],a[28:31],a[56:59],a[216:219]
s_add_u32 s48,s48,53248
s_cmp_eq_u32 s48,159744
s_cselect_b32 s48,0,s48
MF a[220:223],a[28:31],a[60:63],a[220:223]
LW 15
MF v[32:35],a[64:67],a[96:99],v[32:35]
MF v[36:39],a[64:67],a[100:103],v[36:39]
MF v[40:43],a[64:67],a[104:107],v[40:43]
LW 12
MF v[44:47],a[64:67],a[108:111],v[44:47]
LW 9
MF v[48:51],a[64:67],a[112:115],v[48:51]
LW 6
MF v[52:55],a[64:67],a[116:119],v[52:55]
LW 3
MF v[56:59],a[64:67],a[120:123],v[56:59]
LW 0
MF v[60:63],a[64:67],a[124:127],v[60:63]
s_waitcnt vmcnt(17)
MF v[64:67],a[68:71],a[96:99],v[64:67]
s_barrier
MF v[68:71],a[68:71],a[100:103],v[68:71]
buffer_load_dwordx4 a[240:243],v0,s[28:31],0 offen offset:512 nt
RD a[24:27],v4,12288
MF v[72:75],a[68:71],a[104:107],v[72:75]
MF v[76:79],a[68:71],a[108:111],v[76:79]
TR a[32:33],v6,49152
MF v[80:83],a[68:71],a[112:115],v[80:83]
MF v[84:87],a[68:71],a[116:119],v[84:87]
TR a[34:35],v6,50176
MF v[88:91],a[68:71],a[120:123],v[88:91]
MF v[92:95],a[68:71],a[124:127],v[92:95]
RD a[28:31],v4,14336
MF v[96:99],a[72:75],a[96:99],v[96:99]
MF v[100:103],a[72:75],a[100:103],v[100:103]
TR a[36:37],v7,49152
MF v[104:107],a[72:75],a[104:107],v[104:107]
MF v[108:111],a[72:75],a[108:111],v[108:111]
TR a[38:39],v7,50176
MF v[112:115],a[72:75],a[112:115],v[112:115]
MF v[116:119],a[72:75],a[116:119],v[116:119]
RD a[20:23],v4,10240
MF v[120:123],a[72:75],a[120:123],v[120:123]
buffer_load_dwordx4 a[244:247],v0,s[28:31],0 offen offset:640 nt
MF v[124:127],a[72:75],a[124:127],v[124:127]
TR a[40:41],v8,49152
MF v[128:131],a[76:79],a[96:99],v[128:131]
MF v[132:135],a[76:79],a[100:103],v[132:135]
MF v[136:139],a[76:79],a[104:107],v[136:139]
TR a[42:43],v8,50176
MF v[140:143],a[76:79],a[108:111],v[140:143]
MF v[144:147],a[76:79],a[112:115],v[144:147]
RD a[16:19],v4,8192
MF v[148:151],a[76:79],a[116:119],v[148:151]
MF v[152:155],a[76:79],a[120:123],v[152:155]
TR a[44:45],v9,49152
MF v[156:159],a[76:79],a[124:127],v[156:159]
MF v[160:163],a[80:83],a[96:99],v[160:163]
TR a[46:47],v9,50176
MF v[164:167],a[80:83],a[100:103],v[164:167]
MF v[168:171],a[80:83],a[104:107],v[168:171]
RD a[4:7],v4,2048
MF v[172:175],a[80:83],a[108:111],v[172:175]
MF v[176:179],a[80:83],a[112:115],v[176:179]
TR a[48:49],v10,49152
buffer_load_dwordx4 a[248:251],v0,s[28:31],0 offen offset:768 nt
MF v[180:183],a[80:83],a[116:119],v[180:183]
MF v[184:187],a[80:83],a[120:123],v[184:187]
TR a[50:51],v10,50176
MF v[188:191],a[80:83],a[124:127],v[188:191]
MF v[192:195],a[84:87],a[96:99],v[192:195]
RD a[0:3],v4,0
MF v[196:199],a[84:87],a[100:103],v[196:199]
MF v[200:203],a[84:87],a[104:107],v[200:203]
MF v[204:207],a[84:87],a[108:111],v[204:207]
TR a[52:53],v11,49152
MF v[208:211],a[84:87],a[112:115],v[208:211]
MF v[212:215],a[84:87],a[116:119],v[212:215]
TR a[54:55],v11,50176
MF v[216:219],a[84:87],a[120:123],v[216:219]
MF v[220:223],a[84:87],a[124:127],v[220:223]
RD a[8:11],v4,4096
MF v[224:227],a[88:91],a[96:99],v[224:227]
MF v[228:231],a[88:91],a[100:103],v[228:231]
TR a[56:57],v12,49152
MF v[232:235],a[88:91],a[104:107],v[232:235]
buffer_load_dwordx4 a[252:255],v0,s[28:31],0 offen offset:896 nt
MF v[236:239],a[88:91],a[108:111],v[236:239]
TR a[58:59],v12,50176
MF v[240:243],a[88:91],a[112:115],v[240:243]
MF v[244:247],a[88:91],a[116:119],v[244:247]
RD a[12:15],v4,6144
MF v[248:251],a[88:91],a[120:123],v[248:251]
MF v[252:255],a[88:91],a[124:127],v[252:255]
TR a[60:61],v13,49152
MF a[192:195],a[92:95],a[96:99],a[192:195]
MF a[196:199],a[92:95],a[100:103],a[196:199]
TR a[62:63],v13,50176
MF a[200:203],a[92:95],a[104:107],a[200:203]
MF a[204:207],a[92:95],a[108:111],a[204:207]
MF a[208:211],a[92:95],a[112:115],a[208:211]
MF a[212:215],a[92:95],a[116:119],a[212:215]
MF a[216:219],a[92:95],a[120:123],a[216:219]
MF a[220:223],a[92:95],a[124:127],a[220:223]
LW 15
MF v[224:227],a[24:27],a[32:35],v[224:227]
s_mov_b32 s66,0x114040c2
MF v[228:231],a[24:27],a[36:39],v[228:231]
s_mov_b32 s67,0x71854d2
MF v[232:235],a[24:27],a[40:43],v[232:235]
LW 12
s_mov_b32 s70,0x309e6964
MF v[236:239],a[24:27],a[44:47],v[236:239]
LW 9
s_mov_b32 s71,0x35d33cb1
MF v[240:243],a[24:27],a[48:51],v[240:243]
LW 6
s_mov_b32 s72,0x22860df6
MF v[244:247],a[24:27],a[52:55],v[244:247]
LW 3
s_mov_b32 s73,0x15501023
MF v[248:251],a[24:27],a[56:59],v[248:251]
LW 0
s_mov_b32 s76,0x5d6
MF v[252:255],a[24:27],a[60:63],v[252:255]
s_waitcnt vmcnt(21)
MF a[192:195],a[28:31],a[32:35],a[192:195]
s_barrier
MF a[196:199],a[28:31],a[36:39],a[196:199]
s_add_u32 m0,s44,s48
MF a[200:203],a[28:31],a[40:43],a[200:203]
buffer_load_dwordx4 v25,s[8:11],s47 offen sc1 lds
MF a[204:207],a[28:31],a[44:47],a[204:207]
MF a[208:211],a[28:31],a[48:51],a[208:211]
MF a[212:215],a[28:31],a[52:55],a[212:215]
AR v6,a192
AR v7,a193
MF a[216:219],a[28:31],a[56:59],a[216:219]
AR v8,a194
AR v9,a195
MF a[220:223],a[28:31],a[60:63],a[220:223]
CV v224,v224,v225
CV v225,v226,v227
MF v[192:195],a[20:23],a[32:35],v[192:195]
CV v226,v6,v7
CV v227,v8,v9
MF v[196:199],a[20:23],a[36:39],v[196:199]
buffer_load_dwordx4 v25,s[8:11],s47 offen offset:1024 sc1 lds
AR v10,a196
MF v[200:203],a[20:23],a[40:43],v[200:203]
AR v11,a197
AR v12,a198
MF v[204:207],a[20:23],a[44:47],v[204:207]
AR v13,a199
CV v228,v228,v229
MF v[208:211],a[20:23],a[48:51],v[208:211]
CV v229,v230,v231
CV v230,v10,v11
MF v[212:215],a[20:23],a[52:55],v[212:215]
CV v231,v12,v13
AR v6,a200
MF v[216:219],a[20:23],a[56:59],v[216:219]
AR v7,a201
AR v8,a202
MF v[220:223],a[20:23],a[60:63],v[220:223]
AR v9,a203
CV v232,v232,v233
MF v[160:163],a[16:19],a[32:35],v[160:163]
CV v233,v234,v235
CV v234,v6,v7
MF v[164:167],a[16:19],a[36:39],v[164:167]
CV v235,v8,v9
AR v10,a204
MF v[168:171],a[16:19],a[40:43],v[168:171]
AR v11,a205
AR v12,a206
MF v[172:175],a[16:19],a[44:47],v[172:175]
AR v13,a207
CV v236,v236,v237
MF v[176:179],a[16:19],a[48:51],v[176:179]
CV v237,v238,v239
CV v238,v10,v11
MF v[180:183],a[16:19],a[52:55],v[180:183]
CV v239,v12,v13
AR v6,a208
MF v[184:187],a[16:19],a[56:59],v[184:187]
AR v7,a209
AR v8,a210
MF v[188:191],a[16:19],a[60:63],v[188:191]
AR v9,a211
CV v240,v240,v241
MF v[64:67],a[4:7],a[32:35],v[64:67]
CV v241,v242,v243
CV v242,v6,v7
MF v[68:71],a[4:7],a[36:39],v[68:71]
buffer_load_dwordx4 v26,s[8:11],s47 offen offset:2048 sc1 lds
CV v243,v8,v9
MF v[72:75],a[4:7],a[40:43],v[72:75]
AR v10,a212
AR v11,a213
MF v[76:79],a[4:7],a[44:47],v[76:79]
AR v12,a214
AR v13,a215
MF v[80:83],a[4:7],a[48:51],v[80:83]
CV v244,v244,v245
CV v245,v246,v247
MF v[84:87],a[4:7],a[52:55],v[84:87]
CV v246,v10,v11
CV v247,v12,v13
MF v[88:91],a[4:7],a[56:59],v[88:91]
AR v6,a216
AR v7,a217
MF v[92:95],a[4:7],a[60:63],v[92:95]
AR v8,a218
AR v9,a219
MF v[32:35],a[0:3],a[32:35],v[32:35]
CV v248,v248,v249
CV v249,v250,v251
MF v[36:39],a[0:3],a[36:39],v[36:39]
CV v250,v6,v7
CV v251,v8,v9
MF v[40:43],a[0:3],a[40:43],v[40:43]
AR v10,a220
AR v11,a221
MF v[44:47],a[0:3],a[44:47],v[44:47]
AR v12,a222
AR v13,a223
MF v[48:51],a[0:3],a[48:51],v[48:51]
CV v252,v252,v253
CV v253,v254,v255
MF v[52:55],a[0:3],a[52:55],v[52:55]
CV v254,v10,v11
CV v255,v12,v13
MF v[56:59],a[0:3],a[56:59],v[56:59]
buffer_load_dwordx4 v26,s[8:11],s47 offen offset:3072 sc1 lds
s_add_u32 s47,s47,2048
MF v[60:63],a[0:3],a[60:63],v[60:63]
s_add_u32 s43,s45,s48
CV v160,v160,v161
s_add_u32 m0,s43,0
MF v[96:99],a[8:11],a[32:35],v[96:99]
buffer_load_dwordx4 v16,s[12:15],s46 offen lds
CV v161,v162,v163
MF v[100:103],a[8:11],a[36:39],v[100:103]
CV v162,v192,v193
CV v163,v194,v195
MF v[104:107],a[8:11],a[40:43],v[104:107]
AW a104,v160
AW a105,v161
MF v[108:111],a[8:11],a[44:47],v[108:111]
AW a106,v162
AW a107,v163
MF v[112:115],a[8:11],a[48:51],v[112:115]
CV v164,v164,v165
CV v165,v166,v167
MF v[116:119],a[8:11],a[52:55],v[116:119]
CV v166,v196,v197
CV v167,v198,v199
MF v[120:123],a[8:11],a[56:59],v[120:123]
AW a108,v164
AW a109,v165
MF v[124:127],a[8:11],a[60:63],v[124:127]
AW a110,v166
AW a111,v167
MF v[128:131],a[12:15],a[32:35],v[128:131]
buffer_load_dwordx4 v17,s[12:15],s46 offen offset:1024 lds
CV v168,v168,v169
MF v[132:135],a[12:15],a[36:39],v[132:135]
CV v169,v170,v171
CV v170,v200,v201
MF v[136:139],a[12:15],a[40:43],v[136:139]
CV v171,v202,v203
AW a112,v168
MF v[140:143],a[12:15],a[44:47],v[140:143]
AW a113,v169
AW a114,v170
MF v[144:147],a[12:15],a[48:51],v[144:147]
AW a115,v171
CV v172,v172,v173
MF v[148:151],a[12:15],a[52:55],v[148:151]
CV v173,v174,v175
CV v174,v204,v205
MF v[152:155],a[12:15],a[56:59],v[152:155]
CV v175,v206,v207
AW a116,v172
MF v[156:159],a[12:15],a[60:63],v[156:159]
buffer_load_dwordx4 v18,s[12:15],s46 offen offset:2048 lds
buffer_load_dwordx4 v19,s[12:15],s46 offen offset:3072 lds
s_add_u32 m0,s43,4096
s_nop 0
buffer_load_dwordx4 v20,s[12:15],s46 offen lds
buffer_load_dwordx4 v21,s[12:15],s46 offen offset:1024 lds
buffer_load_dwordx4 v22,s[12:15],s46 offen offset:2048 lds
buffer_load_dwordx4 v23,s[12:15],s46 offen offset:3072 lds
s_add_u32 m0,s43,8192
s_nop 0
buffer_load_dwordx4 v24,s[12:15],s46 offen lds
s_add_u32 s46,s46,589824
s_add_u32 s48,s48,53248
s_cmp_eq_u32 s48,159744
s_cselect_b32 s48,0,s48
AW a117,v173
AW a118,v174
AW a119,v175
CV v211,v210,v211
CV v210,v208,v209
CV v208,v176,v177
CV v209,v178,v179
CV v215,v214,v215
CV v214,v212,v213
CV v212,v180,v181
CV v213,v182,v183
CV v219,v218,v219
CV v218,v216,v217
CV v216,v184,v185
CV v217,v186,v187
CV v223,v222,v223
CV v222,v220,v221
CV v220,v188,v189
CV v221,v190,v191
CV v32,v32,v33
CV v33,v34,v35
CV v34,v64,v65
CV v35,v66,v67
AW a120,v32
AW a121,v33
AW a122,v34
AW a123,v35
CV v36,v36,v37
CV v37,v38,v39
CV v38,v68,v69
CV v39,v70,v71
AW a124,v36
AW a125,v37
AW a126,v38
AW a127,v39
CV v40,v40,v41
CV v41,v42,v43
CV v42,v72,v73
CV v43,v74,v75
AW a128,v40
AW a129,v41
AW a130,v42
AW a131,v43
CV v44,v44,v45
CV v45,v46,v47
CV v46,v76,v77
CV v47,v78,v79
AW a132,v44
AW a133,v45
AW a134,v46
AW a135,v47
CV v48,v48,v49
CV v49,v50,v51
CV v50,v80,v81
CV v51,v82,v83
AW a136,v48
AW a137,v49
AW a138,v50
AW a139,v51
CV v52,v52,v53
CV v53,v54,v55
CV v54,v84,v85
CV v55,v86,v87
CV v56,v56,v57
CV v57,v58,v59
CV v58,v88,v89
CV v59,v90,v91
CV v60,v60,v61
CV v61,v62,v63
CV v62,v92,v93
CV v63,v94,v95
CV v96,v96,v97
CV v97,v98,v99
CV v98,v128,v129
CV v99,v130,v131
AW a144,v96
AW a145,v97
AW a146,v98
AW a147,v99
CV v100,v100,v101
CV v101,v102,v103
CV v102,v132,v133
CV v103,v134,v135
AW a148,v100
AW a149,v101
AW a150,v102
AW a151,v103
CV v104,v104,v105
CV v105,v106,v107
CV v106,v136,v137
CV v107,v138,v139
AW a152,v104
AW a153,v105
AW a154,v106
AW a155,v107
CV v108,v108,v109
CV v109,v110,v111
CV v110,v140,v141
CV v111,v142,v143
AW a156,v108
AW a157,v109
AW a158,v110
AW a159,v111
CV v112,v112,v113
CV v113,v114,v115
CV v114,v144,v145
CV v115,v146,v147
AW a192,v112
AW a193,v113
AW a194,v114
AW a195,v115
CV v116,v116,v117
CV v117,v118,v119
CV v118,v148,v149
CV v119,v150,v151
AW a196,v116
AW a197,v117
AW a198,v118
AW a199,v119
CV v120,v120,v121
CV v121,v122,v123
CV v122,v152,v153
CV v123,v154,v155
AW a200,v120
AW a201,v121
AW a202,v122
AW a203,v123
CV v124,v124,v125
CV v125,v126,v127
CV v126,v156,v157
CV v127,v158,v159
AW a204,v124
AW a205,v125
AW a206,v126
AW a207,v127
Lm_z:
s_waitcnt vmcnt(17)
s_barrier
s_cmp_ge_u32 s32,2
s_cbranch_scc1 Lm_zw1
s_bfe_u32 s59,s66,0x60000
s_lshl_b32 s59,s59,10
s_add_u32 s59,s59,s56
buffer_store_dwordx4 a[128:131],v2,s[20:23],s59 offen
v_add_u32 v3,s49,v27
v_add_u32 v4,s49,v28
s_add_u32 s49,s49,53248
s_cmp_eq_u32 s49,159744
s_cselect_b32 s49,0,s49
RD a[0:3],v3,0
TR a[16:17],v4,0
TR a[18:19],v4,2304
RD a[4:7],v3,2048
TR a[20:21],v4,32
TR a[22:23],v4,2336
RD a[8:11],v3,4096
TR a[24:25],v4,64
TR a[26:27],v4,2368
s_bfe_u32 s59,s66,0x60006
s_lshl_b32 s59,s59,10
s_add_u32 s59,s59,s56
buffer_store_dwordx4 a[132:135],v2,s[20:23],s59 offen
RD a[12:15],v3,6144
TR a[28:29],v4,96
TR a[30:31],v4,2400
TR a[32:33],v4,9216
TR a[34:35],v4,11520
TR a[36:37],v4,9248
TR a[38:39],v4,11552
TR a[40:41],v4,9280
TR a[42:43],v4,11584
TR a[44:45],v4,9312
TR a[46:47],v4,11616
TR a[48:49],v4,9344
TR a[50:51],v4,11648
LW 15
MF v[64:67],a[16:19],a[0:3],0
s_add_u32 m0,s44,s48
RD a[52:55],v3,1024
MF v[68:71],a[20:23],a[0:3],0
LW 14
TR a[68:69],v4,18432
buffer_load_dwordx4 v25,s[8:11],s47 offen sc1 lds
MF v[72:75],a[24:27],a[0:3],0
LW 12
buffer_load_dwordx4 v25,s[8:11],s47 offen offset:1024 sc1 lds
MF v[76:79],a[28:31],a[0:3],0
LW 10
TR a[70:71],v4,20736
MF v[80:83],a[0:3],a[32:35],0
LW 9
RD a[56:59],v3,3072
MF v[84:87],a[0:3],a[36:39],0
LW 8
buffer_load_dwordx4 v26,s[8:11],s47 offen offset:2048 sc1 lds
MF v[88:91],a[0:3],a[40:43],0
LW 6
TR a[72:73],v4,18464
MF v[92:95],a[0:3],a[44:47],0
LW 5
TR a[74:75],v4,20768
MF v[96:99],a[0:3],a[48:51],0
buffer_load_dwordx4 v26,s[8:11],s47 offen offset:3072 sc1 lds
s_add_u32 s47,s47,2048
MF v[100:103],a[16:19],a[4:7],0
RD a[60:63],v3,5120
MF v[104:107],a[20:23],a[4:7],0
TR a[76:77],v4,18496
MF v[108:111],a[24:27],a[4:7],0
s_add_u32 s43,s45,s48
s_add_u32 m0,s43,0
MF v[112:115],a[28:31],a[4:7],0
TR a[78:79],v4,20800
buffer_load_dwordx4 v16,s[12:15],s46 offen lds
MF v[116:119],a[4:7],a[32:35],0
RD a[64:67],v3,7168
buffer_load_dwordx4 v17,s[12:15],s46 offen offset:1024 lds
MF v[120:123],a[4:7],a[36:39],0
MF v[124:127],a[4:7],a[40:43],0
TR a[80:81],v4,18528
MF v[128:131],a[4:7],a[44:47],0
buffer_load_dwordx4 v18,s[12:15],s46 offen offset:2048 lds
MF v[132:135],a[4:7],a[48:51],0
TR a[82:83],v4,20832
MF v[136:139],a[16:19],a[8:11],0
TR a[84:85],v4,27648
MF v[140:143],a[20:23],a[8:11],0
buffer_load_dwordx4 v19,s[12:15],s46 offen offset:3072 lds
MF v[144:147],a[24:27],a[8:11],0
TR a[86:87],v4,29952
MF v[148:151],a[28:31],a[8:11],0
TR a[88:89],v4,27680
MF v[152:155],a[8:11],a[32:35],0
s_add_u32 m0,s43,4096
MF v[156:159],a[8:11],a[36:39],0
TR a[90:91],v4,29984
buffer_load_dwordx4 v20,s[12:15],s46 offen lds
MF v[160:163],a[8:11],a[40:43],0
buffer_load_dwordx4 v21,s[12:15],s46 offen offset:1024 lds
TR a[92:93],v4,27712
MF v[164:167],a[8:11],a[44:47],0
MF v[168:171],a[8:11],a[48:51],0
TR a[94:95],v4,30016
MF v[172:175],a[16:19],a[12:15],0
TR a[96:97],v4,27744
buffer_load_dwordx4 v22,s[12:15],s46 offen offset:2048 lds
MF v[176:179],a[20:23],a[12:15],0
MF v[180:183],a[24:27],a[12:15],0
TR a[98:99],v4,30048
MF v[184:187],a[28:31],a[12:15],0
TR a[100:101],v4,27776
buffer_load_dwordx4 v23,s[12:15],s46 offen offset:3072 lds
MF v[188:191],a[12:15],a[32:35],0
MF v[192:195],a[12:15],a[36:39],0
TR a[102:103],v4,30080
MF v[196:199],a[12:15],a[40:43],0
s_add_u32 m0,s43,8192
MF v[200:203],a[12:15],a[44:47],0
buffer_load_dwordx4 v24,s[12:15],s46 offen lds
s_add_u32 s46,s46,589824
MF v[204:207],a[12:15],a[48:51],0
LW 15
s_add_u32 s48,s48,53248
s_cmp_eq_u32 s48,159744
s_cselect_b32 s48,0,s48
MF v[64:67],a[68:71],a[52:55],v[64:67]
MF v[68:71],a[72:75],a[52:55],v[68:71]
LW 13
MF v[72:75],a[76:79],a[52:55],v[72:75]
LW 10
MF v[76:79],a[80:83],a[52:55],v[76:79]
LW 8
MF v[80:83],a[52:55],a[84:87],v[80:83]
LW 6
MF v[84:87],a[52:55],a[88:91],v[84:87]
LW 4
MF v[88:91],a[52:55],a[92:95],v[88:91]
LW 2
MF v[92:95],a[52:55],a[96:99],v[92:95]
LW 0
s_waitcnt vmcnt(15)
MF v[96:99],a[52:55],a[100:103],v[96:99]
s_barrier
MF v[100:103],a[68:71],a[56:59],v[100:103]
s_add_u32 m0,s44,s48
v_add_u32 v3,s49,v27
MF v[104:107],a[72:75],a[56:59],v[104:107]
buffer_load_dwordx4 v25,s[8:11],s47 offen sc1 lds
v_add_u32 v4,s49,v28
MF v[108:111],a[76:79],a[56:59],v[108:111]
s_add_u32 s49,s49,53248
s_cmp_eq_u32 s49,159744
s_cselect_b32 s49,0,s49
MF v[112:115],a[80:83],a[56:59],v[112:115]
RD a[0:3],v3,0
MF v[116:119],a[56:59],a[84:87],v[116:119]
buffer_load_dwordx4 v25,s[8:11],s47 offen offset:1024 sc1 lds
TR a[16:17],v4,0
MF v[120:123],a[56:59],a[88:91],v[120:123]
TR a[18:19],v4,2304
MF v[124:127],a[56:59],a[92:95],v[124:127]
RD a[4:7],v3,2048
MF v[128:131],a[56:59],a[96:99],v[128:131]
TR a[20:21],v4,32
MF v[132:135],a[56:59],a[100:103],v[132:135]
TR a[22:23],v4,2336
MF v[136:139],a[68:71],a[60:63],v[136:139]
buffer_load_dwordx4 v26,s[8:11],s47 offen offset:2048 sc1 lds
RD a[8:11],v3,4096
MF v[140:143],a[72:75],a[60:63],v[140:143]
TR a[24:25],v4,64
MF v[144:147],a[76:79],a[60:63],v[144:147]
TR a[26:27],v4,2368
MF v[148:151],a[80:83],a[60:63],v[148:151]
RD a[12:15],v3,6144
MF v[152:155],a[60:63],a[84:87],v[152:155]
buffer_load_dwordx4 v26,s[8:11],s47 offen offset:3072 sc1 lds
TR a[28:29],v4,96
MF v[156:159],a[60:63],a[88:91],v[156:159]
s_add_u32 s47,s47,2048
TR a[30:31],v4,2400
MF v[160:163],a[60:63],a[92:95],v[160:163]
TR a[32:33],v4,9216
MF v[164:167],a[60:63],a[96:99],v[164:167]
TR a[34:35],v4,11520
MF v[168:171],a[60:63],a[100:103],v[168:171]
TR a[36:37],v4,9248
MF v[172:175],a[68:71],a[64:67],v[172:175]
s_add_u32 s43,s45,s48
s_add_u32 m0,s43,0
TR a[38:39],v4,11552
MF v[176:179],a[72:75],a[64:67],v[176:179]
TR a[40:41],v4,9280
buffer_load_dwordx4 v16,s[12:15],s46 offen lds
MF v[180:183],a[76:79],a[64:67],v[180:183]
TR a[42:43],v4,11584
MF v[184:187],a[80:83],a[64:67],v[184:187]
TR a[44:45],v4,9312
MF v[188:191],a[64:67],a[84:87],v[188:191]
s_bfe_u32 s59,s66,0x6000c
s_lshl_b32 s59,s59,10
TR a[46:47],v4,11616
MF v[192:195],a[64:67],a[88:91],v[192:195]
s_add_u32 s59,s59,s56
TR a[48:49],v4,9344
buffer_store_dwordx4 a[136:139],v2,s[20:23],s59 offen
MF v[196:199],a[64:67],a[92:95],v[196:199]
TR a[50:51],v4,11648
MF v[200:203],a[64:67],a[96:99],v[200:203]
MF v[204:207],a[64:67],a[100:103],v[204:207]
LW 15
MF v[64:67],a[16:19],a[0:3],v[64:67]
buffer_load_dwordx4 v17,s[12:15],s46 offen offset:1024 lds
RD a[52:55],v3,1024
MF v[68:71],a[20:23],a[0:3],v[68:71]
LW 14
TR a[68:69],v4,18432
MF v[72:75],a[24:27],a[0:3],v[72:75]
LW 12
MF v[76:79],a[28:31],a[0:3],v[76:79]
LW 10
TR a[70:71],v4,20736
MF v[80:83],a[0:3],a[32:35],v[80:83]
LW 9
RD a[56:59],v3,3072
buffer_load_dwordx4 v18,s[12:15],s46 offen offset:2048 lds
MF v[84:87],a[0:3],a[36:39],v[84:87]
LW 8
MF v[88:91],a[0:3],a[40:43],v[88:91]
LW 6
TR a[72:73],v4,18464
MF v[92:95],a[0:3],a[44:47],v[92:95]
LW 5
TR a[74:75],v4,20768
MF v[96:99],a[0:3],a[48:51],v[96:99]
buffer_load_dwordx4 v19,s[12:15],s46 offen offset:3072 lds
MF v[100:103],a[16:19],a[4:7],v[100:103]
RD a[60:63],v3,5120
MF v[104:107],a[20:23],a[4:7],v[104:107]
TR a[76:77],v4,18496
MF v[108:111],a[24:27],a[4:7],v[108:111]
MF v[112:115],a[28:31],a[4:7],v[112:115]
s_add_u32 m0,s43,4096
TR a[78:79],v4,20800
MF v[116:119],a[4:7],a[32:35],v[116:119]
RD a[64:67],v3,7168
buffer_load_dwordx4 v20,s[12:15],s46 offen lds
MF v[120:123],a[4:7],a[36:39],v[120:123]
MF v[124:127],a[4:7],a[40:43],v[124:127]
TR a[80:81],v4,18528
MF v[128:131],a[4:7],a[44:47],v[128:131]
buffer_load_dwordx4 v21,s[12:15],s46 offen offset:1024 lds
MF v[132:135],a[4:7],a[48:51],v[132:135]
TR a[82:83],v4,20832
MF v[136:139],a[16:19],a[8:11],v[136:139]
TR a[84:85],v4,27648
MF v[140:143],a[20:23],a[8:11],v[140:143]
MF v[144:147],a[24:27],a[8:11],v[144:147]
TR a[86:87],v4,29952
buffer_load_dwordx4 v22,s[12:15],s46 offen offset:2048 lds
MF v[148:151],a[28:31],a[8:11],v[148:151]
TR a[88:89],v4,27680
MF v[152:155],a[8:11],a[32:35],v[152:155]
MF v[156:159],a[8:11],a[36:39],v[156:159]
TR a[90:91],v4,29984
MF v[160:163],a[8:11],a[40:43],v[160:163]
TR a[92:93],v4,27712
buffer_load_dwordx4 v23,s[12:15],s46 offen offset:3072 lds
MF v[164:167],a[8:11],a[44:47],v[164:167]
MF v[168:171],a[8:11],a[48:51],v[168:171]
TR a[94:95],v4,30016
MF v[172:175],a[16:19],a[12:15],v[172:175]
TR a[96:97],v4,27744
MF v[176:179],a[20:23],a[12:15],v[176:179]
s_add_u32 m0,s43,8192
MF v[180:183],a[24:27],a[12:15],v[180:183]
buffer_load_dwordx4 v24,s[12:15],s46 offen lds
s_add_u32 s46,s46,589824
MF v[184:187],a[28:31],a[12:15],v[184:187]
s_add_u32 s48,s48,53248
s_cmp_eq_u32 s48,159744
s_cselect_b32 s48,0,s48
MF v[188:191],a[12:15],a[32:35],v[188:191]
TR a[98:99],v4,30048
MF v[192:195],a[12:15],a[36:39],v[192:195]
s_bfe_u32 s59,s66,0x60012
s_lshl_b32 s59,s59,10
TR a[100:101],v4,27776
MF v[196:199],a[12:15],a[40:43],v[196:199]
s_add_u32 s59,s59,s56
TR a[102:103],v4,30080
buffer_store_dwordx4 a[144:147],v2,s[20:23],s59 offen
MF v[200:203],a[12:15],a[44:47],v[200:203]
MF v[204:207],a[12:15],a[48:51],v[204:207]
LW 15
MF v[64:67],a[68:71],a[52:55],v[64:67]
v_lshrrev_b32 v5,4,v1
MF v[68:71],a[72:75],a[52:55],v[68:71]
LW 13
MF v[72:75],a[76:79],a[52:55],v[72:75]
LW 10
MF v[76:79],a[80:83],a[52:55],v[76:79]
LW 8
MF v[80:83],a[52:55],a[84:87],v[80:83]
LW 6
v_bfe_u32 v6,v1,2,2
MF v[84:87],a[52:55],a[88:91],v[84:87]
LW 4
MF v[88:91],a[52:55],a[92:95],v[88:91]
LW 2
MF v[92:95],a[52:55],a[96:99],v[92:95]
LW 0
s_waitcnt vmcnt(15)
MF v[96:99],a[52:55],a[100:103],v[96:99]
s_barrier
v_lshl_add_u32 v7,v5,3,v6
MF v[100:103],a[68:71],a[56:59],v[100:103]
s_add_u32 m0,s44,s48
v_add_u32 v3,s49,v27
MF v[104:107],a[72:75],a[56:59],v[104:107]
buffer_load_dwordx4 v25,s[8:11],s47 offen sc1 lds
v_add_u32 v4,s49,v28
MF v[108:111],a[76:79],a[56:59],v[108:111]
s_add_u32 s49,s49,53248
s_cmp_eq_u32 s49,159744
s_cselect_b32 s49,0,s49
MF v[112:115],a[80:83],a[56:59],v[112:115]
RD a[0:3],v3,0
MF v[116:119],a[56:59],a[84:87],v[116:119]
TR a[16:17],v4,0
v_lshlrev_b32 v7,8,v7
MF v[120:123],a[56:59],a[88:91],v[120:123]
TR a[18:19],v4,2304
buffer_load_dwordx4 v25,s[8:11],s47 offen offset:1024 sc1 lds
MF v[124:127],a[56:59],a[92:95],v[124:127]
RD a[4:7],v3,2048
MF v[128:131],a[56:59],a[96:99],v[128:131]
TR a[20:21],v4,32
MF v[132:135],a[56:59],a[100:103],v[132:135]
TR a[22:23],v4,2336
v_and_b32 v5,1,v5
MF v[136:139],a[68:71],a[60:63],v[136:139]
buffer_load_dwordx4 v26,s[8:11],s47 offen offset:2048 sc1 lds
RD a[8:11],v3,4096
MF v[140:143],a[72:75],a[60:63],v[140:143]
TR a[24:25],v4,64
MF v[144:147],a[76:79],a[60:63],v[144:147]
TR a[26:27],v4,2368
MF v[148:151],a[80:83],a[60:63],v[148:151]
RD a[12:15],v3,6144
v_lshl_add_u32 v6,v5,2,v6
MF v[152:155],a[60:63],a[84:87],v[152:155]
buffer_load_dwordx4 v26,s[8:11],s47 offen offset:3072 sc1 lds
TR a[28:29],v4,96
MF v[156:159],a[60:63],a[88:91],v[156:159]
s_add_u32 s47,s47,2048
TR a[30:31],v4,2400
MF v[160:163],a[60:63],a[92:95],v[160:163]
TR a[32:33],v4,9216
MF v[164:167],a[60:63],a[96:99],v[164:167]
TR a[34:35],v4,11520
MF v[168:171],a[60:63],a[100:103],v[168:171]
TR a[36:37],v4,9248
v_and_b32 v5,3,v1
MF v[172:175],a[68:71],a[64:67],v[172:175]
s_add_u32 s43,s45,s48
s_add_u32 m0,s43,0
TR a[38:39],v4,11552
MF v[176:179],a[72:75],a[64:67],v[176:179]
TR a[40:41],v4,9280
buffer_load_dwordx4 v16,s[12:15],s46 offen lds
MF v[180:183],a[76:79],a[64:67],v[180:183]
TR a[42:43],v4,11584
MF v[184:187],a[80:83],a[64:67],v[184:187]
TR a[44:45],v4,9312
v_lshl_add_u32 v7,v5,3,v7
MF v[188:191],a[64:67],a[84:87],v[188:191]
s_bfe_u32 s59,s66,0x60018
s_lshl_b32 s59,s59,10
TR a[46:47],v4,11616
MF v[192:195],a[64:67],a[88:91],v[192:195]
s_add_u32 s59,s59,s56
TR a[48:49],v4,9344
buffer_store_dwordx4 a[148:151],v2,s[20:23],s59 offen
MF v[196:199],a[64:67],a[92:95],v[196:199]
TR a[50:51],v4,11648
MF v[200:203],a[64:67],a[96:99],v[200:203]
MF v[204:207],a[64:67],a[100:103],v[204:207]
LW 15
MF v[64:67],a[16:19],a[0:3],v[64:67]
buffer_load_dwordx4 v17,s[12:15],s46 offen offset:1024 lds
RD a[52:55],v3,1024
MF v[68:71],a[20:23],a[0:3],v[68:71]
LW 14
TR a[68:69],v4,18432
v_add_u32 v7,0x10000,v7
MF v[72:75],a[24:27],a[0:3],v[72:75]
LW 12
MF v[76:79],a[28:31],a[0:3],v[76:79]
LW 10
TR a[70:71],v4,20736
MF v[80:83],a[0:3],a[32:35],v[80:83]
LW 9
buffer_load_dwordx4 v18,s[12:15],s46 offen offset:2048 lds
v_xor_b32 v5,0,v6
MF v[84:87],a[0:3],a[36:39],v[84:87]
LW 7
RD a[56:59],v3,3072
MF v[88:91],a[0:3],a[40:43],v[88:91]
LW 6
TR a[72:73],v4,18464
MF v[92:95],a[0:3],a[44:47],v[92:95]
LW 5
TR a[74:75],v4,20768
MF v[96:99],a[0:3],a[48:51],v[96:99]
buffer_load_dwordx4 v19,s[12:15],s46 offen offset:3072 lds
v_lshl_add_u32 v29,v5,5,v7
MF v[100:103],a[16:19],a[4:7],v[100:103]
RD a[60:63],v3,5120
MF v[104:107],a[20:23],a[4:7],v[104:107]
TR a[76:77],v4,18496
MF v[108:111],a[24:27],a[4:7],v[108:111]
MF v[112:115],a[28:31],a[4:7],v[112:115]
s_add_u32 m0,s43,4096
TR a[78:79],v4,20800
MF v[116:119],a[4:7],a[32:35],v[116:119]
buffer_load_dwordx4 v20,s[12:15],s46 offen lds
v_xor_b32 v5,1,v6
MF v[120:123],a[4:7],a[36:39],v[120:123]
RD a[64:67],v3,7168
MF v[124:127],a[4:7],a[40:43],v[124:127]
TR a[80:81],v4,18528
MF v[128:131],a[4:7],a[44:47],v[128:131]
buffer_load_dwordx4 v21,s[12:15],s46 offen offset:1024 lds
MF v[132:135],a[4:7],a[48:51],v[132:135]
TR a[82:83],v4,20832
v_lshl_add_u32 v30,v5,5,v7
MF v[136:139],a[16:19],a[8:11],v[136:139]
TR a[84:85],v4,27648
MF v[140:143],a[20:23],a[8:11],v[140:143]
MF v[144:147],a[24:27],a[8:11],v[144:147]
TR a[86:87],v4,29952
buffer_load_dwordx4 v22,s[12:15],s46 offen offset:2048 lds
MF v[148:151],a[28:31],a[8:11],v[148:151]
TR a[88:89],v4,27680
v_xor_b32 v5,2,v6
MF v[152:155],a[8:11],a[32:35],v[152:155]
MF v[156:159],a[8:11],a[36:39],v[156:159]
TR a[90:91],v4,29984
MF v[160:163],a[8:11],a[40:43],v[160:163]
TR a[92:93],v4,27712
buffer_load_dwordx4 v23,s[12:15],s46 offen offset:3072 lds
MF v[164:167],a[8:11],a[44:47],v[164:167]
MF v[168:171],a[8:11],a[48:51],v[168:171]
TR a[94:95],v4,30016
v_lshl_add_u32 v31,v5,5,v7
MF v[172:175],a[16:19],a[12:15],v[172:175]
TR a[96:97],v4,27744
MF v[176:179],a[20:23],a[12:15],v[176:179]
s_add_u32 m0,s43,8192
MF v[180:183],a[24:27],a[12:15],v[180:183]
buffer_load_dwordx4 v24,s[12:15],s46 offen lds
s_add_u32 s46,s46,589824
MF v[184:187],a[28:31],a[12:15],v[184:187]
s_add_u32 s48,s48,53248
s_cmp_eq_u32 s48,159744
s_cselect_b32 s48,0,s48
MF v[188:191],a[12:15],a[32:35],v[188:191]
TR a[98:99],v4,30048
v_xor_b32 v5,3,v6
MF v[192:195],a[12:15],a[36:39],v[192:195]
s_bfe_u32 s59,s67,0x60000
s_lshl_b32 s59,s59,10
TR a[100:101],v4,27776
MF v[196:199],a[12:15],a[40:43],v[196:199]
s_add_u32 s59,s59,s56
TR a[102:103],v4,30080
buffer_store_dwordx4 a[152:155],v2,s[20:23],s59 offen
MF v[200:203],a[12:15],a[44:47],v[200:203]
MF v[204:207],a[12:15],a[48:51],v[204:207]
LW 15
MF v[64:67],a[68:71],a[52:55],v[64:67]
v_lshl_add_u32 v32,v5,5,v7
MF v[68:71],a[72:75],a[52:55],v[68:71]
LW 13
MF v[72:75],a[76:79],a[52:55],v[72:75]
LW 10
MF v[76:79],a[80:83],a[52:55],v[76:79]
LW 8
MF v[80:83],a[52:55],a[84:87],v[80:83]
LW 6
v_xor_b32 v5,4,v6
MF v[84:87],a[52:55],a[88:91],v[84:87]
LW 4
MF v[88:91],a[52:55],a[92:95],v[88:91]
LW 2
MF v[92:95],a[52:55],a[96:99],v[92:95]
LW 0
s_waitcnt vmcnt(16)
MF v[96:99],a[52:55],a[100:103],v[96:99]
s_barrier
v_lshl_add_u32 v33,v5,5,v7
MF v[100:103],a[68:71],a[56:59],v[100:103]
s_add_u32 m0,s44,s48
v_add_u32 v3,s49,v27
MF v[104:107],a[72:75],a[56:59],v[104:107]
buffer_load_dwordx4 v25,s[8:11],s47 offen sc1 lds
v_add_u32 v4,s49,v28
MF v[108:111],a[76:79],a[56:59],v[108:111]
s_add_u32 s49,s49,53248
s_cmp_eq_u32 s49,159744
s_cselect_b32 s49,0,s49
MF v[112:115],a[80:83],a[56:59],v[112:115]
RD a[0:3],v3,0
MF v[116:119],a[56:59],a[84:87],v[116:119]
TR a[16:17],v4,0
v_xor_b32 v5,5,v6
MF v[120:123],a[56:59],a[88:91],v[120:123]
TR a[18:19],v4,2304
buffer_load_dwordx4 v25,s[8:11],s47 offen offset:1024 sc1 lds
MF v[124:127],a[56:59],a[92:95],v[124:127]
RD a[4:7],v3,2048
MF v[128:131],a[56:59],a[96:99],v[128:131]
TR a[20:21],v4,32
MF v[132:135],a[56:59],a[100:103],v[132:135]
TR a[22:23],v4,2336
v_lshl_add_u32 v34,v5,5,v7
MF v[136:139],a[68:71],a[60:63],v[136:139]
buffer_load_dwordx4 v26,s[8:11],s47 offen offset:2048 sc1 lds
RD a[8:11],v3,4096
MF v[140:143],a[72:75],a[60:63],v[140:143]
TR a[24:25],v4,64
MF v[144:147],a[76:79],a[60:63],v[144:147]
TR a[26:27],v4,2368
MF v[148:151],a[80:83],a[60:63],v[148:151]
RD a[12:15],v3,6144
v_xor_b32 v5,6,v6
MF v[152:155],a[60:63],a[84:87],v[152:155]
buffer_load_dwordx4 v26,s[8:11],s47 offen offset:3072 sc1 lds
TR a[28:29],v4,96
MF v[156:159],a[60:63],a[88:91],v[156:159]
s_add_u32 s47,s47,2048
TR a[30:31],v4,2400
MF v[160:163],a[60:63],a[92:95],v[160:163]
TR a[32:33],v4,9216
MF v[164:167],a[60:63],a[96:99],v[164:167]
TR a[34:35],v4,11520
MF v[168:171],a[60:63],a[100:103],v[168:171]
TR a[36:37],v4,9248
v_lshl_add_u32 v35,v5,5,v7
MF v[172:175],a[68:71],a[64:67],v[172:175]
s_add_u32 s43,s45,s48
s_add_u32 m0,s43,0
TR a[38:39],v4,11552
MF v[176:179],a[72:75],a[64:67],v[176:179]
TR a[40:41],v4,9280
buffer_load_dwordx4 v16,s[12:15],s46 offen lds
MF v[180:183],a[76:79],a[64:67],v[180:183]
TR a[42:43],v4,11584
MF v[184:187],a[80:83],a[64:67],v[184:187]
TR a[44:45],v4,9312
v_xor_b32 v5,7,v6
MF v[188:191],a[64:67],a[84:87],v[188:191]
s_bfe_u32 s59,s67,0x60006
s_lshl_b32 s59,s59,10
TR a[46:47],v4,11616
MF v[192:195],a[64:67],a[88:91],v[192:195]
s_add_u32 s59,s59,s56
TR a[48:49],v4,9344
buffer_store_dwordx4 a[156:159],v2,s[20:23],s59 offen
MF v[196:199],a[64:67],a[92:95],v[196:199]
TR a[50:51],v4,11648
MF v[200:203],a[64:67],a[96:99],v[200:203]
MF v[204:207],a[64:67],a[100:103],v[204:207]
LW 15
MF v[64:67],a[16:19],a[0:3],v[64:67]
buffer_load_dwordx4 v17,s[12:15],s46 offen offset:1024 lds
RD a[52:55],v3,1024
MF v[68:71],a[20:23],a[0:3],v[68:71]
LW 14
TR a[68:69],v4,18432
v_lshl_add_u32 v36,v5,5,v7
MF v[72:75],a[24:27],a[0:3],v[72:75]
LW 12
MF v[76:79],a[28:31],a[0:3],v[76:79]
LW 10
TR a[70:71],v4,20736
MF v[80:83],a[0:3],a[32:35],v[80:83]
LW 9
buffer_load_dwordx4 v18,s[12:15],s46 offen offset:2048 lds
v_lshrrev_b32 v5,4,v1
MF v[84:87],a[0:3],a[36:39],v[84:87]
LW 7
RD a[56:59],v3,3072
MF v[88:91],a[0:3],a[40:43],v[88:91]
LW 6
TR a[72:73],v4,18464
MF v[92:95],a[0:3],a[44:47],v[92:95]
LW 5
TR a[74:75],v4,20768
MF v[96:99],a[0:3],a[48:51],v[96:99]
s_lshl_b32 s50,s32,5
buffer_load_dwordx4 v19,s[12:15],s46 offen offset:3072 lds
MF v[100:103],a[16:19],a[4:7],v[100:103]
RD a[60:63],v3,5120
MF v[104:107],a[20:23],a[4:7],v[104:107]
TR a[76:77],v4,18496
MF v[108:111],a[24:27],a[4:7],v[108:111]
MF v[112:115],a[28:31],a[4:7],v[112:115]
s_add_u32 m0,s43,4096
TR a[78:79],v4,20800
MF v[116:119],a[4:7],a[32:35],v[116:119]
buffer_load_dwordx4 v20,s[12:15],s46 offen lds
v_add_u32 v6,s50,v5
MF v[120:123],a[4:7],a[36:39],v[120:123]
RD a[64:67],v3,7168
MF v[124:127],a[4:7],a[40:43],v[124:127]
TR a[80:81],v4,18528
MF v[128:131],a[4:7],a[44:47],v[128:131]
buffer_load_dwordx4 v21,s[12:15],s46 offen offset:1024 lds
MF v[132:135],a[4:7],a[48:51],v[132:135]
TR a[82:83],v4,20832
v_lshlrev_b32 v6,13,v6
MF v[136:139],a[16:19],a[8:11],v[136:139]
TR a[84:85],v4,27648
MF v[140:143],a[20:23],a[8:11],v[140:143]
MF v[144:147],a[24:27],a[8:11],v[144:147]
TR a[86:87],v4,29952
buffer_load_dwordx4 v22,s[12:15],s46 offen offset:2048 lds
MF v[148:151],a[28:31],a[8:11],v[148:151]
s_lshl_b32 s50,s35,8
TR a[88:89],v4,27680
MF v[152:155],a[8:11],a[32:35],v[152:155]
MF v[156:159],a[8:11],a[36:39],v[156:159]
TR a[90:91],v4,29984
MF v[160:163],a[8:11],a[40:43],v[160:163]
TR a[92:93],v4,27712
buffer_load_dwordx4 v23,s[12:15],s46 offen offset:3072 lds
MF v[164:167],a[8:11],a[44:47],v[164:167]
MF v[168:171],a[8:11],a[48:51],v[168:171]
TR a[94:95],v4,30016
v_add_u32 v6,s50,v6
MF v[172:175],a[16:19],a[12:15],v[172:175]
TR a[96:97],v4,27744
MF v[176:179],a[20:23],a[12:15],v[176:179]
s_add_u32 m0,s43,8192
MF v[180:183],a[24:27],a[12:15],v[180:183]
buffer_load_dwordx4 v24,s[12:15],s46 offen lds
s_add_u32 s46,s46,589824
MF v[184:187],a[28:31],a[12:15],v[184:187]
s_add_u32 s48,s48,53248
s_cmp_eq_u32 s48,159744
s_cselect_b32 s48,0,s48
MF v[188:191],a[12:15],a[32:35],v[188:191]
TR a[98:99],v4,30048
v_lshlrev_b32 v5,1,v5
MF v[192:195],a[12:15],a[36:39],v[192:195]
s_bfe_u32 s59,s67,0x6000c
s_lshl_b32 s59,s59,10
TR a[100:101],v4,27776
MF v[196:199],a[12:15],a[40:43],v[196:199]
s_add_u32 s59,s59,s56
TR a[102:103],v4,30080
buffer_store_dwordx4 v[52:55],v2,s[20:23],s59 offen
MF v[200:203],a[12:15],a[44:47],v[200:203]
MF v[204:207],a[12:15],a[48:51],v[204:207]
LW 15
MF v[64:67],a[68:71],a[52:55],v[64:67]
v_and_b32 v7,15,v1
MF v[68:71],a[72:75],a[52:55],v[68:71]
LW 13
MF v[72:75],a[76:79],a[52:55],v[72:75]
LW 10
MF v[76:79],a[80:83],a[52:55],v[76:79]
LW 8
MF v[80:83],a[52:55],a[84:87],v[80:83]
LW 6
v_xor_b32 v5,v5,v7
MF v[84:87],a[52:55],a[88:91],v[84:87]
LW 4
MF v[88:91],a[52:55],a[92:95],v[88:91]
LW 2
MF v[92:95],a[52:55],a[96:99],v[92:95]
LW 0
s_waitcnt vmcnt(16)
MF v[96:99],a[52:55],a[100:103],v[96:99]
s_barrier
v_xor_b32 v7,8,v5
MF v[100:103],a[68:71],a[56:59],v[100:103]
s_add_u32 m0,s44,s48
v_add_u32 v3,s49,v27
MF v[104:107],a[72:75],a[56:59],v[104:107]
buffer_load_dwordx4 v25,s[8:11],s47 offen sc1 lds
v_add_u32 v4,s49,v28
MF v[108:111],a[76:79],a[56:59],v[108:111]
s_add_u32 s49,s49,53248
s_cmp_eq_u32 s49,159744
s_cselect_b32 s49,0,s49
MF v[112:115],a[80:83],a[56:59],v[112:115]
RD a[0:3],v3,0
MF v[116:119],a[56:59],a[84:87],v[116:119]
TR a[16:17],v4,0
v_lshl_add_u32 v5,v5,4,v6
MF v[120:123],a[56:59],a[88:91],v[120:123]
TR a[18:19],v4,2304
buffer_load_dwordx4 v25,s[8:11],s47 offen offset:1024 sc1 lds
MF v[124:127],a[56:59],a[92:95],v[124:127]
RD a[4:7],v3,2048
MF v[128:131],a[56:59],a[96:99],v[128:131]
TR a[20:21],v4,32
MF v[132:135],a[56:59],a[100:103],v[132:135]
TR a[22:23],v4,2336
v_lshl_add_u32 v7,v7,4,v6
MF v[136:139],a[68:71],a[60:63],v[136:139]
buffer_load_dwordx4 v26,s[8:11],s47 offen offset:2048 sc1 lds
RD a[8:11],v3,4096
MF v[140:143],a[72:75],a[60:63],v[140:143]
TR a[24:25],v4,64
MF v[144:147],a[76:79],a[60:63],v[144:147]
TR a[26:27],v4,2368
MF v[148:151],a[80:83],a[60:63],v[148:151]
RD a[12:15],v3,6144
v_add_u32 v37,0,v5
MF v[152:155],a[60:63],a[84:87],v[152:155]
buffer_load_dwordx4 v26,s[8:11],s47 offen offset:3072 sc1 lds
TR a[28:29],v4,96
MF v[156:159],a[60:63],a[88:91],v[156:159]
s_add_u32 s47,s47,2048
TR a[30:31],v4,2400
MF v[160:163],a[60:63],a[92:95],v[160:163]
TR a[32:33],v4,9216
MF v[164:167],a[60:63],a[96:99],v[164:167]
TR a[34:35],v4,11520
MF v[168:171],a[60:63],a[100:103],v[168:171]
TR a[36:37],v4,9248
v_add_u32 v38,31744,v5
MF v[172:175],a[68:71],a[64:67],v[172:175]
s_add_u32 s43,s45,s48
s_add_u32 m0,s43,0
TR a[38:39],v4,11552
MF v[176:179],a[72:75],a[64:67],v[176:179]
TR a[40:41],v4,9280
buffer_load_dwordx4 v16,s[12:15],s46 offen lds
MF v[180:183],a[76:79],a[64:67],v[180:183]
TR a[42:43],v4,11584
MF v[184:187],a[80:83],a[64:67],v[184:187]
TR a[44:45],v4,9312
v_add_u32 v39,63488,v7
MF v[188:191],a[64:67],a[84:87],v[188:191]
s_bfe_u32 s59,s67,0x60012
s_lshl_b32 s59,s59,10
TR a[46:47],v4,11616
MF v[192:195],a[64:67],a[88:91],v[192:195]
s_add_u32 s59,s59,s56
TR a[48:49],v4,9344
buffer_store_dwordx4 v[56:59],v2,s[20:23],s59 offen
MF v[196:199],a[64:67],a[92:95],v[196:199]
TR a[50:51],v4,11648
MF v[200:203],a[64:67],a[96:99],v[200:203]
MF v[204:207],a[64:67],a[100:103],v[204:207]
LW 15
MF v[64:67],a[16:19],a[0:3],v[64:67]
buffer_load_dwordx4 v17,s[12:15],s46 offen offset:1024 lds
RD a[52:55],v3,1024
MF v[68:71],a[20:23],a[0:3],v[68:71]
LW 14
TR a[68:69],v4,18432
v_add_u32 v40,95232,v7
MF v[72:75],a[24:27],a[0:3],v[72:75]
LW 12
MF v[76:79],a[28:31],a[0:3],v[76:79]
LW 10
TR a[70:71],v4,20736
MF v[80:83],a[0:3],a[32:35],v[80:83]
LW 9
buffer_load_dwordx4 v18,s[12:15],s46 offen offset:2048 lds
v_add_u32 v41,131072,v5
MF v[84:87],a[0:3],a[36:39],v[84:87]
LW 7
RD a[56:59],v3,3072
MF v[88:91],a[0:3],a[40:43],v[88:91]
LW 6
TR a[72:73],v4,18464
MF v[92:95],a[0:3],a[44:47],v[92:95]
LW 5
TR a[74:75],v4,20768
MF v[96:99],a[0:3],a[48:51],v[96:99]
buffer_load_dwordx4 v19,s[12:15],s46 offen offset:3072 lds
v_add_u32 v42,162816,v5
MF v[100:103],a[16:19],a[4:7],v[100:103]
RD a[60:63],v3,5120
MF v[104:107],a[20:23],a[4:7],v[104:107]
TR a[76:77],v4,18496
MF v[108:111],a[24:27],a[4:7],v[108:111]
MF v[112:115],a[28:31],a[4:7],v[112:115]
s_add_u32 m0,s43,4096
TR a[78:79],v4,20800
MF v[116:119],a[4:7],a[32:35],v[116:119]
buffer_load_dwordx4 v20,s[12:15],s46 offen lds
v_add_u32 v43,194560,v7
MF v[120:123],a[4:7],a[36:39],v[120:123]
RD a[64:67],v3,7168
MF v[124:127],a[4:7],a[40:43],v[124:127]
TR a[80:81],v4,18528
MF v[128:131],a[4:7],a[44:47],v[128:131]
buffer_load_dwordx4 v21,s[12:15],s46 offen offset:1024 lds
MF v[132:135],a[4:7],a[48:51],v[132:135]
TR a[82:83],v4,20832
v_add_u32 v44,226304,v7
MF v[136:139],a[16:19],a[8:11],v[136:139]
TR a[84:85],v4,27648
MF v[140:143],a[20:23],a[8:11],v[140:143]
MF v[144:147],a[24:27],a[8:11],v[144:147]
TR a[86:87],v4,29952
buffer_load_dwordx4 v22,s[12:15],s46 offen offset:2048 lds
MF v[148:151],a[28:31],a[8:11],v[148:151]
s_lshl_b32 s50,s36,3
TR a[88:89],v4,27680
MF v[152:155],a[8:11],a[32:35],v[152:155]
MF v[156:159],a[8:11],a[36:39],v[156:159]
TR a[90:91],v4,29984
MF v[160:163],a[8:11],a[40:43],v[160:163]
TR a[92:93],v4,27712
buffer_load_dwordx4 v23,s[12:15],s46 offen offset:3072 lds
MF v[164:167],a[8:11],a[44:47],v[164:167]
MF v[168:171],a[8:11],a[48:51],v[168:171]
s_lshl_b32 s51,s32,1
TR a[94:95],v4,30016
MF v[172:175],a[16:19],a[12:15],v[172:175]
TR a[96:97],v4,27744
MF v[176:179],a[20:23],a[12:15],v[176:179]
s_add_u32 m0,s43,8192
MF v[180:183],a[24:27],a[12:15],v[180:183]
buffer_load_dwordx4 v24,s[12:15],s46 offen lds
s_add_u32 s46,s46,589824
MF v[184:187],a[28:31],a[12:15],v[184:187]
s_add_u32 s48,s48,53248
s_cmp_eq_u32 s48,159744
s_cselect_b32 s48,0,s48
MF v[188:191],a[12:15],a[32:35],v[188:191]
s_add_u32 s52,s50,s51
TR a[98:99],v4,30048
MF v[192:195],a[12:15],a[36:39],v[192:195]
s_bfe_u32 s59,s67,0x60018
s_lshl_b32 s59,s59,10
TR a[100:101],v4,27776
MF v[196:199],a[12:15],a[40:43],v[196:199]
s_add_u32 s59,s59,s56
TR a[102:103],v4,30080
buffer_store_dwordx4 v[60:63],v2,s[20:23],s59 offen
MF v[200:203],a[12:15],a[44:47],v[200:203]
MF v[204:207],a[12:15],a[48:51],v[204:207]
LW 15
MF v[64:67],a[68:71],a[52:55],v[64:67]
s_sub_u32 s53,120,s50
MF v[68:71],a[72:75],a[52:55],v[68:71]
LW 13
MF v[72:75],a[76:79],a[52:55],v[72:75]
LW 10
MF v[76:79],a[80:83],a[52:55],v[76:79]
LW 8
MF v[80:83],a[52:55],a[84:87],v[80:83]
LW 6
s_add_u32 s53,s53,s51
MF v[84:87],a[52:55],a[88:91],v[84:87]
LW 4
MF v[88:91],a[52:55],a[92:95],v[88:91]
LW 2
MF v[92:95],a[52:55],a[96:99],v[92:95]
LW 0
s_waitcnt vmcnt(16)
MF v[96:99],a[52:55],a[100:103],v[96:99]
s_barrier
s_mul_i32 s50,s53,18432
MF v[100:103],a[68:71],a[56:59],v[100:103]
s_add_u32 m0,s44,s48
v_add_u32 v3,s49,v27
MF v[104:107],a[72:75],a[56:59],v[104:107]
buffer_load_dwordx4 v25,s[8:11],s47 offen sc1 lds
v_add_u32 v4,s49,v28
MF v[108:111],a[76:79],a[56:59],v[108:111]
s_add_u32 s49,s49,53248
s_cmp_eq_u32 s49,159744
s_cselect_b32 s49,0,s49
MF v[112:115],a[80:83],a[56:59],v[112:115]
buffer_load_dwordx4 v25,s[8:11],s47 offen offset:1024 sc1 lds
RD a[0:3],v3,0
MF v[116:119],a[56:59],a[84:87],v[116:119]
s_mul_i32 s51,s52,18432
TR a[16:17],v4,0
MF v[120:123],a[56:59],a[88:91],v[120:123]
TR a[18:19],v4,2304
MF v[124:127],a[56:59],a[92:95],v[124:127]
RD a[4:7],v3,2048
MF v[128:131],a[56:59],a[96:99],v[128:131]
buffer_load_dwordx4 v26,s[8:11],s47 offen offset:2048 sc1 lds
TR a[20:21],v4,32
MF v[132:135],a[56:59],a[100:103],v[132:135]
TR a[22:23],v4,2336
v_bfe_u32 v5,v1,2,2
MF v[136:139],a[68:71],a[60:63],v[136:139]
RD a[8:11],v3,4096
MF v[140:143],a[72:75],a[60:63],v[140:143]
TR a[24:25],v4,64
MF v[144:147],a[76:79],a[60:63],v[144:147]
buffer_load_dwordx4 v26,s[8:11],s47 offen offset:3072 sc1 lds
TR a[26:27],v4,2368
MF v[148:151],a[80:83],a[60:63],v[148:151]
s_add_u32 s47,s47,2048
RD a[12:15],v3,6144
v_sub_u32 v5,0,v5
MF v[152:155],a[60:63],a[84:87],v[152:155]
TR a[28:29],v4,96
MF v[156:159],a[60:63],a[88:91],v[156:159]
TR a[30:31],v4,2400
MF v[160:163],a[60:63],a[92:95],v[160:163]
s_add_u32 s43,s45,s48
s_add_u32 m0,s43,0
TR a[32:33],v4,9216
MF v[164:167],a[60:63],a[96:99],v[164:167]
TR a[34:35],v4,11520
buffer_load_dwordx4 v16,s[12:15],s46 offen lds
MF v[168:171],a[60:63],a[100:103],v[168:171]
TR a[36:37],v4,9248
v_lshrrev_b32 v6,4,v1
MF v[172:175],a[68:71],a[64:67],v[172:175]
TR a[38:39],v4,11552
MF v[176:179],a[72:75],a[64:67],v[176:179]
s_bfe_u32 s59,s70,0x60000
s_lshl_b32 s59,s59,10
TR a[40:41],v4,9280
MF v[180:183],a[76:79],a[64:67],v[180:183]
s_add_u32 s59,s59,s56
TR a[42:43],v4,11584
buffer_store_dwordx4 v[208:211],v2,s[20:23],s59 offen
MF v[184:187],a[80:83],a[64:67],v[184:187]
TR a[44:45],v4,9312
v_xor_b32 v5,v5,v6
MF v[188:191],a[64:67],a[84:87],v[188:191]
TR a[46:47],v4,11616
MF v[192:195],a[64:67],a[88:91],v[192:195]
buffer_load_dwordx4 v17,s[12:15],s46 offen offset:1024 lds
TR a[48:49],v4,9344
MF v[196:199],a[64:67],a[92:95],v[196:199]
TR a[50:51],v4,11648
MF v[200:203],a[64:67],a[96:99],v[200:203]
MF v[204:207],a[64:67],a[100:103],v[204:207]
LW 15
MF v[64:67],a[16:19],a[0:3],v[64:67]
buffer_load_dwordx4 v18,s[12:15],s46 offen offset:2048 lds
RD a[52:55],v3,1024
MF v[68:71],a[20:23],a[0:3],v[68:71]
LW 14
TR a[68:69],v4,18432
v_and_b32 v5,3,v5
MF v[72:75],a[24:27],a[0:3],v[72:75]
LW 12
MF v[76:79],a[28:31],a[0:3],v[76:79]
LW 10
buffer_load_dwordx4 v19,s[12:15],s46 offen offset:3072 lds
TR a[70:71],v4,20736
MF v[80:83],a[0:3],a[32:35],v[80:83]
LW 9
RD a[56:59],v3,3072
v_lshlrev_b32 v5,4,v5
MF v[84:87],a[0:3],a[36:39],v[84:87]
LW 8
MF v[88:91],a[0:3],a[40:43],v[88:91]
LW 6
TR a[72:73],v4,18464
MF v[92:95],a[0:3],a[44:47],v[92:95]
LW 5
TR a[74:75],v4,20768
s_add_u32 m0,s43,4096
MF v[96:99],a[0:3],a[48:51],v[96:99]
buffer_load_dwordx4 v20,s[12:15],s46 offen lds
v_and_b32 v6,15,v1
MF v[100:103],a[16:19],a[4:7],v[100:103]
RD a[60:63],v3,5120
MF v[104:107],a[20:23],a[4:7],v[104:107]
TR a[76:77],v4,18496
buffer_load_dwordx4 v21,s[12:15],s46 offen offset:1024 lds
MF v[108:111],a[24:27],a[4:7],v[108:111]
MF v[112:115],a[28:31],a[4:7],v[112:115]
TR a[78:79],v4,20800
MF v[116:119],a[4:7],a[32:35],v[116:119]
RD a[64:67],v3,7168
v_lshl_add_u32 v5,v6,6,v5
MF v[120:123],a[4:7],a[36:39],v[120:123]
buffer_load_dwordx4 v22,s[12:15],s46 offen offset:2048 lds
MF v[124:127],a[4:7],a[40:43],v[124:127]
TR a[80:81],v4,18528
MF v[128:131],a[4:7],a[44:47],v[128:131]
MF v[132:135],a[4:7],a[48:51],v[132:135]
TR a[82:83],v4,20832
v_add_u32 v45,s50,v5
MF v[136:139],a[16:19],a[8:11],v[136:139]
TR a[84:85],v4,27648
buffer_load_dwordx4 v23,s[12:15],s46 offen offset:3072 lds
MF v[140:143],a[20:23],a[8:11],v[140:143]
MF v[144:147],a[24:27],a[8:11],v[144:147]
TR a[86:87],v4,29952
MF v[148:151],a[28:31],a[8:11],v[148:151]
s_add_u32 m0,s43,8192
TR a[88:89],v4,27680
v_add_u32 v46,18432,v45
MF v[152:155],a[8:11],a[32:35],v[152:155]
buffer_load_dwordx4 v24,s[12:15],s46 offen lds
s_add_u32 s46,s46,589824
MF v[156:159],a[8:11],a[36:39],v[156:159]
s_add_u32 s48,s48,53248
s_cmp_eq_u32 s48,159744
s_cselect_b32 s48,0,s48
MF v[160:163],a[8:11],a[40:43],v[160:163]
TR a[90:91],v4,29984
MF v[164:167],a[8:11],a[44:47],v[164:167]
s_bfe_u32 s59,s70,0x60006
s_lshl_b32 s59,s59,10
TR a[92:93],v4,27712
MF v[168:171],a[8:11],a[48:51],v[168:171]
s_add_u32 s59,s59,s56
buffer_store_dwordx4 v[212:215],v2,s[20:23],s59 offen
v_add_u32 v47,s51,v5
MF v[172:175],a[16:19],a[12:15],v[172:175]
TR a[94:95],v4,30016
MF v[176:179],a[20:23],a[12:15],v[176:179]
s_lshl_b32 s42,s36,4
s_lshl_b32 s7,s42,4
TR a[96:97],v4,27744
MF v[180:183],a[24:27],a[12:15],v[180:183]
s_add_u32 s7,s7,0x8300000
TR a[98:99],v4,30048
v_lshl_add_u32 v8,v1,2,s7
MF v[184:187],a[28:31],a[12:15],v[184:187]
global_load_dword v9,v8,s[4:5] sc1
v_add_u32 v48,18432,v47
MF v[188:191],a[12:15],a[32:35],v[188:191]
TR a[100:101],v4,27776
MF v[192:195],a[12:15],a[36:39],v[192:195]
s_sub_u32 s42,15,s36
s_lshl_b32 s42,s42,4
s_lshl_b32 s7,s42,4
MF v[196:199],a[12:15],a[40:43],v[196:199]
s_add_u32 s7,s7,0x8300000
TR a[102:103],v4,30080
v_lshl_add_u32 v10,v1,2,s7
MF v[200:203],a[12:15],a[44:47],v[200:203]
global_load_dword v11,v10,s[4:5] sc1
MF v[204:207],a[12:15],a[48:51],v[204:207]
LW 15
MF v[64:67],a[68:71],a[52:55],v[64:67]
MF v[68:71],a[72:75],a[52:55],v[68:71]
LW 13
MF v[72:75],a[76:79],a[52:55],v[72:75]
LW 10
MF v[76:79],a[80:83],a[52:55],v[76:79]
LW 8
MF v[80:83],a[52:55],a[84:87],v[80:83]
LW 6
MF v[84:87],a[52:55],a[88:91],v[84:87]
LW 4
MF v[88:91],a[52:55],a[92:95],v[88:91]
LW 2
MF v[92:95],a[52:55],a[96:99],v[92:95]
LW 0
s_waitcnt vmcnt(18)
MF v[96:99],a[52:55],a[100:103],v[96:99]
s_barrier
MF v[100:103],a[68:71],a[56:59],v[100:103]
s_add_u32 m0,s44,s48
v_add_u32 v3,s49,v27
MF v[104:107],a[72:75],a[56:59],v[104:107]
buffer_load_dwordx4 v25,s[8:11],s47 offen sc1 lds
v_add_u32 v4,s49,v28
MF v[108:111],a[76:79],a[56:59],v[108:111]
s_add_u32 s49,s49,53248
s_cmp_eq_u32 s49,159744
s_cselect_b32 s49,0,s49
MF v[112:115],a[80:83],a[56:59],v[112:115]
RD a[0:3],v3,0
MF v[116:119],a[56:59],a[84:87],v[116:119]
buffer_load_dwordx4 v25,s[8:11],s47 offen offset:1024 sc1 lds
TR a[16:17],v4,0
MF v[120:123],a[56:59],a[88:91],v[120:123]
TR a[18:19],v4,2304
MF v[124:127],a[56:59],a[92:95],v[124:127]
RD a[4:7],v3,2048
MF v[128:131],a[56:59],a[96:99],v[128:131]
TR a[20:21],v4,32
MF v[132:135],a[56:59],a[100:103],v[132:135]
TR a[22:23],v4,2336
MF v[136:139],a[68:71],a[60:63],v[136:139]
buffer_load_dwordx4 v26,s[8:11],s47 offen offset:2048 sc1 lds
RD a[8:11],v3,4096
MF v[140:143],a[72:75],a[60:63],v[140:143]
TR a[24:25],v4,64
MF v[144:147],a[76:79],a[60:63],v[144:147]
TR a[26:27],v4,2368
MF v[148:151],a[80:83],a[60:63],v[148:151]
RD a[12:15],v3,6144
MF v[152:155],a[60:63],a[84:87],v[152:155]
buffer_load_dwordx4 v26,s[8:11],s47 offen offset:3072 sc1 lds
TR a[28:29],v4,96
MF v[156:159],a[60:63],a[88:91],v[156:159]
s_add_u32 s47,s47,2048
TR a[30:31],v4,2400
MF v[160:163],a[60:63],a[92:95],v[160:163]
TR a[32:33],v4,9216
MF v[164:167],a[60:63],a[96:99],v[164:167]
TR a[34:35],v4,11520
MF v[168:171],a[60:63],a[100:103],v[168:171]
TR a[36:37],v4,9248
MF v[172:175],a[68:71],a[64:67],v[172:175]
s_add_u32 s43,s45,s48
s_add_u32 m0,s43,0
TR a[38:39],v4,11552
MF v[176:179],a[72:75],a[64:67],v[176:179]
TR a[40:41],v4,9280
buffer_load_dwordx4 v16,s[12:15],s46 offen lds
MF v[180:183],a[76:79],a[64:67],v[180:183]
TR a[42:43],v4,11584
MF v[184:187],a[80:83],a[64:67],v[184:187]
TR a[44:45],v4,9312
MF v[188:191],a[64:67],a[84:87],v[188:191]
s_bfe_u32 s59,s70,0x6000c
s_lshl_b32 s59,s59,10
TR a[46:47],v4,11616
MF v[192:195],a[64:67],a[88:91],v[192:195]
s_add_u32 s59,s59,s56
TR a[48:49],v4,9344
buffer_store_dwordx4 v[216:219],v2,s[20:23],s59 offen
MF v[196:199],a[64:67],a[92:95],v[196:199]
TR a[50:51],v4,11648
MF v[200:203],a[64:67],a[96:99],v[200:203]
MF v[204:207],a[64:67],a[100:103],v[204:207]
LW 15
MF v[64:67],a[16:19],a[0:3],v[64:67]
buffer_load_dwordx4 v17,s[12:15],s46 offen offset:1024 lds
RD a[52:55],v3,1024
MF v[68:71],a[20:23],a[0:3],v[68:71]
LW 14
TR a[68:69],v4,18432
MF v[72:75],a[24:27],a[0:3],v[72:75]
LW 12
MF v[76:79],a[28:31],a[0:3],v[76:79]
LW 10
buffer_load_dwordx4 v18,s[12:15],s46 offen offset:2048 lds
TR a[70:71],v4,20736
MF v[80:83],a[0:3],a[32:35],v[80:83]
LW 9
RD a[56:59],v3,3072
MF v[84:87],a[0:3],a[36:39],v[84:87]
LW 8
MF v[88:91],a[0:3],a[40:43],v[88:91]
LW 6
TR a[72:73],v4,18464
MF v[92:95],a[0:3],a[44:47],v[92:95]
LW 5
TR a[74:75],v4,20768
buffer_load_dwordx4 v19,s[12:15],s46 offen offset:3072 lds
MF v[96:99],a[0:3],a[48:51],v[96:99]
MF v[100:103],a[16:19],a[4:7],v[100:103]
RD a[60:63],v3,5120
MF v[104:107],a[20:23],a[4:7],v[104:107]
s_add_u32 m0,s43,4096
TR a[76:77],v4,18496
MF v[108:111],a[24:27],a[4:7],v[108:111]
buffer_load_dwordx4 v20,s[12:15],s46 offen lds
MF v[112:115],a[28:31],a[4:7],v[112:115]
TR a[78:79],v4,20800
MF v[116:119],a[4:7],a[32:35],v[116:119]
RD a[64:67],v3,7168
MF v[120:123],a[4:7],a[36:39],v[120:123]
buffer_load_dwordx4 v21,s[12:15],s46 offen offset:1024 lds
MF v[124:127],a[4:7],a[40:43],v[124:127]
TR a[80:81],v4,18528
MF v[128:131],a[4:7],a[44:47],v[128:131]
MF v[132:135],a[4:7],a[48:51],v[132:135]
TR a[82:83],v4,20832
MF v[136:139],a[16:19],a[8:11],v[136:139]
TR a[84:85],v4,27648
buffer_load_dwordx4 v22,s[12:15],s46 offen offset:2048 lds
MF v[140:143],a[20:23],a[8:11],v[140:143]
MF v[144:147],a[24:27],a[8:11],v[144:147]
TR a[86:87],v4,29952
MF v[148:151],a[28:31],a[8:11],v[148:151]
TR a[88:89],v4,27680
buffer_load_dwordx4 v23,s[12:15],s46 offen offset:3072 lds
MF v[152:155],a[8:11],a[32:35],v[152:155]
MF v[156:159],a[8:11],a[36:39],v[156:159]
TR a[90:91],v4,29984
MF v[160:163],a[8:11],a[40:43],v[160:163]
TR a[92:93],v4,27712
MF v[164:167],a[8:11],a[44:47],v[164:167]
s_add_u32 m0,s43,8192
MF v[168:171],a[8:11],a[48:51],v[168:171]
buffer_load_dwordx4 v24,s[12:15],s46 offen lds
s_add_u32 s46,s46,589824
MF v[172:175],a[16:19],a[12:15],v[172:175]
s_add_u32 s48,s48,53248
s_cmp_eq_u32 s48,159744
s_cselect_b32 s48,0,s48
MF v[176:179],a[20:23],a[12:15],v[176:179]
s_bfe_u32 s59,s70,0x60012
s_lshl_b32 s59,s59,10
TR a[94:95],v4,30016
MF v[180:183],a[24:27],a[12:15],v[180:183]
s_add_u32 s59,s59,s56
buffer_store_dwordx4 v[220:223],v2,s[20:23],s59 offen
TR a[96:97],v4,27744
MF v[184:187],a[28:31],a[12:15],v[184:187]
TR a[98:99],v4,30048
MF v[188:191],a[12:15],a[32:35],v[188:191]
TR a[100:101],v4,27776
MF v[192:195],a[12:15],a[36:39],v[192:195]
s_add_u32 s40,s0,Lm_q-Lm_pc
s_addc_u32 s41,s1,0
s_lshr_b32 s7,s2,3
MF v[196:199],a[12:15],a[40:43],v[196:199]
s_lshl_b32 s7,s7,2
s_add_u32 s7,s7,s32
s_lshl_b32 s7,s7,9
MF v[200:203],a[12:15],a[44:47],v[200:203]
v_and_b32 v12,3,v1
v_lshl_add_u32 v12,v12,7,s7
MF v[204:207],a[12:15],a[48:51],v[204:207]
LW 15
TR a[102:103],v4,30080
v_min_u32 v12,Lm_codeend-Lm_q-4,v12
global_load_dword a208,v12,s[40:41]
MF v[64:67],a[68:71],a[52:55],v[64:67]
MF v[68:71],a[72:75],a[52:55],v[68:71]
LW 13
MF v[72:75],a[76:79],a[52:55],v[72:75]
LW 10
MF v[76:79],a[80:83],a[52:55],v[76:79]
LW 8
MF v[80:83],a[52:55],a[84:87],v[80:83]
LW 6
MF v[84:87],a[52:55],a[88:91],v[84:87]
LW 4
MF v[88:91],a[52:55],a[92:95],v[88:91]
LW 2
MF v[92:95],a[52:55],a[96:99],v[92:95]
LW 0
s_waitcnt vmcnt(19)
MF v[96:99],a[52:55],a[100:103],v[96:99]
s_barrier
s_waitcnt vmcnt(17)
v_cmp_ne_u32 vcc,s3,v9
s_nop 0
s_cbranch_vccnz Lm_pl3
Lm_pl3r:
s_waitcnt vmcnt(16)
v_cmp_ne_u32 vcc,s3,v11
s_nop 0
s_cbranch_vccnz Lm_pl4
Lm_pl4r:
MF v[100:103],a[68:71],a[56:59],v[100:103]
s_mov_b32 s12,s68
s_mov_b32 s13,s69
v_add_u32 v3,s49,v27
MF v[104:107],a[72:75],a[56:59],v[104:107]
s_mov_b32 s14,0x480000
s_mov_b32 s15,0x20000
s_lshl_b32 s50,s32,13
MF v[108:111],a[76:79],a[56:59],v[108:111]
v_add_u32 v4,s49,v28
s_add_u32 s49,s49,53248
MF v[112:115],a[80:83],a[56:59],v[112:115]
s_cmp_eq_u32 s49,159744
s_cselect_b32 s49,0,s49
RD a[0:3],v3,0
MF v[116:119],a[56:59],a[84:87],v[116:119]
s_add_u32 m0,s50,65536
s_mov_b32 s46,0
buffer_load_dwordx4 v37,s[12:15],s46 offen lds
MF v[120:123],a[56:59],a[88:91],v[120:123]
TR a[16:17],v4,0
MF v[124:127],a[56:59],a[92:95],v[124:127]
TR a[18:19],v4,2304
MF v[128:131],a[56:59],a[96:99],v[128:131]
buffer_load_dwordx4 v38,s[12:15],s46 offen offset:1024 lds
RD a[4:7],v3,2048
MF v[132:135],a[56:59],a[100:103],v[132:135]
TR a[20:21],v4,32
MF v[136:139],a[68:71],a[60:63],v[136:139]
TR a[22:23],v4,2336
MF v[140:143],a[72:75],a[60:63],v[140:143]
RD a[8:11],v3,4096
MF v[144:147],a[76:79],a[60:63],v[144:147]
buffer_load_dwordx4 v39,s[12:15],s46 offen offset:2048 lds
TR a[24:25],v4,64
MF v[148:151],a[80:83],a[60:63],v[148:151]
TR a[26:27],v4,2368
MF v[152:155],a[60:63],a[84:87],v[152:155]
RD a[12:15],v3,6144
MF v[156:159],a[60:63],a[88:91],v[156:159]
TR a[28:29],v4,96
MF v[160:163],a[60:63],a[92:95],v[160:163]
buffer_load_dwordx4 v40,s[12:15],s46 offen offset:3072 lds
TR a[30:31],v4,2400
MF v[164:167],a[60:63],a[96:99],v[164:167]
TR a[32:33],v4,9216
MF v[168:171],a[60:63],a[100:103],v[168:171]
TR a[34:35],v4,11520
MF v[172:175],a[68:71],a[64:67],v[172:175]
TR a[36:37],v4,9248
MF v[176:179],a[72:75],a[64:67],v[176:179]
s_add_u32 m0,s50,69632
s_mov_b32 s46,0
TR a[38:39],v4,11552
MF v[180:183],a[76:79],a[64:67],v[180:183]
buffer_load_dwordx4 v41,s[12:15],s46 offen lds
TR a[40:41],v4,9280
MF v[184:187],a[80:83],a[64:67],v[184:187]
TR a[42:43],v4,11584
MF v[188:191],a[64:67],a[84:87],v[188:191]
TR a[44:45],v4,9312
MF v[192:195],a[64:67],a[88:91],v[192:195]
buffer_load_dwordx4 v42,s[12:15],s46 offen offset:1024 lds
TR a[46:47],v4,11616
MF v[196:199],a[64:67],a[92:95],v[196:199]
TR a[48:49],v4,9344
MF v[200:203],a[64:67],a[96:99],v[200:203]
TR a[50:51],v4,11648
MF v[204:207],a[64:67],a[100:103],v[204:207]
LW 15
MF v[64:67],a[16:19],a[0:3],v[64:67]
buffer_load_dwordx4 v43,s[12:15],s46 offen offset:2048 lds
RD a[52:55],v3,1024
MF v[68:71],a[20:23],a[0:3],v[68:71]
LW 14
TR a[68:69],v4,18432
MF v[72:75],a[24:27],a[0:3],v[72:75]
LW 12
MF v[76:79],a[28:31],a[0:3],v[76:79]
LW 10
buffer_load_dwordx4 v44,s[12:15],s46 offen offset:3072 lds
TR a[70:71],v4,20736
MF v[80:83],a[0:3],a[32:35],v[80:83]
LW 9
RD a[56:59],v3,3072
MF v[84:87],a[0:3],a[36:39],v[84:87]
LW 8
MF v[88:91],a[0:3],a[40:43],v[88:91]
LW 6
TR a[72:73],v4,18464
MF v[92:95],a[0:3],a[44:47],v[92:95]
LW 5
s_movk_i32 s47,0
buffer_load_dwordx4 a[128:131],v45,s[8:11],s47 offen sc1
MF v[96:99],a[0:3],a[48:51],v[96:99]
TR a[74:75],v4,20768
MF v[100:103],a[16:19],a[4:7],v[100:103]
RD a[60:63],v3,5120
MF v[104:107],a[20:23],a[4:7],v[104:107]
TR a[76:77],v4,18496
buffer_load_dwordx4 a[132:135],v46,s[8:11],s47 offen sc1
MF v[108:111],a[24:27],a[4:7],v[108:111]
MF v[112:115],a[28:31],a[4:7],v[112:115]
TR a[78:79],v4,20800
MF v[116:119],a[4:7],a[32:35],v[116:119]
RD a[64:67],v3,7168
MF v[120:123],a[4:7],a[36:39],v[120:123]
buffer_load_dwordx4 a[136:139],v47,s[8:11],s47 offen sc1
MF v[124:127],a[4:7],a[40:43],v[124:127]
TR a[80:81],v4,18528
MF v[128:131],a[4:7],a[44:47],v[128:131]
MF v[132:135],a[4:7],a[48:51],v[132:135]
TR a[82:83],v4,20832
MF v[136:139],a[16:19],a[8:11],v[136:139]
TR a[84:85],v4,27648
buffer_load_dwordx4 a[140:143],v48,s[8:11],s47 offen sc1
MF v[140:143],a[20:23],a[8:11],v[140:143]
MF v[144:147],a[24:27],a[8:11],v[144:147]
TR a[86:87],v4,29952
MF v[148:151],a[28:31],a[8:11],v[148:151]
s_bfe_u32 s59,s70,0x60018
s_lshl_b32 s59,s59,10
s_add_u32 s59,s59,s56
MF v[152:155],a[8:11],a[32:35],v[152:155]
TR a[88:89],v4,27680
buffer_store_dwordx4 v[224:227],v2,s[20:23],s59 offen
MF v[156:159],a[8:11],a[36:39],v[156:159]
TR a[90:91],v4,29984
MF v[160:163],a[8:11],a[40:43],v[160:163]
TR a[92:93],v4,27712
MF v[164:167],a[8:11],a[44:47],v[164:167]
s_bfe_u32 s59,s71,0x60000
s_lshl_b32 s59,s59,10
s_add_u32 s59,s59,s56
MF v[168:171],a[8:11],a[48:51],v[168:171]
TR a[94:95],v4,30016
buffer_store_dwordx4 v[228:231],v2,s[20:23],s59 offen
MF v[172:175],a[16:19],a[12:15],v[172:175]
TR a[96:97],v4,27744
MF v[176:179],a[20:23],a[12:15],v[176:179]
s_bfe_u32 s59,s71,0x60006
s_lshl_b32 s59,s59,10
s_add_u32 s59,s59,s56
MF v[180:183],a[24:27],a[12:15],v[180:183]
TR a[98:99],v4,30048
buffer_store_dwordx4 v[232:235],v2,s[20:23],s59 offen
MF v[184:187],a[28:31],a[12:15],v[184:187]
TR a[100:101],v4,27776
MF v[188:191],a[12:15],a[32:35],v[188:191]
MF v[192:195],a[12:15],a[36:39],v[192:195]
s_bfe_u32 s59,s71,0x6000c
s_lshl_b32 s59,s59,10
s_add_u32 s59,s59,s56
MF v[196:199],a[12:15],a[40:43],v[196:199]
TR a[102:103],v4,30080
buffer_store_dwordx4 v[236:239],v2,s[20:23],s59 offen
MF v[200:203],a[12:15],a[44:47],v[200:203]
MF v[204:207],a[12:15],a[48:51],v[204:207]
LW 15
MF v[64:67],a[68:71],a[52:55],v[64:67]
MF v[68:71],a[72:75],a[52:55],v[68:71]
LW 13
MF v[72:75],a[76:79],a[52:55],v[72:75]
LW 10
MF v[76:79],a[80:83],a[52:55],v[76:79]
LW 8
MF v[80:83],a[52:55],a[84:87],v[80:83]
LW 6
MF v[84:87],a[52:55],a[88:91],v[84:87]
LW 4
MF v[88:91],a[52:55],a[92:95],v[88:91]
LW 2
MF v[92:95],a[52:55],a[96:99],v[92:95]
LW 0
s_waitcnt vmcnt(18)
MF v[96:99],a[52:55],a[100:103],v[96:99]
s_barrier
MF v[100:103],a[68:71],a[56:59],v[100:103]
s_add_u32 m0,s50,98304
s_mov_b32 s46,1048576
v_add_u32 v3,s49,v27
MF v[104:107],a[72:75],a[56:59],v[104:107]
buffer_load_dwordx4 v37,s[12:15],s46 offen lds
v_add_u32 v4,s49,v28
MF v[108:111],a[76:79],a[56:59],v[108:111]
s_add_u32 s49,s49,53248
s_cmp_eq_u32 s49,159744
s_cselect_b32 s49,0,s49
MF v[112:115],a[80:83],a[56:59],v[112:115]
RD a[0:3],v3,0
MF v[116:119],a[56:59],a[84:87],v[116:119]
buffer_load_dwordx4 v38,s[12:15],s46 offen offset:1024 lds
TR a[16:17],v4,0
MF v[120:123],a[56:59],a[88:91],v[120:123]
TR a[18:19],v4,2304
MF v[124:127],a[56:59],a[92:95],v[124:127]
RD a[4:7],v3,2048
MF v[128:131],a[56:59],a[96:99],v[128:131]
TR a[20:21],v4,32
MF v[132:135],a[56:59],a[100:103],v[132:135]
TR a[22:23],v4,2336
MF v[136:139],a[68:71],a[60:63],v[136:139]
buffer_load_dwordx4 v39,s[12:15],s46 offen offset:2048 lds
RD a[8:11],v3,4096
MF v[140:143],a[72:75],a[60:63],v[140:143]
TR a[24:25],v4,64
MF v[144:147],a[76:79],a[60:63],v[144:147]
TR a[26:27],v4,2368
MF v[148:151],a[80:83],a[60:63],v[148:151]
RD a[12:15],v3,6144
MF v[152:155],a[60:63],a[84:87],v[152:155]
buffer_load_dwordx4 v40,s[12:15],s46 offen offset:3072 lds
TR a[28:29],v4,96
MF v[156:159],a[60:63],a[88:91],v[156:159]
TR a[30:31],v4,2400
MF v[160:163],a[60:63],a[92:95],v[160:163]
TR a[32:33],v4,9216
MF v[164:167],a[60:63],a[96:99],v[164:167]
TR a[34:35],v4,11520
MF v[168:171],a[60:63],a[100:103],v[168:171]
TR a[36:37],v4,9248
MF v[172:175],a[68:71],a[64:67],v[172:175]
s_add_u32 m0,s50,102400
s_mov_b32 s46,1048576
TR a[38:39],v4,11552
MF v[176:179],a[72:75],a[64:67],v[176:179]
TR a[40:41],v4,9280
buffer_load_dwordx4 v41,s[12:15],s46 offen lds
MF v[180:183],a[76:79],a[64:67],v[180:183]
TR a[42:43],v4,11584
MF v[184:187],a[80:83],a[64:67],v[184:187]
TR a[44:45],v4,9312
MF v[188:191],a[64:67],a[84:87],v[188:191]
buffer_load_dwordx4 v42,s[12:15],s46 offen offset:1024 lds
TR a[46:47],v4,11616
MF v[192:195],a[64:67],a[88:91],v[192:195]
TR a[48:49],v4,9344
MF v[196:199],a[64:67],a[92:95],v[196:199]
TR a[50:51],v4,11648
MF v[200:203],a[64:67],a[96:99],v[200:203]
MF v[204:207],a[64:67],a[100:103],v[204:207]
LW 15
MF v[64:67],a[16:19],a[0:3],v[64:67]
buffer_load_dwordx4 v43,s[12:15],s46 offen offset:2048 lds
RD a[52:55],v3,1024
MF v[68:71],a[20:23],a[0:3],v[68:71]
LW 14
TR a[68:69],v4,18432
MF v[72:75],a[24:27],a[0:3],v[72:75]
LW 12
MF v[76:79],a[28:31],a[0:3],v[76:79]
LW 10
buffer_load_dwordx4 v44,s[12:15],s46 offen offset:3072 lds
TR a[70:71],v4,20736
MF v[80:83],a[0:3],a[32:35],v[80:83]
LW 9
RD a[56:59],v3,3072
MF v[84:87],a[0:3],a[36:39],v[84:87]
LW 8
MF v[88:91],a[0:3],a[40:43],v[88:91]
LW 6
TR a[72:73],v4,18464
MF v[92:95],a[0:3],a[44:47],v[92:95]
LW 5
s_movk_i32 s47,0
buffer_load_dwordx4 a[144:147],v45,s[8:11],s47 offen offset:1024 sc1
MF v[96:99],a[0:3],a[48:51],v[96:99]
TR a[74:75],v4,20768
MF v[100:103],a[16:19],a[4:7],v[100:103]
RD a[60:63],v3,5120
MF v[104:107],a[20:23],a[4:7],v[104:107]
TR a[76:77],v4,18496
buffer_load_dwordx4 a[148:151],v46,s[8:11],s47 offen offset:1024 sc1
MF v[108:111],a[24:27],a[4:7],v[108:111]
MF v[112:115],a[28:31],a[4:7],v[112:115]
TR a[78:79],v4,20800
MF v[116:119],a[4:7],a[32:35],v[116:119]
RD a[64:67],v3,7168
MF v[120:123],a[4:7],a[36:39],v[120:123]
buffer_load_dwordx4 a[152:155],v47,s[8:11],s47 offen offset:1024 sc1
MF v[124:127],a[4:7],a[40:43],v[124:127]
TR a[80:81],v4,18528
MF v[128:131],a[4:7],a[44:47],v[128:131]
MF v[132:135],a[4:7],a[48:51],v[132:135]
TR a[82:83],v4,20832
MF v[136:139],a[16:19],a[8:11],v[136:139]
TR a[84:85],v4,27648
buffer_load_dwordx4 a[156:159],v48,s[8:11],s47 offen offset:1024 sc1
MF v[140:143],a[20:23],a[8:11],v[140:143]
MF v[144:147],a[24:27],a[8:11],v[144:147]
TR a[86:87],v4,29952
MF v[148:151],a[28:31],a[8:11],v[148:151]
s_bfe_u32 s59,s71,0x60012
s_lshl_b32 s59,s59,10
s_add_u32 s59,s59,s56
MF v[152:155],a[8:11],a[32:35],v[152:155]
TR a[88:89],v4,27680
buffer_store_dwordx4 v[240:243],v2,s[20:23],s59 offen
MF v[156:159],a[8:11],a[36:39],v[156:159]
TR a[90:91],v4,29984
MF v[160:163],a[8:11],a[40:43],v[160:163]
TR a[92:93],v4,27712
MF v[164:167],a[8:11],a[44:47],v[164:167]
s_bfe_u32 s59,s71,0x60018
s_lshl_b32 s59,s59,10
s_add_u32 s59,s59,s56
MF v[168:171],a[8:11],a[48:51],v[168:171]
TR a[94:95],v4,30016
buffer_store_dwordx4 v[244:247],v2,s[20:23],s59 offen
MF v[172:175],a[16:19],a[12:15],v[172:175]
TR a[96:97],v4,27744
MF v[176:179],a[20:23],a[12:15],v[176:179]
s_bfe_u32 s59,s72,0x60000
s_lshl_b32 s59,s59,10
s_add_u32 s59,s59,s56
MF v[180:183],a[24:27],a[12:15],v[180:183]
TR a[98:99],v4,30048
buffer_store_dwordx4 v[248:251],v2,s[20:23],s59 offen
MF v[184:187],a[28:31],a[12:15],v[184:187]
TR a[100:101],v4,27776
MF v[188:191],a[12:15],a[32:35],v[188:191]
MF v[192:195],a[12:15],a[36:39],v[192:195]
s_bfe_u32 s59,s72,0x60006
s_lshl_b32 s59,s59,10
s_add_u32 s59,s59,s56
MF v[196:199],a[12:15],a[40:43],v[196:199]
TR a[102:103],v4,30080
buffer_store_dwordx4 v[252:255],v2,s[20:23],s59 offen
MF v[200:203],a[12:15],a[44:47],v[200:203]
MF v[204:207],a[12:15],a[48:51],v[204:207]
LW 15
MF v[64:67],a[68:71],a[52:55],v[64:67]
MF v[68:71],a[72:75],a[52:55],v[68:71]
LW 13
MF v[72:75],a[76:79],a[52:55],v[72:75]
LW 10
MF v[76:79],a[80:83],a[52:55],v[76:79]
LW 8
MF v[80:83],a[52:55],a[84:87],v[80:83]
LW 6
MF v[84:87],a[52:55],a[88:91],v[84:87]
LW 4
MF v[88:91],a[52:55],a[92:95],v[88:91]
LW 2
MF v[92:95],a[52:55],a[96:99],v[92:95]
LW 0
MF v[96:99],a[52:55],a[100:103],v[96:99]
s_barrier
MF v[100:103],a[68:71],a[56:59],v[100:103]
s_add_u32 m0,s50,131072
s_mov_b32 s46,2097152
buffer_load_dwordx4 v37,s[12:15],s46 offen lds
MF v[104:107],a[72:75],a[56:59],v[104:107]
MF v[108:111],a[76:79],a[56:59],v[108:111]
buffer_load_dwordx4 v38,s[12:15],s46 offen offset:1024 lds
MF v[112:115],a[80:83],a[56:59],v[112:115]
MF v[116:119],a[56:59],a[84:87],v[116:119]
buffer_load_dwordx4 v39,s[12:15],s46 offen offset:2048 lds
MF v[120:123],a[56:59],a[88:91],v[120:123]
MF v[124:127],a[56:59],a[92:95],v[124:127]
buffer_load_dwordx4 v40,s[12:15],s46 offen offset:3072 lds
MF v[128:131],a[56:59],a[96:99],v[128:131]
MF v[132:135],a[56:59],a[100:103],v[132:135]
MF v[136:139],a[68:71],a[60:63],v[136:139]
s_add_u32 m0,s50,135168
s_mov_b32 s46,2097152
buffer_load_dwordx4 v41,s[12:15],s46 offen lds
MF v[140:143],a[72:75],a[60:63],v[140:143]
MF v[144:147],a[76:79],a[60:63],v[144:147]
buffer_load_dwordx4 v42,s[12:15],s46 offen offset:1024 lds
MF v[148:151],a[80:83],a[60:63],v[148:151]
MF v[152:155],a[60:63],a[84:87],v[152:155]
buffer_load_dwordx4 v43,s[12:15],s46 offen offset:2048 lds
MF v[156:159],a[60:63],a[88:91],v[156:159]
MF v[160:163],a[60:63],a[92:95],v[160:163]
buffer_load_dwordx4 v44,s[12:15],s46 offen offset:3072 lds
MF v[164:167],a[60:63],a[96:99],v[164:167]
MF v[168:171],a[60:63],a[100:103],v[168:171]
MF v[172:175],a[68:71],a[64:67],v[172:175]
s_movk_i32 s47,0
buffer_load_dwordx4 a[160:163],v45,s[8:11],s47 offen offset:2048 sc1
MF v[176:179],a[72:75],a[64:67],v[176:179]
MF v[180:183],a[76:79],a[64:67],v[180:183]
buffer_load_dwordx4 a[164:167],v46,s[8:11],s47 offen offset:2048 sc1
MF v[184:187],a[80:83],a[64:67],v[184:187]
MF v[188:191],a[64:67],a[84:87],v[188:191]
buffer_load_dwordx4 a[168:171],v47,s[8:11],s47 offen offset:2048 sc1
MF v[192:195],a[64:67],a[88:91],v[192:195]
MF v[196:199],a[64:67],a[92:95],v[196:199]
buffer_load_dwordx4 a[172:175],v48,s[8:11],s47 offen offset:2048 sc1
MF v[200:203],a[64:67],a[96:99],v[200:203]
MF v[204:207],a[64:67],a[100:103],v[204:207]
s_nop 7
s_add_u32 s24,s4,0x3f00000
s_addc_u32 s25,s5,0
s_mov_b32 s26,0x80000
s_mov_b32 s27,0x20000
s_mov_b32 s40,0xbdd2d3e8
s_mov_b32 s41,0xbdd2d3e8
v_mov_b32 v50,0xc0135761
v_mov_b32 v51,0xc0135761
s_lshl_b32 s42,s33,1
s_and_b32 s43,s32,1
s_add_u32 s42,s42,s43
s_lshl_b32 s42,s42,13
v_lshl_add_u32 v49,v1,3,s42
s_add_u32 s28,s4,0x6b00000
s_addc_u32 s29,s5,0
s_mov_b32 s30,0x800000
s_mov_b32 s31,0x20000
AR v3,a176
s_waitcnt vmcnt(16)
v_pk_mul_f32 v[60:61],v[80:81],v[80:81]
v_pk_fma_f32 v[60:61],v[60:61],s[40:41],v[50:51]
v_pk_mul_f32 v[60:61],v[60:61],v[80:81]
v_exp_f32 v60,v60
v_pk_mul_f32 v[62:63],v[82:83],v[82:83]
v_exp_f32 v61,v61
v_pk_fma_f32 v[62:63],v[62:63],s[40:41],v[50:51]
v_pk_add_f32 v[60:61],v[60:61],1.0 op_sel_hi:[1,0]
v_pk_mul_f32 v[62:63],v[62:63],v[82:83]
v_rcp_f32 v60,v60
v_exp_f32 v62,v62
v_pk_mul_f32 v[248:249],v[116:117],v[116:117]
v_rcp_f32 v61,v61
v_exp_f32 v63,v63
v_pk_fma_f32 v[248:249],v[248:249],s[40:41],v[50:51]
v_pk_mul_f32 v[80:81],v[80:81],v[60:61]
v_pk_add_f32 v[62:63],v[62:63],1.0 op_sel_hi:[1,0]
v_pk_mul_f32 v[248:249],v[248:249],v[116:117]
s_bfe_u32 s59,s72,0x6000c
s_lshl_b32 s59,s59,10
s_add_u32 s59,s59,s56
buffer_store_dwordx4 a[104:107],v2,s[20:23],s59 offen
v_pk_mul_f32 v[4:5],v[80:81],1.0 op_sel_hi:[1,0]
v_rcp_f32 v62,v62
v_exp_f32 v248,v248
v_pk_mul_f32 v[250:251],v[118:119],v[118:119]
v_pk_mul_f32 v[20:21],v[80:81],v[80:81]
v_rcp_f32 v63,v63
v_exp_f32 v249,v249
v_pk_fma_f32 v[250:251],v[250:251],s[40:41],v[50:51]
CV v208,v80,v81
v_pk_mul_f32 v[82:83],v[82:83],v[62:63]
v_pk_add_f32 v[248:249],v[248:249],1.0 op_sel_hi:[1,0]
v_pk_mul_f32 v[250:251],v[250:251],v[118:119]
v_pk_mul_f32 v[6:7],v[82:83],1.0 op_sel_hi:[1,0]
v_rcp_f32 v248,v248
v_exp_f32 v250,v250
v_pk_mul_f32 v[252:253],v[152:153],v[152:153]
v_pk_mul_f32 v[22:23],v[82:83],v[82:83]
v_rcp_f32 v249,v249
s_bfe_u32 s59,s72,0x60012
s_lshl_b32 s59,s59,10
s_add_u32 s59,s59,s56
buffer_store_dwordx4 a[108:111],v2,s[20:23],s59 offen
v_exp_f32 v251,v251
v_pk_fma_f32 v[252:253],v[252:253],s[40:41],v[50:51]
CV v209,v82,v83
v_pk_mul_f32 v[116:117],v[116:117],v[248:249]
v_pk_add_f32 v[250:251],v[250:251],1.0 op_sel_hi:[1,0]
v_pk_mul_f32 v[252:253],v[252:253],v[152:153]
v_pk_mul_f32 v[8:9],v[116:117],1.0 op_sel_hi:[1,0]
v_rcp_f32 v250,v250
v_exp_f32 v252,v252
v_pk_mul_f32 v[254:255],v[154:155],v[154:155]
v_pk_mul_f32 v[24:25],v[116:117],v[116:117]
v_rcp_f32 v251,v251
v_exp_f32 v253,v253
v_pk_fma_f32 v[254:255],v[254:255],s[40:41],v[50:51]
CV v210,v116,v117
v_pk_mul_f32 v[118:119],v[118:119],v[250:251]
v_pk_add_f32 v[252:253],v[252:253],1.0 op_sel_hi:[1,0]
v_pk_mul_f32 v[254:255],v[254:255],v[154:155]
s_bfe_u32 s59,s72,0x60018
s_lshl_b32 s59,s59,10
s_add_u32 s59,s59,s56
buffer_store_dwordx4 a[112:115],v2,s[20:23],s59 offen
v_pk_mul_f32 v[10:11],v[118:119],1.0 op_sel_hi:[1,0]
v_rcp_f32 v252,v252
v_exp_f32 v254,v254
v_pk_mul_f32 v[60:61],v[188:189],v[188:189]
v_pk_mul_f32 v[26:27],v[118:119],v[118:119]
v_rcp_f32 v253,v253
v_exp_f32 v255,v255
v_pk_fma_f32 v[60:61],v[60:61],s[40:41],v[50:51]
CV v211,v118,v119
v_pk_mul_f32 v[152:153],v[152:153],v[252:253]
v_pk_add_f32 v[254:255],v[254:255],1.0 op_sel_hi:[1,0]
v_pk_mul_f32 v[60:61],v[60:61],v[188:189]
v_pk_mul_f32 v[12:13],v[152:153],1.0 op_sel_hi:[1,0]
v_rcp_f32 v254,v254
v_exp_f32 v60,v60
v_pk_mul_f32 v[62:63],v[190:191],v[190:191]
v_pk_mul_f32 v[52:53],v[152:153],v[152:153]
v_rcp_f32 v255,v255
s_bfe_u32 s59,s73,0x60000
s_lshl_b32 s59,s59,10
s_add_u32 s59,s59,s56
buffer_store_dwordx4 a[116:119],v2,s[20:23],s59 offen
v_exp_f32 v61,v61
v_pk_fma_f32 v[62:63],v[62:63],s[40:41],v[50:51]
CV v228,v152,v153
v_pk_mul_f32 v[154:155],v[154:155],v[254:255]
v_pk_add_f32 v[60:61],v[60:61],1.0 op_sel_hi:[1,0]
v_pk_mul_f32 v[62:63],v[62:63],v[190:191]
v_pk_mul_f32 v[14:15],v[154:155],1.0 op_sel_hi:[1,0]
v_rcp_f32 v60,v60
v_exp_f32 v62,v62
v_pk_mul_f32 v[248:249],v[84:85],v[84:85]
v_pk_mul_f32 v[54:55],v[154:155],v[154:155]
v_rcp_f32 v61,v61
v_exp_f32 v63,v63
v_pk_fma_f32 v[248:249],v[248:249],s[40:41],v[50:51]
CV v229,v154,v155
v_pk_mul_f32 v[188:189],v[188:189],v[60:61]
v_pk_add_f32 v[62:63],v[62:63],1.0 op_sel_hi:[1,0]
s_bfe_u32 s59,s73,0x60006
s_lshl_b32 s59,s59,10
s_add_u32 s59,s59,s56
buffer_store_dwordx4 a[120:123],v2,s[20:23],s59 offen
v_pk_mul_f32 v[248:249],v[248:249],v[84:85]
v_pk_mul_f32 v[16:17],v[188:189],1.0 op_sel_hi:[1,0]
v_rcp_f32 v62,v62
v_exp_f32 v248,v248
v_pk_mul_f32 v[250:251],v[86:87],v[86:87]
v_pk_mul_f32 v[56:57],v[188:189],v[188:189]
v_rcp_f32 v63,v63
v_exp_f32 v249,v249
v_pk_fma_f32 v[250:251],v[250:251],s[40:41],v[50:51]
CV v230,v188,v189
v_pk_mul_f32 v[190:191],v[190:191],v[62:63]
v_pk_add_f32 v[248:249],v[248:249],1.0 op_sel_hi:[1,0]
v_pk_mul_f32 v[250:251],v[250:251],v[86:87]
v_pk_mul_f32 v[18:19],v[190:191],1.0 op_sel_hi:[1,0]
v_rcp_f32 v248,v248
v_exp_f32 v250,v250
v_pk_mul_f32 v[252:253],v[120:121],v[120:121]
v_pk_mul_f32 v[58:59],v[190:191],v[190:191]
s_bfe_u32 s59,s73,0x6000c
s_lshl_b32 s59,s59,10
s_add_u32 s59,s59,s56
buffer_store_dwordx4 a[124:127],v2,s[20:23],s59 offen
v_rcp_f32 v249,v249
v_exp_f32 v251,v251
v_pk_fma_f32 v[252:253],v[252:253],s[40:41],v[50:51]
CV v231,v190,v191
v_pk_mul_f32 v[84:85],v[84:85],v[248:249]
v_pk_add_f32 v[250:251],v[250:251],1.0 op_sel_hi:[1,0]
v_pk_mul_f32 v[252:253],v[252:253],v[120:121]
v_pk_add_f32 v[4:5],v[4:5],v[84:85]
v_rcp_f32 v250,v250
v_exp_f32 v252,v252
v_pk_mul_f32 v[254:255],v[122:123],v[122:123]
v_pk_fma_f32 v[20:21],v[84:85],v[84:85],v[20:21]
v_rcp_f32 v251,v251
v_exp_f32 v253,v253
v_pk_fma_f32 v[254:255],v[254:255],s[40:41],v[50:51]
CV v212,v84,v85
v_pk_mul_f32 v[86:87],v[86:87],v[250:251]
v_pk_add_f32 v[252:253],v[252:253],1.0 op_sel_hi:[1,0]
s_bfe_u32 s59,s73,0x60012
s_lshl_b32 s59,s59,10
s_add_u32 s59,s59,s56
buffer_store_dwordx4 a[192:195],v2,s[20:23],s59 offen
v_pk_mul_f32 v[254:255],v[254:255],v[122:123]
v_pk_add_f32 v[6:7],v[6:7],v[86:87]
v_rcp_f32 v252,v252
v_exp_f32 v254,v254
v_pk_mul_f32 v[60:61],v[156:157],v[156:157]
v_pk_fma_f32 v[22:23],v[86:87],v[86:87],v[22:23]
v_rcp_f32 v253,v253
v_exp_f32 v255,v255
v_pk_fma_f32 v[60:61],v[60:61],s[40:41],v[50:51]
CV v213,v86,v87
v_pk_mul_f32 v[120:121],v[120:121],v[252:253]
v_pk_add_f32 v[254:255],v[254:255],1.0 op_sel_hi:[1,0]
v_pk_mul_f32 v[60:61],v[60:61],v[156:157]
v_pk_add_f32 v[8:9],v[8:9],v[120:121]
v_rcp_f32 v254,v254
v_exp_f32 v60,v60
v_pk_mul_f32 v[62:63],v[158:159],v[158:159]
v_pk_fma_f32 v[24:25],v[120:121],v[120:121],v[24:25]
s_bfe_u32 s59,s73,0x60018
s_lshl_b32 s59,s59,10
s_add_u32 s59,s59,s56
buffer_store_dwordx4 a[196:199],v2,s[20:23],s59 offen
v_rcp_f32 v255,v255
v_exp_f32 v61,v61
v_pk_fma_f32 v[62:63],v[62:63],s[40:41],v[50:51]
CV v214,v120,v121
v_pk_mul_f32 v[122:123],v[122:123],v[254:255]
v_pk_add_f32 v[60:61],v[60:61],1.0 op_sel_hi:[1,0]
v_pk_mul_f32 v[62:63],v[62:63],v[158:159]
v_pk_add_f32 v[10:11],v[10:11],v[122:123]
v_rcp_f32 v60,v60
v_exp_f32 v62,v62
v_pk_mul_f32 v[248:249],v[192:193],v[192:193]
v_pk_fma_f32 v[26:27],v[122:123],v[122:123],v[26:27]
v_rcp_f32 v61,v61
v_exp_f32 v63,v63
v_pk_fma_f32 v[248:249],v[248:249],s[40:41],v[50:51]
CV v215,v122,v123
v_pk_mul_f32 v[156:157],v[156:157],v[60:61]
s_bfe_u32 s59,s76,0x60000
s_lshl_b32 s59,s59,10
s_add_u32 s59,s59,s56
buffer_store_dwordx4 a[200:203],v2,s[20:23],s59 offen
v_pk_add_f32 v[62:63],v[62:63],1.0 op_sel_hi:[1,0]
v_pk_mul_f32 v[248:249],v[248:249],v[192:193]
v_pk_add_f32 v[12:13],v[12:13],v[156:157]
v_rcp_f32 v62,v62
v_exp_f32 v248,v248
v_pk_mul_f32 v[250:251],v[194:195],v[194:195]
v_pk_fma_f32 v[52:53],v[156:157],v[156:157],v[52:53]
v_rcp_f32 v63,v63
v_exp_f32 v249,v249
v_pk_fma_f32 v[250:251],v[250:251],s[40:41],v[50:51]
CV v232,v156,v157
v_pk_mul_f32 v[158:159],v[158:159],v[62:63]
v_pk_add_f32 v[248:249],v[248:249],1.0 op_sel_hi:[1,0]
v_pk_mul_f32 v[250:251],v[250:251],v[194:195]
v_pk_add_f32 v[14:15],v[14:15],v[158:159]
v_rcp_f32 v248,v248
v_exp_f32 v250,v250
v_pk_mul_f32 v[252:253],v[88:89],v[88:89]
s_bfe_u32 s59,s76,0x60006
s_lshl_b32 s59,s59,10
s_add_u32 s59,s59,s56
buffer_store_dwordx4 a[204:207],v2,s[20:23],s59 offen
v_pk_fma_f32 v[54:55],v[158:159],v[158:159],v[54:55]
v_rcp_f32 v249,v249
v_exp_f32 v251,v251
v_pk_fma_f32 v[252:253],v[252:253],s[40:41],v[50:51]
CV v233,v158,v159
v_pk_mul_f32 v[192:193],v[192:193],v[248:249]
v_pk_add_f32 v[250:251],v[250:251],1.0 op_sel_hi:[1,0]
v_pk_mul_f32 v[252:253],v[252:253],v[88:89]
v_pk_add_f32 v[16:17],v[16:17],v[192:193]
v_rcp_f32 v250,v250
v_exp_f32 v252,v252
v_pk_mul_f32 v[254:255],v[90:91],v[90:91]
v_pk_fma_f32 v[56:57],v[192:193],v[192:193],v[56:57]
v_rcp_f32 v251,v251
v_exp_f32 v253,v253
v_pk_fma_f32 v[254:255],v[254:255],s[40:41],v[50:51]
CV v234,v192,v193
v_pk_mul_f32 v[194:195],v[194:195],v[250:251]
s_add_u32 m0,s50,0
s_mov_b32 s46,3145728
buffer_load_dwordx4 v37,s[12:15],s46 offen lds
v_pk_add_f32 v[252:253],v[252:253],1.0 op_sel_hi:[1,0]
v_pk_mul_f32 v[254:255],v[254:255],v[90:91]
v_pk_add_f32 v[18:19],v[18:19],v[194:195]
v_rcp_f32 v252,v252
v_exp_f32 v254,v254
v_pk_mul_f32 v[60:61],v[124:125],v[124:125]
v_pk_fma_f32 v[58:59],v[194:195],v[194:195],v[58:59]
v_rcp_f32 v253,v253
v_exp_f32 v255,v255
v_pk_fma_f32 v[60:61],v[60:61],s[40:41],v[50:51]
CV v235,v194,v195
v_pk_mul_f32 v[88:89],v[88:89],v[252:253]
v_pk_add_f32 v[254:255],v[254:255],1.0 op_sel_hi:[1,0]
v_pk_mul_f32 v[60:61],v[60:61],v[124:125]
v_pk_add_f32 v[4:5],v[4:5],v[88:89]
v_rcp_f32 v254,v254
v_exp_f32 v60,v60
v_pk_mul_f32 v[62:63],v[126:127],v[126:127]
buffer_load_dwordx4 v38,s[12:15],s46 offen offset:1024 lds
v_pk_fma_f32 v[20:21],v[88:89],v[88:89],v[20:21]
v_rcp_f32 v255,v255
v_exp_f32 v61,v61
v_pk_fma_f32 v[62:63],v[62:63],s[40:41],v[50:51]
CV v216,v88,v89
v_pk_mul_f32 v[90:91],v[90:91],v[254:255]
v_pk_add_f32 v[60:61],v[60:61],1.0 op_sel_hi:[1,0]
v_pk_mul_f32 v[62:63],v[62:63],v[126:127]
v_pk_add_f32 v[6:7],v[6:7],v[90:91]
v_rcp_f32 v60,v60
v_exp_f32 v62,v62
v_pk_mul_f32 v[248:249],v[160:161],v[160:161]
v_pk_fma_f32 v[22:23],v[90:91],v[90:91],v[22:23]
v_rcp_f32 v61,v61
v_exp_f32 v63,v63
v_pk_fma_f32 v[248:249],v[248:249],s[40:41],v[50:51]
CV v217,v90,v91
v_pk_mul_f32 v[124:125],v[124:125],v[60:61]
buffer_load_dwordx4 v39,s[12:15],s46 offen offset:2048 lds
v_pk_add_f32 v[62:63],v[62:63],1.0 op_sel_hi:[1,0]
v_pk_mul_f32 v[248:249],v[248:249],v[160:161]
v_pk_add_f32 v[8:9],v[8:9],v[124:125]
v_rcp_f32 v62,v62
v_exp_f32 v248,v248
v_pk_mul_f32 v[250:251],v[162:163],v[162:163]
v_pk_fma_f32 v[24:25],v[124:125],v[124:125],v[24:25]
v_rcp_f32 v63,v63
v_exp_f32 v249,v249
v_pk_fma_f32 v[250:251],v[250:251],s[40:41],v[50:51]
CV v218,v124,v125
v_pk_mul_f32 v[126:127],v[126:127],v[62:63]
v_pk_add_f32 v[248:249],v[248:249],1.0 op_sel_hi:[1,0]
v_pk_mul_f32 v[250:251],v[250:251],v[162:163]
v_pk_add_f32 v[10:11],v[10:11],v[126:127]
v_rcp_f32 v248,v248
v_exp_f32 v250,v250
buffer_load_dwordx4 v40,s[12:15],s46 offen offset:3072 lds
v_pk_mul_f32 v[252:253],v[196:197],v[196:197]
v_pk_fma_f32 v[26:27],v[126:127],v[126:127],v[26:27]
v_rcp_f32 v249,v249
v_exp_f32 v251,v251
v_pk_fma_f32 v[252:253],v[252:253],s[40:41],v[50:51]
CV v219,v126,v127
v_pk_mul_f32 v[160:161],v[160:161],v[248:249]
v_pk_add_f32 v[250:251],v[250:251],1.0 op_sel_hi:[1,0]
v_pk_mul_f32 v[252:253],v[252:253],v[196:197]
v_pk_add_f32 v[12:13],v[12:13],v[160:161]
v_rcp_f32 v250,v250
v_exp_f32 v252,v252
v_pk_mul_f32 v[254:255],v[198:199],v[198:199]
v_pk_fma_f32 v[52:53],v[160:161],v[160:161],v[52:53]
v_rcp_f32 v251,v251
v_exp_f32 v253,v253
v_pk_fma_f32 v[254:255],v[254:255],s[40:41],v[50:51]
CV v236,v160,v161
s_add_u32 m0,s50,4096
s_mov_b32 s46,3145728
buffer_load_dwordx4 v41,s[12:15],s46 offen lds
v_pk_mul_f32 v[162:163],v[162:163],v[250:251]
v_pk_add_f32 v[252:253],v[252:253],1.0 op_sel_hi:[1,0]
v_pk_mul_f32 v[254:255],v[254:255],v[198:199]
v_pk_add_f32 v[14:15],v[14:15],v[162:163]
v_rcp_f32 v252,v252
v_exp_f32 v254,v254
v_pk_mul_f32 v[60:61],v[92:93],v[92:93]
v_pk_fma_f32 v[54:55],v[162:163],v[162:163],v[54:55]
v_rcp_f32 v253,v253
v_exp_f32 v255,v255
v_pk_fma_f32 v[60:61],v[60:61],s[40:41],v[50:51]
CV v237,v162,v163
v_pk_mul_f32 v[196:197],v[196:197],v[252:253]
v_pk_add_f32 v[254:255],v[254:255],1.0 op_sel_hi:[1,0]
v_pk_mul_f32 v[60:61],v[60:61],v[92:93]
v_pk_add_f32 v[16:17],v[16:17],v[196:197]
v_rcp_f32 v254,v254
v_exp_f32 v60,v60
buffer_load_dwordx4 v42,s[12:15],s46 offen offset:1024 lds
v_pk_mul_f32 v[62:63],v[94:95],v[94:95]
v_pk_fma_f32 v[56:57],v[196:197],v[196:197],v[56:57]
v_rcp_f32 v255,v255
v_exp_f32 v61,v61
v_pk_fma_f32 v[62:63],v[62:63],s[40:41],v[50:51]
CV v238,v196,v197
v_pk_mul_f32 v[198:199],v[198:199],v[254:255]
v_pk_add_f32 v[60:61],v[60:61],1.0 op_sel_hi:[1,0]
v_pk_mul_f32 v[62:63],v[62:63],v[94:95]
v_pk_add_f32 v[18:19],v[18:19],v[198:199]
v_rcp_f32 v60,v60
v_exp_f32 v62,v62
v_pk_mul_f32 v[248:249],v[128:129],v[128:129]
v_pk_fma_f32 v[58:59],v[198:199],v[198:199],v[58:59]
v_rcp_f32 v61,v61
v_exp_f32 v63,v63
v_pk_fma_f32 v[248:249],v[248:249],s[40:41],v[50:51]
CV v239,v198,v199
buffer_load_dwordx4 v43,s[12:15],s46 offen offset:2048 lds
v_pk_mul_f32 v[92:93],v[92:93],v[60:61]
v_pk_add_f32 v[62:63],v[62:63],1.0 op_sel_hi:[1,0]
v_pk_mul_f32 v[248:249],v[248:249],v[128:129]
v_pk_add_f32 v[4:5],v[4:5],v[92:93]
v_rcp_f32 v62,v62
v_exp_f32 v248,v248
v_pk_mul_f32 v[250:251],v[130:131],v[130:131]
v_pk_fma_f32 v[20:21],v[92:93],v[92:93],v[20:21]
v_rcp_f32 v63,v63
v_exp_f32 v249,v249
v_pk_fma_f32 v[250:251],v[250:251],s[40:41],v[50:51]
CV v220,v92,v93
v_pk_mul_f32 v[94:95],v[94:95],v[62:63]
v_pk_add_f32 v[248:249],v[248:249],1.0 op_sel_hi:[1,0]
v_pk_mul_f32 v[250:251],v[250:251],v[130:131]
v_pk_add_f32 v[6:7],v[6:7],v[94:95]
v_rcp_f32 v248,v248
buffer_load_dwordx4 v44,s[12:15],s46 offen offset:3072 lds
v_exp_f32 v250,v250
v_pk_mul_f32 v[252:253],v[164:165],v[164:165]
v_pk_fma_f32 v[22:23],v[94:95],v[94:95],v[22:23]
v_rcp_f32 v249,v249
v_exp_f32 v251,v251
v_pk_fma_f32 v[252:253],v[252:253],s[40:41],v[50:51]
CV v221,v94,v95
v_pk_mul_f32 v[128:129],v[128:129],v[248:249]
v_pk_add_f32 v[250:251],v[250:251],1.0 op_sel_hi:[1,0]
v_pk_mul_f32 v[252:253],v[252:253],v[164:165]
v_pk_add_f32 v[8:9],v[8:9],v[128:129]
v_rcp_f32 v250,v250
v_exp_f32 v252,v252
v_pk_mul_f32 v[254:255],v[166:167],v[166:167]
v_pk_fma_f32 v[24:25],v[128:129],v[128:129],v[24:25]
v_rcp_f32 v251,v251
v_exp_f32 v253,v253
v_pk_fma_f32 v[254:255],v[254:255],s[40:41],v[50:51]
s_lshr_b32 s46,s32,1
s_lshl_b32 s46,s46,17
s_add_u32 s50,s50,s46
s_add_u32 m0,s50,32768
s_mov_b32 s46,4194304
buffer_load_dwordx4 v37,s[12:15],s46 offen lds
CV v222,v128,v129
v_pk_mul_f32 v[130:131],v[130:131],v[250:251]
v_pk_add_f32 v[252:253],v[252:253],1.0 op_sel_hi:[1,0]
v_pk_mul_f32 v[254:255],v[254:255],v[166:167]
v_pk_add_f32 v[10:11],v[10:11],v[130:131]
v_rcp_f32 v252,v252
v_exp_f32 v254,v254
v_pk_mul_f32 v[60:61],v[200:201],v[200:201]
v_pk_fma_f32 v[26:27],v[130:131],v[130:131],v[26:27]
v_rcp_f32 v253,v253
v_exp_f32 v255,v255
v_pk_fma_f32 v[60:61],v[60:61],s[40:41],v[50:51]
CV v223,v130,v131
v_pk_mul_f32 v[164:165],v[164:165],v[252:253]
v_pk_add_f32 v[254:255],v[254:255],1.0 op_sel_hi:[1,0]
v_pk_mul_f32 v[60:61],v[60:61],v[200:201]
v_pk_add_f32 v[12:13],v[12:13],v[164:165]
v_rcp_f32 v254,v254
buffer_load_dwordx4 v38,s[12:15],s46 offen offset:1024 lds
v_exp_f32 v60,v60
v_pk_mul_f32 v[62:63],v[202:203],v[202:203]
v_pk_fma_f32 v[52:53],v[164:165],v[164:165],v[52:53]
v_rcp_f32 v255,v255
v_exp_f32 v61,v61
v_pk_fma_f32 v[62:63],v[62:63],s[40:41],v[50:51]
CV v240,v164,v165
v_pk_mul_f32 v[166:167],v[166:167],v[254:255]
v_pk_add_f32 v[60:61],v[60:61],1.0 op_sel_hi:[1,0]
v_pk_mul_f32 v[62:63],v[62:63],v[202:203]
v_pk_add_f32 v[14:15],v[14:15],v[166:167]
v_rcp_f32 v60,v60
v_exp_f32 v62,v62
v_pk_mul_f32 v[248:249],v[96:97],v[96:97]
v_pk_fma_f32 v[54:55],v[166:167],v[166:167],v[54:55]
v_rcp_f32 v61,v61
v_exp_f32 v63,v63
v_pk_fma_f32 v[248:249],v[248:249],s[40:41],v[50:51]
buffer_load_dwordx4 v39,s[12:15],s46 offen offset:2048 lds
CV v241,v166,v167
v_pk_mul_f32 v[200:201],v[200:201],v[60:61]
v_pk_add_f32 v[62:63],v[62:63],1.0 op_sel_hi:[1,0]
v_pk_mul_f32 v[248:249],v[248:249],v[96:97]
v_pk_add_f32 v[16:17],v[16:17],v[200:201]
v_rcp_f32 v62,v62
v_exp_f32 v248,v248
v_pk_mul_f32 v[250:251],v[98:99],v[98:99]
v_pk_fma_f32 v[56:57],v[200:201],v[200:201],v[56:57]
v_rcp_f32 v63,v63
v_exp_f32 v249,v249
v_pk_fma_f32 v[250:251],v[250:251],s[40:41],v[50:51]
CV v242,v200,v201
v_pk_mul_f32 v[202:203],v[202:203],v[62:63]
v_pk_add_f32 v[248:249],v[248:249],1.0 op_sel_hi:[1,0]
v_pk_mul_f32 v[250:251],v[250:251],v[98:99]
v_pk_add_f32 v[18:19],v[18:19],v[202:203]
v_rcp_f32 v248,v248
buffer_load_dwordx4 v40,s[12:15],s46 offen offset:3072 lds
v_exp_f32 v250,v250
v_pk_mul_f32 v[252:253],v[132:133],v[132:133]
v_pk_fma_f32 v[58:59],v[202:203],v[202:203],v[58:59]
v_rcp_f32 v249,v249
v_exp_f32 v251,v251
v_pk_fma_f32 v[252:253],v[252:253],s[40:41],v[50:51]
CV v243,v202,v203
v_pk_mul_f32 v[96:97],v[96:97],v[248:249]
v_pk_add_f32 v[250:251],v[250:251],1.0 op_sel_hi:[1,0]
v_pk_mul_f32 v[252:253],v[252:253],v[132:133]
v_pk_add_f32 v[4:5],v[4:5],v[96:97]
v_rcp_f32 v250,v250
v_exp_f32 v252,v252
v_pk_mul_f32 v[254:255],v[134:135],v[134:135]
v_pk_fma_f32 v[20:21],v[96:97],v[96:97],v[20:21]
v_rcp_f32 v251,v251
v_exp_f32 v253,v253
s_add_u32 m0,s50,36864
s_mov_b32 s46,4194304
buffer_load_dwordx4 v41,s[12:15],s46 offen lds
v_pk_fma_f32 v[254:255],v[254:255],s[40:41],v[50:51]
CV v224,v96,v97
v_pk_mul_f32 v[98:99],v[98:99],v[250:251]
v_pk_add_f32 v[252:253],v[252:253],1.0 op_sel_hi:[1,0]
v_pk_mul_f32 v[254:255],v[254:255],v[134:135]
v_pk_add_f32 v[6:7],v[6:7],v[98:99]
v_rcp_f32 v252,v252
v_exp_f32 v254,v254
v_pk_mul_f32 v[60:61],v[168:169],v[168:169]
v_pk_fma_f32 v[22:23],v[98:99],v[98:99],v[22:23]
v_rcp_f32 v253,v253
v_exp_f32 v255,v255
v_pk_fma_f32 v[60:61],v[60:61],s[40:41],v[50:51]
CV v225,v98,v99
v_pk_mul_f32 v[132:133],v[132:133],v[252:253]
v_pk_add_f32 v[254:255],v[254:255],1.0 op_sel_hi:[1,0]
v_pk_mul_f32 v[60:61],v[60:61],v[168:169]
v_pk_add_f32 v[8:9],v[8:9],v[132:133]
buffer_load_dwordx4 v42,s[12:15],s46 offen offset:1024 lds
v_rcp_f32 v254,v254
v_exp_f32 v60,v60
v_pk_mul_f32 v[62:63],v[170:171],v[170:171]
v_pk_fma_f32 v[24:25],v[132:133],v[132:133],v[24:25]
v_rcp_f32 v255,v255
v_exp_f32 v61,v61
v_pk_fma_f32 v[62:63],v[62:63],s[40:41],v[50:51]
CV v226,v132,v133
v_pk_mul_f32 v[134:135],v[134:135],v[254:255]
v_pk_add_f32 v[60:61],v[60:61],1.0 op_sel_hi:[1,0]
v_pk_mul_f32 v[62:63],v[62:63],v[170:171]
v_pk_add_f32 v[10:11],v[10:11],v[134:135]
v_rcp_f32 v60,v60
v_exp_f32 v62,v62
v_pk_mul_f32 v[248:249],v[204:205],v[204:205]
v_pk_fma_f32 v[26:27],v[134:135],v[134:135],v[26:27]
v_rcp_f32 v61,v61
v_exp_f32 v63,v63
buffer_load_dwordx4 v43,s[12:15],s46 offen offset:2048 lds
v_pk_fma_f32 v[248:249],v[248:249],s[40:41],v[50:51]
CV v227,v134,v135
v_pk_mul_f32 v[168:169],v[168:169],v[60:61]
v_pk_add_f32 v[62:63],v[62:63],1.0 op_sel_hi:[1,0]
v_pk_mul_f32 v[248:249],v[248:249],v[204:205]
v_pk_add_f32 v[12:13],v[12:13],v[168:169]
v_rcp_f32 v62,v62
v_exp_f32 v248,v248
v_pk_mul_f32 v[250:251],v[206:207],v[206:207]
v_pk_fma_f32 v[52:53],v[168:169],v[168:169],v[52:53]
v_rcp_f32 v63,v63
v_exp_f32 v249,v249
v_pk_fma_f32 v[250:251],v[250:251],s[40:41],v[50:51]
CV v244,v168,v169
v_pk_mul_f32 v[170:171],v[170:171],v[62:63]
v_pk_add_f32 v[248:249],v[248:249],1.0 op_sel_hi:[1,0]
v_pk_mul_f32 v[250:251],v[250:251],v[206:207]
v_pk_add_f32 v[14:15],v[14:15],v[170:171]
buffer_load_dwordx4 v44,s[12:15],s46 offen offset:3072 lds
v_rcp_f32 v248,v248
v_exp_f32 v250,v250
v_pk_fma_f32 v[54:55],v[170:171],v[170:171],v[54:55]
v_rcp_f32 v249,v249
v_exp_f32 v251,v251
CV v245,v170,v171
v_pk_mul_f32 v[204:205],v[204:205],v[248:249]
v_pk_add_f32 v[250:251],v[250:251],1.0 op_sel_hi:[1,0]
v_pk_add_f32 v[16:17],v[16:17],v[204:205]
v_rcp_f32 v250,v250
v_pk_fma_f32 v[56:57],v[204:205],v[204:205],v[56:57]
v_rcp_f32 v251,v251
CV v246,v204,v205
v_pk_mul_f32 v[206:207],v[206:207],v[250:251]
v_pk_add_f32 v[18:19],v[18:19],v[206:207]
v_pk_fma_f32 v[58:59],v[206:207],v[206:207],v[58:59]
CV v247,v206,v207
s_mul_i32 s40,s2,36864
s_add_u32 s40,s40,0x23ffe00
s_add_u32 s20,s4,s40
s_addc_u32 s21,s5,0
s_mov_b32 s22,0x9200
s_mov_b32 s23,0x20000
s_lshr_b32 s42,s57,4
s_lshl_b32 s42,s42,4
s_lshl_b32 s7,s42,4
s_add_u32 s7,s7,0x8307000
v_lshl_add_u32 v50,v1,2,s7
global_load_dword v51,v50,s[4:5] sc1
s_mov_b32 s63,s57
v_and_b32 v60,8,v1
v_cmp_ne_u32 s[54:55],0,v60
v_and_b32 v60,4,v1
v_cmp_ne_u32 s[56:57],0,v60
v_and_b32 v60,2,v1
v_cmp_ne_u32 s[58:59],0,v60
v_and_b32 v60,1,v1
v_cmp_ne_u32 s[60:61],0,v60
s_nop 1
v_cndmask_b32 v60,v12,v4,s[54:55]
v_cndmask_b32 v4,v4,v12,s[54:55]
v_cndmask_b32 v61,v52,v20,s[54:55]
v_cndmask_b32 v20,v20,v52,s[54:55]
v_add_f32_dpp v4,v60,v4 row_ror:8 row_mask:0xf bank_mask:0xf
v_cndmask_b32 v248,v13,v5,s[54:55]
v_cndmask_b32 v5,v5,v13,s[54:55]
v_add_f32_dpp v20,v61,v20 row_ror:8 row_mask:0xf bank_mask:0xf
v_cndmask_b32 v249,v53,v21,s[54:55]
v_cndmask_b32 v21,v21,v53,s[54:55]
v_add_f32_dpp v5,v248,v5 row_ror:8 row_mask:0xf bank_mask:0xf
v_cndmask_b32 v60,v14,v6,s[54:55]
v_cndmask_b32 v6,v6,v14,s[54:55]
v_add_f32_dpp v21,v249,v21 row_ror:8 row_mask:0xf bank_mask:0xf
v_cndmask_b32 v61,v54,v22,s[54:55]
v_cndmask_b32 v22,v22,v54,s[54:55]
v_add_f32_dpp v6,v60,v6 row_ror:8 row_mask:0xf bank_mask:0xf
v_cndmask_b32 v248,v15,v7,s[54:55]
v_cndmask_b32 v7,v7,v15,s[54:55]
v_add_f32_dpp v22,v61,v22 row_ror:8 row_mask:0xf bank_mask:0xf
v_cndmask_b32 v249,v55,v23,s[54:55]
v_cndmask_b32 v23,v23,v55,s[54:55]
v_add_f32_dpp v7,v248,v7 row_ror:8 row_mask:0xf bank_mask:0xf
v_cndmask_b32 v60,v16,v8,s[54:55]
v_cndmask_b32 v8,v8,v16,s[54:55]
v_add_f32_dpp v23,v249,v23 row_ror:8 row_mask:0xf bank_mask:0xf
v_cndmask_b32 v61,v56,v24,s[54:55]
v_cndmask_b32 v24,v24,v56,s[54:55]
v_add_f32_dpp v8,v60,v8 row_ror:8 row_mask:0xf bank_mask:0xf
v_cndmask_b32 v248,v17,v9,s[54:55]
v_cndmask_b32 v9,v9,v17,s[54:55]
v_add_f32_dpp v24,v61,v24 row_ror:8 row_mask:0xf bank_mask:0xf
v_cndmask_b32 v249,v57,v25,s[54:55]
v_cndmask_b32 v25,v25,v57,s[54:55]
v_add_f32_dpp v9,v248,v9 row_ror:8 row_mask:0xf bank_mask:0xf
v_cndmask_b32 v60,v18,v10,s[54:55]
v_cndmask_b32 v10,v10,v18,s[54:55]
v_add_f32_dpp v25,v249,v25 row_ror:8 row_mask:0xf bank_mask:0xf
v_cndmask_b32 v61,v58,v26,s[54:55]
v_cndmask_b32 v26,v26,v58,s[54:55]
v_add_f32_dpp v10,v60,v10 row_ror:8 row_mask:0xf bank_mask:0xf
v_cndmask_b32 v248,v19,v11,s[54:55]
v_cndmask_b32 v11,v11,v19,s[54:55]
v_add_f32_dpp v26,v61,v26 row_ror:8 row_mask:0xf bank_mask:0xf
v_cndmask_b32 v249,v59,v27,s[54:55]
v_cndmask_b32 v27,v27,v59,s[54:55]
v_add_f32_dpp v11,v248,v11 row_ror:8 row_mask:0xf bank_mask:0xf
s_nop 1
v_add_f32_dpp v27,v249,v27 row_ror:8 row_mask:0xf bank_mask:0xf
v_cndmask_b32 v60,v8,v4,s[56:57]
v_cndmask_b32 v4,v4,v8,s[56:57]
v_cndmask_b32 v61,v24,v20,s[56:57]
v_cndmask_b32 v20,v20,v24,s[56:57]
v_add_f32_dpp v4,v60,v4 row_half_mirror row_mask:0xf bank_mask:0xf
v_cndmask_b32 v248,v9,v5,s[56:57]
v_cndmask_b32 v5,v5,v9,s[56:57]
v_add_f32_dpp v20,v61,v20 row_half_mirror row_mask:0xf bank_mask:0xf
v_cndmask_b32 v249,v25,v21,s[56:57]
v_cndmask_b32 v21,v21,v25,s[56:57]
v_add_f32_dpp v5,v248,v5 row_half_mirror row_mask:0xf bank_mask:0xf
v_cndmask_b32 v60,v10,v6,s[56:57]
v_cndmask_b32 v6,v6,v10,s[56:57]
v_add_f32_dpp v21,v249,v21 row_half_mirror row_mask:0xf bank_mask:0xf
v_cndmask_b32 v61,v26,v22,s[56:57]
v_cndmask_b32 v22,v22,v26,s[56:57]
v_add_f32_dpp v6,v60,v6 row_half_mirror row_mask:0xf bank_mask:0xf
v_cndmask_b32 v248,v11,v7,s[56:57]
v_cndmask_b32 v7,v7,v11,s[56:57]
v_add_f32_dpp v22,v61,v22 row_half_mirror row_mask:0xf bank_mask:0xf
v_cndmask_b32 v249,v27,v23,s[56:57]
v_cndmask_b32 v23,v23,v27,s[56:57]
v_add_f32_dpp v7,v248,v7 row_half_mirror row_mask:0xf bank_mask:0xf
s_nop 1
v_add_f32_dpp v23,v249,v23 row_half_mirror row_mask:0xf bank_mask:0xf
v_cndmask_b32 v60,v6,v4,s[58:59]
v_cndmask_b32 v4,v4,v6,s[58:59]
v_cndmask_b32 v61,v22,v20,s[58:59]
v_cndmask_b32 v20,v20,v22,s[58:59]
v_add_f32_dpp v4,v60,v4 quad_perm:[2,3,0,1] row_mask:0xf bank_mask:0xf
v_cndmask_b32 v248,v7,v5,s[58:59]
v_cndmask_b32 v5,v5,v7,s[58:59]
v_add_f32_dpp v20,v61,v20 quad_perm:[2,3,0,1] row_mask:0xf bank_mask:0xf
v_cndmask_b32 v249,v23,v21,s[58:59]
v_cndmask_b32 v21,v21,v23,s[58:59]
v_add_f32_dpp v5,v248,v5 quad_perm:[2,3,0,1] row_mask:0xf bank_mask:0xf
s_nop 1
v_add_f32_dpp v21,v249,v21 quad_perm:[2,3,0,1] row_mask:0xf bank_mask:0xf
v_cndmask_b32 v60,v5,v4,s[60:61]
v_cndmask_b32 v4,v4,v5,s[60:61]
v_cndmask_b32 v61,v21,v20,s[60:61]
v_cndmask_b32 v20,v20,v21,s[60:61]
v_add_f32_dpp v4,v60,v4 quad_perm:[1,0,3,2] row_mask:0xf bank_mask:0xf
s_nop 1
v_add_f32_dpp v20,v61,v20 quad_perm:[1,0,3,2] row_mask:0xf bank_mask:0xf
v_accvgpr_mov_b32 a96,a224
v_accvgpr_mov_b32 a97,a225
v_accvgpr_mov_b32 a98,a226
v_accvgpr_mov_b32 a99,a227
v_accvgpr_mov_b32 a100,a228
v_accvgpr_mov_b32 a101,a229
v_accvgpr_mov_b32 a102,a230
v_accvgpr_mov_b32 a103,a231
v_accvgpr_mov_b32 a104,a232
v_accvgpr_mov_b32 a105,a233
v_accvgpr_mov_b32 a106,a234
v_accvgpr_mov_b32 a107,a235
v_accvgpr_mov_b32 a108,a236
v_accvgpr_mov_b32 a109,a237
v_accvgpr_mov_b32 a110,a238
v_accvgpr_mov_b32 a111,a239
v_accvgpr_mov_b32 a112,a240
v_accvgpr_mov_b32 a113,a241
v_accvgpr_mov_b32 a114,a242
v_accvgpr_mov_b32 a115,a243
v_accvgpr_mov_b32 a116,a244
v_accvgpr_mov_b32 a117,a245
v_accvgpr_mov_b32 a118,a246
v_accvgpr_mov_b32 a119,a247
v_accvgpr_mov_b32 a120,a248
v_accvgpr_mov_b32 a121,a249
v_accvgpr_mov_b32 a122,a250
v_accvgpr_mov_b32 a123,a251
v_accvgpr_mov_b32 a124,a252
v_accvgpr_mov_b32 a125,a253
v_accvgpr_mov_b32 a126,a254
v_accvgpr_mov_b32 a127,a255
v_mov_b32 v12,v4
v_mov_b32 v13,v20
s_and_b32 s42,s32,1
s_lshl_b32 s42,s42,9
s_add_u32 s42,s42,49152
v_lshl_add_u32 v28,v1,3,s42
CV v4,v64,v65
CV v5,v66,v67
CV v6,v100,v101
CV v7,v102,v103
CV v8,v136,v137
CV v9,v138,v139
CV v10,v172,v173
CV v11,v174,v175
CV v14,v68,v69
CV v15,v70,v71
CV v16,v104,v105
CV v17,v106,v107
CV v18,v140,v141
CV v19,v142,v143
CV v20,v176,v177
CV v21,v178,v179
CV v22,v72,v73
CV v23,v74,v75
CV v24,v108,v109
CV v25,v110,v111
CV v26,v144,v145
CV v27,v146,v147
CV v52,v180,v181
CV v53,v182,v183
CV v54,v76,v77
CV v55,v78,v79
CV v56,v112,v113
CV v57,v114,v115
CV v58,v148,v149
CV v59,v150,v151
CV v60,v184,v185
CV v61,v186,v187
s_branch Lm_q
Lm_pl1:
s_mov_b32 s7,0x40000
Lm_pl1s:
s_sleep 1
global_load_dword v31,v30,s[4:5] sc1
s_sub_u32 s7,s7,1
s_cmp_eq_u32 s7,0
s_cbranch_scc1 Lm_pl1x
s_waitcnt vmcnt(0)
v_cmp_ne_u32 vcc,s3,v31
s_nop 1
s_cbranch_vccnz Lm_pl1s
Lm_pl1x:
s_waitcnt vmcnt(0)
s_branch Lm_pl1r
Lm_pl2:
s_mov_b32 s7,0x40000
Lm_pl2s:
s_sleep 1
global_load_dword v31,v30,s[4:5] sc1
s_sub_u32 s7,s7,1
s_cmp_eq_u32 s7,0
s_cbranch_scc1 Lm_pl2x
s_waitcnt vmcnt(0)
v_cmp_ne_u32 vcc,s3,v31
s_nop 1
s_cbranch_vccnz Lm_pl2s
Lm_pl2x:
s_waitcnt vmcnt(0)
s_branch Lm_pl2r
Lm_pl3:
s_mov_b32 s7,0x40000
Lm_pl3s:
s_sleep 1
global_load_dword v9,v8,s[4:5] sc1
s_sub_u32 s7,s7,1
s_cmp_eq_u32 s7,0
s_cbranch_scc1 Lm_pl3x
s_waitcnt vmcnt(0)
v_cmp_ne_u32 vcc,s3,v9
s_nop 1
s_cbranch_vccnz Lm_pl3s
Lm_pl3x:
s_waitcnt vmcnt(0)
s_branch Lm_pl3r
Lm_pl4:
s_mov_b32 s7,0x40000
Lm_pl4s:
s_sleep 1
global_load_dword v11,v10,s[4:5] sc1
s_sub_u32 s7,s7,1
s_cmp_eq_u32 s7,0
s_cbranch_scc1 Lm_pl4x
s_waitcnt vmcnt(0)
v_cmp_ne_u32 vcc,s3,v11
s_nop 1
s_cbranch_vccnz Lm_pl4s
Lm_pl4x:
s_waitcnt vmcnt(0)
s_branch Lm_pl4r
Lm_zw1:
s_bfe_u32 s59,s66,0x60000
s_lshl_b32 s59,s59,10
s_add_u32 s59,s59,s56
buffer_store_dwordx4 a[128:131],v2,s[20:23],s59 offen
v_add_u32 v3,s49,v27
v_add_u32 v4,s49,v28
s_add_u32 s49,s49,53248
s_cmp_eq_u32 s49,159744
s_cselect_b32 s49,0,s49
RD a[0:3],v3,0
TR a[16:17],v4,128
TR a[18:19],v4,2432
RD a[4:7],v3,2048
TR a[20:21],v4,160
TR a[22:23],v4,2464
RD a[8:11],v3,4096
TR a[24:25],v4,192
TR a[26:27],v4,2496
s_bfe_u32 s59,s66,0x60006
s_lshl_b32 s59,s59,10
s_add_u32 s59,s59,s56
buffer_store_dwordx4 a[132:135],v2,s[20:23],s59 offen
RD a[12:15],v3,6144
TR a[28:29],v4,224
TR a[30:31],v4,2528
TR a[32:33],v4,256
TR a[34:35],v4,2560
TR a[36:37],v4,9376
TR a[38:39],v4,11680
TR a[40:41],v4,9408
TR a[42:43],v4,11712
TR a[44:45],v4,9440
TR a[46:47],v4,11744
TR a[48:49],v4,9472
TR a[50:51],v4,11776
LW 15
MF v[64:67],a[16:19],a[0:3],0
s_add_u32 m0,s44,s48
RD a[52:55],v3,1024
MF v[68:71],a[20:23],a[0:3],0
LW 14
TR a[68:69],v4,18560
buffer_load_dwordx4 v25,s[8:11],s47 offen sc1 lds
MF v[72:75],a[24:27],a[0:3],0
LW 12
buffer_load_dwordx4 v25,s[8:11],s47 offen offset:1024 sc1 lds
MF v[76:79],a[28:31],a[0:3],0
LW 10
TR a[70:71],v4,20864
MF v[80:83],a[32:35],a[0:3],0
LW 9
RD a[56:59],v3,3072
MF v[84:87],a[0:3],a[36:39],0
LW 8
buffer_load_dwordx4 v26,s[8:11],s47 offen offset:2048 sc1 lds
MF v[88:91],a[0:3],a[40:43],0
LW 6
TR a[72:73],v4,18592
MF v[92:95],a[0:3],a[44:47],0
LW 5
TR a[74:75],v4,20896
MF v[96:99],a[0:3],a[48:51],0
buffer_load_dwordx4 v26,s[8:11],s47 offen offset:3072 sc1 lds
s_add_u32 s47,s47,2048
MF v[100:103],a[16:19],a[4:7],0
RD a[60:63],v3,5120
MF v[104:107],a[20:23],a[4:7],0
TR a[76:77],v4,18624
MF v[108:111],a[24:27],a[4:7],0
s_add_u32 s43,s45,s48
s_add_u32 m0,s43,0
MF v[112:115],a[28:31],a[4:7],0
TR a[78:79],v4,20928
buffer_load_dwordx4 v16,s[12:15],s46 offen lds
MF v[116:119],a[32:35],a[4:7],0
RD a[64:67],v3,7168
buffer_load_dwordx4 v17,s[12:15],s46 offen offset:1024 lds
MF v[120:123],a[4:7],a[36:39],0
MF v[124:127],a[4:7],a[40:43],0
TR a[80:81],v4,18656
MF v[128:131],a[4:7],a[44:47],0
buffer_load_dwordx4 v18,s[12:15],s46 offen offset:2048 lds
MF v[132:135],a[4:7],a[48:51],0
TR a[82:83],v4,20960
MF v[136:139],a[16:19],a[8:11],0
TR a[84:85],v4,18688
MF v[140:143],a[20:23],a[8:11],0
buffer_load_dwordx4 v19,s[12:15],s46 offen offset:3072 lds
MF v[144:147],a[24:27],a[8:11],0
TR a[86:87],v4,20992
MF v[148:151],a[28:31],a[8:11],0
TR a[88:89],v4,27808
MF v[152:155],a[32:35],a[8:11],0
s_add_u32 m0,s43,4096
MF v[156:159],a[8:11],a[36:39],0
TR a[90:91],v4,30112
buffer_load_dwordx4 v20,s[12:15],s46 offen lds
MF v[160:163],a[8:11],a[40:43],0
buffer_load_dwordx4 v21,s[12:15],s46 offen offset:1024 lds
TR a[92:93],v4,27840
MF v[164:167],a[8:11],a[44:47],0
MF v[168:171],a[8:11],a[48:51],0
TR a[94:95],v4,30144
MF v[172:175],a[16:19],a[12:15],0
TR a[96:97],v4,27872
buffer_load_dwordx4 v22,s[12:15],s46 offen offset:2048 lds
MF v[176:179],a[20:23],a[12:15],0
MF v[180:183],a[24:27],a[12:15],0
TR a[98:99],v4,30176
MF v[184:187],a[28:31],a[12:15],0
TR a[100:101],v4,27904
buffer_load_dwordx4 v23,s[12:15],s46 offen offset:3072 lds
MF v[188:191],a[32:35],a[12:15],0
MF v[192:195],a[12:15],a[36:39],0
TR a[102:103],v4,30208
MF v[196:199],a[12:15],a[40:43],0
s_add_u32 m0,s43,8192
MF v[200:203],a[12:15],a[44:47],0
buffer_load_dwordx4 v24,s[12:15],s46 offen lds
s_add_u32 s46,s46,589824
MF v[204:207],a[12:15],a[48:51],0
LW 15
s_add_u32 s48,s48,53248
s_cmp_eq_u32 s48,159744
s_cselect_b32 s48,0,s48
MF v[64:67],a[68:71],a[52:55],v[64:67]
MF v[68:71],a[72:75],a[52:55],v[68:71]
LW 13
MF v[72:75],a[76:79],a[52:55],v[72:75]
LW 10
MF v[76:79],a[80:83],a[52:55],v[76:79]
LW 8
MF v[80:83],a[84:87],a[52:55],v[80:83]
LW 6
MF v[84:87],a[52:55],a[88:91],v[84:87]
LW 4
MF v[88:91],a[52:55],a[92:95],v[88:91]
LW 2
MF v[92:95],a[52:55],a[96:99],v[92:95]
LW 0
s_waitcnt vmcnt(15)
MF v[96:99],a[52:55],a[100:103],v[96:99]
s_barrier
MF v[100:103],a[68:71],a[56:59],v[100:103]
s_add_u32 m0,s44,s48
v_add_u32 v3,s49,v27
MF v[104:107],a[72:75],a[56:59],v[104:107]
buffer_load_dwordx4 v25,s[8:11],s47 offen sc1 lds
v_add_u32 v4,s49,v28
MF v[108:111],a[76:79],a[56:59],v[108:111]
s_add_u32 s49,s49,53248
s_cmp_eq_u32 s49,159744
s_cselect_b32 s49,0,s49
MF v[112:115],a[80:83],a[56:59],v[112:115]
RD a[0:3],v3,0
MF v[116:119],a[84:87],a[56:59],v[116:119]
buffer_load_dwordx4 v25,s[8:11],s47 offen offset:1024 sc1 lds
TR a[16:17],v4,128
MF v[120:123],a[56:59],a[88:91],v[120:123]
TR a[18:19],v4,2432
MF v[124:127],a[56:59],a[92:95],v[124:127]
RD a[4:7],v3,2048
MF v[128:131],a[56:59],a[96:99],v[128:131]
TR a[20:21],v4,160
MF v[132:135],a[56:59],a[100:103],v[132:135]
TR a[22:23],v4,2464
MF v[136:139],a[68:71],a[60:63],v[136:139]
buffer_load_dwordx4 v26,s[8:11],s47 offen offset:2048 sc1 lds
RD a[8:11],v3,4096
MF v[140:143],a[72:75],a[60:63],v[140:143]
TR a[24:25],v4,192
MF v[144:147],a[76:79],a[60:63],v[144:147]
TR a[26:27],v4,2496
MF v[148:151],a[80:83],a[60:63],v[148:151]
RD a[12:15],v3,6144
MF v[152:155],a[84:87],a[60:63],v[152:155]
buffer_load_dwordx4 v26,s[8:11],s47 offen offset:3072 sc1 lds
TR a[28:29],v4,224
MF v[156:159],a[60:63],a[88:91],v[156:159]
s_add_u32 s47,s47,2048
TR a[30:31],v4,2528
MF v[160:163],a[60:63],a[92:95],v[160:163]
TR a[32:33],v4,256
MF v[164:167],a[60:63],a[96:99],v[164:167]
TR a[34:35],v4,2560
MF v[168:171],a[60:63],a[100:103],v[168:171]
TR a[36:37],v4,9376
MF v[172:175],a[68:71],a[64:67],v[172:175]
s_add_u32 s43,s45,s48
s_add_u32 m0,s43,0
TR a[38:39],v4,11680
MF v[176:179],a[72:75],a[64:67],v[176:179]
TR a[40:41],v4,9408
buffer_load_dwordx4 v16,s[12:15],s46 offen lds
MF v[180:183],a[76:79],a[64:67],v[180:183]
TR a[42:43],v4,11712
MF v[184:187],a[80:83],a[64:67],v[184:187]
TR a[44:45],v4,9440
MF v[188:191],a[84:87],a[64:67],v[188:191]
s_bfe_u32 s59,s66,0x6000c
s_lshl_b32 s59,s59,10
TR a[46:47],v4,11744
MF v[192:195],a[64:67],a[88:91],v[192:195]
s_add_u32 s59,s59,s56
TR a[48:49],v4,9472
buffer_store_dwordx4 a[136:139],v2,s[20:23],s59 offen
MF v[196:199],a[64:67],a[92:95],v[196:199]
TR a[50:51],v4,11776
MF v[200:203],a[64:67],a[96:99],v[200:203]
MF v[204:207],a[64:67],a[100:103],v[204:207]
LW 15
MF v[64:67],a[16:19],a[0:3],v[64:67]
buffer_load_dwordx4 v17,s[12:15],s46 offen offset:1024 lds
RD a[52:55],v3,1024
MF v[68:71],a[20:23],a[0:3],v[68:71]
LW 14
TR a[68:69],v4,18560
MF v[72:75],a[24:27],a[0:3],v[72:75]
LW 12
MF v[76:79],a[28:31],a[0:3],v[76:79]
LW 10
TR a[70:71],v4,20864
MF v[80:83],a[32:35],a[0:3],v[80:83]
LW 9
RD a[56:59],v3,3072
buffer_load_dwordx4 v18,s[12:15],s46 offen offset:2048 lds
MF v[84:87],a[0:3],a[36:39],v[84:87]
LW 8
MF v[88:91],a[0:3],a[40:43],v[88:91]
LW 6
TR a[72:73],v4,18592
MF v[92:95],a[0:3],a[44:47],v[92:95]
LW 5
TR a[74:75],v4,20896
MF v[96:99],a[0:3],a[48:51],v[96:99]
buffer_load_dwordx4 v19,s[12:15],s46 offen offset:3072 lds
MF v[100:103],a[16:19],a[4:7],v[100:103]
RD a[60:63],v3,5120
MF v[104:107],a[20:23],a[4:7],v[104:107]
TR a[76:77],v4,18624
MF v[108:111],a[24:27],a[4:7],v[108:111]
MF v[112:115],a[28:31],a[4:7],v[112:115]
s_add_u32 m0,s43,4096
TR a[78:79],v4,20928
MF v[116:119],a[32:35],a[4:7],v[116:119]
RD a[64:67],v3,7168
buffer_load_dwordx4 v20,s[12:15],s46 offen lds
MF v[120:123],a[4:7],a[36:39],v[120:123]
MF v[124:127],a[4:7],a[40:43],v[124:127]
TR a[80:81],v4,18656
MF v[128:131],a[4:7],a[44:47],v[128:131]
buffer_load_dwordx4 v21,s[12:15],s46 offen offset:1024 lds
MF v[132:135],a[4:7],a[48:51],v[132:135]
TR a[82:83],v4,20960
MF v[136:139],a[16:19],a[8:11],v[136:139]
TR a[84:85],v4,18688
MF v[140:143],a[20:23],a[8:11],v[140:143]
MF v[144:147],a[24:27],a[8:11],v[144:147]
TR a[86:87],v4,20992
buffer_load_dwordx4 v22,s[12:15],s46 offen offset:2048 lds
MF v[148:151],a[28:31],a[8:11],v[148:151]
TR a[88:89],v4,27808
MF v[152:155],a[32:35],a[8:11],v[152:155]
MF v[156:159],a[8:11],a[36:39],v[156:159]
TR a[90:91],v4,30112
MF v[160:163],a[8:11],a[40:43],v[160:163]
TR a[92:93],v4,27840
buffer_load_dwordx4 v23,s[12:15],s46 offen offset:3072 lds
MF v[164:167],a[8:11],a[44:47],v[164:167]
MF v[168:171],a[8:11],a[48:51],v[168:171]
TR a[94:95],v4,30144
MF v[172:175],a[16:19],a[12:15],v[172:175]
TR a[96:97],v4,27872
MF v[176:179],a[20:23],a[12:15],v[176:179]
s_add_u32 m0,s43,8192
MF v[180:183],a[24:27],a[12:15],v[180:183]
buffer_load_dwordx4 v24,s[12:15],s46 offen lds
s_add_u32 s46,s46,589824
MF v[184:187],a[28:31],a[12:15],v[184:187]
s_add_u32 s48,s48,53248
s_cmp_eq_u32 s48,159744
s_cselect_b32 s48,0,s48
MF v[188:191],a[32:35],a[12:15],v[188:191]
TR a[98:99],v4,30176
MF v[192:195],a[12:15],a[36:39],v[192:195]
s_bfe_u32 s59,s66,0x60012
s_lshl_b32 s59,s59,10
TR a[100:101],v4,27904
MF v[196:199],a[12:15],a[40:43],v[196:199]
s_add_u32 s59,s59,s56
TR a[102:103],v4,30208
buffer_store_dwordx4 a[144:147],v2,s[20:23],s59 offen
MF v[200:203],a[12:15],a[44:47],v[200:203]
MF v[204:207],a[12:15],a[48:51],v[204:207]
LW 15
MF v[64:67],a[68:71],a[52:55],v[64:67]
v_lshrrev_b32 v5,4,v1
MF v[68:71],a[72:75],a[52:55],v[68:71]
LW 13
MF v[72:75],a[76:79],a[52:55],v[72:75]
LW 10
MF v[76:79],a[80:83],a[52:55],v[76:79]
LW 8
MF v[80:83],a[84:87],a[52:55],v[80:83]
LW 6
v_bfe_u32 v6,v1,2,2
MF v[84:87],a[52:55],a[88:91],v[84:87]
LW 4
MF v[88:91],a[52:55],a[92:95],v[88:91]
LW 2
MF v[92:95],a[52:55],a[96:99],v[92:95]
LW 0
s_waitcnt vmcnt(15)
MF v[96:99],a[52:55],a[100:103],v[96:99]
s_barrier
v_lshl_add_u32 v7,v5,3,v6
MF v[100:103],a[68:71],a[56:59],v[100:103]
s_add_u32 m0,s44,s48
v_add_u32 v3,s49,v27
MF v[104:107],a[72:75],a[56:59],v[104:107]
buffer_load_dwordx4 v25,s[8:11],s47 offen sc1 lds
v_add_u32 v4,s49,v28
MF v[108:111],a[76:79],a[56:59],v[108:111]
s_add_u32 s49,s49,53248
s_cmp_eq_u32 s49,159744
s_cselect_b32 s49,0,s49
MF v[112:115],a[80:83],a[56:59],v[112:115]
RD a[0:3],v3,0
MF v[116:119],a[84:87],a[56:59],v[116:119]
TR a[16:17],v4,128
v_lshlrev_b32 v7,8,v7
MF v[120:123],a[56:59],a[88:91],v[120:123]
TR a[18:19],v4,2432
buffer_load_dwordx4 v25,s[8:11],s47 offen offset:1024 sc1 lds
MF v[124:127],a[56:59],a[92:95],v[124:127]
RD a[4:7],v3,2048
MF v[128:131],a[56:59],a[96:99],v[128:131]
TR a[20:21],v4,160
MF v[132:135],a[56:59],a[100:103],v[132:135]
TR a[22:23],v4,2464
v_and_b32 v5,1,v5
MF v[136:139],a[68:71],a[60:63],v[136:139]
buffer_load_dwordx4 v26,s[8:11],s47 offen offset:2048 sc1 lds
RD a[8:11],v3,4096
MF v[140:143],a[72:75],a[60:63],v[140:143]
TR a[24:25],v4,192
MF v[144:147],a[76:79],a[60:63],v[144:147]
TR a[26:27],v4,2496
MF v[148:151],a[80:83],a[60:63],v[148:151]
RD a[12:15],v3,6144
v_lshl_add_u32 v6,v5,2,v6
MF v[152:155],a[84:87],a[60:63],v[152:155]
buffer_load_dwordx4 v26,s[8:11],s47 offen offset:3072 sc1 lds
TR a[28:29],v4,224
MF v[156:159],a[60:63],a[88:91],v[156:159]
s_add_u32 s47,s47,2048
TR a[30:31],v4,2528
MF v[160:163],a[60:63],a[92:95],v[160:163]
TR a[32:33],v4,256
MF v[164:167],a[60:63],a[96:99],v[164:167]
TR a[34:35],v4,2560
MF v[168:171],a[60:63],a[100:103],v[168:171]
TR a[36:37],v4,9376
v_and_b32 v5,3,v1
MF v[172:175],a[68:71],a[64:67],v[172:175]
s_add_u32 s43,s45,s48
s_add_u32 m0,s43,0
TR a[38:39],v4,11680
MF v[176:179],a[72:75],a[64:67],v[176:179]
TR a[40:41],v4,9408
buffer_load_dwordx4 v16,s[12:15],s46 offen lds
MF v[180:183],a[76:79],a[64:67],v[180:183]
TR a[42:43],v4,11712
MF v[184:187],a[80:83],a[64:67],v[184:187]
TR a[44:45],v4,9440
v_lshl_add_u32 v7,v5,3,v7
MF v[188:191],a[84:87],a[64:67],v[188:191]
s_bfe_u32 s59,s66,0x60018
s_lshl_b32 s59,s59,10
TR a[46:47],v4,11744
MF v[192:195],a[64:67],a[88:91],v[192:195]
s_add_u32 s59,s59,s56
TR a[48:49],v4,9472
buffer_store_dwordx4 a[148:151],v2,s[20:23],s59 offen
MF v[196:199],a[64:67],a[92:95],v[196:199]
TR a[50:51],v4,11776
MF v[200:203],a[64:67],a[96:99],v[200:203]
MF v[204:207],a[64:67],a[100:103],v[204:207]
LW 15
MF v[64:67],a[16:19],a[0:3],v[64:67]
buffer_load_dwordx4 v17,s[12:15],s46 offen offset:1024 lds
RD a[52:55],v3,1024
MF v[68:71],a[20:23],a[0:3],v[68:71]
LW 14
TR a[68:69],v4,18560
v_add_u32 v7,0x10000,v7
MF v[72:75],a[24:27],a[0:3],v[72:75]
LW 12
MF v[76:79],a[28:31],a[0:3],v[76:79]
LW 10
TR a[70:71],v4,20864
MF v[80:83],a[32:35],a[0:3],v[80:83]
LW 9
buffer_load_dwordx4 v18,s[12:15],s46 offen offset:2048 lds
v_xor_b32 v5,0,v6
MF v[84:87],a[0:3],a[36:39],v[84:87]
LW 7
RD a[56:59],v3,3072
MF v[88:91],a[0:3],a[40:43],v[88:91]
LW 6
TR a[72:73],v4,18592
MF v[92:95],a[0:3],a[44:47],v[92:95]
LW 5
TR a[74:75],v4,20896
MF v[96:99],a[0:3],a[48:51],v[96:99]
buffer_load_dwordx4 v19,s[12:15],s46 offen offset:3072 lds
v_lshl_add_u32 v29,v5,5,v7
MF v[100:103],a[16:19],a[4:7],v[100:103]
RD a[60:63],v3,5120
MF v[104:107],a[20:23],a[4:7],v[104:107]
TR a[76:77],v4,18624
MF v[108:111],a[24:27],a[4:7],v[108:111]
MF v[112:115],a[28:31],a[4:7],v[112:115]
s_add_u32 m0,s43,4096
TR a[78:79],v4,20928
MF v[116:119],a[32:35],a[4:7],v[116:119]
buffer_load_dwordx4 v20,s[12:15],s46 offen lds
v_xor_b32 v5,1,v6
MF v[120:123],a[4:7],a[36:39],v[120:123]
RD a[64:67],v3,7168
MF v[124:127],a[4:7],a[40:43],v[124:127]
TR a[80:81],v4,18656
MF v[128:131],a[4:7],a[44:47],v[128:131]
buffer_load_dwordx4 v21,s[12:15],s46 offen offset:1024 lds
MF v[132:135],a[4:7],a[48:51],v[132:135]
TR a[82:83],v4,20960
v_lshl_add_u32 v30,v5,5,v7
MF v[136:139],a[16:19],a[8:11],v[136:139]
TR a[84:85],v4,18688
MF v[140:143],a[20:23],a[8:11],v[140:143]
MF v[144:147],a[24:27],a[8:11],v[144:147]
TR a[86:87],v4,20992
buffer_load_dwordx4 v22,s[12:15],s46 offen offset:2048 lds
MF v[148:151],a[28:31],a[8:11],v[148:151]
TR a[88:89],v4,27808
v_xor_b32 v5,2,v6
MF v[152:155],a[32:35],a[8:11],v[152:155]
MF v[156:159],a[8:11],a[36:39],v[156:159]
TR a[90:91],v4,30112
MF v[160:163],a[8:11],a[40:43],v[160:163]
TR a[92:93],v4,27840
buffer_load_dwordx4 v23,s[12:15],s46 offen offset:3072 lds
MF v[164:167],a[8:11],a[44:47],v[164:167]
MF v[168:171],a[8:11],a[48:51],v[168:171]
TR a[94:95],v4,30144
v_lshl_add_u32 v31,v5,5,v7
MF v[172:175],a[16:19],a[12:15],v[172:175]
TR a[96:97],v4,27872
MF v[176:179],a[20:23],a[12:15],v[176:179]
s_add_u32 m0,s43,8192
MF v[180:183],a[24:27],a[12:15],v[180:183]
buffer_load_dwordx4 v24,s[12:15],s46 offen lds
s_add_u32 s46,s46,589824
MF v[184:187],a[28:31],a[12:15],v[184:187]
s_add_u32 s48,s48,53248
s_cmp_eq_u32 s48,159744
s_cselect_b32 s48,0,s48
MF v[188:191],a[32:35],a[12:15],v[188:191]
TR a[98:99],v4,30176
v_xor_b32 v5,3,v6
MF v[192:195],a[12:15],a[36:39],v[192:195]
s_bfe_u32 s59,s67,0x60000
s_lshl_b32 s59,s59,10
TR a[100:101],v4,27904
MF v[196:199],a[12:15],a[40:43],v[196:199]
s_add_u32 s59,s59,s56
TR a[102:103],v4,30208
buffer_store_dwordx4 a[152:155],v2,s[20:23],s59 offen
MF v[200:203],a[12:15],a[44:47],v[200:203]
MF v[204:207],a[12:15],a[48:51],v[204:207]
LW 15
MF v[64:67],a[68:71],a[52:55],v[64:67]
v_lshl_add_u32 v32,v5,5,v7
MF v[68:71],a[72:75],a[52:55],v[68:71]
LW 13
MF v[72:75],a[76:79],a[52:55],v[72:75]
LW 10
MF v[76:79],a[80:83],a[52:55],v[76:79]
LW 8
MF v[80:83],a[84:87],a[52:55],v[80:83]
LW 6
v_xor_b32 v5,4,v6
MF v[84:87],a[52:55],a[88:91],v[84:87]
LW 4
MF v[88:91],a[52:55],a[92:95],v[88:91]
LW 2
MF v[92:95],a[52:55],a[96:99],v[92:95]
LW 0
s_waitcnt vmcnt(16)
MF v[96:99],a[52:55],a[100:103],v[96:99]
s_barrier
v_lshl_add_u32 v33,v5,5,v7
MF v[100:103],a[68:71],a[56:59],v[100:103]
s_add_u32 m0,s44,s48
v_add_u32 v3,s49,v27
MF v[104:107],a[72:75],a[56:59],v[104:107]
buffer_load_dwordx4 v25,s[8:11],s47 offen sc1 lds
v_add_u32 v4,s49,v28
MF v[108:111],a[76:79],a[56:59],v[108:111]
s_add_u32 s49,s49,53248
s_cmp_eq_u32 s49,159744
s_cselect_b32 s49,0,s49
MF v[112:115],a[80:83],a[56:59],v[112:115]
RD a[0:3],v3,0
MF v[116:119],a[84:87],a[56:59],v[116:119]
TR a[16:17],v4,128
v_xor_b32 v5,5,v6
MF v[120:123],a[56:59],a[88:91],v[120:123]
TR a[18:19],v4,2432
buffer_load_dwordx4 v25,s[8:11],s47 offen offset:1024 sc1 lds
MF v[124:127],a[56:59],a[92:95],v[124:127]
RD a[4:7],v3,2048
MF v[128:131],a[56:59],a[96:99],v[128:131]
TR a[20:21],v4,160
MF v[132:135],a[56:59],a[100:103],v[132:135]
TR a[22:23],v4,2464
v_lshl_add_u32 v34,v5,5,v7
MF v[136:139],a[68:71],a[60:63],v[136:139]
buffer_load_dwordx4 v26,s[8:11],s47 offen offset:2048 sc1 lds
RD a[8:11],v3,4096
MF v[140:143],a[72:75],a[60:63],v[140:143]
TR a[24:25],v4,192
MF v[144:147],a[76:79],a[60:63],v[144:147]
TR a[26:27],v4,2496
MF v[148:151],a[80:83],a[60:63],v[148:151]
RD a[12:15],v3,6144
v_xor_b32 v5,6,v6
MF v[152:155],a[84:87],a[60:63],v[152:155]
buffer_load_dwordx4 v26,s[8:11],s47 offen offset:3072 sc1 lds
TR a[28:29],v4,224
MF v[156:159],a[60:63],a[88:91],v[156:159]
s_add_u32 s47,s47,2048
TR a[30:31],v4,2528
MF v[160:163],a[60:63],a[92:95],v[160:163]
TR a[32:33],v4,256
MF v[164:167],a[60:63],a[96:99],v[164:167]
TR a[34:35],v4,2560
MF v[168:171],a[60:63],a[100:103],v[168:171]
TR a[36:37],v4,9376
v_lshl_add_u32 v35,v5,5,v7
MF v[172:175],a[68:71],a[64:67],v[172:175]
s_add_u32 s43,s45,s48
s_add_u32 m0,s43,0
TR a[38:39],v4,11680
MF v[176:179],a[72:75],a[64:67],v[176:179]
TR a[40:41],v4,9408
buffer_load_dwordx4 v16,s[12:15],s46 offen lds
MF v[180:183],a[76:79],a[64:67],v[180:183]
TR a[42:43],v4,11712
MF v[184:187],a[80:83],a[64:67],v[184:187]
TR a[44:45],v4,9440
v_xor_b32 v5,7,v6
MF v[188:191],a[84:87],a[64:67],v[188:191]
s_bfe_u32 s59,s67,0x60006
s_lshl_b32 s59,s59,10
TR a[46:47],v4,11744
MF v[192:195],a[64:67],a[88:91],v[192:195]
s_add_u32 s59,s59,s56
TR a[48:49],v4,9472
buffer_store_dwordx4 a[156:159],v2,s[20:23],s59 offen
MF v[196:199],a[64:67],a[92:95],v[196:199]
TR a[50:51],v4,11776
MF v[200:203],a[64:67],a[96:99],v[200:203]
MF v[204:207],a[64:67],a[100:103],v[204:207]
LW 15
MF v[64:67],a[16:19],a[0:3],v[64:67]
buffer_load_dwordx4 v17,s[12:15],s46 offen offset:1024 lds
RD a[52:55],v3,1024
MF v[68:71],a[20:23],a[0:3],v[68:71]
LW 14
TR a[68:69],v4,18560
v_lshl_add_u32 v36,v5,5,v7
MF v[72:75],a[24:27],a[0:3],v[72:75]
LW 12
MF v[76:79],a[28:31],a[0:3],v[76:79]
LW 10
TR a[70:71],v4,20864
MF v[80:83],a[32:35],a[0:3],v[80:83]
LW 9
buffer_load_dwordx4 v18,s[12:15],s46 offen offset:2048 lds
v_lshrrev_b32 v5,4,v1
MF v[84:87],a[0:3],a[36:39],v[84:87]
LW 7
RD a[56:59],v3,3072
MF v[88:91],a[0:3],a[40:43],v[88:91]
LW 6
TR a[72:73],v4,18592
MF v[92:95],a[0:3],a[44:47],v[92:95]
LW 5
TR a[74:75],v4,20896
MF v[96:99],a[0:3],a[48:51],v[96:99]
s_lshl_b32 s50,s32,5
buffer_load_dwordx4 v19,s[12:15],s46 offen offset:3072 lds
MF v[100:103],a[16:19],a[4:7],v[100:103]
RD a[60:63],v3,5120
MF v[104:107],a[20:23],a[4:7],v[104:107]
TR a[76:77],v4,18624
MF v[108:111],a[24:27],a[4:7],v[108:111]
MF v[112:115],a[28:31],a[4:7],v[112:115]
s_add_u32 m0,s43,4096
TR a[78:79],v4,20928
MF v[116:119],a[32:35],a[4:7],v[116:119]
buffer_load_dwordx4 v20,s[12:15],s46 offen lds
v_add_u32 v6,s50,v5
MF v[120:123],a[4:7],a[36:39],v[120:123]
RD a[64:67],v3,7168
MF v[124:127],a[4:7],a[40:43],v[124:127]
TR a[80:81],v4,18656
MF v[128:131],a[4:7],a[44:47],v[128:131]
buffer_load_dwordx4 v21,s[12:15],s46 offen offset:1024 lds
MF v[132:135],a[4:7],a[48:51],v[132:135]
TR a[82:83],v4,20960
v_lshlrev_b32 v6,13,v6
MF v[136:139],a[16:19],a[8:11],v[136:139]
TR a[84:85],v4,18688
MF v[140:143],a[20:23],a[8:11],v[140:143]
MF v[144:147],a[24:27],a[8:11],v[144:147]
TR a[86:87],v4,20992
buffer_load_dwordx4 v22,s[12:15],s46 offen offset:2048 lds
MF v[148:151],a[28:31],a[8:11],v[148:151]
s_lshl_b32 s50,s35,8
TR a[88:89],v4,27808
MF v[152:155],a[32:35],a[8:11],v[152:155]
MF v[156:159],a[8:11],a[36:39],v[156:159]
TR a[90:91],v4,30112
MF v[160:163],a[8:11],a[40:43],v[160:163]
TR a[92:93],v4,27840
buffer_load_dwordx4 v23,s[12:15],s46 offen offset:3072 lds
MF v[164:167],a[8:11],a[44:47],v[164:167]
MF v[168:171],a[8:11],a[48:51],v[168:171]
TR a[94:95],v4,30144
v_add_u32 v6,s50,v6
MF v[172:175],a[16:19],a[12:15],v[172:175]
TR a[96:97],v4,27872
MF v[176:179],a[20:23],a[12:15],v[176:179]
s_add_u32 m0,s43,8192
MF v[180:183],a[24:27],a[12:15],v[180:183]
buffer_load_dwordx4 v24,s[12:15],s46 offen lds
s_add_u32 s46,s46,589824
MF v[184:187],a[28:31],a[12:15],v[184:187]
s_add_u32 s48,s48,53248
s_cmp_eq_u32 s48,159744
s_cselect_b32 s48,0,s48
MF v[188:191],a[32:35],a[12:15],v[188:191]
TR a[98:99],v4,30176
v_lshlrev_b32 v5,1,v5
MF v[192:195],a[12:15],a[36:39],v[192:195]
s_bfe_u32 s59,s67,0x6000c
s_lshl_b32 s59,s59,10
TR a[100:101],v4,27904
MF v[196:199],a[12:15],a[40:43],v[196:199]
s_add_u32 s59,s59,s56
TR a[102:103],v4,30208
buffer_store_dwordx4 v[52:55],v2,s[20:23],s59 offen
MF v[200:203],a[12:15],a[44:47],v[200:203]
MF v[204:207],a[12:15],a[48:51],v[204:207]
LW 15
MF v[64:67],a[68:71],a[52:55],v[64:67]
v_and_b32 v7,15,v1
MF v[68:71],a[72:75],a[52:55],v[68:71]
LW 13
MF v[72:75],a[76:79],a[52:55],v[72:75]
LW 10
MF v[76:79],a[80:83],a[52:55],v[76:79]
LW 8
MF v[80:83],a[84:87],a[52:55],v[80:83]
LW 6
v_xor_b32 v5,v5,v7
MF v[84:87],a[52:55],a[88:91],v[84:87]
LW 4
MF v[88:91],a[52:55],a[92:95],v[88:91]
LW 2
MF v[92:95],a[52:55],a[96:99],v[92:95]
LW 0
s_waitcnt vmcnt(16)
MF v[96:99],a[52:55],a[100:103],v[96:99]
s_barrier
v_xor_b32 v7,8,v5
MF v[100:103],a[68:71],a[56:59],v[100:103]
s_add_u32 m0,s44,s48
v_add_u32 v3,s49,v27
MF v[104:107],a[72:75],a[56:59],v[104:107]
buffer_load_dwordx4 v25,s[8:11],s47 offen sc1 lds
v_add_u32 v4,s49,v28
MF v[108:111],a[76:79],a[56:59],v[108:111]
s_add_u32 s49,s49,53248
s_cmp_eq_u32 s49,159744
s_cselect_b32 s49,0,s49
MF v[112:115],a[80:83],a[56:59],v[112:115]
RD a[0:3],v3,0
MF v[116:119],a[84:87],a[56:59],v[116:119]
TR a[16:17],v4,128
v_lshl_add_u32 v5,v5,4,v6
MF v[120:123],a[56:59],a[88:91],v[120:123]
TR a[18:19],v4,2432
buffer_load_dwordx4 v25,s[8:11],s47 offen offset:1024 sc1 lds
MF v[124:127],a[56:59],a[92:95],v[124:127]
RD a[4:7],v3,2048
MF v[128:131],a[56:59],a[96:99],v[128:131]
TR a[20:21],v4,160
MF v[132:135],a[56:59],a[100:103],v[132:135]
TR a[22:23],v4,2464
v_lshl_add_u32 v7,v7,4,v6
MF v[136:139],a[68:71],a[60:63],v[136:139]
buffer_load_dwordx4 v26,s[8:11],s47 offen offset:2048 sc1 lds
RD a[8:11],v3,4096
MF v[140:143],a[72:75],a[60:63],v[140:143]
TR a[24:25],v4,192
MF v[144:147],a[76:79],a[60:63],v[144:147]
TR a[26:27],v4,2496
MF v[148:151],a[80:83],a[60:63],v[148:151]
RD a[12:15],v3,6144
v_add_u32 v37,0,v5
MF v[152:155],a[84:87],a[60:63],v[152:155]
buffer_load_dwordx4 v26,s[8:11],s47 offen offset:3072 sc1 lds
TR a[28:29],v4,224
MF v[156:159],a[60:63],a[88:91],v[156:159]
s_add_u32 s47,s47,2048
TR a[30:31],v4,2528
MF v[160:163],a[60:63],a[92:95],v[160:163]
TR a[32:33],v4,256
MF v[164:167],a[60:63],a[96:99],v[164:167]
TR a[34:35],v4,2560
MF v[168:171],a[60:63],a[100:103],v[168:171]
TR a[36:37],v4,9376
v_add_u32 v38,31744,v5
MF v[172:175],a[68:71],a[64:67],v[172:175]
s_add_u32 s43,s45,s48
s_add_u32 m0,s43,0
TR a[38:39],v4,11680
MF v[176:179],a[72:75],a[64:67],v[176:179]
TR a[40:41],v4,9408
buffer_load_dwordx4 v16,s[12:15],s46 offen lds
MF v[180:183],a[76:79],a[64:67],v[180:183]
TR a[42:43],v4,11712
MF v[184:187],a[80:83],a[64:67],v[184:187]
TR a[44:45],v4,9440
v_add_u32 v39,63488,v7
MF v[188:191],a[84:87],a[64:67],v[188:191]
s_bfe_u32 s59,s67,0x60012
s_lshl_b32 s59,s59,10
TR a[46:47],v4,11744
MF v[192:195],a[64:67],a[88:91],v[192:195]
s_add_u32 s59,s59,s56
TR a[48:49],v4,9472
buffer_store_dwordx4 v[56:59],v2,s[20:23],s59 offen
MF v[196:199],a[64:67],a[92:95],v[196:199]
TR a[50:51],v4,11776
MF v[200:203],a[64:67],a[96:99],v[200:203]
MF v[204:207],a[64:67],a[100:103],v[204:207]
LW 15
MF v[64:67],a[16:19],a[0:3],v[64:67]
buffer_load_dwordx4 v17,s[12:15],s46 offen offset:1024 lds
RD a[52:55],v3,1024
MF v[68:71],a[20:23],a[0:3],v[68:71]
LW 14
TR a[68:69],v4,18560
v_add_u32 v40,95232,v7
MF v[72:75],a[24:27],a[0:3],v[72:75]
LW 12
MF v[76:79],a[28:31],a[0:3],v[76:79]
LW 10
TR a[70:71],v4,20864
MF v[80:83],a[32:35],a[0:3],v[80:83]
LW 9
buffer_load_dwordx4 v18,s[12:15],s46 offen offset:2048 lds
v_add_u32 v41,131072,v5
MF v[84:87],a[0:3],a[36:39],v[84:87]
LW 7
RD a[56:59],v3,3072
MF v[88:91],a[0:3],a[40:43],v[88:91]
LW 6
TR a[72:73],v4,18592
MF v[92:95],a[0:3],a[44:47],v[92:95]
LW 5
TR a[74:75],v4,20896
MF v[96:99],a[0:3],a[48:51],v[96:99]
buffer_load_dwordx4 v19,s[12:15],s46 offen offset:3072 lds
v_add_u32 v42,162816,v5
MF v[100:103],a[16:19],a[4:7],v[100:103]
RD a[60:63],v3,5120
MF v[104:107],a[20:23],a[4:7],v[104:107]
TR a[76:77],v4,18624
MF v[108:111],a[24:27],a[4:7],v[108:111]
MF v[112:115],a[28:31],a[4:7],v[112:115]
s_add_u32 m0,s43,4096
TR a[78:79],v4,20928
MF v[116:119],a[32:35],a[4:7],v[116:119]
buffer_load_dwordx4 v20,s[12:15],s46 offen lds
v_add_u32 v43,194560,v7
MF v[120:123],a[4:7],a[36:39],v[120:123]
RD a[64:67],v3,7168
MF v[124:127],a[4:7],a[40:43],v[124:127]
TR a[80:81],v4,18656
MF v[128:131],a[4:7],a[44:47],v[128:131]
buffer_load_dwordx4 v21,s[12:15],s46 offen offset:1024 lds
MF v[132:135],a[4:7],a[48:51],v[132:135]
TR a[82:83],v4,20960
v_add_u32 v44,226304,v7
MF v[136:139],a[16:19],a[8:11],v[136:139]
TR a[84:85],v4,18688
MF v[140:143],a[20:23],a[8:11],v[140:143]
MF v[144:147],a[24:27],a[8:11],v[144:147]
TR a[86:87],v4,20992
buffer_load_dwordx4 v22,s[12:15],s46 offen offset:2048 lds
MF v[148:151],a[28:31],a[8:11],v[148:151]
s_lshl_b32 s50,s36,3
TR a[88:89],v4,27808
MF v[152:155],a[32:35],a[8:11],v[152:155]
MF v[156:159],a[8:11],a[36:39],v[156:159]
TR a[90:91],v4,30112
MF v[160:163],a[8:11],a[40:43],v[160:163]
TR a[92:93],v4,27840
buffer_load_dwordx4 v23,s[12:15],s46 offen offset:3072 lds
MF v[164:167],a[8:11],a[44:47],v[164:167]
MF v[168:171],a[8:11],a[48:51],v[168:171]
s_lshl_b32 s51,s32,1
TR a[94:95],v4,30144
MF v[172:175],a[16:19],a[12:15],v[172:175]
TR a[96:97],v4,27872
MF v[176:179],a[20:23],a[12:15],v[176:179]
s_add_u32 m0,s43,8192
MF v[180:183],a[24:27],a[12:15],v[180:183]
buffer_load_dwordx4 v24,s[12:15],s46 offen lds
s_add_u32 s46,s46,589824
MF v[184:187],a[28:31],a[12:15],v[184:187]
s_add_u32 s48,s48,53248
s_cmp_eq_u32 s48,159744
s_cselect_b32 s48,0,s48
MF v[188:191],a[32:35],a[12:15],v[188:191]
s_add_u32 s52,s50,s51
TR a[98:99],v4,30176
MF v[192:195],a[12:15],a[36:39],v[192:195]
s_bfe_u32 s59,s67,0x60018
s_lshl_b32 s59,s59,10
TR a[100:101],v4,27904
MF v[196:199],a[12:15],a[40:43],v[196:199]
s_add_u32 s59,s59,s56
TR a[102:103],v4,30208
buffer_store_dwordx4 v[60:63],v2,s[20:23],s59 offen
MF v[200:203],a[12:15],a[44:47],v[200:203]
MF v[204:207],a[12:15],a[48:51],v[204:207]
LW 15
MF v[64:67],a[68:71],a[52:55],v[64:67]
s_sub_u32 s53,120,s50
MF v[68:71],a[72:75],a[52:55],v[68:71]
LW 13
MF v[72:75],a[76:79],a[52:55],v[72:75]
LW 10
MF v[76:79],a[80:83],a[52:55],v[76:79]
LW 8
MF v[80:83],a[84:87],a[52:55],v[80:83]
LW 6
s_add_u32 s53,s53,s51
MF v[84:87],a[52:55],a[88:91],v[84:87]
LW 4
MF v[88:91],a[52:55],a[92:95],v[88:91]
LW 2
MF v[92:95],a[52:55],a[96:99],v[92:95]
LW 0
s_waitcnt vmcnt(16)
MF v[96:99],a[52:55],a[100:103],v[96:99]
s_barrier
s_mul_i32 s50,s53,18432
MF v[100:103],a[68:71],a[56:59],v[100:103]
s_add_u32 m0,s44,s48
v_add_u32 v3,s49,v27
MF v[104:107],a[72:75],a[56:59],v[104:107]
buffer_load_dwordx4 v25,s[8:11],s47 offen sc1 lds
v_add_u32 v4,s49,v28
MF v[108:111],a[76:79],a[56:59],v[108:111]
s_add_u32 s49,s49,53248
s_cmp_eq_u32 s49,159744
s_cselect_b32 s49,0,s49
MF v[112:115],a[80:83],a[56:59],v[112:115]
buffer_load_dwordx4 v25,s[8:11],s47 offen offset:1024 sc1 lds
RD a[0:3],v3,0
MF v[116:119],a[84:87],a[56:59],v[116:119]
s_mul_i32 s51,s52,18432
TR a[16:17],v4,128
MF v[120:123],a[56:59],a[88:91],v[120:123]
TR a[18:19],v4,2432
MF v[124:127],a[56:59],a[92:95],v[124:127]
RD a[4:7],v3,2048
MF v[128:131],a[56:59],a[96:99],v[128:131]
buffer_load_dwordx4 v26,s[8:11],s47 offen offset:2048 sc1 lds
TR a[20:21],v4,160
MF v[132:135],a[56:59],a[100:103],v[132:135]
TR a[22:23],v4,2464
v_bfe_u32 v5,v1,2,2
MF v[136:139],a[68:71],a[60:63],v[136:139]
RD a[8:11],v3,4096
MF v[140:143],a[72:75],a[60:63],v[140:143]
TR a[24:25],v4,192
MF v[144:147],a[76:79],a[60:63],v[144:147]
buffer_load_dwordx4 v26,s[8:11],s47 offen offset:3072 sc1 lds
TR a[26:27],v4,2496
MF v[148:151],a[80:83],a[60:63],v[148:151]
s_add_u32 s47,s47,2048
RD a[12:15],v3,6144
v_sub_u32 v5,0,v5
MF v[152:155],a[84:87],a[60:63],v[152:155]
TR a[28:29],v4,224
MF v[156:159],a[60:63],a[88:91],v[156:159]
TR a[30:31],v4,2528
MF v[160:163],a[60:63],a[92:95],v[160:163]
s_add_u32 s43,s45,s48
s_add_u32 m0,s43,0
TR a[32:33],v4,256
MF v[164:167],a[60:63],a[96:99],v[164:167]
TR a[34:35],v4,2560
buffer_load_dwordx4 v16,s[12:15],s46 offen lds
MF v[168:171],a[60:63],a[100:103],v[168:171]
TR a[36:37],v4,9376
v_lshrrev_b32 v6,4,v1
MF v[172:175],a[68:71],a[64:67],v[172:175]
TR a[38:39],v4,11680
MF v[176:179],a[72:75],a[64:67],v[176:179]
s_bfe_u32 s59,s70,0x60000
s_lshl_b32 s59,s59,10
TR a[40:41],v4,9408
MF v[180:183],a[76:79],a[64:67],v[180:183]
s_add_u32 s59,s59,s56
TR a[42:43],v4,11712
buffer_store_dwordx4 v[208:211],v2,s[20:23],s59 offen
MF v[184:187],a[80:83],a[64:67],v[184:187]
TR a[44:45],v4,9440
v_xor_b32 v5,v5,v6
MF v[188:191],a[84:87],a[64:67],v[188:191]
TR a[46:47],v4,11744
MF v[192:195],a[64:67],a[88:91],v[192:195]
buffer_load_dwordx4 v17,s[12:15],s46 offen offset:1024 lds
TR a[48:49],v4,9472
MF v[196:199],a[64:67],a[92:95],v[196:199]
TR a[50:51],v4,11776
MF v[200:203],a[64:67],a[96:99],v[200:203]
MF v[204:207],a[64:67],a[100:103],v[204:207]
LW 15
MF v[64:67],a[16:19],a[0:3],v[64:67]
buffer_load_dwordx4 v18,s[12:15],s46 offen offset:2048 lds
RD a[52:55],v3,1024
MF v[68:71],a[20:23],a[0:3],v[68:71]
LW 14
TR a[68:69],v4,18560
v_and_b32 v5,3,v5
MF v[72:75],a[24:27],a[0:3],v[72:75]
LW 12
MF v[76:79],a[28:31],a[0:3],v[76:79]
LW 10
buffer_load_dwordx4 v19,s[12:15],s46 offen offset:3072 lds
TR a[70:71],v4,20864
MF v[80:83],a[32:35],a[0:3],v[80:83]
LW 9
RD a[56:59],v3,3072
v_lshlrev_b32 v5,4,v5
MF v[84:87],a[0:3],a[36:39],v[84:87]
LW 8
MF v[88:91],a[0:3],a[40:43],v[88:91]
LW 6
TR a[72:73],v4,18592
MF v[92:95],a[0:3],a[44:47],v[92:95]
LW 5
TR a[74:75],v4,20896
s_add_u32 m0,s43,4096
MF v[96:99],a[0:3],a[48:51],v[96:99]
buffer_load_dwordx4 v20,s[12:15],s46 offen lds
v_and_b32 v6,15,v1
MF v[100:103],a[16:19],a[4:7],v[100:103]
RD a[60:63],v3,5120
MF v[104:107],a[20:23],a[4:7],v[104:107]
TR a[76:77],v4,18624
buffer_load_dwordx4 v21,s[12:15],s46 offen offset:1024 lds
MF v[108:111],a[24:27],a[4:7],v[108:111]
MF v[112:115],a[28:31],a[4:7],v[112:115]
TR a[78:79],v4,20928
MF v[116:119],a[32:35],a[4:7],v[116:119]
RD a[64:67],v3,7168
v_lshl_add_u32 v5,v6,6,v5
MF v[120:123],a[4:7],a[36:39],v[120:123]
buffer_load_dwordx4 v22,s[12:15],s46 offen offset:2048 lds
MF v[124:127],a[4:7],a[40:43],v[124:127]
TR a[80:81],v4,18656
MF v[128:131],a[4:7],a[44:47],v[128:131]
MF v[132:135],a[4:7],a[48:51],v[132:135]
TR a[82:83],v4,20960
v_add_u32 v45,s50,v5
MF v[136:139],a[16:19],a[8:11],v[136:139]
TR a[84:85],v4,18688
buffer_load_dwordx4 v23,s[12:15],s46 offen offset:3072 lds
MF v[140:143],a[20:23],a[8:11],v[140:143]
MF v[144:147],a[24:27],a[8:11],v[144:147]
TR a[86:87],v4,20992
MF v[148:151],a[28:31],a[8:11],v[148:151]
s_add_u32 m0,s43,8192
TR a[88:89],v4,27808
v_add_u32 v46,18432,v45
MF v[152:155],a[32:35],a[8:11],v[152:155]
buffer_load_dwordx4 v24,s[12:15],s46 offen lds
s_add_u32 s46,s46,589824
MF v[156:159],a[8:11],a[36:39],v[156:159]
s_add_u32 s48,s48,53248
s_cmp_eq_u32 s48,159744
s_cselect_b32 s48,0,s48
MF v[160:163],a[8:11],a[40:43],v[160:163]
TR a[90:91],v4,30112
MF v[164:167],a[8:11],a[44:47],v[164:167]
s_bfe_u32 s59,s70,0x60006
s_lshl_b32 s59,s59,10
TR a[92:93],v4,27840
MF v[168:171],a[8:11],a[48:51],v[168:171]
s_add_u32 s59,s59,s56
buffer_store_dwordx4 v[212:215],v2,s[20:23],s59 offen
v_add_u32 v47,s51,v5
MF v[172:175],a[16:19],a[12:15],v[172:175]
TR a[94:95],v4,30144
MF v[176:179],a[20:23],a[12:15],v[176:179]
s_lshl_b32 s42,s36,4
s_lshl_b32 s7,s42,4
TR a[96:97],v4,27872
MF v[180:183],a[24:27],a[12:15],v[180:183]
s_add_u32 s7,s7,0x8300000
TR a[98:99],v4,30176
v_lshl_add_u32 v8,v1,2,s7
MF v[184:187],a[28:31],a[12:15],v[184:187]
global_load_dword v9,v8,s[4:5] sc1
v_add_u32 v48,18432,v47
MF v[188:191],a[32:35],a[12:15],v[188:191]
TR a[100:101],v4,27904
MF v[192:195],a[12:15],a[36:39],v[192:195]
s_sub_u32 s42,15,s36
s_lshl_b32 s42,s42,4
s_lshl_b32 s7,s42,4
MF v[196:199],a[12:15],a[40:43],v[196:199]
s_add_u32 s7,s7,0x8300000
TR a[102:103],v4,30208
v_lshl_add_u32 v10,v1,2,s7
MF v[200:203],a[12:15],a[44:47],v[200:203]
global_load_dword v11,v10,s[4:5] sc1
MF v[204:207],a[12:15],a[48:51],v[204:207]
LW 15
MF v[64:67],a[68:71],a[52:55],v[64:67]
MF v[68:71],a[72:75],a[52:55],v[68:71]
LW 13
MF v[72:75],a[76:79],a[52:55],v[72:75]
LW 10
MF v[76:79],a[80:83],a[52:55],v[76:79]
LW 8
MF v[80:83],a[84:87],a[52:55],v[80:83]
LW 6
MF v[84:87],a[52:55],a[88:91],v[84:87]
LW 4
MF v[88:91],a[52:55],a[92:95],v[88:91]
LW 2
MF v[92:95],a[52:55],a[96:99],v[92:95]
LW 0
s_waitcnt vmcnt(18)
MF v[96:99],a[52:55],a[100:103],v[96:99]
s_barrier
MF v[100:103],a[68:71],a[56:59],v[100:103]
s_add_u32 m0,s44,s48
v_add_u32 v3,s49,v27
MF v[104:107],a[72:75],a[56:59],v[104:107]
buffer_load_dwordx4 v25,s[8:11],s47 offen sc1 lds
v_add_u32 v4,s49,v28
MF v[108:111],a[76:79],a[56:59],v[108:111]
s_add_u32 s49,s49,53248
s_cmp_eq_u32 s49,159744
s_cselect_b32 s49,0,s49
MF v[112:115],a[80:83],a[56:59],v[112:115]
RD a[0:3],v3,0
MF v[116:119],a[84:87],a[56:59],v[116:119]
buffer_load_dwordx4 v25,s[8:11],s47 offen offset:1024 sc1 lds
TR a[16:17],v4,128
MF v[120:123],a[56:59],a[88:91],v[120:123]
TR a[18:19],v4,2432
MF v[124:127],a[56:59],a[92:95],v[124:127]
RD a[4:7],v3,2048
MF v[128:131],a[56:59],a[96:99],v[128:131]
TR a[20:21],v4,160
MF v[132:135],a[56:59],a[100:103],v[132:135]
TR a[22:23],v4,2464
MF v[136:139],a[68:71],a[60:63],v[136:139]
buffer_load_dwordx4 v26,s[8:11],s47 offen offset:2048 sc1 lds
RD a[8:11],v3,4096
MF v[140:143],a[72:75],a[60:63],v[140:143]
TR a[24:25],v4,192
MF v[144:147],a[76:79],a[60:63],v[144:147]
TR a[26:27],v4,2496
MF v[148:151],a[80:83],a[60:63],v[148:151]
RD a[12:15],v3,6144
MF v[152:155],a[84:87],a[60:63],v[152:155]
buffer_load_dwordx4 v26,s[8:11],s47 offen offset:3072 sc1 lds
TR a[28:29],v4,224
MF v[156:159],a[60:63],a[88:91],v[156:159]
s_add_u32 s47,s47,2048
TR a[30:31],v4,2528
MF v[160:163],a[60:63],a[92:95],v[160:163]
TR a[32:33],v4,256
MF v[164:167],a[60:63],a[96:99],v[164:167]
TR a[34:35],v4,2560
MF v[168:171],a[60:63],a[100:103],v[168:171]
TR a[36:37],v4,9376
MF v[172:175],a[68:71],a[64:67],v[172:175]
s_add_u32 s43,s45,s48
s_add_u32 m0,s43,0
TR a[38:39],v4,11680
MF v[176:179],a[72:75],a[64:67],v[176:179]
TR a[40:41],v4,9408
buffer_load_dwordx4 v16,s[12:15],s46 offen lds
MF v[180:183],a[76:79],a[64:67],v[180:183]
TR a[42:43],v4,11712
MF v[184:187],a[80:83],a[64:67],v[184:187]
TR a[44:45],v4,9440
MF v[188:191],a[84:87],a[64:67],v[188:191]
s_bfe_u32 s59,s70,0x6000c
s_lshl_b32 s59,s59,10
TR a[46:47],v4,11744
MF v[192:195],a[64:67],a[88:91],v[192:195]
s_add_u32 s59,s59,s56
TR a[48:49],v4,9472
buffer_store_dwordx4 v[216:219],v2,s[20:23],s59 offen
MF v[196:199],a[64:67],a[92:95],v[196:199]
TR a[50:51],v4,11776
MF v[200:203],a[64:67],a[96:99],v[200:203]
MF v[204:207],a[64:67],a[100:103],v[204:207]
LW 15
MF v[64:67],a[16:19],a[0:3],v[64:67]
buffer_load_dwordx4 v17,s[12:15],s46 offen offset:1024 lds
RD a[52:55],v3,1024
MF v[68:71],a[20:23],a[0:3],v[68:71]
LW 14
TR a[68:69],v4,18560
MF v[72:75],a[24:27],a[0:3],v[72:75]
LW 12
MF v[76:79],a[28:31],a[0:3],v[76:79]
LW 10
buffer_load_dwordx4 v18,s[12:15],s46 offen offset:2048 lds
TR a[70:71],v4,20864
MF v[80:83],a[32:35],a[0:3],v[80:83]
LW 9
RD a[56:59],v3,3072
MF v[84:87],a[0:3],a[36:39],v[84:87]
LW 8
MF v[88:91],a[0:3],a[40:43],v[88:91]
LW 6
TR a[72:73],v4,18592
MF v[92:95],a[0:3],a[44:47],v[92:95]
LW 5
TR a[74:75],v4,20896
buffer_load_dwordx4 v19,s[12:15],s46 offen offset:3072 lds
MF v[96:99],a[0:3],a[48:51],v[96:99]
MF v[100:103],a[16:19],a[4:7],v[100:103]
RD a[60:63],v3,5120
MF v[104:107],a[20:23],a[4:7],v[104:107]
s_add_u32 m0,s43,4096
TR a[76:77],v4,18624
MF v[108:111],a[24:27],a[4:7],v[108:111]
buffer_load_dwordx4 v20,s[12:15],s46 offen lds
MF v[112:115],a[28:31],a[4:7],v[112:115]
TR a[78:79],v4,20928
MF v[116:119],a[32:35],a[4:7],v[116:119]
RD a[64:67],v3,7168
MF v[120:123],a[4:7],a[36:39],v[120:123]
buffer_load_dwordx4 v21,s[12:15],s46 offen offset:1024 lds
MF v[124:127],a[4:7],a[40:43],v[124:127]
TR a[80:81],v4,18656
MF v[128:131],a[4:7],a[44:47],v[128:131]
MF v[132:135],a[4:7],a[48:51],v[132:135]
TR a[82:83],v4,20960
MF v[136:139],a[16:19],a[8:11],v[136:139]
TR a[84:85],v4,18688
buffer_load_dwordx4 v22,s[12:15],s46 offen offset:2048 lds
MF v[140:143],a[20:23],a[8:11],v[140:143]
MF v[144:147],a[24:27],a[8:11],v[144:147]
TR a[86:87],v4,20992
MF v[148:151],a[28:31],a[8:11],v[148:151]
TR a[88:89],v4,27808
buffer_load_dwordx4 v23,s[12:15],s46 offen offset:3072 lds
MF v[152:155],a[32:35],a[8:11],v[152:155]
MF v[156:159],a[8:11],a[36:39],v[156:159]
TR a[90:91],v4,30112
MF v[160:163],a[8:11],a[40:43],v[160:163]
TR a[92:93],v4,27840
MF v[164:167],a[8:11],a[44:47],v[164:167]
s_add_u32 m0,s43,8192
MF v[168:171],a[8:11],a[48:51],v[168:171]
buffer_load_dwordx4 v24,s[12:15],s46 offen lds
s_add_u32 s46,s46,589824
MF v[172:175],a[16:19],a[12:15],v[172:175]
s_add_u32 s48,s48,53248
s_cmp_eq_u32 s48,159744
s_cselect_b32 s48,0,s48
MF v[176:179],a[20:23],a[12:15],v[176:179]
s_bfe_u32 s59,s70,0x60012
s_lshl_b32 s59,s59,10
TR a[94:95],v4,30144
MF v[180:183],a[24:27],a[12:15],v[180:183]
s_add_u32 s59,s59,s56
buffer_store_dwordx4 v[220:223],v2,s[20:23],s59 offen
TR a[96:97],v4,27872
MF v[184:187],a[28:31],a[12:15],v[184:187]
TR a[98:99],v4,30176
MF v[188:191],a[32:35],a[12:15],v[188:191]
TR a[100:101],v4,27904
MF v[192:195],a[12:15],a[36:39],v[192:195]
s_add_u32 s40,s0,Lm_q-Lm_pc
s_addc_u32 s41,s1,0
s_lshr_b32 s7,s2,3
MF v[196:199],a[12:15],a[40:43],v[196:199]
s_lshl_b32 s7,s7,2
s_add_u32 s7,s7,s32
s_lshl_b32 s7,s7,9
MF v[200:203],a[12:15],a[44:47],v[200:203]
v_and_b32 v12,3,v1
v_lshl_add_u32 v12,v12,7,s7
MF v[204:207],a[12:15],a[48:51],v[204:207]
LW 15
TR a[102:103],v4,30208
v_min_u32 v12,Lm_codeend-Lm_q-4,v12
global_load_dword a208,v12,s[40:41]
MF v[64:67],a[68:71],a[52:55],v[64:67]
MF v[68:71],a[72:75],a[52:55],v[68:71]
LW 13
MF v[72:75],a[76:79],a[52:55],v[72:75]
LW 10
MF v[76:79],a[80:83],a[52:55],v[76:79]
LW 8
MF v[80:83],a[84:87],a[52:55],v[80:83]
LW 6
MF v[84:87],a[52:55],a[88:91],v[84:87]
LW 4
MF v[88:91],a[52:55],a[92:95],v[88:91]
LW 2
MF v[92:95],a[52:55],a[96:99],v[92:95]
LW 0
s_waitcnt vmcnt(19)
MF v[96:99],a[52:55],a[100:103],v[96:99]
s_barrier
s_waitcnt vmcnt(17)
v_cmp_ne_u32 vcc,s3,v9
s_nop 0
s_cbranch_vccnz Lm_pl5
Lm_pl5r:
s_waitcnt vmcnt(16)
v_cmp_ne_u32 vcc,s3,v11
s_nop 0
s_cbranch_vccnz Lm_pl6
Lm_pl6r:
MF v[100:103],a[68:71],a[56:59],v[100:103]
s_mov_b32 s12,s68
s_mov_b32 s13,s69
v_add_u32 v3,s49,v27
MF v[104:107],a[72:75],a[56:59],v[104:107]
s_mov_b32 s14,0x480000
s_mov_b32 s15,0x20000
s_lshl_b32 s50,s32,13
MF v[108:111],a[76:79],a[56:59],v[108:111]
v_add_u32 v4,s49,v28
s_add_u32 s49,s49,53248
MF v[112:115],a[80:83],a[56:59],v[112:115]
s_cmp_eq_u32 s49,159744
s_cselect_b32 s49,0,s49
RD a[0:3],v3,0
MF v[116:119],a[84:87],a[56:59],v[116:119]
s_add_u32 m0,s50,65536
s_mov_b32 s46,0
buffer_load_dwordx4 v37,s[12:15],s46 offen lds
MF v[120:123],a[56:59],a[88:91],v[120:123]
TR a[16:17],v4,128
MF v[124:127],a[56:59],a[92:95],v[124:127]
TR a[18:19],v4,2432
MF v[128:131],a[56:59],a[96:99],v[128:131]
buffer_load_dwordx4 v38,s[12:15],s46 offen offset:1024 lds
RD a[4:7],v3,2048
MF v[132:135],a[56:59],a[100:103],v[132:135]
TR a[20:21],v4,160
MF v[136:139],a[68:71],a[60:63],v[136:139]
TR a[22:23],v4,2464
MF v[140:143],a[72:75],a[60:63],v[140:143]
RD a[8:11],v3,4096
MF v[144:147],a[76:79],a[60:63],v[144:147]
buffer_load_dwordx4 v39,s[12:15],s46 offen offset:2048 lds
TR a[24:25],v4,192
MF v[148:151],a[80:83],a[60:63],v[148:151]
TR a[26:27],v4,2496
MF v[152:155],a[84:87],a[60:63],v[152:155]
RD a[12:15],v3,6144
MF v[156:159],a[60:63],a[88:91],v[156:159]
TR a[28:29],v4,224
MF v[160:163],a[60:63],a[92:95],v[160:163]
buffer_load_dwordx4 v40,s[12:15],s46 offen offset:3072 lds
TR a[30:31],v4,2528
MF v[164:167],a[60:63],a[96:99],v[164:167]
TR a[32:33],v4,256
MF v[168:171],a[60:63],a[100:103],v[168:171]
TR a[34:35],v4,2560
MF v[172:175],a[68:71],a[64:67],v[172:175]
TR a[36:37],v4,9376
MF v[176:179],a[72:75],a[64:67],v[176:179]
s_add_u32 m0,s50,69632
s_mov_b32 s46,0
TR a[38:39],v4,11680
MF v[180:183],a[76:79],a[64:67],v[180:183]
buffer_load_dwordx4 v41,s[12:15],s46 offen lds
TR a[40:41],v4,9408
MF v[184:187],a[80:83],a[64:67],v[184:187]
TR a[42:43],v4,11712
MF v[188:191],a[84:87],a[64:67],v[188:191]
TR a[44:45],v4,9440
MF v[192:195],a[64:67],a[88:91],v[192:195]
buffer_load_dwordx4 v42,s[12:15],s46 offen offset:1024 lds
TR a[46:47],v4,11744
MF v[196:199],a[64:67],a[92:95],v[196:199]
TR a[48:49],v4,9472
MF v[200:203],a[64:67],a[96:99],v[200:203]
TR a[50:51],v4,11776
MF v[204:207],a[64:67],a[100:103],v[204:207]
LW 15
MF v[64:67],a[16:19],a[0:3],v[64:67]
buffer_load_dwordx4 v43,s[12:15],s46 offen offset:2048 lds
RD a[52:55],v3,1024
MF v[68:71],a[20:23],a[0:3],v[68:71]
LW 14
TR a[68:69],v4,18560
MF v[72:75],a[24:27],a[0:3],v[72:75]
LW 12
MF v[76:79],a[28:31],a[0:3],v[76:79]
LW 10
buffer_load_dwordx4 v44,s[12:15],s46 offen offset:3072 lds
TR a[70:71],v4,20864
MF v[80:83],a[32:35],a[0:3],v[80:83]
LW 9
RD a[56:59],v3,3072
MF v[84:87],a[0:3],a[36:39],v[84:87]
LW 8
MF v[88:91],a[0:3],a[40:43],v[88:91]
LW 6
TR a[72:73],v4,18592
MF v[92:95],a[0:3],a[44:47],v[92:95]
LW 5
s_movk_i32 s47,0
buffer_load_dwordx4 a[128:131],v45,s[8:11],s47 offen sc1
MF v[96:99],a[0:3],a[48:51],v[96:99]
TR a[74:75],v4,20896
MF v[100:103],a[16:19],a[4:7],v[100:103]
RD a[60:63],v3,5120
MF v[104:107],a[20:23],a[4:7],v[104:107]
TR a[76:77],v4,18624
buffer_load_dwordx4 a[132:135],v46,s[8:11],s47 offen sc1
MF v[108:111],a[24:27],a[4:7],v[108:111]
MF v[112:115],a[28:31],a[4:7],v[112:115]
TR a[78:79],v4,20928
MF v[116:119],a[32:35],a[4:7],v[116:119]
RD a[64:67],v3,7168
MF v[120:123],a[4:7],a[36:39],v[120:123]
buffer_load_dwordx4 a[136:139],v47,s[8:11],s47 offen sc1
MF v[124:127],a[4:7],a[40:43],v[124:127]
TR a[80:81],v4,18656
MF v[128:131],a[4:7],a[44:47],v[128:131]
MF v[132:135],a[4:7],a[48:51],v[132:135]
TR a[82:83],v4,20960
MF v[136:139],a[16:19],a[8:11],v[136:139]
TR a[84:85],v4,18688
buffer_load_dwordx4 a[140:143],v48,s[8:11],s47 offen sc1
MF v[140:143],a[20:23],a[8:11],v[140:143]
MF v[144:147],a[24:27],a[8:11],v[144:147]
TR a[86:87],v4,20992
MF v[148:151],a[28:31],a[8:11],v[148:151]
s_bfe_u32 s59,s70,0x60018
s_lshl_b32 s59,s59,10
s_add_u32 s59,s59,s56
MF v[152:155],a[32:35],a[8:11],v[152:155]
TR a[88:89],v4,27808
buffer_store_dwordx4 v[224:227],v2,s[20:23],s59 offen
MF v[156:159],a[8:11],a[36:39],v[156:159]
TR a[90:91],v4,30112
MF v[160:163],a[8:11],a[40:43],v[160:163]
TR a[92:93],v4,27840
MF v[164:167],a[8:11],a[44:47],v[164:167]
s_bfe_u32 s59,s71,0x60000
s_lshl_b32 s59,s59,10
s_add_u32 s59,s59,s56
MF v[168:171],a[8:11],a[48:51],v[168:171]
TR a[94:95],v4,30144
buffer_store_dwordx4 v[228:231],v2,s[20:23],s59 offen
MF v[172:175],a[16:19],a[12:15],v[172:175]
TR a[96:97],v4,27872
MF v[176:179],a[20:23],a[12:15],v[176:179]
s_bfe_u32 s59,s71,0x60006
s_lshl_b32 s59,s59,10
s_add_u32 s59,s59,s56
MF v[180:183],a[24:27],a[12:15],v[180:183]
TR a[98:99],v4,30176
buffer_store_dwordx4 v[232:235],v2,s[20:23],s59 offen
MF v[184:187],a[28:31],a[12:15],v[184:187]
TR a[100:101],v4,27904
MF v[188:191],a[32:35],a[12:15],v[188:191]
MF v[192:195],a[12:15],a[36:39],v[192:195]
s_bfe_u32 s59,s71,0x6000c
s_lshl_b32 s59,s59,10
s_add_u32 s59,s59,s56
MF v[196:199],a[12:15],a[40:43],v[196:199]
TR a[102:103],v4,30208
buffer_store_dwordx4 v[236:239],v2,s[20:23],s59 offen
MF v[200:203],a[12:15],a[44:47],v[200:203]
MF v[204:207],a[12:15],a[48:51],v[204:207]
LW 15
MF v[64:67],a[68:71],a[52:55],v[64:67]
MF v[68:71],a[72:75],a[52:55],v[68:71]
LW 13
MF v[72:75],a[76:79],a[52:55],v[72:75]
LW 10
MF v[76:79],a[80:83],a[52:55],v[76:79]
LW 8
MF v[80:83],a[84:87],a[52:55],v[80:83]
LW 6
MF v[84:87],a[52:55],a[88:91],v[84:87]
LW 4
MF v[88:91],a[52:55],a[92:95],v[88:91]
LW 2
MF v[92:95],a[52:55],a[96:99],v[92:95]
LW 0
s_waitcnt vmcnt(18)
MF v[96:99],a[52:55],a[100:103],v[96:99]
s_barrier
MF v[100:103],a[68:71],a[56:59],v[100:103]
s_add_u32 m0,s50,98304
s_mov_b32 s46,1048576
v_add_u32 v3,s49,v27
MF v[104:107],a[72:75],a[56:59],v[104:107]
buffer_load_dwordx4 v37,s[12:15],s46 offen lds
v_add_u32 v4,s49,v28
MF v[108:111],a[76:79],a[56:59],v[108:111]
s_add_u32 s49,s49,53248
s_cmp_eq_u32 s49,159744
s_cselect_b32 s49,0,s49
MF v[112:115],a[80:83],a[56:59],v[112:115]
RD a[0:3],v3,0
MF v[116:119],a[84:87],a[56:59],v[116:119]
buffer_load_dwordx4 v38,s[12:15],s46 offen offset:1024 lds
TR a[16:17],v4,128
MF v[120:123],a[56:59],a[88:91],v[120:123]
TR a[18:19],v4,2432
MF v[124:127],a[56:59],a[92:95],v[124:127]
RD a[4:7],v3,2048
MF v[128:131],a[56:59],a[96:99],v[128:131]
TR a[20:21],v4,160
MF v[132:135],a[56:59],a[100:103],v[132:135]
TR a[22:23],v4,2464
MF v[136:139],a[68:71],a[60:63],v[136:139]
buffer_load_dwordx4 v39,s[12:15],s46 offen offset:2048 lds
RD a[8:11],v3,4096
MF v[140:143],a[72:75],a[60:63],v[140:143]
TR a[24:25],v4,192
MF v[144:147],a[76:79],a[60:63],v[144:147]
TR a[26:27],v4,2496
MF v[148:151],a[80:83],a[60:63],v[148:151]
RD a[12:15],v3,6144
MF v[152:155],a[84:87],a[60:63],v[152:155]
buffer_load_dwordx4 v40,s[12:15],s46 offen offset:3072 lds
TR a[28:29],v4,224
MF v[156:159],a[60:63],a[88:91],v[156:159]
TR a[30:31],v4,2528
MF v[160:163],a[60:63],a[92:95],v[160:163]
TR a[32:33],v4,256
MF v[164:167],a[60:63],a[96:99],v[164:167]
TR a[34:35],v4,2560
MF v[168:171],a[60:63],a[100:103],v[168:171]
TR a[36:37],v4,9376
MF v[172:175],a[68:71],a[64:67],v[172:175]
s_add_u32 m0,s50,102400
s_mov_b32 s46,1048576
TR a[38:39],v4,11680
MF v[176:179],a[72:75],a[64:67],v[176:179]
TR a[40:41],v4,9408
buffer_load_dwordx4 v41,s[12:15],s46 offen lds
MF v[180:183],a[76:79],a[64:67],v[180:183]
TR a[42:43],v4,11712
MF v[184:187],a[80:83],a[64:67],v[184:187]
TR a[44:45],v4,9440
MF v[188:191],a[84:87],a[64:67],v[188:191]
buffer_load_dwordx4 v42,s[12:15],s46 offen offset:1024 lds
TR a[46:47],v4,11744
MF v[192:195],a[64:67],a[88:91],v[192:195]
TR a[48:49],v4,9472
MF v[196:199],a[64:67],a[92:95],v[196:199]
TR a[50:51],v4,11776
MF v[200:203],a[64:67],a[96:99],v[200:203]
MF v[204:207],a[64:67],a[100:103],v[204:207]
LW 15
MF v[64:67],a[16:19],a[0:3],v[64:67]
buffer_load_dwordx4 v43,s[12:15],s46 offen offset:2048 lds
RD a[52:55],v3,1024
MF v[68:71],a[20:23],a[0:3],v[68:71]
LW 14
TR a[68:69],v4,18560
MF v[72:75],a[24:27],a[0:3],v[72:75]
LW 12
MF v[76:79],a[28:31],a[0:3],v[76:79]
LW 10
buffer_load_dwordx4 v44,s[12:15],s46 offen offset:3072 lds
TR a[70:71],v4,20864
MF v[80:83],a[32:35],a[0:3],v[80:83]
LW 9
RD a[56:59],v3,3072
MF v[84:87],a[0:3],a[36:39],v[84:87]
LW 8
MF v[88:91],a[0:3],a[40:43],v[88:91]
LW 6
TR a[72:73],v4,18592
MF v[92:95],a[0:3],a[44:47],v[92:95]
LW 5
s_movk_i32 s47,0
buffer_load_dwordx4 a[144:147],v45,s[8:11],s47 offen offset:1024 sc1
MF v[96:99],a[0:3],a[48:51],v[96:99]
TR a[74:75],v4,20896
MF v[100:103],a[16:19],a[4:7],v[100:103]
RD a[60:63],v3,5120
MF v[104:107],a[20:23],a[4:7],v[104:107]
TR a[76:77],v4,18624
buffer_load_dwordx4 a[148:151],v46,s[8:11],s47 offen offset:1024 sc1
MF v[108:111],a[24:27],a[4:7],v[108:111]
MF v[112:115],a[28:31],a[4:7],v[112:115]
TR a[78:79],v4,20928
MF v[116:119],a[32:35],a[4:7],v[116:119]
RD a[64:67],v3,7168
MF v[120:123],a[4:7],a[36:39],v[120:123]
buffer_load_dwordx4 a[152:155],v47,s[8:11],s47 offen offset:1024 sc1
MF v[124:127],a[4:7],a[40:43],v[124:127]
TR a[80:81],v4,18656
MF v[128:131],a[4:7],a[44:47],v[128:131]
MF v[132:135],a[4:7],a[48:51],v[132:135]
TR a[82:83],v4,20960
MF v[136:139],a[16:19],a[8:11],v[136:139]
TR a[84:85],v4,18688
buffer_load_dwordx4 a[156:159],v48,s[8:11],s47 offen offset:1024 sc1
MF v[140:143],a[20:23],a[8:11],v[140:143]
MF v[144:147],a[24:27],a[8:11],v[144:147]
TR a[86:87],v4,20992
MF v[148:151],a[28:31],a[8:11],v[148:151]
s_bfe_u32 s59,s71,0x60012
s_lshl_b32 s59,s59,10
s_add_u32 s59,s59,s56
MF v[152:155],a[32:35],a[8:11],v[152:155]
TR a[88:89],v4,27808
buffer_store_dwordx4 v[240:243],v2,s[20:23],s59 offen
MF v[156:159],a[8:11],a[36:39],v[156:159]
TR a[90:91],v4,30112
MF v[160:163],a[8:11],a[40:43],v[160:163]
TR a[92:93],v4,27840
MF v[164:167],a[8:11],a[44:47],v[164:167]
s_bfe_u32 s59,s71,0x60018
s_lshl_b32 s59,s59,10
s_add_u32 s59,s59,s56
MF v[168:171],a[8:11],a[48:51],v[168:171]
TR a[94:95],v4,30144
buffer_store_dwordx4 v[244:247],v2,s[20:23],s59 offen
MF v[172:175],a[16:19],a[12:15],v[172:175]
TR a[96:97],v4,27872
MF v[176:179],a[20:23],a[12:15],v[176:179]
s_bfe_u32 s59,s72,0x60000
s_lshl_b32 s59,s59,10
s_add_u32 s59,s59,s56
MF v[180:183],a[24:27],a[12:15],v[180:183]
TR a[98:99],v4,30176
buffer_store_dwordx4 v[248:251],v2,s[20:23],s59 offen
MF v[184:187],a[28:31],a[12:15],v[184:187]
TR a[100:101],v4,27904
MF v[188:191],a[32:35],a[12:15],v[188:191]
MF v[192:195],a[12:15],a[36:39],v[192:195]
s_bfe_u32 s59,s72,0x60006
s_lshl_b32 s59,s59,10
s_add_u32 s59,s59,s56
MF v[196:199],a[12:15],a[40:43],v[196:199]
TR a[102:103],v4,30208
buffer_store_dwordx4 v[252:255],v2,s[20:23],s59 offen
MF v[200:203],a[12:15],a[44:47],v[200:203]
MF v[204:207],a[12:15],a[48:51],v[204:207]
LW 15
MF v[64:67],a[68:71],a[52:55],v[64:67]
MF v[68:71],a[72:75],a[52:55],v[68:71]
LW 13
MF v[72:75],a[76:79],a[52:55],v[72:75]
LW 10
MF v[76:79],a[80:83],a[52:55],v[76:79]
LW 8
MF v[80:83],a[84:87],a[52:55],v[80:83]
LW 6
MF v[84:87],a[52:55],a[88:91],v[84:87]
LW 4
MF v[88:91],a[52:55],a[92:95],v[88:91]
LW 2
MF v[92:95],a[52:55],a[96:99],v[92:95]
LW 0
MF v[96:99],a[52:55],a[100:103],v[96:99]
s_barrier
MF v[100:103],a[68:71],a[56:59],v[100:103]
s_add_u32 m0,s50,131072
s_mov_b32 s46,2097152
buffer_load_dwordx4 v37,s[12:15],s46 offen lds
MF v[104:107],a[72:75],a[56:59],v[104:107]
MF v[108:111],a[76:79],a[56:59],v[108:111]
buffer_load_dwordx4 v38,s[12:15],s46 offen offset:1024 lds
MF v[112:115],a[80:83],a[56:59],v[112:115]
MF v[116:119],a[84:87],a[56:59],v[116:119]
buffer_load_dwordx4 v39,s[12:15],s46 offen offset:2048 lds
MF v[120:123],a[56:59],a[88:91],v[120:123]
MF v[124:127],a[56:59],a[92:95],v[124:127]
buffer_load_dwordx4 v40,s[12:15],s46 offen offset:3072 lds
MF v[128:131],a[56:59],a[96:99],v[128:131]
MF v[132:135],a[56:59],a[100:103],v[132:135]
MF v[136:139],a[68:71],a[60:63],v[136:139]
s_add_u32 m0,s50,135168
s_mov_b32 s46,2097152
buffer_load_dwordx4 v41,s[12:15],s46 offen lds
MF v[140:143],a[72:75],a[60:63],v[140:143]
MF v[144:147],a[76:79],a[60:63],v[144:147]
buffer_load_dwordx4 v42,s[12:15],s46 offen offset:1024 lds
MF v[148:151],a[80:83],a[60:63],v[148:151]
MF v[152:155],a[84:87],a[60:63],v[152:155]
buffer_load_dwordx4 v43,s[12:15],s46 offen offset:2048 lds
MF v[156:159],a[60:63],a[88:91],v[156:159]
MF v[160:163],a[60:63],a[92:95],v[160:163]
buffer_load_dwordx4 v44,s[12:15],s46 offen offset:3072 lds
MF v[164:167],a[60:63],a[96:99],v[164:167]
MF v[168:171],a[60:63],a[100:103],v[168:171]
MF v[172:175],a[68:71],a[64:67],v[172:175]
s_movk_i32 s47,0
buffer_load_dwordx4 a[160:163],v45,s[8:11],s47 offen offset:2048 sc1
MF v[176:179],a[72:75],a[64:67],v[176:179]
MF v[180:183],a[76:79],a[64:67],v[180:183]
buffer_load_dwordx4 a[164:167],v46,s[8:11],s47 offen offset:2048 sc1
MF v[184:187],a[80:83],a[64:67],v[184:187]
MF v[188:191],a[84:87],a[64:67],v[188:191]
buffer_load_dwordx4 a[168:171],v47,s[8:11],s47 offen offset:2048 sc1
MF v[192:195],a[64:67],a[88:91],v[192:195]
MF v[196:199],a[64:67],a[92:95],v[196:199]
buffer_load_dwordx4 a[172:175],v48,s[8:11],s47 offen offset:2048 sc1
MF v[200:203],a[64:67],a[96:99],v[200:203]
MF v[204:207],a[64:67],a[100:103],v[204:207]
s_nop 7
s_add_u32 s24,s4,0x3f00000
s_addc_u32 s25,s5,0
s_mov_b32 s26,0x80000
s_mov_b32 s27,0x20000
s_mov_b32 s40,0xbdd2d3e8
s_mov_b32 s41,0xbdd2d3e8
v_mov_b32 v50,0xc0135761
v_mov_b32 v51,0xc0135761
s_lshl_b32 s42,s33,1
s_and_b32 s43,s32,1
s_add_u32 s42,s42,s43
s_lshl_b32 s42,s42,13
v_lshl_add_u32 v49,v1,3,s42
s_add_u32 s28,s4,0x6b00000
s_addc_u32 s29,s5,0
s_mov_b32 s30,0x800000
s_mov_b32 s31,0x20000
AR v3,a176
s_waitcnt vmcnt(16)
v_pk_mul_f32 v[60:61],v[84:85],v[84:85]
v_pk_fma_f32 v[60:61],v[60:61],s[40:41],v[50:51]
v_pk_mul_f32 v[60:61],v[60:61],v[84:85]
v_exp_f32 v60,v60
v_pk_mul_f32 v[62:63],v[86:87],v[86:87]
v_exp_f32 v61,v61
v_pk_fma_f32 v[62:63],v[62:63],s[40:41],v[50:51]
v_pk_add_f32 v[60:61],v[60:61],1.0 op_sel_hi:[1,0]
v_pk_mul_f32 v[62:63],v[62:63],v[86:87]
v_rcp_f32 v60,v60
v_exp_f32 v62,v62
v_pk_mul_f32 v[248:249],v[120:121],v[120:121]
v_rcp_f32 v61,v61
v_exp_f32 v63,v63
v_pk_fma_f32 v[248:249],v[248:249],s[40:41],v[50:51]
s_bfe_u32 s59,s72,0x6000c
s_lshl_b32 s59,s59,10
s_add_u32 s59,s59,s56
buffer_store_dwordx4 a[104:107],v2,s[20:23],s59 offen
v_pk_mul_f32 v[84:85],v[84:85],v[60:61]
v_pk_add_f32 v[62:63],v[62:63],1.0 op_sel_hi:[1,0]
v_pk_mul_f32 v[248:249],v[248:249],v[120:121]
v_pk_mul_f32 v[4:5],v[84:85],1.0 op_sel_hi:[1,0]
v_rcp_f32 v62,v62
v_exp_f32 v248,v248
v_pk_mul_f32 v[250:251],v[122:123],v[122:123]
v_pk_mul_f32 v[20:21],v[84:85],v[84:85]
v_rcp_f32 v63,v63
v_exp_f32 v249,v249
v_pk_fma_f32 v[250:251],v[250:251],s[40:41],v[50:51]
CV v208,v84,v85
v_pk_mul_f32 v[86:87],v[86:87],v[62:63]
v_pk_add_f32 v[248:249],v[248:249],1.0 op_sel_hi:[1,0]
s_bfe_u32 s59,s72,0x60012
s_lshl_b32 s59,s59,10
s_add_u32 s59,s59,s56
buffer_store_dwordx4 a[108:111],v2,s[20:23],s59 offen
v_pk_mul_f32 v[250:251],v[250:251],v[122:123]
v_pk_mul_f32 v[6:7],v[86:87],1.0 op_sel_hi:[1,0]
v_rcp_f32 v248,v248
v_exp_f32 v250,v250
v_pk_mul_f32 v[252:253],v[156:157],v[156:157]
v_pk_mul_f32 v[22:23],v[86:87],v[86:87]
v_rcp_f32 v249,v249
v_exp_f32 v251,v251
v_pk_fma_f32 v[252:253],v[252:253],s[40:41],v[50:51]
CV v209,v86,v87
v_pk_mul_f32 v[120:121],v[120:121],v[248:249]
v_pk_add_f32 v[250:251],v[250:251],1.0 op_sel_hi:[1,0]
v_pk_mul_f32 v[252:253],v[252:253],v[156:157]
v_pk_mul_f32 v[8:9],v[120:121],1.0 op_sel_hi:[1,0]
s_bfe_u32 s59,s72,0x60018
s_lshl_b32 s59,s59,10
s_add_u32 s59,s59,s56
buffer_store_dwordx4 a[112:115],v2,s[20:23],s59 offen
v_rcp_f32 v250,v250
v_exp_f32 v252,v252
v_pk_mul_f32 v[254:255],v[158:159],v[158:159]
v_pk_mul_f32 v[24:25],v[120:121],v[120:121]
v_rcp_f32 v251,v251
v_exp_f32 v253,v253
v_pk_fma_f32 v[254:255],v[254:255],s[40:41],v[50:51]
CV v210,v120,v121
v_pk_mul_f32 v[122:123],v[122:123],v[250:251]
v_pk_add_f32 v[252:253],v[252:253],1.0 op_sel_hi:[1,0]
v_pk_mul_f32 v[254:255],v[254:255],v[158:159]
v_pk_mul_f32 v[10:11],v[122:123],1.0 op_sel_hi:[1,0]
v_rcp_f32 v252,v252
v_exp_f32 v254,v254
s_bfe_u32 s59,s73,0x60000
s_lshl_b32 s59,s59,10
s_add_u32 s59,s59,s56
buffer_store_dwordx4 a[116:119],v2,s[20:23],s59 offen
v_pk_mul_f32 v[60:61],v[192:193],v[192:193]
v_pk_mul_f32 v[26:27],v[122:123],v[122:123]
v_rcp_f32 v253,v253
v_exp_f32 v255,v255
v_pk_fma_f32 v[60:61],v[60:61],s[40:41],v[50:51]
CV v211,v122,v123
v_pk_mul_f32 v[156:157],v[156:157],v[252:253]
v_pk_add_f32 v[254:255],v[254:255],1.0 op_sel_hi:[1,0]
v_pk_mul_f32 v[60:61],v[60:61],v[192:193]
v_pk_mul_f32 v[12:13],v[156:157],1.0 op_sel_hi:[1,0]
v_rcp_f32 v254,v254
v_exp_f32 v60,v60
v_pk_mul_f32 v[62:63],v[194:195],v[194:195]
v_pk_mul_f32 v[52:53],v[156:157],v[156:157]
v_rcp_f32 v255,v255
s_bfe_u32 s59,s73,0x60006
s_lshl_b32 s59,s59,10
s_add_u32 s59,s59,s56
buffer_store_dwordx4 a[120:123],v2,s[20:23],s59 offen
v_exp_f32 v61,v61
v_pk_fma_f32 v[62:63],v[62:63],s[40:41],v[50:51]
CV v228,v156,v157
v_pk_mul_f32 v[158:159],v[158:159],v[254:255]
v_pk_add_f32 v[60:61],v[60:61],1.0 op_sel_hi:[1,0]
v_pk_mul_f32 v[62:63],v[62:63],v[194:195]
v_pk_mul_f32 v[14:15],v[158:159],1.0 op_sel_hi:[1,0]
v_rcp_f32 v60,v60
v_exp_f32 v62,v62
v_pk_mul_f32 v[248:249],v[88:89],v[88:89]
v_pk_mul_f32 v[54:55],v[158:159],v[158:159]
v_rcp_f32 v61,v61
v_exp_f32 v63,v63
v_pk_fma_f32 v[248:249],v[248:249],s[40:41],v[50:51]
s_bfe_u32 s59,s73,0x6000c
s_lshl_b32 s59,s59,10
s_add_u32 s59,s59,s56
buffer_store_dwordx4 a[124:127],v2,s[20:23],s59 offen
CV v229,v158,v159
v_pk_mul_f32 v[192:193],v[192:193],v[60:61]
v_pk_add_f32 v[62:63],v[62:63],1.0 op_sel_hi:[1,0]
v_pk_mul_f32 v[248:249],v[248:249],v[88:89]
v_pk_mul_f32 v[16:17],v[192:193],1.0 op_sel_hi:[1,0]
v_rcp_f32 v62,v62
v_exp_f32 v248,v248
v_pk_mul_f32 v[250:251],v[90:91],v[90:91]
v_pk_mul_f32 v[56:57],v[192:193],v[192:193]
v_rcp_f32 v63,v63
v_exp_f32 v249,v249
v_pk_fma_f32 v[250:251],v[250:251],s[40:41],v[50:51]
CV v230,v192,v193
v_pk_mul_f32 v[194:195],v[194:195],v[62:63]
s_bfe_u32 s59,s73,0x60012
s_lshl_b32 s59,s59,10
s_add_u32 s59,s59,s56
buffer_store_dwordx4 a[192:195],v2,s[20:23],s59 offen
v_pk_add_f32 v[248:249],v[248:249],1.0 op_sel_hi:[1,0]
v_pk_mul_f32 v[250:251],v[250:251],v[90:91]
v_pk_mul_f32 v[18:19],v[194:195],1.0 op_sel_hi:[1,0]
v_rcp_f32 v248,v248
v_exp_f32 v250,v250
v_pk_mul_f32 v[252:253],v[124:125],v[124:125]
v_pk_mul_f32 v[58:59],v[194:195],v[194:195]
v_rcp_f32 v249,v249
v_exp_f32 v251,v251
v_pk_fma_f32 v[252:253],v[252:253],s[40:41],v[50:51]
CV v231,v194,v195
v_pk_mul_f32 v[88:89],v[88:89],v[248:249]
v_pk_add_f32 v[250:251],v[250:251],1.0 op_sel_hi:[1,0]
v_pk_mul_f32 v[252:253],v[252:253],v[124:125]
s_bfe_u32 s59,s73,0x60018
s_lshl_b32 s59,s59,10
s_add_u32 s59,s59,s56
buffer_store_dwordx4 a[196:199],v2,s[20:23],s59 offen
v_pk_add_f32 v[4:5],v[4:5],v[88:89]
v_rcp_f32 v250,v250
v_exp_f32 v252,v252
v_pk_mul_f32 v[254:255],v[126:127],v[126:127]
v_pk_fma_f32 v[20:21],v[88:89],v[88:89],v[20:21]
v_rcp_f32 v251,v251
v_exp_f32 v253,v253
v_pk_fma_f32 v[254:255],v[254:255],s[40:41],v[50:51]
CV v212,v88,v89
v_pk_mul_f32 v[90:91],v[90:91],v[250:251]
v_pk_add_f32 v[252:253],v[252:253],1.0 op_sel_hi:[1,0]
v_pk_mul_f32 v[254:255],v[254:255],v[126:127]
v_pk_add_f32 v[6:7],v[6:7],v[90:91]
v_rcp_f32 v252,v252
s_bfe_u32 s59,s76,0x60000
s_lshl_b32 s59,s59,10
s_add_u32 s59,s59,s56
buffer_store_dwordx4 a[200:203],v2,s[20:23],s59 offen
v_exp_f32 v254,v254
v_pk_mul_f32 v[60:61],v[160:161],v[160:161]
v_pk_fma_f32 v[22:23],v[90:91],v[90:91],v[22:23]
v_rcp_f32 v253,v253
v_exp_f32 v255,v255
v_pk_fma_f32 v[60:61],v[60:61],s[40:41],v[50:51]
CV v213,v90,v91
v_pk_mul_f32 v[124:125],v[124:125],v[252:253]
v_pk_add_f32 v[254:255],v[254:255],1.0 op_sel_hi:[1,0]
v_pk_mul_f32 v[60:61],v[60:61],v[160:161]
v_pk_add_f32 v[8:9],v[8:9],v[124:125]
v_rcp_f32 v254,v254
v_exp_f32 v60,v60
v_pk_mul_f32 v[62:63],v[162:163],v[162:163]
v_pk_fma_f32 v[24:25],v[124:125],v[124:125],v[24:25]
s_bfe_u32 s59,s76,0x60006
s_lshl_b32 s59,s59,10
s_add_u32 s59,s59,s56
buffer_store_dwordx4 a[204:207],v2,s[20:23],s59 offen
v_rcp_f32 v255,v255
v_exp_f32 v61,v61
v_pk_fma_f32 v[62:63],v[62:63],s[40:41],v[50:51]
CV v214,v124,v125
v_pk_mul_f32 v[126:127],v[126:127],v[254:255]
v_pk_add_f32 v[60:61],v[60:61],1.0 op_sel_hi:[1,0]
v_pk_mul_f32 v[62:63],v[62:63],v[162:163]
v_pk_add_f32 v[10:11],v[10:11],v[126:127]
v_rcp_f32 v60,v60
v_exp_f32 v62,v62
v_pk_mul_f32 v[248:249],v[196:197],v[196:197]
v_pk_fma_f32 v[26:27],v[126:127],v[126:127],v[26:27]
v_rcp_f32 v61,v61
v_exp_f32 v63,v63
s_add_u32 m0,s50,0
s_mov_b32 s46,3145728
buffer_load_dwordx4 v37,s[12:15],s46 offen lds
v_pk_fma_f32 v[248:249],v[248:249],s[40:41],v[50:51]
CV v215,v126,v127
v_pk_mul_f32 v[160:161],v[160:161],v[60:61]
v_pk_add_f32 v[62:63],v[62:63],1.0 op_sel_hi:[1,0]
v_pk_mul_f32 v[248:249],v[248:249],v[196:197]
v_pk_add_f32 v[12:13],v[12:13],v[160:161]
v_rcp_f32 v62,v62
v_exp_f32 v248,v248
v_pk_mul_f32 v[250:251],v[198:199],v[198:199]
v_pk_fma_f32 v[52:53],v[160:161],v[160:161],v[52:53]
v_rcp_f32 v63,v63
v_exp_f32 v249,v249
v_pk_fma_f32 v[250:251],v[250:251],s[40:41],v[50:51]
CV v232,v160,v161
buffer_load_dwordx4 v38,s[12:15],s46 offen offset:1024 lds
v_pk_mul_f32 v[162:163],v[162:163],v[62:63]
v_pk_add_f32 v[248:249],v[248:249],1.0 op_sel_hi:[1,0]
v_pk_mul_f32 v[250:251],v[250:251],v[198:199]
v_pk_add_f32 v[14:15],v[14:15],v[162:163]
v_rcp_f32 v248,v248
v_exp_f32 v250,v250
v_pk_mul_f32 v[252:253],v[92:93],v[92:93]
v_pk_fma_f32 v[54:55],v[162:163],v[162:163],v[54:55]
v_rcp_f32 v249,v249
v_exp_f32 v251,v251
v_pk_fma_f32 v[252:253],v[252:253],s[40:41],v[50:51]
CV v233,v162,v163
v_pk_mul_f32 v[196:197],v[196:197],v[248:249]
v_pk_add_f32 v[250:251],v[250:251],1.0 op_sel_hi:[1,0]
buffer_load_dwordx4 v39,s[12:15],s46 offen offset:2048 lds
v_pk_mul_f32 v[252:253],v[252:253],v[92:93]
v_pk_add_f32 v[16:17],v[16:17],v[196:197]
v_rcp_f32 v250,v250
v_exp_f32 v252,v252
v_pk_mul_f32 v[254:255],v[94:95],v[94:95]
v_pk_fma_f32 v[56:57],v[196:197],v[196:197],v[56:57]
v_rcp_f32 v251,v251
v_exp_f32 v253,v253
v_pk_fma_f32 v[254:255],v[254:255],s[40:41],v[50:51]
CV v234,v196,v197
v_pk_mul_f32 v[198:199],v[198:199],v[250:251]
v_pk_add_f32 v[252:253],v[252:253],1.0 op_sel_hi:[1,0]
v_pk_mul_f32 v[254:255],v[254:255],v[94:95]
v_pk_add_f32 v[18:19],v[18:19],v[198:199]
v_rcp_f32 v252,v252
buffer_load_dwordx4 v40,s[12:15],s46 offen offset:3072 lds
v_exp_f32 v254,v254
v_pk_mul_f32 v[60:61],v[128:129],v[128:129]
v_pk_fma_f32 v[58:59],v[198:199],v[198:199],v[58:59]
v_rcp_f32 v253,v253
v_exp_f32 v255,v255
v_pk_fma_f32 v[60:61],v[60:61],s[40:41],v[50:51]
CV v235,v198,v199
v_pk_mul_f32 v[92:93],v[92:93],v[252:253]
v_pk_add_f32 v[254:255],v[254:255],1.0 op_sel_hi:[1,0]
v_pk_mul_f32 v[60:61],v[60:61],v[128:129]
v_pk_add_f32 v[4:5],v[4:5],v[92:93]
v_rcp_f32 v254,v254
v_exp_f32 v60,v60
v_pk_mul_f32 v[62:63],v[130:131],v[130:131]
s_add_u32 m0,s50,4096
s_mov_b32 s46,3145728
buffer_load_dwordx4 v41,s[12:15],s46 offen lds
v_pk_fma_f32 v[20:21],v[92:93],v[92:93],v[20:21]
v_rcp_f32 v255,v255
v_exp_f32 v61,v61
v_pk_fma_f32 v[62:63],v[62:63],s[40:41],v[50:51]
CV v216,v92,v93
v_pk_mul_f32 v[94:95],v[94:95],v[254:255]
v_pk_add_f32 v[60:61],v[60:61],1.0 op_sel_hi:[1,0]
v_pk_mul_f32 v[62:63],v[62:63],v[130:131]
v_pk_add_f32 v[6:7],v[6:7],v[94:95]
v_rcp_f32 v60,v60
v_exp_f32 v62,v62
v_pk_mul_f32 v[248:249],v[164:165],v[164:165]
v_pk_fma_f32 v[22:23],v[94:95],v[94:95],v[22:23]
v_rcp_f32 v61,v61
buffer_load_dwordx4 v42,s[12:15],s46 offen offset:1024 lds
v_exp_f32 v63,v63
v_pk_fma_f32 v[248:249],v[248:249],s[40:41],v[50:51]
CV v217,v94,v95
v_pk_mul_f32 v[128:129],v[128:129],v[60:61]
v_pk_add_f32 v[62:63],v[62:63],1.0 op_sel_hi:[1,0]
v_pk_mul_f32 v[248:249],v[248:249],v[164:165]
v_pk_add_f32 v[8:9],v[8:9],v[128:129]
v_rcp_f32 v62,v62
v_exp_f32 v248,v248
v_pk_mul_f32 v[250:251],v[166:167],v[166:167]
v_pk_fma_f32 v[24:25],v[128:129],v[128:129],v[24:25]
v_rcp_f32 v63,v63
v_exp_f32 v249,v249
v_pk_fma_f32 v[250:251],v[250:251],s[40:41],v[50:51]
buffer_load_dwordx4 v43,s[12:15],s46 offen offset:2048 lds
CV v218,v128,v129
v_pk_mul_f32 v[130:131],v[130:131],v[62:63]
v_pk_add_f32 v[248:249],v[248:249],1.0 op_sel_hi:[1,0]
v_pk_mul_f32 v[250:251],v[250:251],v[166:167]
v_pk_add_f32 v[10:11],v[10:11],v[130:131]
v_rcp_f32 v248,v248
v_exp_f32 v250,v250
v_pk_mul_f32 v[252:253],v[200:201],v[200:201]
v_pk_fma_f32 v[26:27],v[130:131],v[130:131],v[26:27]
v_rcp_f32 v249,v249
v_exp_f32 v251,v251
v_pk_fma_f32 v[252:253],v[252:253],s[40:41],v[50:51]
CV v219,v130,v131
v_pk_mul_f32 v[164:165],v[164:165],v[248:249]
buffer_load_dwordx4 v44,s[12:15],s46 offen offset:3072 lds
v_pk_add_f32 v[250:251],v[250:251],1.0 op_sel_hi:[1,0]
v_pk_mul_f32 v[252:253],v[252:253],v[200:201]
v_pk_add_f32 v[12:13],v[12:13],v[164:165]
v_rcp_f32 v250,v250
v_exp_f32 v252,v252
v_pk_mul_f32 v[254:255],v[202:203],v[202:203]
v_pk_fma_f32 v[52:53],v[164:165],v[164:165],v[52:53]
v_rcp_f32 v251,v251
v_exp_f32 v253,v253
v_pk_fma_f32 v[254:255],v[254:255],s[40:41],v[50:51]
CV v236,v164,v165
v_pk_mul_f32 v[166:167],v[166:167],v[250:251]
v_pk_add_f32 v[252:253],v[252:253],1.0 op_sel_hi:[1,0]
v_pk_mul_f32 v[254:255],v[254:255],v[202:203]
v_pk_add_f32 v[14:15],v[14:15],v[166:167]
s_lshr_b32 s46,s32,1
s_lshl_b32 s46,s46,17
s_add_u32 s50,s50,s46
s_add_u32 m0,s50,32768
s_mov_b32 s46,4194304
buffer_load_dwordx4 v37,s[12:15],s46 offen lds
v_rcp_f32 v252,v252
v_exp_f32 v254,v254
v_pk_mul_f32 v[60:61],v[96:97],v[96:97]
v_pk_fma_f32 v[54:55],v[166:167],v[166:167],v[54:55]
v_rcp_f32 v253,v253
v_exp_f32 v255,v255
v_pk_fma_f32 v[60:61],v[60:61],s[40:41],v[50:51]
CV v237,v166,v167
v_pk_mul_f32 v[200:201],v[200:201],v[252:253]
v_pk_add_f32 v[254:255],v[254:255],1.0 op_sel_hi:[1,0]
v_pk_mul_f32 v[60:61],v[60:61],v[96:97]
v_pk_add_f32 v[16:17],v[16:17],v[200:201]
v_rcp_f32 v254,v254
v_exp_f32 v60,v60
buffer_load_dwordx4 v38,s[12:15],s46 offen offset:1024 lds
v_pk_mul_f32 v[62:63],v[98:99],v[98:99]
v_pk_fma_f32 v[56:57],v[200:201],v[200:201],v[56:57]
v_rcp_f32 v255,v255
v_exp_f32 v61,v61
v_pk_fma_f32 v[62:63],v[62:63],s[40:41],v[50:51]
CV v238,v200,v201
v_pk_mul_f32 v[202:203],v[202:203],v[254:255]
v_pk_add_f32 v[60:61],v[60:61],1.0 op_sel_hi:[1,0]
v_pk_mul_f32 v[62:63],v[62:63],v[98:99]
v_pk_add_f32 v[18:19],v[18:19],v[202:203]
v_rcp_f32 v60,v60
v_exp_f32 v62,v62
v_pk_mul_f32 v[248:249],v[132:133],v[132:133]
v_pk_fma_f32 v[58:59],v[202:203],v[202:203],v[58:59]
buffer_load_dwordx4 v39,s[12:15],s46 offen offset:2048 lds
v_rcp_f32 v61,v61
v_exp_f32 v63,v63
v_pk_fma_f32 v[248:249],v[248:249],s[40:41],v[50:51]
CV v239,v202,v203
v_pk_mul_f32 v[96:97],v[96:97],v[60:61]
v_pk_add_f32 v[62:63],v[62:63],1.0 op_sel_hi:[1,0]
v_pk_mul_f32 v[248:249],v[248:249],v[132:133]
v_pk_add_f32 v[4:5],v[4:5],v[96:97]
v_rcp_f32 v62,v62
v_exp_f32 v248,v248
v_pk_mul_f32 v[250:251],v[134:135],v[134:135]
v_pk_fma_f32 v[20:21],v[96:97],v[96:97],v[20:21]
v_rcp_f32 v63,v63
v_exp_f32 v249,v249
buffer_load_dwordx4 v40,s[12:15],s46 offen offset:3072 lds
v_pk_fma_f32 v[250:251],v[250:251],s[40:41],v[50:51]
CV v220,v96,v97
v_pk_mul_f32 v[98:99],v[98:99],v[62:63]
v_pk_add_f32 v[248:249],v[248:249],1.0 op_sel_hi:[1,0]
v_pk_mul_f32 v[250:251],v[250:251],v[134:135]
v_pk_add_f32 v[6:7],v[6:7],v[98:99]
v_rcp_f32 v248,v248
v_exp_f32 v250,v250
v_pk_mul_f32 v[252:253],v[168:169],v[168:169]
v_pk_fma_f32 v[22:23],v[98:99],v[98:99],v[22:23]
v_rcp_f32 v249,v249
v_exp_f32 v251,v251
v_pk_fma_f32 v[252:253],v[252:253],s[40:41],v[50:51]
CV v221,v98,v99
v_pk_mul_f32 v[132:133],v[132:133],v[248:249]
s_add_u32 m0,s50,36864
s_mov_b32 s46,4194304
buffer_load_dwordx4 v41,s[12:15],s46 offen lds
v_pk_add_f32 v[250:251],v[250:251],1.0 op_sel_hi:[1,0]
v_pk_mul_f32 v[252:253],v[252:253],v[168:169]
v_pk_add_f32 v[8:9],v[8:9],v[132:133]
v_rcp_f32 v250,v250
v_exp_f32 v252,v252
v_pk_mul_f32 v[254:255],v[170:171],v[170:171]
v_pk_fma_f32 v[24:25],v[132:133],v[132:133],v[24:25]
v_rcp_f32 v251,v251
v_exp_f32 v253,v253
v_pk_fma_f32 v[254:255],v[254:255],s[40:41],v[50:51]
CV v222,v132,v133
v_pk_mul_f32 v[134:135],v[134:135],v[250:251]
v_pk_add_f32 v[252:253],v[252:253],1.0 op_sel_hi:[1,0]
v_pk_mul_f32 v[254:255],v[254:255],v[170:171]
buffer_load_dwordx4 v42,s[12:15],s46 offen offset:1024 lds
v_pk_add_f32 v[10:11],v[10:11],v[134:135]
v_rcp_f32 v252,v252
v_exp_f32 v254,v254
v_pk_mul_f32 v[60:61],v[204:205],v[204:205]
v_pk_fma_f32 v[26:27],v[134:135],v[134:135],v[26:27]
v_rcp_f32 v253,v253
v_exp_f32 v255,v255
v_pk_fma_f32 v[60:61],v[60:61],s[40:41],v[50:51]
CV v223,v134,v135
v_pk_mul_f32 v[168:169],v[168:169],v[252:253]
v_pk_add_f32 v[254:255],v[254:255],1.0 op_sel_hi:[1,0]
v_pk_mul_f32 v[60:61],v[60:61],v[204:205]
v_pk_add_f32 v[12:13],v[12:13],v[168:169]
v_rcp_f32 v254,v254
buffer_load_dwordx4 v43,s[12:15],s46 offen offset:2048 lds
v_exp_f32 v60,v60
v_pk_mul_f32 v[62:63],v[206:207],v[206:207]
v_pk_fma_f32 v[52:53],v[168:169],v[168:169],v[52:53]
v_rcp_f32 v255,v255
v_exp_f32 v61,v61
v_pk_fma_f32 v[62:63],v[62:63],s[40:41],v[50:51]
CV v240,v168,v169
v_pk_mul_f32 v[170:171],v[170:171],v[254:255]
v_pk_add_f32 v[60:61],v[60:61],1.0 op_sel_hi:[1,0]
v_pk_mul_f32 v[62:63],v[62:63],v[206:207]
v_pk_add_f32 v[14:15],v[14:15],v[170:171]
v_rcp_f32 v60,v60
v_exp_f32 v62,v62
v_pk_fma_f32 v[54:55],v[170:171],v[170:171],v[54:55]
buffer_load_dwordx4 v44,s[12:15],s46 offen offset:3072 lds
v_rcp_f32 v61,v61
v_exp_f32 v63,v63
CV v241,v170,v171
v_pk_mul_f32 v[204:205],v[204:205],v[60:61]
v_pk_add_f32 v[62:63],v[62:63],1.0 op_sel_hi:[1,0]
v_pk_add_f32 v[16:17],v[16:17],v[204:205]
v_rcp_f32 v62,v62
v_pk_fma_f32 v[56:57],v[204:205],v[204:205],v[56:57]
v_rcp_f32 v63,v63
CV v242,v204,v205
v_pk_mul_f32 v[206:207],v[206:207],v[62:63]
v_pk_add_f32 v[18:19],v[18:19],v[206:207]
v_pk_fma_f32 v[58:59],v[206:207],v[206:207],v[58:59]
CV v243,v206,v207
s_mul_i32 s40,s2,36864
s_add_u32 s40,s40,0x23ffe00
s_add_u32 s20,s4,s40
s_addc_u32 s21,s5,0
s_mov_b32 s22,0x9200
s_mov_b32 s23,0x20000
s_lshr_b32 s42,s57,4
s_lshl_b32 s42,s42,4
s_lshl_b32 s7,s42,4
s_add_u32 s7,s7,0x8307000
v_lshl_add_u32 v50,v1,2,s7
global_load_dword v51,v50,s[4:5] sc1
s_mov_b32 s63,s57
v_and_b32 v60,8,v1
v_cmp_ne_u32 s[54:55],0,v60
v_and_b32 v60,4,v1
v_cmp_ne_u32 s[56:57],0,v60
v_and_b32 v60,2,v1
v_cmp_ne_u32 s[58:59],0,v60
v_and_b32 v60,1,v1
v_cmp_ne_u32 s[60:61],0,v60
s_nop 1
v_cndmask_b32 v60,v12,v4,s[54:55]
v_cndmask_b32 v4,v4,v12,s[54:55]
v_cndmask_b32 v61,v52,v20,s[54:55]
v_cndmask_b32 v20,v20,v52,s[54:55]
v_add_f32_dpp v4,v60,v4 row_ror:8 row_mask:0xf bank_mask:0xf
v_cndmask_b32 v248,v13,v5,s[54:55]
v_cndmask_b32 v5,v5,v13,s[54:55]
v_add_f32_dpp v20,v61,v20 row_ror:8 row_mask:0xf bank_mask:0xf
v_cndmask_b32 v249,v53,v21,s[54:55]
v_cndmask_b32 v21,v21,v53,s[54:55]
v_add_f32_dpp v5,v248,v5 row_ror:8 row_mask:0xf bank_mask:0xf
v_cndmask_b32 v60,v14,v6,s[54:55]
v_cndmask_b32 v6,v6,v14,s[54:55]
v_add_f32_dpp v21,v249,v21 row_ror:8 row_mask:0xf bank_mask:0xf
v_cndmask_b32 v61,v54,v22,s[54:55]
v_cndmask_b32 v22,v22,v54,s[54:55]
v_add_f32_dpp v6,v60,v6 row_ror:8 row_mask:0xf bank_mask:0xf
v_cndmask_b32 v248,v15,v7,s[54:55]
v_cndmask_b32 v7,v7,v15,s[54:55]
v_add_f32_dpp v22,v61,v22 row_ror:8 row_mask:0xf bank_mask:0xf
v_cndmask_b32 v249,v55,v23,s[54:55]
v_cndmask_b32 v23,v23,v55,s[54:55]
v_add_f32_dpp v7,v248,v7 row_ror:8 row_mask:0xf bank_mask:0xf
v_cndmask_b32 v60,v16,v8,s[54:55]
v_cndmask_b32 v8,v8,v16,s[54:55]
v_add_f32_dpp v23,v249,v23 row_ror:8 row_mask:0xf bank_mask:0xf
v_cndmask_b32 v61,v56,v24,s[54:55]
v_cndmask_b32 v24,v24,v56,s[54:55]
v_add_f32_dpp v8,v60,v8 row_ror:8 row_mask:0xf bank_mask:0xf
v_cndmask_b32 v248,v17,v9,s[54:55]
v_cndmask_b32 v9,v9,v17,s[54:55]
v_add_f32_dpp v24,v61,v24 row_ror:8 row_mask:0xf bank_mask:0xf
v_cndmask_b32 v249,v57,v25,s[54:55]
v_cndmask_b32 v25,v25,v57,s[54:55]
v_add_f32_dpp v9,v248,v9 row_ror:8 row_mask:0xf bank_mask:0xf
v_cndmask_b32 v60,v18,v10,s[54:55]
v_cndmask_b32 v10,v10,v18,s[54:55]
v_add_f32_dpp v25,v249,v25 row_ror:8 row_mask:0xf bank_mask:0xf
v_cndmask_b32 v61,v58,v26,s[54:55]
v_cndmask_b32 v26,v26,v58,s[54:55]
v_add_f32_dpp v10,v60,v10 row_ror:8 row_mask:0xf bank_mask:0xf
v_cndmask_b32 v248,v19,v11,s[54:55]
v_cndmask_b32 v11,v11,v19,s[54:55]
v_add_f32_dpp v26,v61,v26 row_ror:8 row_mask:0xf bank_mask:0xf
v_cndmask_b32 v249,v59,v27,s[54:55]
v_cndmask_b32 v27,v27,v59,s[54:55]
v_add_f32_dpp v11,v248,v11 row_ror:8 row_mask:0xf bank_mask:0xf
s_nop 1
v_add_f32_dpp v27,v249,v27 row_ror:8 row_mask:0xf bank_mask:0xf
v_cndmask_b32 v60,v8,v4,s[56:57]
v_cndmask_b32 v4,v4,v8,s[56:57]
v_cndmask_b32 v61,v24,v20,s[56:57]
v_cndmask_b32 v20,v20,v24,s[56:57]
v_add_f32_dpp v4,v60,v4 row_half_mirror row_mask:0xf bank_mask:0xf
v_cndmask_b32 v248,v9,v5,s[56:57]
v_cndmask_b32 v5,v5,v9,s[56:57]
v_add_f32_dpp v20,v61,v20 row_half_mirror row_mask:0xf bank_mask:0xf
v_cndmask_b32 v249,v25,v21,s[56:57]
v_cndmask_b32 v21,v21,v25,s[56:57]
v_add_f32_dpp v5,v248,v5 row_half_mirror row_mask:0xf bank_mask:0xf
v_cndmask_b32 v60,v10,v6,s[56:57]
v_cndmask_b32 v6,v6,v10,s[56:57]
v_add_f32_dpp v21,v249,v21 row_half_mirror row_mask:0xf bank_mask:0xf
v_cndmask_b32 v61,v26,v22,s[56:57]
v_cndmask_b32 v22,v22,v26,s[56:57]
v_add_f32_dpp v6,v60,v6 row_half_mirror row_mask:0xf bank_mask:0xf
v_cndmask_b32 v248,v11,v7,s[56:57]
v_cndmask_b32 v7,v7,v11,s[56:57]
v_add_f32_dpp v22,v61,v22 row_half_mirror row_mask:0xf bank_mask:0xf
v_cndmask_b32 v249,v27,v23,s[56:57]
v_cndmask_b32 v23,v23,v27,s[56:57]
v_add_f32_dpp v7,v248,v7 row_half_mirror row_mask:0xf bank_mask:0xf
s_nop 1
v_add_f32_dpp v23,v249,v23 row_half_mirror row_mask:0xf bank_mask:0xf
v_cndmask_b32 v60,v6,v4,s[58:59]
v_cndmask_b32 v4,v4,v6,s[58:59]
v_cndmask_b32 v61,v22,v20,s[58:59]
v_cndmask_b32 v20,v20,v22,s[58:59]
v_add_f32_dpp v4,v60,v4 quad_perm:[2,3,0,1] row_mask:0xf bank_mask:0xf
v_cndmask_b32 v248,v7,v5,s[58:59]
v_cndmask_b32 v5,v5,v7,s[58:59]
v_add_f32_dpp v20,v61,v20 quad_perm:[2,3,0,1] row_mask:0xf bank_mask:0xf
v_cndmask_b32 v249,v23,v21,s[58:59]
v_cndmask_b32 v21,v21,v23,s[58:59]
v_add_f32_dpp v5,v248,v5 quad_perm:[2,3,0,1] row_mask:0xf bank_mask:0xf
s_nop 1
v_add_f32_dpp v21,v249,v21 quad_perm:[2,3,0,1] row_mask:0xf bank_mask:0xf
v_cndmask_b32 v60,v5,v4,s[60:61]
v_cndmask_b32 v4,v4,v5,s[60:61]
v_cndmask_b32 v61,v21,v20,s[60:61]
v_cndmask_b32 v20,v20,v21,s[60:61]
v_add_f32_dpp v4,v60,v4 quad_perm:[1,0,3,2] row_mask:0xf bank_mask:0xf
s_nop 1
v_add_f32_dpp v20,v61,v20 quad_perm:[1,0,3,2] row_mask:0xf bank_mask:0xf
v_accvgpr_mov_b32 a96,a224
v_accvgpr_mov_b32 a97,a225
v_accvgpr_mov_b32 a98,a226
v_accvgpr_mov_b32 a99,a227
v_accvgpr_mov_b32 a100,a228
v_accvgpr_mov_b32 a101,a229
v_accvgpr_mov_b32 a102,a230
v_accvgpr_mov_b32 a103,a231
v_accvgpr_mov_b32 a104,a232
v_accvgpr_mov_b32 a105,a233
v_accvgpr_mov_b32 a106,a234
v_accvgpr_mov_b32 a107,a235
v_accvgpr_mov_b32 a108,a236
v_accvgpr_mov_b32 a109,a237
v_accvgpr_mov_b32 a110,a238
v_accvgpr_mov_b32 a111,a239
v_accvgpr_mov_b32 a112,a240
v_accvgpr_mov_b32 a113,a241
v_accvgpr_mov_b32 a114,a242
v_accvgpr_mov_b32 a115,a243
v_accvgpr_mov_b32 a116,a244
v_accvgpr_mov_b32 a117,a245
v_accvgpr_mov_b32 a118,a246
v_accvgpr_mov_b32 a119,a247
v_accvgpr_mov_b32 a120,a248
v_accvgpr_mov_b32 a121,a249
v_accvgpr_mov_b32 a122,a250
v_accvgpr_mov_b32 a123,a251
v_accvgpr_mov_b32 a124,a252
v_accvgpr_mov_b32 a125,a253
v_accvgpr_mov_b32 a126,a254
v_accvgpr_mov_b32 a127,a255
v_mov_b32 v12,v4
v_mov_b32 v13,v20
s_and_b32 s42,s32,1
s_lshl_b32 s42,s42,9
s_add_u32 s42,s42,49152
v_lshl_add_u32 v28,v1,3,s42
ds_write_b64 v28,v[12:13]
CV v4,v64,v65
CV v5,v66,v67
CV v6,v100,v101
CV v7,v102,v103
CV v8,v136,v137
CV v9,v138,v139
CV v10,v172,v173
CV v11,v174,v175
CV v14,v68,v69
CV v15,v70,v71
CV v16,v104,v105
CV v17,v106,v107
CV v18,v140,v141
CV v19,v142,v143
CV v20,v176,v177
CV v21,v178,v179
CV v22,v72,v73
CV v23,v74,v75
CV v24,v108,v109
CV v25,v110,v111
CV v26,v144,v145
CV v27,v146,v147
CV v52,v180,v181
CV v53,v182,v183
CV v54,v76,v77
CV v55,v78,v79
CV v56,v112,v113
CV v57,v114,v115
CV v58,v148,v149
CV v59,v150,v151
CV v60,v184,v185
CV v61,v186,v187
CV v62,v80,v81
CV v63,v82,v83
CV v248,v116,v117
CV v249,v118,v119
CV v250,v152,v153
CV v251,v154,v155
CV v192,v188,v189
CV v193,v190,v191
Lm_q:
s_waitcnt vmcnt(43)
LW 0
s_barrier
ds_read_b64 v[38:39],v28
TR a[192:193],v29,0
TR a[194:195],v29,1024
TR a[196:197],v30,0
TR a[198:199],v30,1024
TR a[200:201],v31,0
TR a[202:203],v31,1024
TR a[204:205],v32,0
TR a[206:207],v32,1024
TR a[208:209],v33,0
TR a[210:211],v33,1024
TR a[212:213],v34,0
TR a[214:215],v34,1024
TR a[216:217],v35,0
TR a[218:219],v35,1024
TR a[220:221],v36,0
TR a[222:223],v36,1024
LW 14
MF v[64:67],a[192:195],a[128:131],0
s_movk_i32 s47,0
buffer_load_dwordx4 a[176:179],v45,s[8:11],s47 offen offset:3072 sc1
TR a[224:225],v29,8192
MF v[68:71],a[192:195],a[132:135],0
v_lshlrev_b32 v252,3,v1
s_and_b32 s59,s32,1
MF v[72:75],a[192:195],a[136:139],0
TR a[226:227],v29,9216
MF v[76:79],a[192:195],a[140:143],0
LW 14
TR a[228:229],v30,8192
s_mul_i32 s59,s59,18432
MF v[80:83],a[196:199],a[128:131],0
AW a0,0
MF v[84:87],a[196:199],a[132:135],0
TR a[230:231],v30,9216
v_add_u32 v252,s59,v252
MF v[88:91],a[196:199],a[136:139],0
buffer_load_dwordx4 a[180:183],v46,s[8:11],s47 offen offset:3072 sc1
MF v[92:95],a[196:199],a[140:143],0
LW 14
AW a1,0
s_lshr_b32 s60,s32,1
MF v[96:99],a[200:203],a[128:131],0
s_lshl_b32 s59,s60,11
TR a[232:233],v31,8192
MF v[100:103],a[200:203],a[132:135],0
TR a[234:235],v31,9216
MF v[104:107],a[200:203],a[136:139],0
v_add_u32 v252,s59,v252
AW a2,0
MF v[108:111],a[200:203],a[140:143],0
LW 14
TR a[236:237],v32,8192
MF v[112:115],a[204:207],a[128:131],0
s_and_b32 s59,s34,1
buffer_load_dwordx4 a[184:187],v47,s[8:11],s47 offen offset:3072 sc1
MF v[116:119],a[204:207],a[132:135],0
TR a[238:239],v32,9216
AW a3,0
MF v[120:123],a[204:207],a[136:139],0
s_xor_b32 s61,s59,1
MF v[124:127],a[204:207],a[140:143],0
LW 14
s_lshl_b32 s61,s61,9
TR a[240:241],v33,8192
MF v[128:131],a[208:211],a[128:131],0
TR a[242:243],v33,9216
MF v[132:135],a[208:211],a[132:135],0
v_add_u32 v252,s61,v252
AW a4,0
MF v[136:139],a[208:211],a[136:139],0
TR a[244:245],v34,8192
buffer_load_dwordx4 a[188:191],v48,s[8:11],s47 offen offset:3072 sc1
MF v[140:143],a[208:211],a[140:143],0
LW 15
s_xor_b32 s60,s60,1
MF v[144:147],a[212:215],a[128:131],0
TR a[246:247],v34,9216
AW a5,0
MF v[148:151],a[212:215],a[132:135],0
s_and_b32 s59,s59,s60
MF v[152:155],a[212:215],a[136:139],0
s_mul_i32 s59,s59,4608
TR a[248:249],v35,8192
MF v[156:159],a[212:215],a[140:143],0
LW 15
AW a6,0
MF v[160:163],a[216:219],a[128:131],0
s_movk_i32 s43,0
TR a[250:251],v35,9216
v_add_u32 v255,s59,v252
MF v[164:167],a[216:219],a[132:135],0
buffer_store_dwordx4 a[96:99],v3,s[28:31],s43 offen sc1
MF v[168:171],a[216:219],a[136:139],0
s_lshl_b32 s60,s60,31
TR a[252:253],v36,8192
AW a7,0
MF v[172:175],a[216:219],a[140:143],0
LW 15
MF v[176:179],a[220:223],a[128:131],0
TR a[254:255],v36,9216
v_add_u32 v253,s60,v252
MF v[180:183],a[220:223],a[132:135],0
MF v[184:187],a[220:223],a[136:139],0
MF v[188:191],a[220:223],a[140:143],0
LW 14
s_waitcnt vmcnt(48)
MF v[64:67],a[224:227],a[144:147],v[64:67]
s_movk_i32 s59,0
TR a[192:193],v29,16384
v_add_f32 v12,v12,v38
MF v[68:71],a[224:227],a[148:151],v[68:71]
v_add_f32 v13,v13,v39
s_lshr_b32 s42,s32,1
MF v[72:75],a[224:227],a[152:155],v[72:75]
s_lshl_b32 s42,s42,30
s_lshl_b32 s41,s34,9
s_add_u32 s42,s42,s41
MF v[76:79],a[224:227],a[156:159],v[76:79]
LW 13
TR a[194:195],v29,17408
buffer_store_dwordx2 v[12:13],v49,s[24:27],s42 offen sc1
MF v[80:83],a[228:231],a[144:147],v[80:83]
TR a[196:197],v30,16384
AW a8,0
MF v[84:87],a[228:231],a[148:151],v[84:87]
s_movk_i32 s47,4096
TR a[198:199],v30,17408
buffer_load_dwordx4 a[128:131],v45,s[8:11],s47 offen sc1
MF v[88:91],a[228:231],a[152:155],v[88:91]
MF v[92:95],a[228:231],a[156:159],v[92:95]
LW 14
TR a[200:201],v31,16384
AW a9,0
MF v[96:99],a[232:235],a[144:147],v[96:99]
buffer_store_dwordx2 v[4:5],v255,s[20:23],s59 offen
MF v[100:103],a[232:235],a[148:151],v[100:103]
TR a[202:203],v31,17408
MF v[104:107],a[232:235],a[152:155],v[104:107]
buffer_load_dwordx4 a[132:135],v46,s[8:11],s47 offen sc1
AW a10,0
MF v[108:111],a[232:235],a[156:159],v[108:111]
LW 14
TR a[204:205],v32,16384
MF v[112:115],a[236:239],a[144:147],v[112:115]
MF v[116:119],a[236:239],a[148:151],v[116:119]
TR a[206:207],v32,17408
AW a11,0
MF v[120:123],a[236:239],a[152:155],v[120:123]
MF v[124:127],a[236:239],a[156:159],v[124:127]
LW 14
s_movk_i32 s59,4608
TR a[208:209],v33,16384
MF v[128:131],a[240:243],a[144:147],v[128:131]
TR a[210:211],v33,17408
buffer_load_dwordx4 a[136:139],v47,s[8:11],s47 offen sc1
MF v[132:135],a[240:243],a[148:151],v[132:135]
AW a12,0
MF v[136:139],a[240:243],a[152:155],v[136:139]
TR a[212:213],v34,16384
MF v[140:143],a[240:243],a[156:159],v[140:143]
LW 15
MF v[144:147],a[244:247],a[144:147],v[144:147]
TR a[214:215],v34,17408
AW a13,0
MF v[148:151],a[244:247],a[148:151],v[148:151]
buffer_load_dwordx4 a[140:143],v48,s[8:11],s47 offen sc1
MF v[152:155],a[244:247],a[152:155],v[152:155]
buffer_store_dwordx2 v[6:7],v255,s[20:23],s59 offen
TR a[216:217],v35,16384
MF v[156:159],a[244:247],a[156:159],v[156:159]
LW 15
AW a14,0
MF v[160:163],a[248:251],a[144:147],v[160:163]
TR a[218:219],v35,17408
MF v[164:167],a[248:251],a[148:151],v[164:167]
s_movk_i32 s43,0
buffer_store_dwordx4 a[100:103],v3,s[28:31],s43 offen offset:2048 sc1
MF v[168:171],a[248:251],a[152:155],v[168:171]
TR a[220:221],v36,16384
AW a15,0
MF v[172:175],a[248:251],a[156:159],v[172:175]
LW 15
MF v[176:179],a[252:255],a[144:147],v[176:179]
TR a[222:223],v36,17408
MF v[180:183],a[252:255],a[148:151],v[180:183]
MF v[184:187],a[252:255],a[152:155],v[184:187]
MF v[188:191],a[252:255],a[156:159],v[188:191]
LW 14
s_waitcnt vmcnt(40)
MF v[64:67],a[192:195],a[160:163],v[64:67]
s_movk_i32 s47,4096
buffer_load_dwordx4 a[144:147],v45,s[8:11],s47 offen offset:1024 sc1
TR a[224:225],v29,24576
MF v[68:71],a[192:195],a[164:167],v[68:71]
s_movk_i32 s59,9216
TR a[226:227],v29,25600
MF v[72:75],a[192:195],a[168:171],v[72:75]
MF v[76:79],a[192:195],a[172:175],v[76:79]
LW 14
TR a[228:229],v30,24576
MF v[80:83],a[196:199],a[160:163],v[80:83]
AW a16,0
MF v[84:87],a[196:199],a[164:167],v[84:87]
TR a[230:231],v30,25600
MF v[88:91],a[196:199],a[168:171],v[88:91]
buffer_load_dwordx4 a[148:151],v46,s[8:11],s47 offen offset:1024 sc1
MF v[92:95],a[196:199],a[172:175],v[92:95]
LW 14
TR a[232:233],v31,24576
AW a17,0
MF v[96:99],a[200:203],a[160:163],v[96:99]
buffer_store_dwordx2 v[8:9],v255,s[20:23],s59 offen
MF v[100:103],a[200:203],a[164:167],v[100:103]
TR a[234:235],v31,25600
MF v[104:107],a[200:203],a[168:171],v[104:107]
AW a18,0
MF v[108:111],a[200:203],a[172:175],v[108:111]
LW 14
TR a[236:237],v32,24576
MF v[112:115],a[204:207],a[160:163],v[112:115]
buffer_load_dwordx4 a[152:155],v47,s[8:11],s47 offen offset:1024 sc1
MF v[116:119],a[204:207],a[164:167],v[116:119]
TR a[238:239],v32,25600
AW a19,0
MF v[120:123],a[204:207],a[168:171],v[120:123]
MF v[124:127],a[204:207],a[172:175],v[124:127]
LW 14
s_movk_i32 s59,13824
TR a[240:241],v33,24576
MF v[128:131],a[208:211],a[160:163],v[128:131]
TR a[242:243],v33,25600
MF v[132:135],a[208:211],a[164:167],v[132:135]
AW a20,0
MF v[136:139],a[208:211],a[168:171],v[136:139]
TR a[244:245],v34,24576
buffer_load_dwordx4 a[156:159],v48,s[8:11],s47 offen offset:1024 sc1
MF v[140:143],a[208:211],a[172:175],v[140:143]
LW 15
MF v[144:147],a[212:215],a[160:163],v[144:147]
TR a[246:247],v34,25600
AW a21,0
MF v[148:151],a[212:215],a[164:167],v[148:151]
MF v[152:155],a[212:215],a[168:171],v[152:155]
buffer_store_dwordx2 v[10:11],v255,s[20:23],s59 offen
TR a[248:249],v35,24576
MF v[156:159],a[212:215],a[172:175],v[156:159]
LW 15
AW a22,0
MF v[160:163],a[216:219],a[160:163],v[160:163]
s_lshl_b32 s40,s35,20
s_add_u32 s40,s40,0x400000
TR a[250:251],v35,25600
MF v[164:167],a[216:219],a[164:167],v[164:167]
s_sub_u32 s40,s40,0x10000
s_add_u32 s16,s4,s40
s_addc_u32 s17,s5,0
MF v[168:171],a[216:219],a[168:171],v[168:171]
s_sub_u32 s18,17,s36
s_lshl_b32 s18,s18,16
s_mov_b32 s19,0x20000
MF v[172:175],a[216:219],a[172:175],v[172:175]
LW 14
s_lshl_b32 s48,s32,12
s_add_u32 s48,s48,0xc000
MF v[176:179],a[220:223],a[160:163],v[176:179]
TR a[252:253],v36,24576
AW a23,0
MF v[180:183],a[220:223],a[164:167],v[180:183]
TR a[254:255],v36,25600
MF v[184:187],a[220:223],a[168:171],v[184:187]
MF v[188:191],a[220:223],a[172:175],v[188:191]
LW 14
s_waitcnt vmcnt(15)
MF v[64:67],a[224:227],a[176:179],v[64:67]
s_barrier
s_movk_i32 s59,512
MF v[68:71],a[224:227],a[180:183],v[68:71]
s_movk_i32 s47,4096
buffer_load_dwordx4 a[160:163],v45,s[8:11],s47 offen offset:2048 sc1
TR a[192:193],v29,32768
MF v[72:75],a[224:227],a[184:187],v[72:75]
TR a[194:195],v29,33792
MF v[76:79],a[224:227],a[188:191],v[76:79]
LW 14
MF v[80:83],a[228:231],a[176:179],v[80:83]
TR a[196:197],v30,32768
AW a24,0
MF v[84:87],a[228:231],a[180:183],v[84:87]
MF v[88:91],a[228:231],a[184:187],v[88:91]
TR a[198:199],v30,33792
MF v[92:95],a[228:231],a[188:191],v[92:95]
LW 14
buffer_load_dwordx4 a[164:167],v46,s[8:11],s47 offen offset:2048 sc1
AW a25,0
MF v[96:99],a[232:235],a[176:179],v[96:99]
TR a[200:201],v31,32768
buffer_store_dwordx2 v[14:15],v252,s[20:23],s59 offen
MF v[100:103],a[232:235],a[180:183],v[100:103]
MF v[104:107],a[232:235],a[184:187],v[104:107]
TR a[202:203],v31,33792
AW a26,0
MF v[108:111],a[232:235],a[188:191],v[108:111]
LW 14
TR a[204:205],v32,32768
MF v[112:115],a[236:239],a[176:179],v[112:115]
MF v[116:119],a[236:239],a[180:183],v[116:119]
TR a[206:207],v32,33792
buffer_load_dwordx4 a[168:171],v47,s[8:11],s47 offen offset:2048 sc1
MF v[120:123],a[236:239],a[184:187],v[120:123]
AW a27,0
MF v[124:127],a[236:239],a[188:191],v[124:127]
LW 14
TR a[208:209],v33,32768
s_movk_i32 s59,5120
MF v[128:131],a[240:243],a[176:179],v[128:131]
MF v[132:135],a[240:243],a[180:183],v[132:135]
TR a[210:211],v33,33792
AW a28,0
MF v[136:139],a[240:243],a[184:187],v[136:139]
MF v[140:143],a[240:243],a[188:191],v[140:143]
LW 14
TR a[212:213],v34,32768
buffer_load_dwordx4 a[172:175],v48,s[8:11],s47 offen offset:2048 sc1
MF v[144:147],a[244:247],a[176:179],v[144:147]
TR a[214:215],v34,33792
AW a29,0
MF v[148:151],a[244:247],a[180:183],v[148:151]
MF v[152:155],a[244:247],a[184:187],v[152:155]
TR a[216:217],v35,32768
buffer_store_dwordx2 v[16:17],v252,s[20:23],s59 offen
MF v[156:159],a[244:247],a[188:191],v[156:159]
LW 15
AW a30,0
MF v[160:163],a[248:251],a[176:179],v[160:163]
TR a[218:219],v35,33792
MF v[164:167],a[248:251],a[180:183],v[164:167]
s_movk_i32 s43,4096
buffer_store_dwordx4 a[104:107],v3,s[28:31],s43 offen sc1
MF v[168:171],a[248:251],a[184:187],v[168:171]
TR a[220:221],v36,32768
AW a31,0
MF v[172:175],a[248:251],a[188:191],v[172:175]
LW 15
MF v[176:179],a[252:255],a[176:179],v[176:179]
TR a[222:223],v36,33792
MF v[180:183],a[252:255],a[180:183],v[180:183]
MF v[184:187],a[252:255],a[184:187],v[184:187]
MF v[188:191],a[252:255],a[188:191],v[188:191]
LW 14
s_waitcnt vmcnt(15)
MF v[64:67],a[192:195],a[128:131],v[64:67]
s_movk_i32 s47,4096
buffer_load_dwordx4 a[176:179],v45,s[8:11],s47 offen offset:3072 sc1
TR a[224:225],v29,40960
MF v[68:71],a[192:195],a[132:135],v[68:71]
s_movk_i32 s59,9728
TR a[226:227],v29,41984
MF v[72:75],a[192:195],a[136:139],v[72:75]
MF v[76:79],a[192:195],a[140:143],v[76:79]
LW 14
TR a[228:229],v30,40960
MF v[80:83],a[196:199],a[128:131],v[80:83]
AW a32,0
MF v[84:87],a[196:199],a[132:135],v[84:87]
TR a[230:231],v30,41984
MF v[88:91],a[196:199],a[136:139],v[88:91]
buffer_load_dwordx4 a[180:183],v46,s[8:11],s47 offen offset:3072 sc1
MF v[92:95],a[196:199],a[140:143],v[92:95]
LW 14
TR a[232:233],v31,40960
AW a33,0
MF v[96:99],a[200:203],a[128:131],v[96:99]
buffer_store_dwordx2 v[18:19],v252,s[20:23],s59 offen
MF v[100:103],a[200:203],a[132:135],v[100:103]
TR a[234:235],v31,41984
MF v[104:107],a[200:203],a[136:139],v[104:107]
AW a34,0
MF v[108:111],a[200:203],a[140:143],v[108:111]
LW 14
TR a[236:237],v32,40960
MF v[112:115],a[204:207],a[128:131],v[112:115]
buffer_load_dwordx4 a[184:187],v47,s[8:11],s47 offen offset:3072 sc1
MF v[116:119],a[204:207],a[132:135],v[116:119]
TR a[238:239],v32,41984
AW a35,0
MF v[120:123],a[204:207],a[136:139],v[120:123]
MF v[124:127],a[204:207],a[140:143],v[124:127]
LW 14
s_movk_i32 s59,14336
TR a[240:241],v33,40960
MF v[128:131],a[208:211],a[128:131],v[128:131]
TR a[242:243],v33,41984
MF v[132:135],a[208:211],a[132:135],v[132:135]
AW a36,0
MF v[136:139],a[208:211],a[136:139],v[136:139]
TR a[244:245],v34,40960
buffer_load_dwordx4 a[188:191],v48,s[8:11],s47 offen offset:3072 sc1
MF v[140:143],a[208:211],a[140:143],v[140:143]
LW 15
MF v[144:147],a[212:215],a[128:131],v[144:147]
TR a[246:247],v34,41984
AW a37,0
MF v[148:151],a[212:215],a[132:135],v[148:151]
MF v[152:155],a[212:215],a[136:139],v[152:155]
buffer_store_dwordx2 v[20:21],v252,s[20:23],s59 offen
TR a[248:249],v35,40960
MF v[156:159],a[212:215],a[140:143],v[156:159]
LW 15
AW a38,0
MF v[160:163],a[216:219],a[128:131],v[160:163]
s_movk_i32 s43,4096
buffer_store_dwordx4 a[108:111],v3,s[28:31],s43 offen offset:2048 sc1
TR a[250:251],v35,41984
MF v[164:167],a[216:219],a[132:135],v[164:167]
MF v[168:171],a[216:219],a[136:139],v[168:171]
TR a[252:253],v36,40960
AW a39,0
MF v[172:175],a[216:219],a[140:143],v[172:175]
LW 15
MF v[176:179],a[220:223],a[128:131],v[176:179]
TR a[254:255],v36,41984
MF v[180:183],a[220:223],a[132:135],v[180:183]
MF v[184:187],a[220:223],a[136:139],v[184:187]
MF v[188:191],a[220:223],a[140:143],v[188:191]
LW 14
s_waitcnt vmcnt(15)
MF v[64:67],a[224:227],a[144:147],v[64:67]
s_waitcnt vmcnt(15)
v_cmp_ne_u32 vcc,s37,v51
s_nop 0
s_cbranch_vccnz Lm_wb7
Lm_wb7r:
MF v[68:71],a[224:227],a[148:151],v[68:71]
s_movk_i32 s47,8192
s_movk_i32 s59,1024
TR a[192:193],v29,49152
MF v[72:75],a[224:227],a[152:155],v[72:75]
TR a[194:195],v29,50176
buffer_load_dwordx4 a[128:131],v45,s[8:11],s47 offen sc1
MF v[76:79],a[224:227],a[156:159],v[76:79]
LW 14
TR a[196:197],v30,49152
MF v[80:83],a[228:231],a[144:147],v[80:83]
AW a40,0
MF v[84:87],a[228:231],a[148:151],v[84:87]
TR a[198:199],v30,50176
MF v[88:91],a[228:231],a[152:155],v[88:91]
buffer_load_dwordx4 a[132:135],v46,s[8:11],s47 offen sc1
MF v[92:95],a[228:231],a[156:159],v[92:95]
LW 14
TR a[200:201],v31,49152
AW a41,0
MF v[96:99],a[232:235],a[144:147],v[96:99]
buffer_store_dwordx2 v[22:23],v252,s[20:23],s59 offen
MF v[100:103],a[232:235],a[148:151],v[100:103]
TR a[202:203],v31,50176
MF v[104:107],a[232:235],a[152:155],v[104:107]
AW a42,0
MF v[108:111],a[232:235],a[156:159],v[108:111]
LW 14
TR a[204:205],v32,49152
buffer_load_dwordx4 a[136:139],v47,s[8:11],s47 offen sc1
MF v[112:115],a[236:239],a[144:147],v[112:115]
MF v[116:119],a[236:239],a[148:151],v[116:119]
TR a[206:207],v32,50176
AW a43,0
MF v[120:123],a[236:239],a[152:155],v[120:123]
MF v[124:127],a[236:239],a[156:159],v[124:127]
LW 14
s_movk_i32 s59,5632
TR a[208:209],v33,49152
MF v[128:131],a[240:243],a[144:147],v[128:131]
TR a[210:211],v33,50176
buffer_load_dwordx4 a[140:143],v48,s[8:11],s47 offen sc1
MF v[132:135],a[240:243],a[148:151],v[132:135]
AW a44,0
MF v[136:139],a[240:243],a[152:155],v[136:139]
TR a[212:213],v34,49152
MF v[140:143],a[240:243],a[156:159],v[140:143]
LW 15
MF v[144:147],a[244:247],a[144:147],v[144:147]
TR a[214:215],v34,50176
AW a45,0
MF v[148:151],a[244:247],a[148:151],v[148:151]
s_lshl_b32 s42,s33,4
s_add_u32 s42,s42,s34
s_lshl_b32 s7,s42,4
MF v[152:155],a[244:247],a[152:155],v[152:155]
s_lshl_b32 s41,s32,2
s_add_u32 s7,s7,s41
s_add_u32 s7,s7,0x8302000
MF v[156:159],a[244:247],a[156:159],v[156:159]
LW 14
v_mov_b32 v12,s7
v_mov_b32 v13,s3
MF v[160:163],a[248:251],a[144:147],v[160:163]
TR a[216:217],v35,49152
global_store_dword v12,v13,s[4:5] sc1
MF v[164:167],a[248:251],a[148:151],v[164:167]
buffer_store_dwordx2 v[24:25],v252,s[20:23],s59 offen
AW a46,0
MF v[168:171],a[248:251],a[152:155],v[168:171]
s_lshl_b32 s7,s63,4
s_lshl_b32 s41,s32,2
TR a[218:219],v35,50176
MF v[172:175],a[248:251],a[156:159],v[172:175]
LW 14
s_add_u32 s7,s7,s41
s_add_u32 s7,s7,0x8301000
MF v[176:179],a[252:255],a[144:147],v[176:179]
v_mov_b32 v50,s7
v_mov_b32 v51,s3
MF v[180:183],a[252:255],a[148:151],v[180:183]
TR a[220:221],v36,49152
global_store_dword v50,v51,s[4:5] sc1
MF v[184:187],a[252:255],a[152:155],v[184:187]
TR a[222:223],v36,50176
AW a47,0
MF v[188:191],a[252:255],a[156:159],v[188:191]
LW 14
s_waitcnt vmcnt(17)
MF v[64:67],a[192:195],a[160:163],v[64:67]
s_movk_i32 s47,8192
buffer_load_dwordx4 a[144:147],v45,s[8:11],s47 offen offset:1024 sc1
TR a[224:225],v29,57344
MF v[68:71],a[192:195],a[164:167],v[68:71]
s_movk_i32 s59,10240
TR a[226:227],v29,58368
MF v[72:75],a[192:195],a[168:171],v[72:75]
MF v[76:79],a[192:195],a[172:175],v[76:79]
LW 14
TR a[228:229],v30,57344
MF v[80:83],a[196:199],a[160:163],v[80:83]
AW a48,0
MF v[84:87],a[196:199],a[164:167],v[84:87]
TR a[230:231],v30,58368
MF v[88:91],a[196:199],a[168:171],v[88:91]
buffer_load_dwordx4 a[148:151],v46,s[8:11],s47 offen offset:1024 sc1
MF v[92:95],a[196:199],a[172:175],v[92:95]
LW 14
TR a[232:233],v31,57344
AW a49,0
MF v[96:99],a[200:203],a[160:163],v[96:99]
buffer_store_dwordx2 v[26:27],v252,s[20:23],s59 offen
MF v[100:103],a[200:203],a[164:167],v[100:103]
TR a[234:235],v31,58368
MF v[104:107],a[200:203],a[168:171],v[104:107]
AW a50,0
MF v[108:111],a[200:203],a[172:175],v[108:111]
LW 14
TR a[236:237],v32,57344
MF v[112:115],a[204:207],a[160:163],v[112:115]
buffer_load_dwordx4 a[152:155],v47,s[8:11],s47 offen offset:1024 sc1
MF v[116:119],a[204:207],a[164:167],v[116:119]
TR a[238:239],v32,58368
AW a51,0
MF v[120:123],a[204:207],a[168:171],v[120:123]
MF v[124:127],a[204:207],a[172:175],v[124:127]
LW 14
s_movk_i32 s59,14848
TR a[240:241],v33,57344
MF v[128:131],a[208:211],a[160:163],v[128:131]
TR a[242:243],v33,58368
MF v[132:135],a[208:211],a[164:167],v[132:135]
AW a52,0
MF v[136:139],a[208:211],a[168:171],v[136:139]
TR a[244:245],v34,57344
buffer_load_dwordx4 a[156:159],v48,s[8:11],s47 offen offset:1024 sc1
MF v[140:143],a[208:211],a[172:175],v[140:143]
LW 15
MF v[144:147],a[212:215],a[160:163],v[144:147]
TR a[246:247],v34,58368
AW a53,0
MF v[148:151],a[212:215],a[164:167],v[148:151]
MF v[152:155],a[212:215],a[168:171],v[152:155]
buffer_store_dwordx2 v[52:53],v252,s[20:23],s59 offen
TR a[248:249],v35,57344
MF v[156:159],a[212:215],a[172:175],v[156:159]
LW 15
AW a54,0
MF v[160:163],a[216:219],a[160:163],v[160:163]
s_movk_i32 s43,8192
buffer_store_dwordx4 a[112:115],v3,s[28:31],s43 offen sc1
TR a[250:251],v35,58368
MF v[164:167],a[216:219],a[164:167],v[164:167]
MF v[168:171],a[216:219],a[168:171],v[168:171]
TR a[252:253],v36,57344
AW a55,0
MF v[172:175],a[216:219],a[172:175],v[172:175]
LW 15
MF v[176:179],a[220:223],a[160:163],v[176:179]
TR a[254:255],v36,58368
MF v[180:183],a[220:223],a[164:167],v[180:183]
MF v[184:187],a[220:223],a[168:171],v[184:187]
MF v[188:191],a[220:223],a[172:175],v[188:191]
LW 14
s_waitcnt vmcnt(17)
MF v[64:67],a[224:227],a[176:179],v[64:67]
s_barrier
s_movk_i32 s59,1536
MF v[68:71],a[224:227],a[180:183],v[68:71]
s_movk_i32 s47,8192
buffer_load_dwordx4 a[160:163],v45,s[8:11],s47 offen offset:2048 sc1
v_add_u32 v29,0x10000,v29
MF v[72:75],a[224:227],a[184:187],v[72:75]
v_add_u32 v30,0x10000,v30
MF v[76:79],a[224:227],a[188:191],v[76:79]
LW 12
v_add_u32 v31,0x10000,v31
MF v[80:83],a[228:231],a[176:179],v[80:83]
v_add_u32 v32,0x10000,v32
AW a56,0
MF v[84:87],a[228:231],a[180:183],v[84:87]
v_add_u32 v33,0x10000,v33
MF v[88:91],a[228:231],a[184:187],v[88:91]
buffer_load_dwordx4 a[164:167],v46,s[8:11],s47 offen offset:2048 sc1
MF v[92:95],a[228:231],a[188:191],v[92:95]
LW 10
AW a57,0
v_add_u32 v34,0x10000,v34
MF v[96:99],a[232:235],a[176:179],v[96:99]
buffer_store_dwordx2 v[54:55],v252,s[20:23],s59 offen
v_add_u32 v35,0x10000,v35
MF v[100:103],a[232:235],a[180:183],v[100:103]
v_add_u32 v36,0x10000,v36
MF v[104:107],a[232:235],a[184:187],v[104:107]
TR a[192:193],v29,0
AW a58,0
MF v[108:111],a[232:235],a[188:191],v[108:111]
LW 9
TR a[194:195],v29,1024
buffer_load_dwordx4 a[168:171],v47,s[8:11],s47 offen offset:2048 sc1
MF v[112:115],a[236:239],a[176:179],v[112:115]
MF v[116:119],a[236:239],a[180:183],v[116:119]
TR a[196:197],v30,0
AW a59,0
MF v[120:123],a[236:239],a[184:187],v[120:123]
TR a[198:199],v30,1024
MF v[124:127],a[236:239],a[188:191],v[124:127]
LW 10
TR a[200:201],v31,0
s_movk_i32 s59,6144
MF v[128:131],a[240:243],a[176:179],v[128:131]
TR a[202:203],v31,1024
buffer_load_dwordx4 a[172:175],v48,s[8:11],s47 offen offset:2048 sc1
MF v[132:135],a[240:243],a[180:183],v[132:135]
TR a[204:205],v32,0
AW a60,0
MF v[136:139],a[240:243],a[184:187],v[136:139]
MF v[140:143],a[240:243],a[188:191],v[140:143]
LW 11
TR a[206:207],v32,1024
MF v[144:147],a[244:247],a[176:179],v[144:147]
TR a[208:209],v33,0
AW a61,0
MF v[148:151],a[244:247],a[180:183],v[148:151]
s_movk_i32 s43,8192
TR a[210:211],v33,1024
buffer_store_dwordx4 a[116:119],v3,s[28:31],s43 offen offset:2048 sc1
MF v[152:155],a[244:247],a[184:187],v[152:155]
TR a[212:213],v34,0
buffer_store_dwordx2 v[56:57],v252,s[20:23],s59 offen
MF v[156:159],a[244:247],a[188:191],v[156:159]
LW 13
TR a[214:215],v34,1024
AW a62,0
MF v[160:163],a[248:251],a[176:179],v[160:163]
MF v[164:167],a[248:251],a[180:183],v[164:167]
TR a[216:217],v35,0
MF v[168:171],a[248:251],a[184:187],v[168:171]
s_add_u32 s40,s0,Lm_att-Lm_pc
s_addc_u32 s41,s1,0
s_lshr_b32 s7,s2,3
MF v[172:175],a[248:251],a[188:191],v[172:175]
LW 13
s_lshl_b32 s7,s7,2
s_add_u32 s7,s7,s32
MF v[176:179],a[252:255],a[176:179],v[176:179]
s_lshl_b32 s7,s7,9
v_and_b32 v12,3,v1
v_lshl_add_u32 v12,v12,7,s7
MF v[180:183],a[252:255],a[180:183],v[180:183]
TR a[218:219],v35,1024
v_min_u32 v12,Lm_codeend-Lm_att-4,v12
MF v[184:187],a[252:255],a[184:187],v[184:187]
global_load_dword v13,v12,s[40:41]
AW a63,0
MF v[188:191],a[252:255],a[188:191],v[188:191]
LW 12
s_waitcnt vmcnt(18)
TR a[220:221],v36,0
TR a[222:223],v36,1024
MF v[64:67],a[192:195],a[128:131],v[64:67]
s_movk_i32 s47,8192
buffer_load_dwordx4 a[176:179],v45,s[8:11],s47 offen offset:3072 sc1
TR a[224:225],v29,8192
MF v[68:71],a[192:195],a[132:135],v[68:71]
s_movk_i32 s59,10752
TR a[226:227],v29,9216
MF v[72:75],a[192:195],a[136:139],v[72:75]
MF v[76:79],a[192:195],a[140:143],v[76:79]
LW 14
TR a[228:229],v30,8192
MF v[80:83],a[196:199],a[128:131],v[80:83]
AW a64,0
MF v[84:87],a[196:199],a[132:135],v[84:87]
TR a[230:231],v30,9216
MF v[88:91],a[196:199],a[136:139],v[88:91]
buffer_load_dwordx4 a[180:183],v46,s[8:11],s47 offen offset:3072 sc1
MF v[92:95],a[196:199],a[140:143],v[92:95]
LW 14
TR a[232:233],v31,8192
AW a65,0
MF v[96:99],a[200:203],a[128:131],v[96:99]
buffer_store_dwordx2 v[58:59],v252,s[20:23],s59 offen
MF v[100:103],a[200:203],a[132:135],v[100:103]
TR a[234:235],v31,9216
MF v[104:107],a[200:203],a[136:139],v[104:107]
AW a66,0
MF v[108:111],a[200:203],a[140:143],v[108:111]
LW 14
TR a[236:237],v32,8192
MF v[112:115],a[204:207],a[128:131],v[112:115]
buffer_load_dwordx4 a[184:187],v47,s[8:11],s47 offen offset:3072 sc1
MF v[116:119],a[204:207],a[132:135],v[116:119]
TR a[238:239],v32,9216
AW a67,0
MF v[120:123],a[204:207],a[136:139],v[120:123]
MF v[124:127],a[204:207],a[140:143],v[124:127]
LW 14
s_movk_i32 s59,15360
TR a[240:241],v33,8192
MF v[128:131],a[208:211],a[128:131],v[128:131]
TR a[242:243],v33,9216
MF v[132:135],a[208:211],a[132:135],v[132:135]
AW a68,0
MF v[136:139],a[208:211],a[136:139],v[136:139]
TR a[244:245],v34,8192
buffer_load_dwordx4 a[188:191],v48,s[8:11],s47 offen offset:3072 sc1
MF v[140:143],a[208:211],a[140:143],v[140:143]
LW 15
MF v[144:147],a[212:215],a[128:131],v[144:147]
TR a[246:247],v34,9216
AW a69,0
MF v[148:151],a[212:215],a[132:135],v[148:151]
MF v[152:155],a[212:215],a[136:139],v[152:155]
buffer_store_dwordx2 v[60:61],v252,s[20:23],s59 offen
TR a[248:249],v35,8192
MF v[156:159],a[212:215],a[140:143],v[156:159]
LW 15
AW a70,0
MF v[160:163],a[216:219],a[128:131],v[160:163]
s_lshr_b32 s42,s35,1
s_lshl_b32 s42,s42,4
TR a[250:251],v35,9216
MF v[164:167],a[216:219],a[132:135],v[164:167]
s_lshl_b32 s7,s42,4
s_add_u32 s7,s7,0x8301000
v_lshl_add_u32 v50,v1,2,s7
MF v[168:171],a[216:219],a[136:139],v[168:171]
TR a[252:253],v36,8192
global_load_dword v51,v50,s[4:5] sc1
MF v[172:175],a[216:219],a[140:143],v[172:175]
LW 15
AW a71,0
MF v[176:179],a[220:223],a[128:131],v[176:179]
TR a[254:255],v36,9216
MF v[180:183],a[220:223],a[132:135],v[180:183]
MF v[184:187],a[220:223],a[136:139],v[184:187]
MF v[188:191],a[220:223],a[140:143],v[188:191]
LW 14
s_waitcnt vmcnt(17)
MF v[64:67],a[224:227],a[144:147],v[64:67]
s_movk_i32 s47,12288
buffer_load_dwordx4 a[128:131],v45,s[8:11],s47 offen sc1
TR a[192:193],v29,16384
MF v[68:71],a[224:227],a[148:151],v[68:71]
s_movk_i32 s59,2048
TR a[194:195],v29,17408
MF v[72:75],a[224:227],a[152:155],v[72:75]
MF v[76:79],a[224:227],a[156:159],v[76:79]
LW 14
TR a[196:197],v30,16384
MF v[80:83],a[228:231],a[144:147],v[80:83]
AW a72,0
MF v[84:87],a[228:231],a[148:151],v[84:87]
TR a[198:199],v30,17408
MF v[88:91],a[228:231],a[152:155],v[88:91]
buffer_load_dwordx4 a[132:135],v46,s[8:11],s47 offen sc1
MF v[92:95],a[228:231],a[156:159],v[92:95]
LW 14
TR a[200:201],v31,16384
AW a73,0
MF v[96:99],a[232:235],a[144:147],v[96:99]
buffer_store_dwordx2 v[62:63],v253,s[20:23],s59 offen
MF v[100:103],a[232:235],a[148:151],v[100:103]
TR a[202:203],v31,17408
MF v[104:107],a[232:235],a[152:155],v[104:107]
AW a74,0
MF v[108:111],a[232:235],a[156:159],v[108:111]
LW 14
TR a[204:205],v32,16384
MF v[112:115],a[236:239],a[144:147],v[112:115]
buffer_load_dwordx4 a[136:139],v47,s[8:11],s47 offen sc1
MF v[116:119],a[236:239],a[148:151],v[116:119]
TR a[206:207],v32,17408
AW a75,0
MF v[120:123],a[236:239],a[152:155],v[120:123]
MF v[124:127],a[236:239],a[156:159],v[124:127]
LW 14
s_movk_i32 s59,6656
TR a[208:209],v33,16384
MF v[128:131],a[240:243],a[144:147],v[128:131]
TR a[210:211],v33,17408
MF v[132:135],a[240:243],a[148:151],v[132:135]
AW a76,0
MF v[136:139],a[240:243],a[152:155],v[136:139]
TR a[212:213],v34,16384
buffer_load_dwordx4 a[140:143],v48,s[8:11],s47 offen sc1
MF v[140:143],a[240:243],a[156:159],v[140:143]
LW 15
MF v[144:147],a[244:247],a[144:147],v[144:147]
TR a[214:215],v34,17408
AW a77,0
MF v[148:151],a[244:247],a[148:151],v[148:151]
MF v[152:155],a[244:247],a[152:155],v[152:155]
buffer_store_dwordx2 v[248:249],v253,s[20:23],s59 offen
TR a[216:217],v35,16384
MF v[156:159],a[244:247],a[156:159],v[156:159]
LW 15
AW a78,0
MF v[160:163],a[248:251],a[144:147],v[160:163]
s_movk_i32 s43,12288
buffer_store_dwordx4 a[120:123],v3,s[28:31],s43 offen sc1
TR a[218:219],v35,17408
MF v[164:167],a[248:251],a[148:151],v[164:167]
MF v[168:171],a[248:251],a[152:155],v[168:171]
TR a[220:221],v36,16384
AW a79,0
MF v[172:175],a[248:251],a[156:159],v[172:175]
LW 15
MF v[176:179],a[252:255],a[144:147],v[176:179]
TR a[222:223],v36,17408
MF v[180:183],a[252:255],a[148:151],v[180:183]
MF v[184:187],a[252:255],a[152:155],v[184:187]
MF v[188:191],a[252:255],a[156:159],v[188:191]
LW 14
s_waitcnt vmcnt(17)
MF v[64:67],a[192:195],a[160:163],v[64:67]
s_movk_i32 s47,12288
buffer_load_dwordx4 a[144:147],v45,s[8:11],s47 offen offset:1024 sc1
TR a[224:225],v29,24576
MF v[68:71],a[192:195],a[164:167],v[68:71]
s_movk_i32 s59,11264
TR a[226:227],v29,25600
MF v[72:75],a[192:195],a[168:171],v[72:75]
MF v[76:79],a[192:195],a[172:175],v[76:79]
LW 14
TR a[228:229],v30,24576
MF v[80:83],a[196:199],a[160:163],v[80:83]
AW a80,0
MF v[84:87],a[196:199],a[164:167],v[84:87]
TR a[230:231],v30,25600
MF v[88:91],a[196:199],a[168:171],v[88:91]
buffer_load_dwordx4 a[148:151],v46,s[8:11],s47 offen offset:1024 sc1
MF v[92:95],a[196:199],a[172:175],v[92:95]
LW 14
TR a[232:233],v31,24576
AW a81,0
MF v[96:99],a[200:203],a[160:163],v[96:99]
buffer_store_dwordx2 v[250:251],v253,s[20:23],s59 offen
MF v[100:103],a[200:203],a[164:167],v[100:103]
TR a[234:235],v31,25600
MF v[104:107],a[200:203],a[168:171],v[104:107]
AW a82,0
MF v[108:111],a[200:203],a[172:175],v[108:111]
LW 14
TR a[236:237],v32,24576
MF v[112:115],a[204:207],a[160:163],v[112:115]
buffer_load_dwordx4 a[152:155],v47,s[8:11],s47 offen offset:1024 sc1
MF v[116:119],a[204:207],a[164:167],v[116:119]
TR a[238:239],v32,25600
AW a83,0
MF v[120:123],a[204:207],a[168:171],v[120:123]
MF v[124:127],a[204:207],a[172:175],v[124:127]
LW 14
s_movk_i32 s59,15872
TR a[240:241],v33,24576
MF v[128:131],a[208:211],a[160:163],v[128:131]
TR a[242:243],v33,25600
MF v[132:135],a[208:211],a[164:167],v[132:135]
AW a84,0
MF v[136:139],a[208:211],a[168:171],v[136:139]
TR a[244:245],v34,24576
buffer_load_dwordx4 a[156:159],v48,s[8:11],s47 offen offset:1024 sc1
MF v[140:143],a[208:211],a[172:175],v[140:143]
LW 15
MF v[144:147],a[212:215],a[160:163],v[144:147]
TR a[246:247],v34,25600
AW a85,0
MF v[148:151],a[212:215],a[164:167],v[148:151]
MF v[152:155],a[212:215],a[168:171],v[152:155]
buffer_store_dwordx2 v[192:193],v253,s[20:23],s59 offen
TR a[248:249],v35,24576
MF v[156:159],a[212:215],a[172:175],v[156:159]
LW 15
AW a86,0
MF v[160:163],a[216:219],a[160:163],v[160:163]
s_movk_i32 s43,12288
buffer_store_dwordx4 a[124:127],v3,s[28:31],s43 offen offset:2048 sc1
TR a[250:251],v35,25600
MF v[164:167],a[216:219],a[164:167],v[164:167]
MF v[168:171],a[216:219],a[168:171],v[168:171]
TR a[252:253],v36,24576
AW a87,0
MF v[172:175],a[216:219],a[172:175],v[172:175]
LW 15
MF v[176:179],a[220:223],a[160:163],v[176:179]
TR a[254:255],v36,25600
MF v[180:183],a[220:223],a[164:167],v[180:183]
MF v[184:187],a[220:223],a[168:171],v[184:187]
MF v[188:191],a[220:223],a[172:175],v[188:191]
LW 14
s_waitcnt vmcnt(16)
MF v[64:67],a[224:227],a[176:179],v[64:67]
s_barrier
s_waitcnt vmcnt(14)
v_cmp_ne_u32 vcc,s3,v51
s_nop 0
s_cbranch_vccnz Lm_pl8
Lm_pl8r:
MF v[68:71],a[224:227],a[180:183],v[68:71]
s_lshl_b32 s52,s2,2
v_add_u32 v29,0xfffe0000,v29
s_add_u32 s52,s52,s32
MF v[72:75],a[224:227],a[184:187],v[72:75]
s_lshl_b32 s52,s52,1
s_movk_i32 s47,12288
buffer_load_dwordx4 a[160:163],v45,s[8:11],s47 offen offset:2048 sc1
MF v[76:79],a[224:227],a[188:191],v[76:79]
LW 12
s_add_u32 s52,s52,0
v_add_u32 v30,0xfffe0000,v30
MF v[80:83],a[228:231],a[176:179],v[80:83]
s_mul_i32 s51,s52,7282
AW a88,0
v_add_u32 v31,0xfffe0000,v31
MF v[84:87],a[228:231],a[180:183],v[84:87]
s_lshr_b32 s51,s51,16
buffer_load_dwordx4 a[164:167],v46,s[8:11],s47 offen offset:2048 sc1
v_add_u32 v32,0xfffe0000,v32
MF v[88:91],a[228:231],a[184:187],v[88:91]
s_mul_i32 s53,s51,9
s_sub_u32 s52,s52,s53
v_add_u32 v33,0xfffe0000,v33
MF v[92:95],a[228:231],a[188:191],v[92:95]
LW 10
AW a89,0
v_add_u32 v34,0xfffe0000,v34
MF v[96:99],a[232:235],a[176:179],v[96:99]
s_min_u32 s49,s51,199
buffer_load_dwordx4 a[168:171],v47,s[8:11],s47 offen offset:2048 sc1
v_add_u32 v35,0xfffe0000,v35
MF v[100:103],a[232:235],a[180:183],v[100:103]
s_cmp_ge_u32 s49,100
s_cselect_b32 s53,2,0
s_cselect_b32 s44,100,0
MF v[104:107],a[232:235],a[184:187],v[104:107]
AW a90,0
v_add_u32 v36,0xfffe0000,v36
MF v[108:111],a[232:235],a[188:191],v[108:111]
LW 8
s_sub_u32 s49,s49,s44
TR a[192:193],v29,0
MF v[112:115],a[236:239],a[176:179],v[112:115]
buffer_load_dwordx4 a[172:175],v48,s[8:11],s47 offen offset:2048 sc1
TR a[194:195],v29,1024
MF v[116:119],a[236:239],a[180:183],v[116:119]
s_cmp_ge_u32 s49,50
s_cselect_b32 s44,50,0
s_cselect_b32 s45,1,0
MF v[120:123],a[236:239],a[184:187],v[120:123]
TR a[196:197],v30,0
AW a91,0
MF v[124:127],a[236:239],a[188:191],v[124:127]
LW 9
s_sub_u32 s49,s49,s44
TR a[198:199],v30,1024
MF v[128:131],a[240:243],a[176:179],v[128:131]
s_add_u32 s48,s48,16384
s_add_u32 s53,s53,s45
TR a[200:201],v31,0
MF v[132:135],a[240:243],a[180:183],v[132:135]
s_mul_i32 s44,s45,32
s_bfe_u32 m0,s48,0x110000
TR a[202:203],v31,1024
MF v[136:139],a[240:243],a[184:187],v[136:139]
s_lshr_b32 s14,s53,1
TR a[204:205],v32,0
AW a92,0
MF v[140:143],a[240:243],a[188:191],v[140:143]
LW 11
TR a[206:207],v32,1024
s_lshl_b32 s14,s14,6
MF v[144:147],a[244:247],a[176:179],v[144:147]
s_add_u32 s44,s44,s14
buffer_load_dwordx4 v2,s[16:19],s48 offen sc1 lds
AW a93,0
MF v[148:151],a[244:247],a[180:183],v[148:151]
s_mul_i32 s45,s45,0
s_add_u32 s45,s45,32
TR a[208:209],v33,0
MF v[152:155],a[244:247],a[184:187],v[152:155]
s_mul_i32 s14,s53,18
TR a[210:211],v33,1024
MF v[156:159],a[244:247],a[188:191],v[156:159]
LW 12
s_sub_u32 s14,s14,s45
TR a[212:213],v34,0
MF v[160:163],a[248:251],a[176:179],v[160:163]
buffer_load_dwordx4 v2,s[16:19],s48 offen offset:1024 sc1 lds
AW a94,0
MF v[164:167],a[248:251],a[180:183],v[164:167]
TR a[214:215],v34,1024
MF v[168:171],a[248:251],a[184:187],v[168:171]
TR a[216:217],v35,0
AW a95,0
MF v[172:175],a[248:251],a[188:191],v[172:175]
LW 13
buffer_load_dwordx4 v2,s[16:19],s48 offen offset:2048 sc1 lds
TR a[218:219],v35,1024
MF v[176:179],a[252:255],a[176:179],v[176:179]
TR a[220:221],v36,0
MF v[180:183],a[252:255],a[180:183],v[180:183]
TR a[222:223],v36,1024
MF v[184:187],a[252:255],a[184:187],v[184:187]
MF v[188:191],a[252:255],a[188:191],v[188:191]
LW 14
s_waitcnt vmcnt(16)
s_cmp_lt_u32 s49,s45
s_cselect_b32 s12,s74,s84
s_cselect_b32 s13,s75,s85
s_cselect_b32 s44,s44,s14
s_add_u32 s44,s44,s49
s_mul_i32 s44,s44,36864
s_lshl_b32 s45,s52,7
MF v[64:67],a[192:195],a[128:131],v[64:67]
s_movk_i32 s47,12288
buffer_load_dwordx4 a[176:179],v45,s[8:11],s47 offen offset:3072 sc1
TR a[224:225],v29,8192
MF v[68:71],a[192:195],a[132:135],v[68:71]
s_add_u32 s44,s44,s45
TR a[226:227],v29,9216
v_mov_b32 v7,0x3f80
MF v[72:75],a[192:195],a[136:139],v[72:75]
s_add_u32 s12,s12,s44
s_addc_u32 s13,s13,0
v_mov_b32 v9,0xff7f0000
MF v[76:79],a[192:195],a[140:143],v[76:79]
LW 14
s_cmp_lt_u32 s51,200
s_cselect_b32 s14,35840,0
MF v[80:83],a[196:199],a[128:131],v[80:83]
s_mov_b32 s15,0x20000
TR a[228:229],v30,8192
AW a96,0
MF v[84:87],a[196:199],a[132:135],v[84:87]
s_lshl_b32 s52,s52,2
buffer_load_dwordx4 a[180:183],v46,s[8:11],s47 offen offset:3072 sc1
v_mov_b32 v10,0xff7fff7f
MF v[88:91],a[196:199],a[136:139],v[88:91]
s_mul_i32 s45,s52,7282
TR a[230:231],v30,9216
MF v[92:95],a[196:199],a[140:143],v[92:95]
LW 14
TR a[232:233],v31,8192
AW a97,0
MF v[96:99],a[200:203],a[128:131],v[96:99]
s_lshr_b32 s45,s45,16
s_lshl_b32 s44,s53,2
v_and_b32 v4,15,v1
MF v[100:103],a[200:203],a[132:135],v[100:103]
s_add_u32 s44,s44,s45
TR a[234:235],v31,9216
buffer_load_dwordx4 a[184:187],v47,s[8:11],s47 offen offset:3072 sc1
MF v[104:107],a[200:203],a[136:139],v[104:107]
s_mul_i32 s44,s44,58
v_lshrrev_b32 v5,4,v1
AW a98,0
MF v[108:111],a[200:203],a[140:143],v[108:111]
LW 14
s_add_u32 s44,s44,s49
TR a[236:237],v32,8192
MF v[112:115],a[204:207],a[128:131],v[112:115]
s_mul_i32 s45,s45,9
MF v[116:119],a[204:207],a[132:135],v[116:119]
s_sub_u32 s52,s52,s45
buffer_load_dwordx4 a[188:191],v48,s[8:11],s47 offen offset:3072 sc1
TR a[238:239],v32,9216
MF v[120:123],a[204:207],a[136:139],v[120:123]
s_mul_i32 s44,s44,9216
AW a99,0
v_lshlrev_b32 v5,3,v5
MF v[124:127],a[204:207],a[140:143],v[124:127]
LW 14
s_and_b32 s53,s53,1
TR a[240:241],v33,8192
MF v[128:131],a[208:211],a[128:131],v[128:131]
s_lshl_b32 s53,s53,2
TR a[242:243],v33,9216
v_sub_u32 v6,v4,v5
MF v[132:135],a[208:211],a[132:135],v[132:135]
s_cmp_lt_u32 s51,200
s_cselect_b32 s51,s44,0x70000000
AW a100,0
MF v[136:139],a[208:211],a[136:139],v[136:139]
s_add_u32 s44,s52,s53
TR a[244:245],v34,8192
buffer_load_dwordx4 v2,s[16:19],s48 offen offset:3072 sc1 lds
MF v[140:143],a[208:211],a[140:143],v[140:143]
LW 15
s_sub_u32 s45,s44,9
v_and_b32 v11,1,v6
MF v[144:147],a[212:215],a[128:131],v[144:147]
s_min_u32 s44,s44,s45
TR a[246:247],v34,9216
AW a101,0
MF v[148:151],a[212:215],a[132:135],v[148:151]
s_lshl_b32 s44,s44,10
v_lshlrev_b32 v11,4,v11
MF v[152:155],a[212:215],a[136:139],v[152:155]
s_add_u32 s48,s48,16384
TR a[248:249],v35,8192
s_bfe_u32 m0,s48,0x110000
MF v[156:159],a[212:215],a[140:143],v[156:159]
LW 15
s_add_u32 s66,s44,s51
s_add_u32 s52,s52,1
MF v[160:163],a[216:219],a[128:131],v[160:163]
TR a[250:251],v35,9216
AW a102,0
MF v[164:167],a[216:219],a[132:135],v[164:167]
s_cmp_eq_u32 s52,9
s_cselect_b32 s52,0,s52
s_cselect_b32 s44,534528,0
MF v[168:171],a[216:219],a[136:139],v[168:171]
TR a[252:253],v36,8192
v_lshlrev_b32 v11,v11,v7
MF v[172:175],a[216:219],a[140:143],v[172:175]
LW 15
buffer_load_dwordx4 v2,s[16:19],s48 offen sc1 lds
AW a103,0
MF v[176:179],a[220:223],a[128:131],v[176:179]
s_add_u32 s51,s51,s44
TR a[254:255],v36,9216
v_lshrrev_b32 v8,1,v6
MF v[180:183],a[220:223],a[132:135],v[180:183]
s_add_u32 s44,s52,s53
s_sub_u32 s45,s44,9
MF v[184:187],a[220:223],a[136:139],v[184:187]
s_min_u32 s44,s44,s45
MF v[188:191],a[220:223],a[140:143],v[188:191]
LW 14
s_waitcnt vmcnt(15)
MF v[64:67],a[224:227],a[144:147],v[64:67]
s_movk_i32 s47,16384
buffer_load_dwordx4 a[128:131],v45,s[8:11],s47 offen sc1
TR a[192:193],v29,16384
MF v[68:71],a[224:227],a[148:151],v[68:71]
s_lshl_b32 s44,s44,10
s_add_u32 s67,s44,s51
v_cmp_eq_u32 s[54:55],0,v8
MF v[72:75],a[224:227],a[152:155],v[72:75]
s_add_u32 s52,s52,1
TR a[194:195],v29,17408
v_cmp_eq_u32 s[56:57],1,v8
MF v[76:79],a[224:227],a[156:159],v[76:79]
LW 14
buffer_load_dwordx4 a[132:135],v46,s[8:11],s47 offen sc1
TR a[196:197],v30,16384
MF v[80:83],a[228:231],a[144:147],v[80:83]
s_cmp_eq_u32 s52,9
s_cselect_b32 s52,0,s52
s_cselect_b32 s44,534528,0
MF v[84:87],a[228:231],a[148:151],v[84:87]
s_add_u32 s51,s51,s44
v_cmp_eq_u32 s[58:59],2,v8
AW a104,0
MF v[88:91],a[228:231],a[152:155],v[88:91]
s_add_u32 s44,s52,s53
TR a[198:199],v30,17408
MF v[92:95],a[228:231],a[156:159],v[92:95]
LW 14
TR a[200:201],v31,16384
AW a105,0
MF v[96:99],a[232:235],a[144:147],v[96:99]
s_sub_u32 s45,s44,9
buffer_load_dwordx4 a[136:139],v47,s[8:11],s47 offen sc1
v_cmp_eq_u32 s[60:61],3,v8
MF v[100:103],a[232:235],a[148:151],v[100:103]
s_min_u32 s44,s44,s45
s_lshl_b32 s44,s44,10
TR a[202:203],v31,17408
MF v[104:107],a[232:235],a[152:155],v[104:107]
s_add_u32 s70,s44,s51
AW a106,0
v_cndmask_b32 v192,0,v11,s[54:55]
MF v[108:111],a[232:235],a[156:159],v[108:111]
LW 14
s_add_u32 s52,s52,1
TR a[204:205],v32,16384
MF v[112:115],a[236:239],a[144:147],v[112:115]
buffer_load_dwordx4 a[140:143],v48,s[8:11],s47 offen sc1
v_cndmask_b32 v193,0,v11,s[56:57]
MF v[116:119],a[236:239],a[148:151],v[116:119]
s_cmp_eq_u32 s52,9
s_cselect_b32 s52,0,s52
s_cselect_b32 s44,534528,0
MF v[120:123],a[236:239],a[152:155],v[120:123]
TR a[206:207],v32,17408
AW a107,0
MF v[124:127],a[236:239],a[156:159],v[124:127]
LW 14
TR a[208:209],v33,16384
v_cndmask_b32 v194,0,v11,s[58:59]
MF v[128:131],a[240:243],a[144:147],v[128:131]
s_add_u32 s51,s51,s44
s_add_u32 s44,s52,s53
buffer_load_dwordx4 v2,s[16:19],s48 offen offset:1024 sc1 lds
MF v[132:135],a[240:243],a[148:151],v[132:135]
s_sub_u32 s45,s44,9
TR a[210:211],v33,17408
AW a108,0
MF v[136:139],a[240:243],a[152:155],v[136:139]
s_min_u32 s44,s44,s45
TR a[212:213],v34,16384
v_cndmask_b32 v195,0,v11,s[60:61]
MF v[140:143],a[240:243],a[156:159],v[140:143]
LW 15
buffer_load_dwordx4 v2,s[16:19],s48 offen offset:2048 sc1 lds
s_lshl_b32 s44,s44,10
MF v[144:147],a[244:247],a[144:147],v[144:147]
s_add_u32 s71,s44,s51
AW a109,0
v_add_u32 v6,16,v6
MF v[148:151],a[244:247],a[148:151],v[148:151]
TR a[214:215],v34,17408
v_lshrrev_b32 v14,3,v1
MF v[152:155],a[244:247],a[152:155],v[152:155]
TR a[216:217],v35,16384
v_mul_u32_u24 v14,1152,v14
MF v[156:159],a[244:247],a[156:159],v[156:159]
LW 15
v_and_b32 v15,7,v1
v_and_b32 v11,1,v6
MF v[160:163],a[248:251],a[144:147],v[160:163]
buffer_load_dwordx4 v2,s[16:19],s48 offen offset:3072 sc1 lds
v_lshl_add_u32 v14,v15,4,v14
MF v[164:167],a[248:251],a[148:151],v[164:167]
TR a[218:219],v35,17408
AW a110,0
MF v[168:171],a[248:251],a[152:155],v[168:171]
v_lshlrev_b32 v11,4,v11
v_lshrrev_b32 v252,2,v1
MF v[172:175],a[248:251],a[156:159],v[172:175]
LW 14
TR a[220:221],v36,16384
v_lshlrev_b32 v252,7,v252
MF v[176:179],a[252:255],a[144:147],v[176:179]
s_lshl_b32 s42,s33,4
AW a111,0
v_and_b32 v15,3,v1
MF v[180:183],a[252:255],a[148:151],v[180:183]
s_lshl_b32 s7,s42,4
s_add_u32 s7,s7,0x8302000
v_lshl_add_u32 v50,v1,2,s7
MF v[184:187],a[252:255],a[152:155],v[184:187]
global_load_dword v51,v50,s[4:5] sc1
v_lshl_add_u32 v252,v15,3,v252
MF v[188:191],a[252:255],a[156:159],v[188:191]
LW 13
s_waitcnt vmcnt(17)
s_lshl_b32 s63,s32,13
s_add_u32 s63,s63,131072
TR a[222:223],v36,17408
v_add_u32 v252,s63,v252
v_lshlrev_b32 v11,v11,v7
MF v[64:67],a[192:195],a[160:163],v[64:67]
s_movk_i32 s47,16384
buffer_load_dwordx4 a[144:147],v45,s[8:11],s47 offen offset:1024 sc1
TR a[224:225],v29,24576
MF v[68:71],a[192:195],a[164:167],v[68:71]
TR a[226:227],v29,25600
v_lshrrev_b32 v8,1,v6
MF v[72:75],a[192:195],a[168:171],v[72:75]
v_cmp_eq_u32 s[54:55],0,v8
MF v[76:79],a[192:195],a[172:175],v[76:79]
LW 14
TR a[228:229],v30,24576
MF v[80:83],a[196:199],a[160:163],v[80:83]
buffer_load_dwordx4 a[148:151],v46,s[8:11],s47 offen offset:1024 sc1
AW a112,0
MF v[84:87],a[196:199],a[164:167],v[84:87]
TR a[230:231],v30,25600
v_cmp_eq_u32 s[56:57],1,v8
MF v[88:91],a[196:199],a[168:171],v[88:91]
MF v[92:95],a[196:199],a[172:175],v[92:95]
LW 14
TR a[232:233],v31,24576
AW a113,0
MF v[96:99],a[200:203],a[160:163],v[96:99]
buffer_load_dwordx4 a[152:155],v47,s[8:11],s47 offen offset:1024 sc1
v_cmp_eq_u32 s[58:59],2,v8
MF v[100:103],a[200:203],a[164:167],v[100:103]
TR a[234:235],v31,25600
MF v[104:107],a[200:203],a[168:171],v[104:107]
v_cmp_eq_u32 s[60:61],3,v8
AW a114,0
MF v[108:111],a[200:203],a[172:175],v[108:111]
LW 14
TR a[236:237],v32,24576
MF v[112:115],a[204:207],a[160:163],v[112:115]
MF v[116:119],a[204:207],a[164:167],v[116:119]
buffer_load_dwordx4 a[156:159],v48,s[8:11],s47 offen offset:1024 sc1
TR a[238:239],v32,25600
MF v[120:123],a[204:207],a[168:171],v[120:123]
AW a115,0
v_cndmask_b32 v196,0,v11,s[54:55]
MF v[124:127],a[204:207],a[172:175],v[124:127]
LW 14
TR a[240:241],v33,24576
MF v[128:131],a[208:211],a[160:163],v[128:131]
TR a[242:243],v33,25600
v_cndmask_b32 v197,0,v11,s[56:57]
MF v[132:135],a[208:211],a[164:167],v[132:135]
s_add_u32 s48,s48,16384
s_bfe_u32 m0,s48,0x110000
AW a116,0
MF v[136:139],a[208:211],a[168:171],v[136:139]
TR a[244:245],v34,24576
MF v[140:143],a[208:211],a[172:175],v[140:143]
LW 15
v_cndmask_b32 v198,0,v11,s[58:59]
MF v[144:147],a[212:215],a[160:163],v[144:147]
TR a[246:247],v34,25600
AW a117,0
MF v[148:151],a[212:215],a[164:167],v[148:151]
v_cndmask_b32 v199,0,v11,s[60:61]
MF v[152:155],a[212:215],a[168:171],v[152:155]
TR a[248:249],v35,24576
buffer_load_dwordx4 v2,s[16:19],s48 offen sc1 lds
MF v[156:159],a[212:215],a[172:175],v[156:159]
LW 15
AW a118,0
MF v[160:163],a[216:219],a[160:163],v[160:163]
TR a[250:251],v35,25600
v_lshrrev_b32 v6,2,v4
MF v[164:167],a[216:219],a[164:167],v[164:167]
MF v[168:171],a[216:219],a[168:171],v[168:171]
buffer_load_dwordx4 v2,s[16:19],s48 offen offset:1024 sc1 lds
TR a[252:253],v36,24576
MF v[172:175],a[216:219],a[172:175],v[172:175]
LW 15
v_and_b32 v4,3,v4
AW a119,0
MF v[176:179],a[220:223],a[160:163],v[176:179]
TR a[254:255],v36,25600
MF v[180:183],a[220:223],a[164:167],v[180:183]
MF v[184:187],a[220:223],a[168:171],v[184:187]
MF v[188:191],a[220:223],a[172:175],v[188:191]
LW 14
s_waitcnt vmcnt(16)
MF v[64:67],a[224:227],a[176:179],v[64:67]
s_barrier
s_waitcnt vmcnt(6)
v_cmp_ne_u32 vcc,s3,v51
s_nop 0
s_cbranch_vccnz Lm_pl9
Lm_pl9r:
MF v[68:71],a[224:227],a[180:183],v[68:71]
s_lshl_b32 s52,s2,2
TR a[192:193],v29,32768
v_lshl_add_u32 v4,v6,3,v4
MF v[72:75],a[224:227],a[184:187],v[72:75]
s_add_u32 s52,s52,s32
s_movk_i32 s43,0
buffer_load_dwordx2 v[16:17],v49,s[24:27],s43 offen sc1
MF v[76:79],a[224:227],a[188:191],v[76:79]
LW 13
v_sub_u32 v4,v4,v5
s_lshl_b32 s52,s52,1
MF v[80:83],a[228:231],a[176:179],v[80:83]
s_add_u32 s52,s52,1
TR a[194:195],v29,33792
AW a120,0
MF v[84:87],a[228:231],a[180:183],v[84:87]
s_movk_i32 s43,0
s_mul_i32 s51,s52,7282
TR a[196:197],v30,32768
MF v[88:91],a[228:231],a[184:187],v[88:91]
s_lshr_b32 s51,s51,16
buffer_load_dwordx2 v[18:19],v49,s[24:27],s43 offen offset:512 sc1
v_cmp_gt_i32 s[54:55],1,v4
MF v[92:95],a[228:231],a[188:191],v[92:95]
LW 13
TR a[198:199],v30,33792
s_mul_i32 s53,s51,9
MF v[96:99],a[232:235],a[176:179],v[96:99]
s_sub_u32 s52,s52,s53
v_cmp_gt_i32 s[56:57],3,v4
AW a121,0
MF v[100:103],a[232:235],a[180:183],v[100:103]
s_movk_i32 s43,0
buffer_load_dwordx2 v[20:21],v49,s[24:27],s43 offen offset:1024 sc1
TR a[200:201],v31,32768
MF v[104:107],a[232:235],a[184:187],v[104:107]
s_min_u32 s49,s51,199
TR a[202:203],v31,33792
v_cmp_gt_i32 s[58:59],5,v4
MF v[108:111],a[232:235],a[188:191],v[108:111]
LW 14
TR a[204:205],v32,32768
AW a122,0
MF v[112:115],a[236:239],a[176:179],v[112:115]
s_cmp_ge_u32 s49,100
s_cselect_b32 s53,2,0
s_cselect_b32 s44,100,0
MF v[116:119],a[236:239],a[180:183],v[116:119]
s_movk_i32 s43,0
buffer_load_dwordx2 v[22:23],v49,s[24:27],s43 offen offset:1536 sc1
v_cmp_gt_i32 s[60:61],7,v4
MF v[120:123],a[236:239],a[184:187],v[120:123]
s_sub_u32 s49,s49,s44
TR a[206:207],v32,33792
AW a123,0
MF v[124:127],a[236:239],a[188:191],v[124:127]
LW 14
TR a[208:209],v33,32768
v_cndmask_b32 v200,0,v9,s[54:55]
MF v[128:131],a[240:243],a[176:179],v[128:131]
s_cmp_ge_u32 s49,50
s_cselect_b32 s44,50,0
s_cselect_b32 s45,1,0
MF v[132:135],a[240:243],a[180:183],v[132:135]
s_movk_i32 s43,0
buffer_load_dwordx2 v[24:25],v49,s[24:27],s43 offen offset:2048 sc1
AW a124,0
MF v[136:139],a[240:243],a[184:187],v[136:139]
s_sub_u32 s49,s49,s44
TR a[210:211],v33,33792
v_cndmask_b32 v201,0,v9,s[56:57]
MF v[140:143],a[240:243],a[188:191],v[140:143]
LW 14
TR a[212:213],v34,32768
s_add_u32 s53,s53,s45
MF v[144:147],a[244:247],a[176:179],v[144:147]
s_mul_i32 s44,s45,32
buffer_load_dwordx4 v2,s[16:19],s48 offen offset:2048 sc1 lds
v_cndmask_b32 v202,0,v9,s[58:59]
MF v[148:151],a[244:247],a[180:183],v[148:151]
s_lshr_b32 s10,s53,1
TR a[214:215],v34,33792
AW a125,0
MF v[152:155],a[244:247],a[184:187],v[152:155]
s_lshl_b32 s10,s10,6
v_cndmask_b32 v203,0,v9,s[60:61]
s_add_u32 s44,s44,s10
MF v[156:159],a[244:247],a[188:191],v[156:159]
LW 14
buffer_load_dwordx4 v2,s[16:19],s48 offen offset:3072 sc1 lds
TR a[216:217],v35,32768
MF v[160:163],a[248:251],a[176:179],v[160:163]
s_mul_i32 s45,s45,0
TR a[218:219],v35,33792
AW a126,0
MF v[164:167],a[248:251],a[180:183],v[164:167]
s_add_u32 s45,s45,32
s_mul_i32 s10,s53,18
v_cmp_gt_i32 s[54:55],0,v4
MF v[168:171],a[248:251],a[184:187],v[168:171]
s_sub_u32 s10,s10,s45
TR a[220:221],v36,32768
AW a127,0
MF v[172:175],a[248:251],a[188:191],v[172:175]
LW 15
s_add_u32 s48,s48,16384
s_bfe_u32 m0,s48,0x110000
MF v[176:179],a[252:255],a[176:179],v[176:179]
TR a[222:223],v36,33792
v_cmp_gt_i32 s[56:57],2,v4
MF v[180:183],a[252:255],a[180:183],v[180:183]
s_cmp_lt_u32 s49,s45
s_cselect_b32 s8,s74,s84
s_cselect_b32 s9,s75,s85
MF v[184:187],a[252:255],a[184:187],v[184:187]
MF v[188:191],a[252:255],a[188:191],v[188:191]
LW 14
s_waitcnt vmcnt(13)
MF v[64:67],a[192:195],a[128:131],v[64:67]
s_movk_i32 s43,0
buffer_load_dwordx2 v[26:27],v49,s[24:27],s43 offen offset:2560 sc1
TR a[224:225],v29,40960
MF v[68:71],a[192:195],a[132:135],v[68:71]
s_cselect_b32 s44,s44,s10
s_add_u32 s44,s44,s49
v_cmp_gt_i32 s[58:59],4,v4
MF v[72:75],a[192:195],a[136:139],v[72:75]
s_mul_i32 s44,s44,36864
TR a[226:227],v29,41984
v_cmp_gt_i32 s[60:61],6,v4
MF v[76:79],a[192:195],a[140:143],v[76:79]
LW 14
TR a[228:229],v30,40960
s_lshl_b32 s45,s52,7
MF v[80:83],a[196:199],a[128:131],v[80:83]
s_add_u32 s44,s44,s45
s_movk_i32 s43,0
buffer_load_dwordx2 v[52:53],v49,s[24:27],s43 offen offset:3072 sc1
MF v[84:87],a[196:199],a[132:135],v[84:87]
s_add_u32 s8,s8,s44
s_addc_u32 s9,s9,0
v_cndmask_b32 v200,v200,v10,s[54:55]
MF v[88:91],a[196:199],a[136:139],v[88:91]
TR a[230:231],v30,41984
MF v[92:95],a[196:199],a[140:143],v[92:95]
LW 14
s_cmp_lt_u32 s51,200
s_cselect_b32 s10,35840,0
MF v[96:99],a[200:203],a[128:131],v[96:99]
s_movk_i32 s43,0
buffer_load_dwordx2 v[54:55],v49,s[24:27],s43 offen offset:3584 sc1
TR a[232:233],v31,40960
MF v[100:103],a[200:203],a[132:135],v[100:103]
s_mov_b32 s11,0x20000
TR a[234:235],v31,41984
v_cndmask_b32 v201,v201,v10,s[56:57]
MF v[104:107],a[200:203],a[136:139],v[104:107]
s_lshl_b32 s52,s52,2
v_cndmask_b32 v202,v202,v10,s[58:59]
MF v[108:111],a[200:203],a[140:143],v[108:111]
LW 14
s_movk_i32 s43,4096
TR a[236:237],v32,40960
MF v[112:115],a[204:207],a[128:131],v[112:115]
s_mul_i32 s45,s52,7282
s_lshr_b32 s45,s45,16
buffer_load_dwordx2 v[56:57],v49,s[24:27],s43 offen sc1
MF v[116:119],a[204:207],a[132:135],v[116:119]
s_lshl_b32 s44,s53,2
TR a[238:239],v32,41984
v_cndmask_b32 v203,v203,v10,s[60:61]
MF v[120:123],a[204:207],a[136:139],v[120:123]
s_add_u32 s44,s44,s45
MF v[124:127],a[204:207],a[140:143],v[124:127]
LW 14
s_movk_i32 s43,4096
TR a[240:241],v33,40960
MF v[128:131],a[208:211],a[128:131],v[128:131]
s_mul_i32 s44,s44,58
buffer_load_dwordx2 v[58:59],v49,s[24:27],s43 offen offset:512 sc1
v_add_u32 v4,4,v4
MF v[132:135],a[208:211],a[132:135],v[132:135]
s_add_u32 s44,s44,s49
TR a[242:243],v33,41984
MF v[136:139],a[208:211],a[136:139],v[136:139]
s_mul_i32 s45,s45,9
TR a[244:245],v34,40960
MF v[140:143],a[208:211],a[140:143],v[140:143]
LW 15
s_sub_u32 s52,s52,s45
v_cmp_gt_i32 s[54:55],1,v4
MF v[144:147],a[212:215],a[128:131],v[144:147]
s_mul_i32 s44,s44,9216
s_movk_i32 s43,4096
buffer_load_dwordx2 v[60:61],v49,s[24:27],s43 offen offset:1024 sc1
MF v[148:151],a[212:215],a[132:135],v[148:151]
s_and_b32 s53,s53,1
TR a[246:247],v34,41984
v_cmp_gt_i32 s[56:57],3,v4
MF v[152:155],a[212:215],a[136:139],v[152:155]
s_lshl_b32 s53,s53,2
TR a[248:249],v35,40960
MF v[156:159],a[212:215],a[140:143],v[156:159]
LW 15
buffer_load_dwordx4 v2,s[16:19],s48 offen sc1 lds
MF v[160:163],a[216:219],a[128:131],v[160:163]
s_cmp_lt_u32 s51,200
s_cselect_b32 s51,s44,0x70000000
TR a[250:251],v35,41984
MF v[164:167],a[216:219],a[132:135],v[164:167]
s_add_u32 s44,s52,s53
v_cmp_gt_i32 s[58:59],5,v4
MF v[168:171],a[216:219],a[136:139],v[168:171]
s_sub_u32 s45,s44,9
TR a[252:253],v36,40960
MF v[172:175],a[216:219],a[140:143],v[172:175]
LW 15
buffer_load_dwordx4 v2,s[16:19],s48 offen offset:1024 sc1 lds
v_cmp_gt_i32 s[60:61],7,v4
MF v[176:179],a[220:223],a[128:131],v[176:179]
s_min_u32 s44,s44,s45
s_lshl_b32 s44,s44,10
TR a[254:255],v36,41984
MF v[180:183],a[220:223],a[132:135],v[180:183]
s_add_u32 s72,s44,s51
MF v[184:187],a[220:223],a[136:139],v[184:187]
MF v[188:191],a[220:223],a[140:143],v[188:191]
LW 14
s_waitcnt vmcnt(17)
MF v[64:67],a[224:227],a[144:147],v[64:67]
s_add_u32 s52,s52,1
s_movk_i32 s43,4096
buffer_load_dwordx2 v[62:63],v49,s[24:27],s43 offen offset:1536 sc1
MF v[68:71],a[224:227],a[148:151],v[68:71]
v_cndmask_b32 v204,0,v9,s[54:55]
MF v[72:75],a[224:227],a[152:155],v[72:75]
s_cmp_eq_u32 s52,9
s_cselect_b32 s52,0,s52
s_cselect_b32 s44,534528,0
MF v[76:79],a[224:227],a[156:159],v[76:79]
LW 12
v_cndmask_b32 v205,0,v9,s[56:57]
MF v[80:83],a[228:231],a[144:147],v[80:83]
s_movk_i32 s43,4096
buffer_load_dwordx2 v[248:249],v49,s[24:27],s43 offen offset:2048 sc1
s_add_u32 s51,s51,s44
MF v[84:87],a[228:231],a[148:151],v[84:87]
s_add_u32 s44,s52,s53
v_cndmask_b32 v206,0,v9,s[58:59]
MF v[88:91],a[228:231],a[152:155],v[88:91]
s_sub_u32 s45,s44,9
MF v[92:95],a[228:231],a[156:159],v[92:95]
LW 10
v_cndmask_b32 v207,0,v9,s[60:61]
s_min_u32 s44,s44,s45
MF v[96:99],a[232:235],a[144:147],v[96:99]
s_movk_i32 s43,4096
buffer_load_dwordx2 v[250:251],v49,s[24:27],s43 offen offset:2560 sc1
s_lshl_b32 s44,s44,10
MF v[100:103],a[232:235],a[148:151],v[100:103]
s_add_u32 s73,s44,s51
MF v[104:107],a[232:235],a[152:155],v[104:107]
s_add_u32 s52,s52,1
v_cmp_gt_i32 s[54:55],0,v4
MF v[108:111],a[232:235],a[156:159],v[108:111]
LW 8
MF v[112:115],a[236:239],a[144:147],v[112:115]
s_cmp_eq_u32 s52,9
s_cselect_b32 s52,0,s52
s_cselect_b32 s44,534528,0
MF v[116:119],a[236:239],a[148:151],v[116:119]
s_movk_i32 s43,4096
buffer_load_dwordx2 v[40:41],v49,s[24:27],s43 offen offset:3072 sc1
v_cmp_gt_i32 s[56:57],2,v4
MF v[120:123],a[236:239],a[152:155],v[120:123]
s_add_u32 s51,s51,s44
MF v[124:127],a[236:239],a[156:159],v[124:127]
LW 6
s_add_u32 s44,s52,s53
v_cmp_gt_i32 s[58:59],4,v4
MF v[128:131],a[240:243],a[144:147],v[128:131]
s_sub_u32 s45,s44,9
MF v[132:135],a[240:243],a[148:151],v[132:135]
s_movk_i32 s43,4096
s_min_u32 s44,s44,s45
v_cmp_gt_i32 s[60:61],6,v4
MF v[136:139],a[240:243],a[152:155],v[136:139]
s_lshl_b32 s44,s44,10
buffer_load_dwordx2 v[42:43],v49,s[24:27],s43 offen offset:3584 sc1
MF v[140:143],a[240:243],a[156:159],v[140:143]
LW 4
s_add_u32 s76,s44,s51
MF v[144:147],a[244:247],a[144:147],v[144:147]
s_add_u32 s52,s52,1
v_cndmask_b32 v204,v204,v10,s[54:55]
MF v[148:151],a[244:247],a[148:151],v[148:151]
s_cmp_eq_u32 s52,9
s_cselect_b32 s52,0,s52
s_cselect_b32 s44,534528,0
MF v[152:155],a[244:247],a[152:155],v[152:155]
buffer_load_dwordx4 v2,s[16:19],s48 offen offset:2048 sc1 lds
v_cndmask_b32 v205,v205,v10,s[56:57]
MF v[156:159],a[244:247],a[156:159],v[156:159]
LW 2
MF v[160:163],a[248:251],a[144:147],v[160:163]
s_add_u32 s51,s51,s44
MF v[164:167],a[248:251],a[148:151],v[164:167]
s_add_u32 s44,s52,s53
v_cndmask_b32 v206,v206,v10,s[58:59]
MF v[168:171],a[248:251],a[152:155],v[168:171]
s_sub_u32 s45,s44,9
buffer_load_dwordx4 v2,s[16:19],s48 offen offset:3072 sc1 lds
MF v[172:175],a[248:251],a[156:159],v[172:175]
LW 0
s_min_u32 s44,s44,s45
v_cndmask_b32 v207,v207,v10,s[60:61]
MF v[176:179],a[252:255],a[144:147],v[176:179]
s_lshl_b32 s44,s44,10
MF v[180:183],a[252:255],a[148:151],v[180:183]
s_add_u32 s77,s44,s51
MF v[184:187],a[252:255],a[152:155],v[184:187]
MF v[188:191],a[252:255],a[156:159],v[188:191]
s_mov_b32 s40,0x3e0293ee
s_mov_b32 s41,0x3e0293ee
s_barrier
s_add_u32 s48,s48,16384
s_bfe_u32 m0,s48,0x110000
s_nop 0
buffer_load_dwordx4 v2,s[16:19],s48 offen sc1 lds
v_pk_mul_f32 v[64:65],v[64:65],s[40:41]
v_pk_mul_f32 v[66:67],v[66:67],s[40:41]
v_pk_mul_f32 v[80:81],v[80:81],s[40:41]
v_pk_mul_f32 v[82:83],v[82:83],s[40:41]
CV v64,v64,v65
CV v65,v66,v67
CV v66,v80,v81
CV v67,v82,v83
AW a128,v64
AW a129,v65
AW a130,v66
AW a131,v67
v_pk_mul_f32 v[96:97],v[96:97],s[40:41]
v_pk_mul_f32 v[98:99],v[98:99],s[40:41]
v_pk_mul_f32 v[112:113],v[112:113],s[40:41]
v_pk_mul_f32 v[114:115],v[114:115],s[40:41]
buffer_load_dwordx4 v2,s[16:19],s48 offen offset:1024 sc1 lds
CV v96,v96,v97
CV v97,v98,v99
CV v98,v112,v113
CV v99,v114,v115
AW a132,v96
AW a133,v97
AW a134,v98
AW a135,v99
v_pk_mul_f32 v[128:129],v[128:129],s[40:41]
v_pk_mul_f32 v[130:131],v[130:131],s[40:41]
v_pk_mul_f32 v[144:145],v[144:145],s[40:41]
v_pk_mul_f32 v[146:147],v[146:147],s[40:41]
CV v128,v128,v129
CV v129,v130,v131
CV v130,v144,v145
CV v131,v146,v147
buffer_load_dwordx4 v2,s[16:19],s48 offen offset:2048 sc1 lds
AW a136,v128
AW a137,v129
AW a138,v130
AW a139,v131
v_pk_mul_f32 v[160:161],v[160:161],s[40:41]
v_pk_mul_f32 v[162:163],v[162:163],s[40:41]
v_pk_mul_f32 v[176:177],v[176:177],s[40:41]
v_pk_mul_f32 v[178:179],v[178:179],s[40:41]
CV v160,v160,v161
CV v161,v162,v163
CV v162,v176,v177
CV v163,v178,v179
AW a140,v160
AW a141,v161
AW a142,v162
AW a143,v163
buffer_load_dwordx4 v2,s[16:19],s48 offen offset:3072 sc1 lds
v_pk_mul_f32 v[68:69],v[68:69],s[40:41]
v_pk_mul_f32 v[70:71],v[70:71],s[40:41]
v_pk_mul_f32 v[84:85],v[84:85],s[40:41]
v_pk_mul_f32 v[86:87],v[86:87],s[40:41]
CV v68,v68,v69
CV v69,v70,v71
CV v70,v84,v85
CV v71,v86,v87
AW a144,v68
AW a145,v69
AW a146,v70
AW a147,v71
v_pk_mul_f32 v[100:101],v[100:101],s[40:41]
v_pk_mul_f32 v[102:103],v[102:103],s[40:41]
v_pk_mul_f32 v[116:117],v[116:117],s[40:41]
v_pk_mul_f32 v[118:119],v[118:119],s[40:41]
s_add_u32 s48,s48,16384
s_bfe_u32 m0,s48,0x110000
s_nop 0
buffer_load_dwordx4 v2,s[16:19],s48 offen sc1 lds
CV v100,v100,v101
CV v101,v102,v103
CV v102,v116,v117
CV v103,v118,v119
AW a148,v100
AW a149,v101
AW a150,v102
AW a151,v103
v_pk_mul_f32 v[132:133],v[132:133],s[40:41]
v_pk_mul_f32 v[134:135],v[134:135],s[40:41]
v_pk_mul_f32 v[148:149],v[148:149],s[40:41]
v_pk_mul_f32 v[150:151],v[150:151],s[40:41]
CV v132,v132,v133
CV v133,v134,v135
CV v134,v148,v149
CV v135,v150,v151
buffer_load_dwordx4 v2,s[16:19],s48 offen offset:1024 sc1 lds
AW a152,v132
AW a153,v133
AW a154,v134
AW a155,v135
v_pk_mul_f32 v[164:165],v[164:165],s[40:41]
v_pk_mul_f32 v[166:167],v[166:167],s[40:41]
v_pk_mul_f32 v[180:181],v[180:181],s[40:41]
v_pk_mul_f32 v[182:183],v[182:183],s[40:41]
CV v164,v164,v165
CV v165,v166,v167
CV v166,v180,v181
CV v167,v182,v183
AW a156,v164
AW a157,v165
AW a158,v166
AW a159,v167
buffer_load_dwordx4 v2,s[16:19],s48 offen offset:2048 sc1 lds
v_pk_mul_f32 v[72:73],v[72:73],s[40:41]
v_pk_mul_f32 v[74:75],v[74:75],s[40:41]
v_pk_mul_f32 v[88:89],v[88:89],s[40:41]
v_pk_mul_f32 v[90:91],v[90:91],s[40:41]
CV v72,v72,v73
CV v73,v74,v75
CV v74,v88,v89
CV v75,v90,v91
AW a160,v72
AW a161,v73
AW a162,v74
AW a163,v75
v_pk_mul_f32 v[104:105],v[104:105],s[40:41]
v_pk_mul_f32 v[106:107],v[106:107],s[40:41]
v_pk_mul_f32 v[120:121],v[120:121],s[40:41]
v_pk_mul_f32 v[122:123],v[122:123],s[40:41]
buffer_load_dwordx4 v2,s[16:19],s48 offen offset:3072 sc1 lds
CV v104,v104,v105
CV v105,v106,v107
CV v106,v120,v121
CV v107,v122,v123
AW a164,v104
AW a165,v105
AW a166,v106
AW a167,v107
v_pk_mul_f32 v[136:137],v[136:137],s[40:41]
v_pk_mul_f32 v[138:139],v[138:139],s[40:41]
v_pk_mul_f32 v[152:153],v[152:153],s[40:41]
v_pk_mul_f32 v[154:155],v[154:155],s[40:41]
CV v136,v136,v137
CV v137,v138,v139
CV v138,v152,v153
CV v139,v154,v155
s_add_u32 s48,s48,16384
s_bfe_u32 m0,s48,0x110000
s_nop 0
buffer_load_dwordx4 v2,s[16:19],s48 offen sc1 lds
AW a168,v136
AW a169,v137
AW a170,v138
AW a171,v139
v_pk_mul_f32 v[168:169],v[168:169],s[40:41]
v_pk_mul_f32 v[170:171],v[170:171],s[40:41]
v_pk_mul_f32 v[184:185],v[184:185],s[40:41]
v_pk_mul_f32 v[186:187],v[186:187],s[40:41]
CV v168,v168,v169
CV v169,v170,v171
CV v170,v184,v185
CV v171,v186,v187
AW a172,v168
AW a173,v169
AW a174,v170
AW a175,v171
buffer_load_dwordx4 v2,s[16:19],s48 offen offset:1024 sc1 lds
v_pk_mul_f32 v[76:77],v[76:77],s[40:41]
v_pk_mul_f32 v[78:79],v[78:79],s[40:41]
v_pk_mul_f32 v[92:93],v[92:93],s[40:41]
v_pk_mul_f32 v[94:95],v[94:95],s[40:41]
CV v76,v76,v77
CV v77,v78,v79
CV v78,v92,v93
CV v79,v94,v95
AW a176,v76
AW a177,v77
AW a178,v78
AW a179,v79
v_pk_mul_f32 v[108:109],v[108:109],s[40:41]
v_pk_mul_f32 v[110:111],v[110:111],s[40:41]
v_pk_mul_f32 v[124:125],v[124:125],s[40:41]
v_pk_mul_f32 v[126:127],v[126:127],s[40:41]
buffer_load_dwordx4 v2,s[16:19],s48 offen offset:2048 sc1 lds
CV v108,v108,v109
CV v109,v110,v111
CV v110,v124,v125
CV v111,v126,v127
AW a180,v108
AW a181,v109
AW a182,v110
AW a183,v111
v_pk_mul_f32 v[140:141],v[140:141],s[40:41]
v_pk_mul_f32 v[142:143],v[142:143],s[40:41]
v_pk_mul_f32 v[156:157],v[156:157],s[40:41]
v_pk_mul_f32 v[158:159],v[158:159],s[40:41]
CV v140,v140,v141
CV v141,v142,v143
CV v142,v156,v157
CV v143,v158,v159
buffer_load_dwordx4 v2,s[16:19],s48 offen offset:3072 sc1 lds
AW a184,v140
AW a185,v141
AW a186,v142
AW a187,v143
v_pk_mul_f32 v[172:173],v[172:173],s[40:41]
v_pk_mul_f32 v[174:175],v[174:175],s[40:41]
v_pk_mul_f32 v[188:189],v[188:189],s[40:41]
v_pk_mul_f32 v[190:191],v[190:191],s[40:41]
CV v172,v172,v173
CV v173,v174,v175
CV v174,v188,v189
CV v175,v190,v191
AW a188,v172
AW a189,v173
AW a190,v174
AW a191,v175
s_mul_i32 s40,s34,589824
s_add_u32 s40,s40,0x35ffc00
s_add_u32 s28,s4,s40
s_addc_u32 s29,s5,0
s_mov_b32 s30,0x90400
s_mov_b32 s31,0x20000
s_lshl_b32 s42,s33,2
s_and_b32 s43,s32,1
s_lshl_b32 s43,s43,1
s_add_u32 s42,s42,s43
s_mul_i32 s42,s42,9216
s_lshr_b32 s43,s32,1
s_mul_i32 s44,s43,5120
s_add_u32 s42,s42,s44
s_and_b32 s44,s34,1
s_xor_b32 s41,s44,1
s_lshl_b32 s41,s41,10
s_add_u32 s42,s42,s41
v_add_u32 v29,s42,v2
s_andn2_b32 s44,s44,s43
s_mul_i32 s44,s44,9216
v_add_u32 v31,s44,v29
s_lshl_b32 s43,s43,31
v_add_u32 v30,s43,v29
s_waitcnt vmcnt(14)
v_pk_add_f32 v[16:17],v[16:17],v[20:21]
v_pk_add_f32 v[18:19],v[18:19],v[22:23]
v_pk_add_f32 v[16:17],v[16:17],v[24:25]
v_pk_add_f32 v[18:19],v[18:19],v[26:27]
v_pk_add_f32 v[16:17],v[16:17],v[52:53]
v_pk_add_f32 v[18:19],v[18:19],v[54:55]
v_pk_add_f32 v[16:17],v[16:17],v[56:57]
v_pk_add_f32 v[18:19],v[18:19],v[58:59]
v_pk_add_f32 v[16:17],v[16:17],v[60:61]
v_pk_add_f32 v[18:19],v[18:19],v[62:63]
v_pk_add_f32 v[16:17],v[16:17],v[248:249]
v_pk_add_f32 v[18:19],v[18:19],v[250:251]
v_pk_add_f32 v[16:17],v[16:17],v[40:41]
v_pk_add_f32 v[18:19],v[18:19],v[42:43]
v_add_f32 v64,v16,v18
v_add_f32 v65,v17,v19
v_mul_f32 v64,0x39e38e39,v64
v_mul_f32 v65,0x39e38e39,v65
v_fma_f32 v65,-v64,v64,v65
v_max_f32 v65,0,v65
CV v65,v64,v65
v_lshlrev_b32 v23,16,v65
v_and_b32 v24,0xffff0000,v65
v_add_f32 v24,0x3727c5ac,v24
CV v24,v24,v24
v_and_b32 v24,0xffff0000,v24
v_sqrt_f32 v24,v24
s_nop 0
CV v24,v24,v24
v_and_b32 v24,0xffff0000,v24
v_rcp_f32 v24,v24
s_nop 0
v_mul_f32 v23,v23,v24
v_sub_f32 v23,0,v23
s_nop 1
v_mov_b32_dpp v80,v24 row_newbcast:0 row_mask:0xf bank_mask:0xf
v_mov_b32_dpp v96,v23 row_newbcast:0 row_mask:0xf bank_mask:0xf
v_mov_b32_dpp v81,v24 row_newbcast:1 row_mask:0xf bank_mask:0xf
v_mov_b32_dpp v97,v23 row_newbcast:1 row_mask:0xf bank_mask:0xf
v_mov_b32_dpp v82,v24 row_newbcast:2 row_mask:0xf bank_mask:0xf
v_mov_b32_dpp v98,v23 row_newbcast:2 row_mask:0xf bank_mask:0xf
v_mov_b32_dpp v83,v24 row_newbcast:3 row_mask:0xf bank_mask:0xf
v_mov_b32_dpp v99,v23 row_newbcast:3 row_mask:0xf bank_mask:0xf
v_mov_b32_dpp v84,v24 row_newbcast:4 row_mask:0xf bank_mask:0xf
v_mov_b32_dpp v100,v23 row_newbcast:4 row_mask:0xf bank_mask:0xf
v_mov_b32_dpp v85,v24 row_newbcast:5 row_mask:0xf bank_mask:0xf
v_mov_b32_dpp v101,v23 row_newbcast:5 row_mask:0xf bank_mask:0xf
v_mov_b32_dpp v86,v24 row_newbcast:6 row_mask:0xf bank_mask:0xf
v_mov_b32_dpp v102,v23 row_newbcast:6 row_mask:0xf bank_mask:0xf
v_mov_b32_dpp v87,v24 row_newbcast:7 row_mask:0xf bank_mask:0xf
v_mov_b32_dpp v103,v23 row_newbcast:7 row_mask:0xf bank_mask:0xf
v_mov_b32_dpp v88,v24 row_newbcast:8 row_mask:0xf bank_mask:0xf
v_mov_b32_dpp v104,v23 row_newbcast:8 row_mask:0xf bank_mask:0xf
v_mov_b32_dpp v89,v24 row_newbcast:9 row_mask:0xf bank_mask:0xf
v_mov_b32_dpp v105,v23 row_newbcast:9 row_mask:0xf bank_mask:0xf
v_mov_b32_dpp v90,v24 row_newbcast:10 row_mask:0xf bank_mask:0xf
v_mov_b32_dpp v106,v23 row_newbcast:10 row_mask:0xf bank_mask:0xf
v_mov_b32_dpp v91,v24 row_newbcast:11 row_mask:0xf bank_mask:0xf
v_mov_b32_dpp v107,v23 row_newbcast:11 row_mask:0xf bank_mask:0xf
v_mov_b32_dpp v92,v24 row_newbcast:12 row_mask:0xf bank_mask:0xf
v_mov_b32_dpp v108,v23 row_newbcast:12 row_mask:0xf bank_mask:0xf
v_mov_b32_dpp v93,v24 row_newbcast:13 row_mask:0xf bank_mask:0xf
v_mov_b32_dpp v109,v23 row_newbcast:13 row_mask:0xf bank_mask:0xf
v_mov_b32_dpp v94,v24 row_newbcast:14 row_mask:0xf bank_mask:0xf
v_mov_b32_dpp v110,v23 row_newbcast:14 row_mask:0xf bank_mask:0xf
v_mov_b32_dpp v95,v24 row_newbcast:15 row_mask:0xf bank_mask:0xf
v_mov_b32_dpp v111,v23 row_newbcast:15 row_mask:0xf bank_mask:0xf
v_mov_b32 v249,v29
v_mov_b32 v250,v30
v_mov_b32 v251,v31
v_lshlrev_b32 v64,16,v208
v_and_b32 v65,0xffff0000,v208
v_lshlrev_b32 v66,16,v209
v_and_b32 v67,0xffff0000,v209
v_lshlrev_b32 v68,16,v210
v_and_b32 v69,0xffff0000,v210
v_lshlrev_b32 v70,16,v211
v_and_b32 v71,0xffff0000,v211
v_pk_fma_f32 v[64:65],v[64:65],v[80:81],v[96:97]
v_pk_fma_f32 v[66:67],v[66:67],v[82:83],v[98:99]
v_pk_fma_f32 v[68:69],v[68:69],v[84:85],v[100:101]
v_pk_fma_f32 v[70:71],v[70:71],v[86:87],v[102:103]
CV v208,v64,v65
CV v209,v66,v67
CV v210,v68,v69
CV v211,v70,v71
s_movk_i32 s43,0
buffer_store_dwordx4 v[208:211],v251,s[28:31],s43 offen sc1
v_lshlrev_b32 v72,16,v212
v_and_b32 v73,0xffff0000,v212
v_lshlrev_b32 v74,16,v213
v_and_b32 v75,0xffff0000,v213
v_lshlrev_b32 v76,16,v214
v_and_b32 v77,0xffff0000,v214
v_lshlrev_b32 v78,16,v215
v_and_b32 v79,0xffff0000,v215
v_pk_fma_f32 v[72:73],v[72:73],v[80:81],v[96:97]
v_pk_fma_f32 v[74:75],v[74:75],v[82:83],v[98:99]
v_pk_fma_f32 v[76:77],v[76:77],v[84:85],v[100:101]
v_pk_fma_f32 v[78:79],v[78:79],v[86:87],v[102:103]
CV v212,v72,v73
CV v213,v74,v75
CV v214,v76,v77
CV v215,v78,v79
s_movk_i32 s43,1024
buffer_store_dwordx4 v[212:215],v249,s[28:31],s43 offen sc1
v_lshlrev_b32 v64,16,v216
v_and_b32 v65,0xffff0000,v216
v_lshlrev_b32 v66,16,v217
v_and_b32 v67,0xffff0000,v217
v_lshlrev_b32 v68,16,v218
v_and_b32 v69,0xffff0000,v218
v_lshlrev_b32 v70,16,v219
v_and_b32 v71,0xffff0000,v219
v_pk_fma_f32 v[64:65],v[64:65],v[80:81],v[96:97]
v_pk_fma_f32 v[66:67],v[66:67],v[82:83],v[98:99]
v_pk_fma_f32 v[68:69],v[68:69],v[84:85],v[100:101]
v_pk_fma_f32 v[70:71],v[70:71],v[86:87],v[102:103]
CV v216,v64,v65
CV v217,v66,v67
CV v218,v68,v69
CV v219,v70,v71
s_movk_i32 s43,2048
buffer_store_dwordx4 v[216:219],v249,s[28:31],s43 offen sc1
v_lshlrev_b32 v72,16,v220
v_and_b32 v73,0xffff0000,v220
v_lshlrev_b32 v74,16,v221
v_and_b32 v75,0xffff0000,v221
v_lshlrev_b32 v76,16,v222
v_and_b32 v77,0xffff0000,v222
v_lshlrev_b32 v78,16,v223
v_and_b32 v79,0xffff0000,v223
v_pk_fma_f32 v[72:73],v[72:73],v[80:81],v[96:97]
v_pk_fma_f32 v[74:75],v[74:75],v[82:83],v[98:99]
v_pk_fma_f32 v[76:77],v[76:77],v[84:85],v[100:101]
v_pk_fma_f32 v[78:79],v[78:79],v[86:87],v[102:103]
CV v220,v72,v73
CV v221,v74,v75
CV v222,v76,v77
CV v223,v78,v79
s_movk_i32 s43,3072
buffer_store_dwordx4 v[220:223],v249,s[28:31],s43 offen sc1
v_lshlrev_b32 v64,16,v224
v_and_b32 v65,0xffff0000,v224
v_lshlrev_b32 v66,16,v225
v_and_b32 v67,0xffff0000,v225
v_lshlrev_b32 v68,16,v226
v_and_b32 v69,0xffff0000,v226
v_lshlrev_b32 v70,16,v227
v_and_b32 v71,0xffff0000,v227
v_pk_fma_f32 v[64:65],v[64:65],v[80:81],v[96:97]
v_pk_fma_f32 v[66:67],v[66:67],v[82:83],v[98:99]
v_pk_fma_f32 v[68:69],v[68:69],v[84:85],v[100:101]
v_pk_fma_f32 v[70:71],v[70:71],v[86:87],v[102:103]
CV v224,v64,v65
CV v225,v66,v67
CV v226,v68,v69
CV v227,v70,v71
s_movk_i32 s43,4096
buffer_store_dwordx4 v[224:227],v250,s[28:31],s43 offen sc1
v_lshlrev_b32 v64,16,v228
v_and_b32 v65,0xffff0000,v228
v_lshlrev_b32 v66,16,v229
v_and_b32 v67,0xffff0000,v229
v_lshlrev_b32 v68,16,v230
v_and_b32 v69,0xffff0000,v230
v_lshlrev_b32 v70,16,v231
v_and_b32 v71,0xffff0000,v231
v_pk_fma_f32 v[64:65],v[64:65],v[88:89],v[104:105]
v_pk_fma_f32 v[66:67],v[66:67],v[90:91],v[106:107]
v_pk_fma_f32 v[68:69],v[68:69],v[92:93],v[108:109]
v_pk_fma_f32 v[70:71],v[70:71],v[94:95],v[110:111]
CV v228,v64,v65
CV v229,v66,v67
CV v230,v68,v69
CV v231,v70,v71
s_movk_i32 s43,9216
buffer_store_dwordx4 v[228:231],v251,s[28:31],s43 offen sc1
v_lshlrev_b32 v72,16,v232
v_and_b32 v73,0xffff0000,v232
v_lshlrev_b32 v74,16,v233
v_and_b32 v75,0xffff0000,v233
v_lshlrev_b32 v76,16,v234
v_and_b32 v77,0xffff0000,v234
v_lshlrev_b32 v78,16,v235
v_and_b32 v79,0xffff0000,v235
v_pk_fma_f32 v[72:73],v[72:73],v[88:89],v[104:105]
v_pk_fma_f32 v[74:75],v[74:75],v[90:91],v[106:107]
v_pk_fma_f32 v[76:77],v[76:77],v[92:93],v[108:109]
v_pk_fma_f32 v[78:79],v[78:79],v[94:95],v[110:111]
CV v232,v72,v73
CV v233,v74,v75
CV v234,v76,v77
CV v235,v78,v79
s_movk_i32 s43,10240
buffer_store_dwordx4 v[232:235],v249,s[28:31],s43 offen sc1
v_lshlrev_b32 v64,16,v236
v_and_b32 v65,0xffff0000,v236
v_lshlrev_b32 v66,16,v237
v_and_b32 v67,0xffff0000,v237
v_lshlrev_b32 v68,16,v238
v_and_b32 v69,0xffff0000,v238
v_lshlrev_b32 v70,16,v239
v_and_b32 v71,0xffff0000,v239
v_pk_fma_f32 v[64:65],v[64:65],v[88:89],v[104:105]
v_pk_fma_f32 v[66:67],v[66:67],v[90:91],v[106:107]
v_pk_fma_f32 v[68:69],v[68:69],v[92:93],v[108:109]
v_pk_fma_f32 v[70:71],v[70:71],v[94:95],v[110:111]
CV v236,v64,v65
CV v237,v66,v67
CV v238,v68,v69
CV v239,v70,v71
s_movk_i32 s43,11264
buffer_store_dwordx4 v[236:239],v249,s[28:31],s43 offen sc1
v_lshlrev_b32 v72,16,v240
v_and_b32 v73,0xffff0000,v240
v_lshlrev_b32 v74,16,v241
v_and_b32 v75,0xffff0000,v241
v_lshlrev_b32 v76,16,v242
v_and_b32 v77,0xffff0000,v242
v_lshlrev_b32 v78,16,v243
v_and_b32 v79,0xffff0000,v243
v_pk_fma_f32 v[72:73],v[72:73],v[88:89],v[104:105]
v_pk_fma_f32 v[74:75],v[74:75],v[90:91],v[106:107]
v_pk_fma_f32 v[76:77],v[76:77],v[92:93],v[108:109]
v_pk_fma_f32 v[78:79],v[78:79],v[94:95],v[110:111]
CV v240,v72,v73
CV v241,v74,v75
CV v242,v76,v77
CV v243,v78,v79
s_movk_i32 s43,12288
buffer_store_dwordx4 v[240:243],v249,s[28:31],s43 offen sc1
v_lshlrev_b32 v64,16,v244
v_and_b32 v65,0xffff0000,v244
v_lshlrev_b32 v66,16,v245
v_and_b32 v67,0xffff0000,v245
v_lshlrev_b32 v68,16,v246
v_and_b32 v69,0xffff0000,v246
v_lshlrev_b32 v70,16,v247
v_and_b32 v71,0xffff0000,v247
v_pk_fma_f32 v[64:65],v[64:65],v[88:89],v[104:105]
v_pk_fma_f32 v[66:67],v[66:67],v[90:91],v[106:107]
v_pk_fma_f32 v[68:69],v[68:69],v[92:93],v[108:109]
v_pk_fma_f32 v[70:71],v[70:71],v[94:95],v[110:111]
CV v244,v64,v65
CV v245,v66,v67
CV v246,v68,v69
CV v247,v70,v71
s_movk_i32 s43,13312
buffer_store_dwordx4 v[244:247],v250,s[28:31],s43 offen sc1
Lm_att:
s_add_u32 s20,s4,0x4000000
s_addc_u32 s21,s5,0
s_mov_b32 s22,0x1900000
s_mov_b32 s23,0x20000
v_mov_b32 v6,0
v_add_u32 v4,0x10000,v2
s_lshl_b32 s40,s36,2
s_add_u32 s41,s40,s32
s_lshl_b32 s41,s41,5
s_sub_u32 s51,0,s41
s_sub_u32 s41,60,s40
s_add_u32 s41,s41,s32
s_lshl_b32 s41,s41,5
s_sub_u32 s50,0,s41
s_lshl_b32 s40,s36,3
s_lshl_b32 s41,s32,1
s_add_u32 s42,s40,s41
s_sub_u32 s43,120,s40
s_add_u32 s43,s43,s41
s_mul_i32 s52,s43,204800
s_mul_i32 s53,s42,204800
s_lshl_b32 s40,s35,12
s_add_u32 s52,s52,s40
s_add_u32 s53,s53,s40
s_waitcnt vmcnt(24)
s_barrier
RD a[192:195],v4,0
RD a[196:199],v4,1024
RD a[200:203],v4,2048
RD a[204:207],v4,3072
RD a[208:211],v4,4096
RD a[212:215],v4,5120
RD a[216:219],v4,6144
RD a[220:223],v4,7168
s_cmp_gt_i32 s51,0
s_cselect_b32 s55,0xff7fff7f,0
s_cmp_eq_u32 s51,0
s_cselect_b32 s54,-1,0
v_mov_b32 v3,s55
v_and_or_b32 v40,v200,s54,v3
v_and_or_b32 v41,v201,s54,v3
v_and_or_b32 v42,v202,s54,v3
v_and_or_b32 v43,v203,s54,v3
v_and_or_b32 v44,v204,s54,v3
v_and_or_b32 v45,v205,s54,v3
v_and_or_b32 v46,v206,s54,v3
v_and_or_b32 v47,v207,s54,v3
s_add_u32 s50,s50,32
s_add_u32 s51,s51,32
LW 0
MF v[48:51],a[192:195],a[128:131],0
v_mov_b32 v144,0
MF v[48:51],a[196:199],a[132:135],v[48:51]
v_mov_b32 v145,0
MF v[48:51],a[200:203],a[136:139],v[48:51]
MF v[48:51],a[204:207],a[140:143],v[48:51]
v_mov_b32 v146,0
MF v[52:55],a[208:211],a[128:131],0
MF v[52:55],a[212:215],a[132:135],v[52:55]
v_mov_b32 v147,0
MF v[52:55],a[216:219],a[136:139],v[52:55]
MF v[52:55],a[220:223],a[140:143],v[52:55]
v_mov_b32 v148,0
MF v[56:59],a[192:195],a[144:147],0
MF v[56:59],a[196:199],a[148:151],v[56:59]
v_mov_b32 v149,0
MF v[56:59],a[200:203],a[152:155],v[56:59]
v_mov_b32 v150,0
MF v[56:59],a[204:207],a[156:159],v[56:59]
MF v[60:63],a[208:211],a[144:147],0
v_mov_b32 v151,0
MF v[60:63],a[212:215],a[148:151],v[60:63]
MF v[60:63],a[216:219],a[152:155],v[60:63]
v_mov_b32 v152,0
MF v[60:63],a[220:223],a[156:159],v[60:63]
MF v[64:67],v[192:195],v[40:43],0
v_mov_b32 v153,0
MF v[64:67],a[192:195],a[160:163],v[64:67]
MF v[64:67],a[196:199],a[164:167],v[64:67]
v_mov_b32 v154,0
MF v[64:67],a[200:203],a[168:171],v[64:67]
v_mov_b32 v155,0
MF v[64:67],a[204:207],a[172:175],v[64:67]
MF v[68:71],v[196:199],v[40:43],0
v_mov_b32 v156,0
MF v[68:71],a[208:211],a[160:163],v[68:71]
MF v[68:71],a[212:215],a[164:167],v[68:71]
v_mov_b32 v157,0
MF v[68:71],a[216:219],a[168:171],v[68:71]
MF v[68:71],a[220:223],a[172:175],v[68:71]
v_mov_b32 v158,0
MF v[72:75],v[192:195],v[44:47],0
MF v[72:75],a[192:195],a[176:179],v[72:75]
v_mov_b32 v159,0
MF v[72:75],a[196:199],a[180:183],v[72:75]
v_mov_b32 v160,0x3f803f80
MF v[72:75],a[200:203],a[184:187],v[72:75]
MF v[72:75],a[204:207],a[188:191],v[72:75]
v_mov_b32 v161,0x3f803f80
MF v[76:79],v[196:199],v[44:47],0
MF v[76:79],a[208:211],a[176:179],v[76:79]
v_mov_b32 v162,0x3f803f80
MF v[76:79],a[212:215],a[180:183],v[76:79]
MF v[76:79],a[216:219],a[184:187],v[76:79]
v_mov_b32 v163,0x3f803f80
MF v[76:79],a[220:223],a[188:191],v[76:79]
s_nop 3
v_max3_f32 v164,v48,v49,v50
v_max3_f32 v166,v56,v57,v58
v_max3_f32 v168,v64,v65,v66
v_max3_f32 v170,v72,v73,v74
v_max3_f32 v165,v51,v52,v53
v_max3_f32 v167,v59,v60,v61
v_max3_f32 v169,v67,v68,v69
v_max3_f32 v171,v75,v76,v77
v_max3_f32 v164,v164,v54,v55
v_max3_f32 v166,v166,v62,v63
v_max3_f32 v168,v168,v70,v71
v_max3_f32 v170,v170,v78,v79
v_max_f32 v164,v164,v165
v_max_f32 v166,v166,v167
v_max_f32 v168,v168,v169
v_max_f32 v170,v170,v171
v_mov_b32 v165,v164
v_mov_b32 v167,v166
v_mov_b32 v169,v168
v_mov_b32 v171,v170
v_permlane16_swap_b32 v164,v165
v_permlane16_swap_b32 v166,v167
v_permlane16_swap_b32 v168,v169
v_permlane16_swap_b32 v170,v171
v_max_f32 v164,v164,v165
v_max_f32 v166,v166,v167
v_max_f32 v168,v168,v169
v_max_f32 v170,v170,v171
v_mov_b32 v165,v164
v_mov_b32 v167,v166
v_mov_b32 v169,v168
v_mov_b32 v171,v170
v_permlane32_swap_b32 v164,v165
v_permlane32_swap_b32 v166,v167
v_permlane32_swap_b32 v168,v169
v_permlane32_swap_b32 v170,v171
v_max_f32 v164,v164,v165
v_max_f32 v166,v166,v167
v_max_f32 v168,v168,v169
v_max_f32 v170,v170,v171
v_add_f32 v164,0x41c00000,v164
v_add_f32 v166,0x41c00000,v166
v_add_f32 v168,0x41c00000,v168
v_add_f32 v170,0x41c00000,v170
v_sub_f32 v16,0,v164
v_sub_f32 v20,0,v166
v_sub_f32 v24,0,v168
v_sub_f32 v28,0,v170
v_sub_f32 v17,0,v164
v_sub_f32 v21,0,v166
v_sub_f32 v25,0,v168
v_sub_f32 v29,0,v170
v_sub_f32 v18,0,v164
v_sub_f32 v22,0,v166
v_sub_f32 v26,0,v168
v_sub_f32 v30,0,v170
v_sub_f32 v19,0,v164
v_sub_f32 v23,0,v166
v_sub_f32 v27,0,v168
v_sub_f32 v31,0,v170
v_sub_f32 v48,v48,v164
v_sub_f32 v56,v56,v166
v_sub_f32 v64,v64,v168
v_sub_f32 v72,v72,v170
v_sub_f32 v49,v49,v164
v_sub_f32 v57,v57,v166
v_sub_f32 v65,v65,v168
v_sub_f32 v73,v73,v170
v_sub_f32 v50,v50,v164
v_sub_f32 v58,v58,v166
v_sub_f32 v66,v66,v168
v_sub_f32 v74,v74,v170
v_sub_f32 v51,v51,v164
v_sub_f32 v59,v59,v166
v_sub_f32 v67,v67,v168
v_sub_f32 v75,v75,v170
v_sub_f32 v52,v52,v164
v_sub_f32 v60,v60,v166
v_sub_f32 v68,v68,v168
v_sub_f32 v76,v76,v170
v_sub_f32 v53,v53,v164
v_sub_f32 v61,v61,v166
v_sub_f32 v69,v69,v168
v_sub_f32 v77,v77,v170
v_sub_f32 v54,v54,v164
v_sub_f32 v62,v62,v166
v_sub_f32 v70,v70,v168
v_sub_f32 v78,v78,v170
v_sub_f32 v55,v55,v164
v_sub_f32 v63,v63,v166
v_sub_f32 v71,v71,v168
v_sub_f32 v79,v79,v170
v_add_u32 v5,0x4000,v4
v_and_b32 v5,0x1ffff,v5
RD a[192:195],v5,0
RD a[196:199],v5,1024
RD a[200:203],v5,2048
RD a[204:207],v5,3072
RD a[208:211],v5,4096
RD a[212:215],v5,5120
RD a[216:219],v5,6144
RD a[220:223],v5,7168
s_cmp_gt_i32 s51,0
s_cselect_b32 s55,0xff7fff7f,0
s_cmp_eq_u32 s51,0
s_cselect_b32 s54,-1,0
v_mov_b32 v3,s55
v_and_or_b32 v40,v200,s54,v3
v_and_or_b32 v41,v201,s54,v3
v_and_or_b32 v42,v202,s54,v3
v_and_or_b32 v43,v203,s54,v3
v_and_or_b32 v44,v204,s54,v3
v_and_or_b32 v45,v205,s54,v3
v_and_or_b32 v46,v206,s54,v3
v_and_or_b32 v47,v207,s54,v3
LW 0
MF v[80:83],a[192:195],a[128:131],v[16:19]
v_exp_f32 v164,v48
MF v[80:83],a[196:199],a[132:135],v[80:83]
s_add_u32 m0,s63,0
v_exp_f32 v165,v49
MF v[80:83],a[200:203],a[136:139],v[80:83]
s_movk_i32 s41,0
buffer_load_dwordx4 v14,s[12:15],s41 offen nt lds
RD a[224:227],v4,8192
MF v[80:83],a[204:207],a[140:143],v[80:83]
RD a[228:231],v4,9216
CV v112,v164,v165
MF v[84:87],a[208:211],a[128:131],v[16:19]
s_movk_i32 s41,8192
v_exp_f32 v166,v50
MF v[84:87],a[212:215],a[132:135],v[84:87]
v_exp_f32 v167,v51
MF v[84:87],a[216:219],a[136:139],v[84:87]
RD a[232:235],v4,10240
CV v113,v166,v167
MF v[84:87],a[220:223],a[140:143],v[84:87]
buffer_load_dwordx4 v14,s[12:15],s41 offen offset:1024 nt lds
v_or3_b32 v6,v6,v112,v113
MF v[88:91],a[192:195],a[144:147],v[20:23]
s_movk_i32 s41,16384
v_exp_f32 v168,v52
MF v[88:91],a[196:199],a[148:151],v[88:91]
v_exp_f32 v169,v53
MF v[88:91],a[200:203],a[152:155],v[88:91]
RD a[236:239],v4,11264
CV v114,v168,v169
MF v[88:91],a[204:207],a[156:159],v[88:91]
v_exp_f32 v170,v54
MF v[92:95],a[208:211],a[144:147],v[20:23]
RD a[240:243],v4,12288
buffer_load_dwordx4 v14,s[12:15],s41 offen offset:2048 nt lds
MF v[92:95],a[212:215],a[148:151],v[92:95]
s_movk_i32 s41,24576
v_exp_f32 v171,v55
MF v[92:95],a[216:219],a[152:155],v[92:95]
CV v115,v170,v171
v_or3_b32 v6,v6,v114,v115
MF v[92:95],a[220:223],a[156:159],v[92:95]
v_exp_f32 v172,v56
MF v[96:99],v[192:195],v[40:43],v[24:27]
v_exp_f32 v173,v57
MF v[96:99],a[192:195],a[160:163],v[96:99]
RD a[244:247],v4,13312
CV v116,v172,v173
MF v[96:99],a[196:199],a[164:167],v[96:99]
v_exp_f32 v174,v58
MF v[96:99],a[200:203],a[168:171],v[96:99]
RD a[248:251],v4,14336
buffer_load_dwordx4 v14,s[12:15],s41 offen offset:3072 nt lds
MF v[96:99],a[204:207],a[172:175],v[96:99]
s_add_u32 m0,s63,4096
v_exp_f32 v175,v59
MF v[100:103],v[196:199],v[40:43],v[24:27]
s_movk_i32 s41,0
CV v117,v174,v175
v_or3_b32 v6,v6,v116,v117
MF v[100:103],a[208:211],a[160:163],v[100:103]
buffer_load_dwordx4 v14,s[8:11],s41 offen nt lds
RD a[252:255],v4,15360
MF v[100:103],a[212:215],a[164:167],v[100:103]
s_movk_i32 s41,8192
v_exp_f32 v176,v60
MF v[100:103],a[216:219],a[168:171],v[100:103]
v_exp_f32 v177,v61
MF v[100:103],a[220:223],a[172:175],v[100:103]
buffer_load_dwordx4 v14,s[8:11],s41 offen offset:1024 nt lds
CV v118,v176,v177
MF v[104:107],v[192:195],v[44:47],v[28:31]
s_movk_i32 s41,16384
v_exp_f32 v178,v62
MF v[104:107],a[192:195],a[176:179],v[104:107]
v_exp_f32 v179,v63
MF v[104:107],a[196:199],a[180:183],v[104:107]
CV v119,v178,v179
v_or3_b32 v6,v6,v118,v119
MF v[104:107],a[200:203],a[184:187],v[104:107]
v_exp_f32 v164,v64
MF v[104:107],a[204:207],a[188:191],v[104:107]
v_exp_f32 v165,v65
MF v[108:111],v[196:199],v[44:47],v[28:31]
buffer_load_dwordx4 v14,s[8:11],s41 offen offset:2048 nt lds
CV v120,v164,v165
MF v[108:111],a[208:211],a[176:179],v[108:111]
s_movk_i32 s41,24576
v_exp_f32 v166,v66
MF v[108:111],a[212:215],a[180:183],v[108:111]
v_exp_f32 v167,v67
v_exp_f32 v168,v68
v_exp_f32 v169,v69
v_exp_f32 v170,v70
v_exp_f32 v171,v71
v_exp_f32 v172,v72
v_exp_f32 v173,v73
v_exp_f32 v174,v74
v_exp_f32 v175,v75
v_exp_f32 v176,v76
v_exp_f32 v177,v77
v_exp_f32 v178,v78
v_exp_f32 v179,v79
MF v[108:111],a[216:219],a[184:187],v[108:111]
s_add_u32 s50,s50,32
buffer_load_dwordx4 v14,s[8:11],s41 offen offset:3072 nt lds
CV v121,v166,v167
v_or3_b32 v6,v6,v120,v121
CV v122,v168,v169
CV v123,v170,v171
v_or3_b32 v6,v6,v122,v123
CV v124,v172,v173
CV v125,v174,v175
v_or3_b32 v6,v6,v124,v125
CV v126,v176,v177
CV v127,v178,v179
v_or3_b32 v6,v6,v126,v127
v_and_b32 v15,0x40004000,v6
v_cmp_ne_u32 vcc,0,v15
MF v[108:111],a[220:223],a[188:191],v[108:111]
s_cbranch_vccnz Lm_fx10
Lm_fx10r:
s_add_u32 s51,s51,32
s_waitcnt vmcnt(8)
s_lshl_b32 s42,s34,4
s_add_u32 s42,s42,s33
s_lshl_b32 s7,s42,4
s_lshl_b32 s41,s32,2
s_add_u32 s7,s7,s41
s_add_u32 s7,s7,0x8303000
v_mov_b32 v11,s7
v_mov_b32 v12,s3
global_store_dword v11,v12,s[4:5] sc1
s_lshl_b32 s42,s33,4
s_add_u32 s42,s42,s34
s_lshl_b32 s7,s42,4
s_lshl_b32 s41,s32,2
s_add_u32 s7,s7,s41
s_add_u32 s7,s7,0x8306000
v_mov_b32 v11,s7
v_mov_b32 v12,s3
global_store_dword v11,v12,s[4:5] sc1
s_lshl_b32 s62,s36,1
s_cmp_eq_u32 s62,0
s_mov_b32 s63,0
s_cbranch_scc1 Lm_DM12
s_sub_u32 s62,s62,1
s_lshl_b32 s40,s62,6
s_add_u32 s50,s50,s40
s_add_u32 s51,s51,s40
s_sub_u32 s62,s62,1
s_mov_b32 s63,1
.p2align 5
Lm_D11:
LW 7
MF a[0:3],a[224:227],v[112:115],a[0:3]
s_barrier
v_exp_f32 v164,v80
MF a[32:35],a[224:227],v[116:119],a[32:35]
v_add_u32 v4,0x4000,v5
v_and_b32 v4,0x1ffff,v4
MF a[64:67],a[224:227],v[120:123],a[64:67]
s_add_u32 s48,s48,16384
s_bfe_u32 m0,s48,0x110000
MF a[96:99],a[224:227],v[124:127],a[96:99]
LW 6
v_exp_f32 v165,v81
MF a[4:7],a[228:231],v[112:115],a[4:7]
RD a[192:195],v4,0
CV v128,v164,v165
MF a[36:39],a[228:231],v[116:119],a[36:39]
v_exp_f32 v166,v82
MF a[68:71],a[228:231],v[120:123],a[68:71]
RD a[196:199],v4,1024
MF a[100:103],a[228:231],v[124:127],a[100:103]
LW 7
v_exp_f32 v167,v83
MF a[8:11],a[232:235],v[112:115],a[8:11]
CV v129,v166,v167
v_or3_b32 v6,v6,v128,v129
MF a[40:43],a[232:235],v[116:119],a[40:43]
RD a[200:203],v4,2048
MF a[72:75],a[232:235],v[120:123],a[72:75]
v_exp_f32 v168,v84
MF a[104:107],a[232:235],v[124:127],a[104:107]
LW 7
v_exp_f32 v169,v85
MF a[12:15],a[236:239],v[112:115],a[12:15]
RD a[204:207],v4,3072
CV v130,v168,v169
MF a[44:47],a[236:239],v[116:119],a[44:47]
v_exp_f32 v170,v86
MF a[76:79],a[236:239],v[120:123],a[76:79]
RD a[208:211],v4,4096
MF a[108:111],a[236:239],v[124:127],a[108:111]
LW 8
v_exp_f32 v171,v87
MF a[16:19],a[240:243],v[112:115],a[16:19]
CV v131,v170,v171
v_or3_b32 v6,v6,v130,v131
MF a[48:51],a[240:243],v[116:119],a[48:51]
buffer_load_dwordx4 v2,s[16:19],s48 offen sc1 lds
RD a[212:215],v4,5120
MF a[80:83],a[240:243],v[120:123],a[80:83]
v_exp_f32 v172,v88
MF a[112:115],a[240:243],v[124:127],a[112:115]
LW 8
RD a[216:219],v4,6144
MF a[20:23],a[244:247],v[112:115],a[20:23]
v_exp_f32 v173,v89
MF a[52:55],a[244:247],v[116:119],a[52:55]
RD a[220:223],v4,7168
CV v132,v172,v173
MF a[84:87],a[244:247],v[120:123],a[84:87]
v_exp_f32 v174,v90
MF a[116:119],a[244:247],v[124:127],a[116:119]
LW 9
v_exp_f32 v175,v91
MF a[24:27],a[248:251],v[112:115],a[24:27]
CV v133,v174,v175
v_or3_b32 v6,v6,v132,v133
MF a[56:59],a[248:251],v[116:119],a[56:59]
v_exp_f32 v176,v92
MF a[88:91],a[248:251],v[120:123],a[88:91]
v_exp_f32 v177,v93
MF a[120:123],a[248:251],v[124:127],a[120:123]
LW 8
CV v134,v176,v177
MF a[28:31],a[252:255],v[112:115],a[28:31]
buffer_load_dwordx4 v2,s[16:19],s48 offen offset:1024 sc1 lds
MF a[60:63],a[252:255],v[116:119],a[60:63]
v_exp_f32 v178,v94
MF a[92:95],a[252:255],v[120:123],a[92:95]
v_exp_f32 v179,v95
MF a[124:127],a[252:255],v[124:127],a[124:127]
CV v135,v178,v179
v_or3_b32 v6,v6,v134,v135
MF v[144:147],v[160:163],v[112:115],v[144:147]
RD a[224:227],v5,8192
MF v[148:151],v[160:163],v[116:119],v[148:151]
v_exp_f32 v164,v96
MF v[152:155],v[160:163],v[120:123],v[152:155]
v_exp_f32 v165,v97
MF v[156:159],v[160:163],v[124:127],v[156:159]
LW 8
RD a[228:231],v5,9216
CV v136,v164,v165
MF v[48:51],a[192:195],a[128:131],v[16:19]
LW 8
v_exp_f32 v166,v98
MF v[48:51],a[196:199],a[132:135],v[48:51]
LW 7
MF v[48:51],a[200:203],a[136:139],v[48:51]
LW 6
v_exp_f32 v167,v99
MF v[48:51],a[204:207],a[140:143],v[48:51]
LW 5
CV v137,v166,v167
v_or3_b32 v6,v6,v136,v137
MF v[52:55],a[208:211],a[128:131],v[16:19]
LW 4
RD a[232:235],v5,10240
MF v[52:55],a[212:215],a[132:135],v[52:55]
LW 4
v_exp_f32 v168,v100
MF v[52:55],a[216:219],a[136:139],v[52:55]
LW 3
buffer_load_dwordx4 v2,s[16:19],s48 offen offset:2048 sc1 lds
MF v[52:55],a[220:223],a[140:143],v[52:55]
v_exp_f32 v169,v101
MF v[56:59],a[192:195],a[144:147],v[20:23]
RD a[236:239],v5,11264
CV v138,v168,v169
MF v[56:59],a[196:199],a[148:151],v[56:59]
v_exp_f32 v170,v102
MF v[56:59],a[200:203],a[152:155],v[56:59]
v_exp_f32 v171,v103
MF v[56:59],a[204:207],a[156:159],v[56:59]
CV v139,v170,v171
v_or3_b32 v6,v6,v138,v139
MF v[60:63],a[208:211],a[144:147],v[20:23]
RD a[240:243],v5,12288
MF v[60:63],a[212:215],a[148:151],v[60:63]
v_exp_f32 v172,v104
MF v[60:63],a[216:219],a[152:155],v[60:63]
v_exp_f32 v173,v105
MF v[60:63],a[220:223],a[156:159],v[60:63]
RD a[244:247],v5,13312
CV v140,v172,v173
MF v[64:67],a[192:195],a[160:163],v[24:27]
v_exp_f32 v174,v106
MF v[64:67],a[196:199],a[164:167],v[64:67]
MF v[64:67],a[200:203],a[168:171],v[64:67]
buffer_load_dwordx4 v2,s[16:19],s48 offen offset:3072 sc1 lds
MF v[64:67],a[204:207],a[172:175],v[64:67]
v_exp_f32 v175,v107
MF v[68:71],a[208:211],a[160:163],v[24:27]
CV v141,v174,v175
v_or3_b32 v6,v6,v140,v141
MF v[68:71],a[212:215],a[164:167],v[68:71]
RD a[248:251],v5,14336
MF v[68:71],a[216:219],a[168:171],v[68:71]
v_exp_f32 v176,v108
MF v[68:71],a[220:223],a[172:175],v[68:71]
v_exp_f32 v177,v109
MF v[72:75],a[192:195],a[176:179],v[28:31]
RD a[252:255],v5,15360
CV v142,v176,v177
MF v[72:75],a[196:199],a[180:183],v[72:75]
v_exp_f32 v178,v110
MF v[72:75],a[200:203],a[184:187],v[72:75]
v_exp_f32 v179,v111
MF v[72:75],a[204:207],a[188:191],v[72:75]
CV v143,v178,v179
v_or3_b32 v6,v6,v142,v143
MF v[76:79],a[208:211],a[176:179],v[28:31]
v_and_b32 v15,0x40004000,v6
v_cmp_ne_u32 vcc,0,v15
MF v[76:79],a[212:215],a[180:183],v[76:79]
MF v[76:79],a[216:219],a[184:187],v[76:79]
MF v[76:79],a[220:223],a[188:191],v[76:79]
LW 7
s_cbranch_vccnz Lm_fx16
Lm_fx16r:
MF a[0:3],a[224:227],v[128:131],a[0:3]
v_exp_f32 v164,v48
MF a[32:35],a[224:227],v[132:135],a[32:35]
v_add_u32 v5,0x4000,v4
v_and_b32 v5,0x1ffff,v5
MF a[64:67],a[224:227],v[136:139],a[64:67]
s_add_u32 s48,s48,16384
RD a[192:195],v5,0
s_bfe_u32 m0,s48,0x110000
MF a[96:99],a[224:227],v[140:143],a[96:99]
LW 7
v_exp_f32 v165,v49
MF a[4:7],a[228:231],v[128:131],a[4:7]
RD a[196:199],v5,1024
CV v112,v164,v165
MF a[36:39],a[228:231],v[132:135],a[36:39]
v_exp_f32 v166,v50
MF a[68:71],a[228:231],v[136:139],a[68:71]
v_exp_f32 v167,v51
MF a[100:103],a[228:231],v[140:143],a[100:103]
LW 7
CV v113,v166,v167
v_or3_b32 v6,v6,v112,v113
MF a[8:11],a[232:235],v[128:131],a[8:11]
RD a[200:203],v5,2048
MF a[40:43],a[232:235],v[132:135],a[40:43]
v_exp_f32 v168,v52
MF a[72:75],a[232:235],v[136:139],a[72:75]
RD a[204:207],v5,3072
MF a[104:107],a[232:235],v[140:143],a[104:107]
LW 8
v_exp_f32 v169,v53
MF a[12:15],a[236:239],v[128:131],a[12:15]
RD a[208:211],v5,4096
CV v114,v168,v169
MF a[44:47],a[236:239],v[132:135],a[44:47]
v_exp_f32 v170,v54
MF a[76:79],a[236:239],v[136:139],a[76:79]
v_exp_f32 v171,v55
MF a[108:111],a[236:239],v[140:143],a[108:111]
LW 8
CV v115,v170,v171
v_or3_b32 v6,v6,v114,v115
MF a[16:19],a[240:243],v[128:131],a[16:19]
buffer_load_dwordx4 v2,s[16:19],s48 offen sc1 lds
RD a[212:215],v5,5120
MF a[48:51],a[240:243],v[132:135],a[48:51]
v_exp_f32 v172,v56
MF a[80:83],a[240:243],v[136:139],a[80:83]
RD a[216:219],v5,6144
MF a[112:115],a[240:243],v[140:143],a[112:115]
LW 9
v_exp_f32 v173,v57
MF a[20:23],a[244:247],v[128:131],a[20:23]
RD a[220:223],v5,7168
CV v116,v172,v173
MF a[52:55],a[244:247],v[132:135],a[52:55]
v_exp_f32 v174,v58
MF a[84:87],a[244:247],v[136:139],a[84:87]
v_exp_f32 v175,v59
MF a[116:119],a[244:247],v[140:143],a[116:119]
LW 9
CV v117,v174,v175
v_or3_b32 v6,v6,v116,v117
MF a[24:27],a[248:251],v[128:131],a[24:27]
v_exp_f32 v176,v60
MF a[56:59],a[248:251],v[132:135],a[56:59]
MF a[88:91],a[248:251],v[136:139],a[88:91]
v_exp_f32 v177,v61
MF a[120:123],a[248:251],v[140:143],a[120:123]
LW 8
CV v118,v176,v177
MF a[28:31],a[252:255],v[128:131],a[28:31]
buffer_load_dwordx4 v2,s[16:19],s48 offen offset:1024 sc1 lds
MF a[60:63],a[252:255],v[132:135],a[60:63]
v_exp_f32 v178,v62
MF a[92:95],a[252:255],v[136:139],a[92:95]
v_exp_f32 v179,v63
MF a[124:127],a[252:255],v[140:143],a[124:127]
CV v119,v178,v179
v_or3_b32 v6,v6,v118,v119
MF v[144:147],v[160:163],v[128:131],v[144:147]
RD a[224:227],v4,8192
MF v[148:151],v[160:163],v[132:135],v[148:151]
v_exp_f32 v164,v64
MF v[152:155],v[160:163],v[136:139],v[152:155]
v_exp_f32 v165,v65
MF v[156:159],v[160:163],v[140:143],v[156:159]
LW 8
RD a[228:231],v4,9216
CV v120,v164,v165
MF v[80:83],a[192:195],a[128:131],v[16:19]
LW 8
v_exp_f32 v166,v66
MF v[80:83],a[196:199],a[132:135],v[80:83]
LW 7
MF v[80:83],a[200:203],a[136:139],v[80:83]
LW 6
v_exp_f32 v167,v67
MF v[80:83],a[204:207],a[140:143],v[80:83]
LW 5
CV v121,v166,v167
v_or3_b32 v6,v6,v120,v121
MF v[84:87],a[208:211],a[128:131],v[16:19]
LW 4
RD a[232:235],v4,10240
MF v[84:87],a[212:215],a[132:135],v[84:87]
LW 4
v_exp_f32 v168,v68
MF v[84:87],a[216:219],a[136:139],v[84:87]
LW 3
buffer_load_dwordx4 v2,s[16:19],s48 offen offset:2048 sc1 lds
MF v[84:87],a[220:223],a[140:143],v[84:87]
v_exp_f32 v169,v69
MF v[88:91],a[192:195],a[144:147],v[20:23]
RD a[236:239],v4,11264
CV v122,v168,v169
MF v[88:91],a[196:199],a[148:151],v[88:91]
v_exp_f32 v170,v70
MF v[88:91],a[200:203],a[152:155],v[88:91]
v_exp_f32 v171,v71
MF v[88:91],a[204:207],a[156:159],v[88:91]
CV v123,v170,v171
v_or3_b32 v6,v6,v122,v123
MF v[92:95],a[208:211],a[144:147],v[20:23]
RD a[240:243],v4,12288
MF v[92:95],a[212:215],a[148:151],v[92:95]
v_exp_f32 v172,v72
MF v[92:95],a[216:219],a[152:155],v[92:95]
v_exp_f32 v173,v73
MF v[92:95],a[220:223],a[156:159],v[92:95]
RD a[244:247],v4,13312
CV v124,v172,v173
MF v[96:99],a[192:195],a[160:163],v[24:27]
v_exp_f32 v174,v74
MF v[96:99],a[196:199],a[164:167],v[96:99]
MF v[96:99],a[200:203],a[168:171],v[96:99]
buffer_load_dwordx4 v2,s[16:19],s48 offen offset:3072 sc1 lds
MF v[96:99],a[204:207],a[172:175],v[96:99]
v_exp_f32 v175,v75
MF v[100:103],a[208:211],a[160:163],v[24:27]
CV v125,v174,v175
v_or3_b32 v6,v6,v124,v125
MF v[100:103],a[212:215],a[164:167],v[100:103]
RD a[248:251],v4,14336
MF v[100:103],a[216:219],a[168:171],v[100:103]
v_exp_f32 v176,v76
MF v[100:103],a[220:223],a[172:175],v[100:103]
v_exp_f32 v177,v77
MF v[104:107],a[192:195],a[176:179],v[28:31]
RD a[252:255],v4,15360
CV v126,v176,v177
MF v[104:107],a[196:199],a[180:183],v[104:107]
v_exp_f32 v178,v78
MF v[104:107],a[200:203],a[184:187],v[104:107]
v_exp_f32 v179,v79
MF v[104:107],a[204:207],a[188:191],v[104:107]
CV v127,v178,v179
v_or3_b32 v6,v6,v126,v127
MF v[108:111],a[208:211],a[176:179],v[28:31]
v_and_b32 v15,0x40004000,v6
v_cmp_ne_u32 vcc,0,v15
MF v[108:111],a[212:215],a[180:183],v[108:111]
MF v[108:111],a[216:219],a[184:187],v[108:111]
MF v[108:111],a[220:223],a[188:191],v[108:111]
s_cbranch_vccnz Lm_fx17
Lm_fx17r:
s_waitcnt vmcnt(12)
s_sub_u32 s62,s62,1
s_cbranch_scc0 Lm_D11
Lm_DM12:
LW 7
MF a[0:3],a[224:227],v[112:115],a[0:3]
s_barrier
v_exp_f32 v164,v80
MF a[32:35],a[224:227],v[116:119],a[32:35]
v_add_u32 v4,0x4000,v5
v_and_b32 v4,0x1ffff,v4
MF a[64:67],a[224:227],v[120:123],a[64:67]
s_add_u32 s48,s48,16384
s_bfe_u32 m0,s48,0x110000
MF a[96:99],a[224:227],v[124:127],a[96:99]
LW 6
s_cmp_gt_i32 s51,0
s_cselect_b32 s55,0xff7fff7f,0
MF a[4:7],a[228:231],v[112:115],a[4:7]
v_exp_f32 v165,v81
MF a[36:39],a[228:231],v[116:119],a[36:39]
RD a[192:195],v4,0
CV v128,v164,v165
MF a[68:71],a[228:231],v[120:123],a[68:71]
v_exp_f32 v166,v82
MF a[100:103],a[228:231],v[124:127],a[100:103]
LW 6
RD a[196:199],v4,1024
MF a[8:11],a[232:235],v[112:115],a[8:11]
s_cmp_eq_u32 s51,0
s_cselect_b32 s54,-1,0
RD a[200:203],v4,2048
MF a[40:43],a[232:235],v[116:119],a[40:43]
v_exp_f32 v167,v83
MF a[72:75],a[232:235],v[120:123],a[72:75]
CV v129,v166,v167
v_or3_b32 v6,v6,v128,v129
MF a[104:107],a[232:235],v[124:127],a[104:107]
LW 7
v_exp_f32 v168,v84
MF a[12:15],a[236:239],v[112:115],a[12:15]
RD a[204:207],v4,3072
v_mov_b32 v3,s55
MF a[44:47],a[236:239],v[116:119],a[44:47]
v_exp_f32 v169,v85
MF a[76:79],a[236:239],v[120:123],a[76:79]
RD a[208:211],v4,4096
CV v130,v168,v169
MF a[108:111],a[236:239],v[124:127],a[108:111]
LW 8
v_and_or_b32 v40,v200,s54,v3
v_and_or_b32 v41,v201,s54,v3
MF a[16:19],a[240:243],v[112:115],a[16:19]
v_exp_f32 v170,v86
MF a[48:51],a[240:243],v[116:119],a[48:51]
buffer_load_dwordx4 v2,s[16:19],s48 offen sc1 lds
RD a[212:215],v4,5120
MF a[80:83],a[240:243],v[120:123],a[80:83]
v_exp_f32 v171,v87
MF a[112:115],a[240:243],v[124:127],a[112:115]
LW 8
CV v131,v170,v171
v_or3_b32 v6,v6,v130,v131
MF a[20:23],a[244:247],v[112:115],a[20:23]
RD a[216:219],v4,6144
v_and_or_b32 v42,v202,s54,v3
MF a[52:55],a[244:247],v[116:119],a[52:55]
v_exp_f32 v172,v88
MF a[84:87],a[244:247],v[120:123],a[84:87]
RD a[220:223],v4,7168
v_and_or_b32 v43,v203,s54,v3
MF a[116:119],a[244:247],v[124:127],a[116:119]
LW 9
v_exp_f32 v173,v89
MF a[24:27],a[248:251],v[112:115],a[24:27]
v_and_or_b32 v44,v204,s54,v3
CV v132,v172,v173
MF a[56:59],a[248:251],v[116:119],a[56:59]
v_exp_f32 v174,v90
MF a[88:91],a[248:251],v[120:123],a[88:91]
v_and_or_b32 v45,v205,s54,v3
v_and_or_b32 v46,v206,s54,v3
MF a[120:123],a[248:251],v[124:127],a[120:123]
LW 8
v_exp_f32 v175,v91
MF a[28:31],a[252:255],v[112:115],a[28:31]
CV v133,v174,v175
v_or3_b32 v6,v6,v132,v133
MF a[60:63],a[252:255],v[116:119],a[60:63]
v_exp_f32 v176,v92
MF a[92:95],a[252:255],v[120:123],a[92:95]
buffer_load_dwordx4 v2,s[16:19],s48 offen offset:1024 sc1 lds
v_and_or_b32 v47,v207,s54,v3
MF a[124:127],a[252:255],v[124:127],a[124:127]
v_exp_f32 v177,v93
MF v[144:147],v[160:163],v[112:115],v[144:147]
RD a[224:227],v5,8192
CV v134,v176,v177
MF v[148:151],v[160:163],v[116:119],v[148:151]
v_exp_f32 v178,v94
MF v[152:155],v[160:163],v[120:123],v[152:155]
v_exp_f32 v179,v95
MF v[156:159],v[160:163],v[124:127],v[156:159]
LW 8
CV v135,v178,v179
v_or3_b32 v6,v6,v134,v135
MF v[48:51],a[192:195],a[128:131],v[16:19]
LW 7
v_exp_f32 v164,v96
MF v[48:51],a[196:199],a[132:135],v[48:51]
LW 6
RD a[228:231],v5,9216
MF v[48:51],a[200:203],a[136:139],v[48:51]
LW 6
v_exp_f32 v165,v97
MF v[48:51],a[204:207],a[140:143],v[48:51]
LW 5
CV v136,v164,v165
MF v[52:55],a[208:211],a[128:131],v[16:19]
LW 4
v_exp_f32 v166,v98
MF v[52:55],a[212:215],a[132:135],v[52:55]
LW 3
RD a[232:235],v5,10240
MF v[52:55],a[216:219],a[136:139],v[52:55]
LW 3
v_exp_f32 v167,v99
MF v[52:55],a[220:223],a[140:143],v[52:55]
CV v137,v166,v167
v_or3_b32 v6,v6,v136,v137
MF v[56:59],a[192:195],a[144:147],v[20:23]
v_exp_f32 v168,v100
MF v[56:59],a[196:199],a[148:151],v[56:59]
RD a[236:239],v5,11264
buffer_load_dwordx4 v2,s[16:19],s48 offen offset:2048 sc1 lds
MF v[56:59],a[200:203],a[152:155],v[56:59]
v_exp_f32 v169,v101
MF v[56:59],a[204:207],a[156:159],v[56:59]
CV v138,v168,v169
MF v[60:63],a[208:211],a[144:147],v[20:23]
v_exp_f32 v170,v102
MF v[60:63],a[212:215],a[148:151],v[60:63]
RD a[240:243],v5,12288
MF v[60:63],a[216:219],a[152:155],v[60:63]
v_exp_f32 v171,v103
MF v[60:63],a[220:223],a[156:159],v[60:63]
CV v139,v170,v171
v_or3_b32 v6,v6,v138,v139
MF v[64:67],v[192:195],v[40:43],v[24:27]
v_exp_f32 v172,v104
MF v[64:67],a[192:195],a[160:163],v[64:67]
RD a[244:247],v5,13312
MF v[64:67],a[196:199],a[164:167],v[64:67]
v_exp_f32 v173,v105
MF v[64:67],a[200:203],a[168:171],v[64:67]
CV v140,v172,v173
MF v[64:67],a[204:207],a[172:175],v[64:67]
v_exp_f32 v174,v106
MF v[68:71],v[196:199],v[40:43],v[24:27]
buffer_load_dwordx4 v2,s[16:19],s48 offen offset:3072 sc1 lds
MF v[68:71],a[208:211],a[160:163],v[68:71]
v_exp_f32 v175,v107
MF v[68:71],a[212:215],a[164:167],v[68:71]
CV v141,v174,v175
v_or3_b32 v6,v6,v140,v141
MF v[68:71],a[216:219],a[168:171],v[68:71]
RD a[248:251],v5,14336
MF v[68:71],a[220:223],a[172:175],v[68:71]
v_exp_f32 v176,v108
MF v[72:75],v[192:195],v[44:47],v[28:31]
v_exp_f32 v177,v109
MF v[72:75],a[192:195],a[176:179],v[72:75]
RD a[252:255],v5,15360
CV v142,v176,v177
MF v[72:75],a[196:199],a[180:183],v[72:75]
v_exp_f32 v178,v110
MF v[72:75],a[200:203],a[184:187],v[72:75]
MF v[72:75],a[204:207],a[188:191],v[72:75]
v_exp_f32 v179,v111
MF v[76:79],v[196:199],v[44:47],v[28:31]
CV v143,v178,v179
v_or3_b32 v6,v6,v142,v143
MF v[76:79],a[208:211],a[176:179],v[76:79]
v_and_b32 v15,0x40004000,v6
v_cmp_ne_u32 vcc,0,v15
MF v[76:79],a[212:215],a[180:183],v[76:79]
MF v[76:79],a[216:219],a[184:187],v[76:79]
s_add_u32 s50,s50,32
s_add_u32 s51,s51,32
MF v[76:79],a[220:223],a[188:191],v[76:79]
LW 7
s_cbranch_vccnz Lm_fx18
Lm_fx18r:
MF a[0:3],a[224:227],v[128:131],a[0:3]
v_exp_f32 v164,v48
MF a[32:35],a[224:227],v[132:135],a[32:35]
v_add_u32 v5,0x4000,v4
v_and_b32 v5,0x1ffff,v5
MF a[64:67],a[224:227],v[136:139],a[64:67]
s_add_u32 s48,s48,16384
RD a[192:195],v5,0
s_bfe_u32 m0,s48,0x110000
MF a[96:99],a[224:227],v[140:143],a[96:99]
LW 7
s_cmp_gt_i32 s51,0
s_cselect_b32 s55,0xff7fff7f,0
MF a[4:7],a[228:231],v[128:131],a[4:7]
v_exp_f32 v165,v49
MF a[36:39],a[228:231],v[132:135],a[36:39]
RD a[196:199],v5,1024
CV v112,v164,v165
MF a[68:71],a[228:231],v[136:139],a[68:71]
v_exp_f32 v166,v50
MF a[100:103],a[228:231],v[140:143],a[100:103]
LW 7
s_cmp_eq_u32 s51,0
s_cselect_b32 s54,-1,0
MF a[8:11],a[232:235],v[128:131],a[8:11]
v_exp_f32 v167,v51
MF a[40:43],a[232:235],v[132:135],a[40:43]
CV v113,v166,v167
v_or3_b32 v6,v6,v112,v113
MF a[72:75],a[232:235],v[136:139],a[72:75]
RD a[200:203],v5,2048
v_mov_b32 v3,s55
MF a[104:107],a[232:235],v[140:143],a[104:107]
LW 7
v_exp_f32 v168,v52
MF a[12:15],a[236:239],v[128:131],a[12:15]
RD a[204:207],v5,3072
v_and_or_b32 v40,v200,s54,v3
MF a[44:47],a[236:239],v[132:135],a[44:47]
v_exp_f32 v169,v53
MF a[76:79],a[236:239],v[136:139],a[76:79]
RD a[208:211],v5,4096
CV v114,v168,v169
MF a[108:111],a[236:239],v[140:143],a[108:111]
LW 8
v_exp_f32 v170,v54
MF a[16:19],a[240:243],v[128:131],a[16:19]
RD a[212:215],v5,5120
v_and_or_b32 v41,v201,s54,v3
MF a[48:51],a[240:243],v[132:135],a[48:51]
v_exp_f32 v171,v55
MF a[80:83],a[240:243],v[136:139],a[80:83]
CV v115,v170,v171
v_or3_b32 v6,v6,v114,v115
MF a[112:115],a[240:243],v[140:143],a[112:115]
LW 8
buffer_load_dwordx4 v2,s[16:19],s48 offen sc1 lds
v_and_or_b32 v42,v202,s54,v3
MF a[20:23],a[244:247],v[128:131],a[20:23]
RD a[216:219],v5,6144
v_and_or_b32 v43,v203,s54,v3
MF a[52:55],a[244:247],v[132:135],a[52:55]
v_exp_f32 v172,v56
MF a[84:87],a[244:247],v[136:139],a[84:87]
v_exp_f32 v173,v57
MF a[116:119],a[244:247],v[140:143],a[116:119]
LW 8
RD a[220:223],v5,7168
CV v116,v172,v173
MF a[24:27],a[248:251],v[128:131],a[24:27]
v_and_or_b32 v44,v204,s54,v3
v_and_or_b32 v45,v205,s54,v3
MF a[56:59],a[248:251],v[132:135],a[56:59]
v_exp_f32 v174,v58
MF a[88:91],a[248:251],v[136:139],a[88:91]
v_exp_f32 v175,v59
MF a[120:123],a[248:251],v[140:143],a[120:123]
LW 8
CV v117,v174,v175
v_or3_b32 v6,v6,v116,v117
MF a[28:31],a[252:255],v[128:131],a[28:31]
v_and_or_b32 v46,v206,s54,v3
v_and_or_b32 v47,v207,s54,v3
MF a[60:63],a[252:255],v[132:135],a[60:63]
v_exp_f32 v176,v60
MF a[92:95],a[252:255],v[136:139],a[92:95]
v_exp_f32 v177,v61
MF a[124:127],a[252:255],v[140:143],a[124:127]
buffer_load_dwordx4 v2,s[16:19],s48 offen offset:1024 sc1 lds
CV v118,v176,v177
MF v[144:147],v[160:163],v[128:131],v[144:147]
v_exp_f32 v178,v62
MF v[148:151],v[160:163],v[132:135],v[148:151]
RD a[224:227],v4,8192
MF v[152:155],v[160:163],v[136:139],v[152:155]
v_exp_f32 v179,v63
MF v[156:159],v[160:163],v[140:143],v[156:159]
LW 8
CV v119,v178,v179
v_or3_b32 v6,v6,v118,v119
MF v[80:83],a[192:195],a[128:131],v[16:19]
LW 7
v_exp_f32 v164,v64
MF v[80:83],a[196:199],a[132:135],v[80:83]
LW 6
RD a[228:231],v4,9216
MF v[80:83],a[200:203],a[136:139],v[80:83]
LW 6
v_exp_f32 v165,v65
MF v[80:83],a[204:207],a[140:143],v[80:83]
LW 5
CV v120,v164,v165
MF v[84:87],a[208:211],a[128:131],v[16:19]
LW 4
v_exp_f32 v166,v66
MF v[84:87],a[212:215],a[132:135],v[84:87]
LW 3
RD a[232:235],v4,10240
MF v[84:87],a[216:219],a[136:139],v[84:87]
LW 3
v_exp_f32 v167,v67
MF v[84:87],a[220:223],a[140:143],v[84:87]
CV v121,v166,v167
v_or3_b32 v6,v6,v120,v121
MF v[88:91],a[192:195],a[144:147],v[20:23]
v_exp_f32 v168,v68
MF v[88:91],a[196:199],a[148:151],v[88:91]
RD a[236:239],v4,11264
buffer_load_dwordx4 v2,s[16:19],s48 offen offset:2048 sc1 lds
MF v[88:91],a[200:203],a[152:155],v[88:91]
v_exp_f32 v169,v69
MF v[88:91],a[204:207],a[156:159],v[88:91]
CV v122,v168,v169
MF v[92:95],a[208:211],a[144:147],v[20:23]
v_exp_f32 v170,v70
MF v[92:95],a[212:215],a[148:151],v[92:95]
RD a[240:243],v4,12288
MF v[92:95],a[216:219],a[152:155],v[92:95]
v_exp_f32 v171,v71
MF v[92:95],a[220:223],a[156:159],v[92:95]
CV v123,v170,v171
v_or3_b32 v6,v6,v122,v123
MF v[96:99],v[192:195],v[40:43],v[24:27]
v_exp_f32 v172,v72
MF v[96:99],a[192:195],a[160:163],v[96:99]
RD a[244:247],v4,13312
MF v[96:99],a[196:199],a[164:167],v[96:99]
v_exp_f32 v173,v73
MF v[96:99],a[200:203],a[168:171],v[96:99]
CV v124,v172,v173
MF v[96:99],a[204:207],a[172:175],v[96:99]
v_exp_f32 v174,v74
MF v[100:103],v[196:199],v[40:43],v[24:27]
buffer_load_dwordx4 v2,s[16:19],s48 offen offset:3072 sc1 lds
MF v[100:103],a[208:211],a[160:163],v[100:103]
v_exp_f32 v175,v75
MF v[100:103],a[212:215],a[164:167],v[100:103]
CV v125,v174,v175
v_or3_b32 v6,v6,v124,v125
MF v[100:103],a[216:219],a[168:171],v[100:103]
RD a[248:251],v4,14336
MF v[100:103],a[220:223],a[172:175],v[100:103]
v_exp_f32 v176,v76
MF v[104:107],v[192:195],v[44:47],v[28:31]
v_exp_f32 v177,v77
MF v[104:107],a[192:195],a[176:179],v[104:107]
RD a[252:255],v4,15360
CV v126,v176,v177
MF v[104:107],a[196:199],a[180:183],v[104:107]
v_exp_f32 v178,v78
MF v[104:107],a[200:203],a[184:187],v[104:107]
MF v[104:107],a[204:207],a[188:191],v[104:107]
v_exp_f32 v179,v79
MF v[108:111],v[196:199],v[44:47],v[28:31]
CV v127,v178,v179
v_or3_b32 v6,v6,v126,v127
MF v[108:111],a[208:211],a[176:179],v[108:111]
v_and_b32 v15,0x40004000,v6
v_cmp_ne_u32 vcc,0,v15
MF v[108:111],a[212:215],a[180:183],v[108:111]
MF v[108:111],a[216:219],a[184:187],v[108:111]
s_add_u32 s50,s50,32
s_add_u32 s51,s51,32
MF v[108:111],a[220:223],a[188:191],v[108:111]
s_cbranch_vccnz Lm_fx19
Lm_fx19r:
s_waitcnt vmcnt(12)
s_sub_u32 s63,s63,1
s_cbranch_scc0 Lm_DM12
Lm_T15:
LW 7
MF a[0:3],a[224:227],v[112:115],a[0:3]
s_barrier
v_exp_f32 v164,v80
MF a[32:35],a[224:227],v[116:119],a[32:35]
s_waitcnt vmcnt(8)
v_add_u32 v4,0x4000,v5
v_and_b32 v4,0x1ffff,v4
MF a[64:67],a[224:227],v[120:123],a[64:67]
s_add_u32 s48,s48,16384
s_bfe_u32 m0,s48,0x110000
RD a[192:195],v4,0
MF a[96:99],a[224:227],v[124:127],a[96:99]
LW 7
v_exp_f32 v165,v81
MF a[4:7],a[228:231],v[112:115],a[4:7]
s_cmp_gt_i32 s50,0
s_cselect_b32 s55,0xff7fff7f,0
CV v128,v164,v165
MF a[36:39],a[228:231],v[116:119],a[36:39]
v_exp_f32 v166,v82
MF a[68:71],a[228:231],v[120:123],a[68:71]
buffer_load_dwordx4 v2,s[16:19],s48 offen sc1 lds
RD a[196:199],v4,1024
MF a[100:103],a[228:231],v[124:127],a[100:103]
LW 7
buffer_load_dwordx4 v2,s[16:19],s48 offen offset:1024 sc1 lds
RD a[200:203],v4,2048
MF a[8:11],a[232:235],v[112:115],a[8:11]
v_exp_f32 v167,v83
MF a[40:43],a[232:235],v[116:119],a[40:43]
CV v129,v166,v167
v_or3_b32 v6,v6,v128,v129
MF a[72:75],a[232:235],v[120:123],a[72:75]
v_exp_f32 v168,v84
MF a[104:107],a[232:235],v[124:127],a[104:107]
LW 7
buffer_load_dwordx4 v2,s[16:19],s48 offen offset:2048 sc1 lds
RD a[204:207],v4,3072
MF a[12:15],a[236:239],v[112:115],a[12:15]
v_exp_f32 v169,v85
MF a[44:47],a[236:239],v[116:119],a[44:47]
s_cmp_eq_u32 s50,0
s_cselect_b32 s54,-1,0
RD a[208:211],v4,4096
MF a[76:79],a[236:239],v[120:123],a[76:79]
RD a[212:215],v4,5120
CV v130,v168,v169
MF a[108:111],a[236:239],v[124:127],a[108:111]
LW 9
v_exp_f32 v170,v86
MF a[16:19],a[240:243],v[112:115],a[16:19]
buffer_load_dwordx4 v2,s[16:19],s48 offen offset:3072 sc1 lds
v_mov_b32 v3,s55
MF a[48:51],a[240:243],v[116:119],a[48:51]
v_exp_f32 v171,v87
MF a[80:83],a[240:243],v[120:123],a[80:83]
RD a[216:219],v4,6144
CV v131,v170,v171
MF a[112:115],a[240:243],v[124:127],a[112:115]
LW 9
RD a[220:223],v4,7168
v_or3_b32 v6,v6,v130,v131
MF a[20:23],a[244:247],v[112:115],a[20:23]
TR v[208:209],v252,0
v_and_or_b32 v40,v200,s54,v3
MF a[52:55],a[244:247],v[116:119],a[52:55]
v_exp_f32 v172,v88
MF a[84:87],a[244:247],v[120:123],a[84:87]
v_exp_f32 v173,v89
MF a[116:119],a[244:247],v[124:127],a[116:119]
LW 10
TR v[210:211],v252,2048
CV v132,v172,v173
MF a[24:27],a[248:251],v[112:115],a[24:27]
v_exp_f32 v174,v90
MF a[56:59],a[248:251],v[116:119],a[56:59]
TR v[212:213],v252,32
v_and_or_b32 v41,v201,s54,v3
MF a[88:91],a[248:251],v[120:123],a[88:91]
v_exp_f32 v175,v91
MF a[120:123],a[248:251],v[124:127],a[120:123]
LW 11
TR v[214:215],v252,2080
CV v133,v174,v175
MF a[28:31],a[252:255],v[112:115],a[28:31]
v_exp_f32 v176,v92
MF a[60:63],a[252:255],v[116:119],a[60:63]
v_and_or_b32 v42,v202,s54,v3
v_or3_b32 v6,v6,v132,v133
MF a[92:95],a[252:255],v[120:123],a[92:95]
v_exp_f32 v177,v93
MF a[124:127],a[252:255],v[124:127],a[124:127]
TR v[216:217],v252,64
CV v134,v176,v177
MF v[144:147],v[160:163],v[112:115],v[144:147]
TR v[218:219],v252,2112
v_and_or_b32 v43,v203,s54,v3
MF v[148:151],v[160:163],v[116:119],v[148:151]
v_and_or_b32 v44,v204,s54,v3
v_and_or_b32 v45,v205,s54,v3
v_and_or_b32 v46,v206,s54,v3
v_and_or_b32 v47,v207,s54,v3
v_exp_f32 v178,v94
MF v[152:155],v[160:163],v[120:123],v[152:155]
v_exp_f32 v179,v95
MF v[156:159],v[160:163],v[124:127],v[156:159]
TR v[220:221],v252,96
CV v135,v178,v179
MF v[48:51],v[192:195],v[40:43],v[16:19]
LW 14
v_exp_f32 v164,v96
MF v[48:51],a[192:195],a[128:131],v[48:51]
LW 13
TR v[222:223],v252,2144
v_or3_b32 v6,v6,v134,v135
MF v[48:51],a[196:199],a[132:135],v[48:51]
LW 13
v_exp_f32 v165,v97
MF v[48:51],a[200:203],a[136:139],v[48:51]
LW 12
TR v[224:225],v252,4096
CV v136,v164,v165
MF v[48:51],a[204:207],a[140:143],v[48:51]
v_exp_f32 v166,v98
MF v[52:55],v[196:199],v[40:43],v[16:19]
LW 12
v_exp_f32 v167,v99
MF v[52:55],a[208:211],a[128:131],v[52:55]
LW 11
TR v[226:227],v252,6144
CV v137,v166,v167
MF v[52:55],a[212:215],a[132:135],v[52:55]
LW 11
v_exp_f32 v168,v100
MF v[52:55],a[216:219],a[136:139],v[52:55]
LW 10
TR v[228:229],v252,4128
v_or3_b32 v6,v6,v136,v137
MF v[52:55],a[220:223],a[140:143],v[52:55]
v_exp_f32 v169,v101
MF v[56:59],v[192:195],v[44:47],v[20:23]
TR v[230:231],v252,6176
CV v138,v168,v169
MF v[56:59],a[192:195],a[144:147],v[56:59]
RD a[224:227],v5,8192
MF v[56:59],a[196:199],a[148:151],v[56:59]
v_exp_f32 v170,v102
MF v[56:59],a[200:203],a[152:155],v[56:59]
RD a[228:231],v5,9216
MF v[56:59],a[204:207],a[156:159],v[56:59]
v_exp_f32 v171,v103
MF v[60:63],v[196:199],v[44:47],v[20:23]
TR v[232:233],v252,4160
CV v139,v170,v171
MF v[60:63],a[208:211],a[144:147],v[60:63]
v_exp_f32 v172,v104
MF v[60:63],a[212:215],a[148:151],v[60:63]
TR v[234:235],v252,6208
v_exp_f32 v173,v105
v_exp_f32 v174,v106
v_exp_f32 v175,v107
v_exp_f32 v176,v108
v_exp_f32 v177,v109
v_exp_f32 v178,v110
v_exp_f32 v179,v111
v_or3_b32 v6,v6,v138,v139
MF v[60:63],a[216:219],a[152:155],v[60:63]
TR v[236:237],v252,4192
TR v[238:239],v252,6240
s_add_u32 s50,s50,32
RD a[232:235],v5,10240
RD a[236:239],v5,11264
RD a[240:243],v5,12288
RD a[244:247],v5,13312
RD a[248:251],v5,14336
RD a[252:255],v5,15360
CV v140,v172,v173
CV v141,v174,v175
v_or3_b32 v6,v6,v140,v141
CV v142,v176,v177
CV v143,v178,v179
v_or3_b32 v6,v6,v142,v143
v_and_b32 v15,0x40004000,v6
v_cmp_ne_u32 vcc,0,v15
MF v[60:63],a[220:223],a[156:159],v[60:63]
s_cbranch_vccnz Lm_fx20
Lm_fx20r:
LW 0
s_add_u32 s51,s51,32
MF a[0:3],a[224:227],v[128:131],a[0:3]
v_exp_f32 v164,v48
MF a[32:35],a[224:227],v[132:135],a[32:35]
v_add_u32 v5,0x4000,v4
v_and_b32 v5,0x1ffff,v5
MF a[64:67],a[224:227],v[136:139],a[64:67]
s_add_u32 s48,s48,16384
v_exp_f32 v165,v49
MF a[96:99],a[224:227],v[140:143],a[96:99]
s_bfe_u32 m0,s48,0x110000
s_cmp_gt_i32 s50,0
s_cselect_b32 s55,0xff7fff7f,0
MF a[4:7],a[228:231],v[128:131],a[4:7]
RD a[192:195],v5,0
CV v112,v164,v165
MF a[36:39],a[228:231],v[132:135],a[36:39]
s_cmp_eq_u32 s50,0
s_cselect_b32 s54,-1,0
RD a[196:199],v5,1024
MF a[68:71],a[228:231],v[136:139],a[68:71]
RD a[200:203],v5,2048
buffer_load_dwordx4 v2,s[16:19],s48 offen sc1 lds
MF a[100:103],a[228:231],v[140:143],a[100:103]
v_exp_f32 v166,v50
MF a[8:11],a[232:235],v[128:131],a[8:11]
RD a[204:207],v5,3072
v_mov_b32 v3,s55
MF a[40:43],a[232:235],v[132:135],a[40:43]
v_exp_f32 v167,v51
MF a[72:75],a[232:235],v[136:139],a[72:75]
CV v113,v166,v167
v_or3_b32 v6,v6,v112,v113
MF a[104:107],a[232:235],v[140:143],a[104:107]
buffer_load_dwordx4 v2,s[16:19],s48 offen offset:1024 sc1 lds
v_and_or_b32 v40,v200,s54,v3
MF a[12:15],a[236:239],v[128:131],a[12:15]
v_exp_f32 v168,v52
MF a[44:47],a[236:239],v[132:135],a[44:47]
RD a[208:211],v5,4096
v_and_or_b32 v41,v201,s54,v3
MF a[76:79],a[236:239],v[136:139],a[76:79]
buffer_load_dwordx4 v2,s[16:19],s48 offen offset:2048 sc1 lds
v_and_or_b32 v42,v202,s54,v3
MF a[108:111],a[236:239],v[140:143],a[108:111]
RD a[212:215],v5,5120
v_and_or_b32 v43,v203,s54,v3
MF a[16:19],a[240:243],v[128:131],a[16:19]
buffer_load_dwordx4 v2,s[16:19],s48 offen offset:3072 sc1 lds
v_and_or_b32 v44,v204,s54,v3
MF a[48:51],a[240:243],v[132:135],a[48:51]
v_exp_f32 v169,v53
MF a[80:83],a[240:243],v[136:139],a[80:83]
v_and_or_b32 v45,v205,s54,v3
CV v114,v168,v169
MF a[112:115],a[240:243],v[140:143],a[112:115]
RD a[216:219],v5,6144
v_and_or_b32 v46,v206,s54,v3
MF a[20:23],a[244:247],v[128:131],a[20:23]
v_exp_f32 v170,v54
MF a[52:55],a[244:247],v[132:135],a[52:55]
RD a[220:223],v5,7168
v_and_or_b32 v47,v207,s54,v3
MF a[84:87],a[244:247],v[136:139],a[84:87]
s_add_u32 s24,s4,0x8400000
s_addc_u32 s25,s5,0
s_mov_b32 s26,0x828000
MF a[116:119],a[244:247],v[140:143],a[116:119]
s_mov_b32 s27,0x20000
v_exp_f32 v171,v55
MF a[24:27],a[248:251],v[128:131],a[24:27]
CV v115,v170,v171
v_or3_b32 v6,v6,v114,v115
MF a[56:59],a[248:251],v[132:135],a[56:59]
v_exp_f32 v172,v56
MF a[88:91],a[248:251],v[136:139],a[88:91]
buffer_store_dwordx4 v[208:211],v2,s[24:27],s66 offen sc1
buffer_store_dwordx4 v[212:215],v2,s[24:27],s67 offen sc1
MF a[120:123],a[248:251],v[140:143],a[120:123]
v_exp_f32 v173,v57
MF a[28:31],a[252:255],v[128:131],a[28:31]
s_add_u32 s40,s0,Lm_sp-Lm_pc
s_addc_u32 s41,s1,0
CV v116,v172,v173
MF a[60:63],a[252:255],v[132:135],a[60:63]
s_lshr_b32 s7,s2,3
v_exp_f32 v174,v58
MF a[92:95],a[252:255],v[136:139],a[92:95]
s_lshl_b32 s7,s7,2
v_exp_f32 v175,v59
MF a[124:127],a[252:255],v[140:143],a[124:127]
s_add_u32 s7,s7,s32
CV v117,v174,v175
v_or3_b32 v6,v6,v116,v117
MF v[144:147],v[160:163],v[128:131],v[144:147]
s_lshl_b32 s7,s7,9
v_and_b32 v13,3,v1
v_lshl_add_u32 v13,v13,7,s7
MF v[148:151],v[160:163],v[132:135],v[148:151]
RD a[224:227],v4,8192
v_min_u32 v13,Lm_codeend-Lm_sp-4,v13
MF v[152:155],v[160:163],v[136:139],v[152:155]
global_load_dword v14,v13,s[40:41]
buffer_store_dwordx4 v[216:219],v2,s[24:27],s70 offen sc1
MF v[156:159],v[160:163],v[140:143],v[156:159]
v_exp_f32 v176,v60
MF v[80:83],v[192:195],v[40:43],v[16:19]
LW 8
v_exp_f32 v177,v61
MF v[80:83],a[192:195],a[128:131],v[80:83]
LW 7
RD a[228:231],v4,9216
CV v118,v176,v177
MF v[80:83],a[196:199],a[132:135],v[80:83]
LW 7
RD a[232:235],v4,10240
buffer_store_dwordx4 v[220:223],v2,s[24:27],s71 offen sc1
MF v[80:83],a[200:203],a[136:139],v[80:83]
LW 7
v_exp_f32 v178,v62
MF v[80:83],a[204:207],a[140:143],v[80:83]
v_exp_f32 v179,v63
MF v[84:87],v[196:199],v[40:43],v[16:19]
LW 6
CV v119,v178,v179
v_or3_b32 v6,v6,v118,v119
MF v[84:87],a[208:211],a[128:131],v[84:87]
LW 5
v_and_b32 v15,0x40004000,v6
v_cmp_ne_u32 vcc,0,v15
MF v[84:87],a[212:215],a[132:135],v[84:87]
LW 4
s_add_u32 s8,s4,0x6b00000
s_addc_u32 s9,s5,0
MF v[84:87],a[216:219],a[136:139],v[84:87]
LW 3
s_mov_b32 s10,0x800000
s_mov_b32 s11,0x20000
MF v[84:87],a[220:223],a[140:143],v[84:87]
s_mul_i32 s40,s34,589824
RD a[236:239],v4,11264
s_add_u32 s40,s40,0x3600000
MF v[88:91],v[192:195],v[44:47],v[20:23]
s_add_u32 s12,s4,s40
s_addc_u32 s13,s5,0
buffer_store_dwordx4 v[224:227],v2,s[24:27],s72 offen sc1
MF v[88:91],a[192:195],a[144:147],v[88:91]
buffer_store_dwordx4 v[228:231],v2,s[24:27],s73 offen sc1
RD a[240:243],v4,12288
MF v[88:91],a[196:199],a[148:151],v[88:91]
s_mov_b32 s14,0x90000
s_mov_b32 s15,0x20000
RD a[244:247],v4,13312
MF v[88:91],a[200:203],a[152:155],v[88:91]
s_lshl_b32 s37,s33,3
s_lshl_b32 s40,s32,1
RD a[248:251],v4,14336
MF v[88:91],a[204:207],a[156:159],v[88:91]
s_add_u32 s37,s37,s40
s_lshl_b32 s40,s37,16
RD a[252:255],v4,15360
MF v[92:95],v[196:199],v[44:47],v[20:23]
v_add_u32 v24,s40,v2
v_add_u32 v25,0x10000,v24
MF v[92:95],a[208:211],a[144:147],v[92:95]
v_add_u32 v26,4096,v2
v_add_u32 v27,8192,v2
MF v[92:95],a[212:215],a[148:151],v[92:95]
s_mul_i32 s45,s32,9216
buffer_store_dwordx4 v[232:235],v2,s[24:27],s76 offen sc1
buffer_store_dwordx4 v[236:239],v2,s[24:27],s77 offen sc1
MF v[92:95],a[216:219],a[152:155],v[92:95]
s_add_u32 s50,s50,32
s_add_u32 s51,s51,32
MF v[92:95],a[220:223],a[156:159],v[92:95]
s_cbranch_vccnz Lm_fx21
Lm_fx21r:
s_waitcnt vmcnt(12)
s_nop 7
v_rcp_f32 v164,v152
AR v208,a64
AR v209,a65
AR v210,a66
AR v211,a67
AR v212,a68
AR v213,a69
AR v214,a70
AR v215,a71
v_pk_mul_f32 v[208:209],v[208:209],v[164:165] op_sel_hi:[1,0]
v_pk_mul_f32 v[210:211],v[210:211],v[164:165] op_sel_hi:[1,0]
v_pk_mul_f32 v[212:213],v[212:213],v[164:165] op_sel_hi:[1,0]
v_pk_mul_f32 v[214:215],v[214:215],v[164:165] op_sel_hi:[1,0]
CV v240,v208,v209
CV v241,v210,v211
CV v242,v212,v213
CV v243,v214,v215
buffer_store_dwordx4 v[240:243],v2,s[20:23],s53 offen sc1
AR v216,a72
AR v217,a73
AR v218,a74
AR v219,a75
AR v220,a76
AR v221,a77
AR v222,a78
AR v223,a79
v_pk_mul_f32 v[216:217],v[216:217],v[164:165] op_sel_hi:[1,0]
v_pk_mul_f32 v[218:219],v[218:219],v[164:165] op_sel_hi:[1,0]
v_pk_mul_f32 v[220:221],v[220:221],v[164:165] op_sel_hi:[1,0]
v_pk_mul_f32 v[222:223],v[222:223],v[164:165] op_sel_hi:[1,0]
CV v244,v216,v217
CV v245,v218,v219
CV v246,v220,v221
CV v247,v222,v223
buffer_store_dwordx4 v[244:247],v2,s[20:23],s53 offen offset:1024 sc1
AR v224,a80
AR v225,a81
AR v226,a82
AR v227,a83
AR v228,a84
AR v229,a85
AR v230,a86
AR v231,a87
v_pk_mul_f32 v[224:225],v[224:225],v[164:165] op_sel_hi:[1,0]
v_pk_mul_f32 v[226:227],v[226:227],v[164:165] op_sel_hi:[1,0]
v_pk_mul_f32 v[228:229],v[228:229],v[164:165] op_sel_hi:[1,0]
v_pk_mul_f32 v[230:231],v[230:231],v[164:165] op_sel_hi:[1,0]
CV v248,v224,v225
CV v249,v226,v227
CV v250,v228,v229
CV v251,v230,v231
buffer_store_dwordx4 v[248:251],v2,s[20:23],s53 offen offset:2048 sc1
AR v232,a88
AR v233,a89
AR v234,a90
AR v235,a91
AR v236,a92
AR v237,a93
AR v238,a94
AR v239,a95
v_pk_mul_f32 v[232:233],v[232:233],v[164:165] op_sel_hi:[1,0]
v_pk_mul_f32 v[234:235],v[234:235],v[164:165] op_sel_hi:[1,0]
v_pk_mul_f32 v[236:237],v[236:237],v[164:165] op_sel_hi:[1,0]
v_pk_mul_f32 v[238:239],v[238:239],v[164:165] op_sel_hi:[1,0]
CV v252,v232,v233
CV v253,v234,v235
CV v254,v236,v237
CV v255,v238,v239
buffer_store_dwordx4 v[252:255],v2,s[20:23],s53 offen offset:3072 sc1
s_add_u32 s53,s53,204800
v_rcp_f32 v164,v156
AR v208,a96
AR v209,a97
AR v210,a98
AR v211,a99
AR v212,a100
AR v213,a101
AR v214,a102
AR v215,a103
v_pk_mul_f32 v[208:209],v[208:209],v[164:165] op_sel_hi:[1,0]
v_pk_mul_f32 v[210:211],v[210:211],v[164:165] op_sel_hi:[1,0]
v_pk_mul_f32 v[212:213],v[212:213],v[164:165] op_sel_hi:[1,0]
v_pk_mul_f32 v[214:215],v[214:215],v[164:165] op_sel_hi:[1,0]
CV v240,v208,v209
CV v241,v210,v211
CV v242,v212,v213
CV v243,v214,v215
buffer_store_dwordx4 v[240:243],v2,s[20:23],s53 offen sc1
AR v216,a104
AR v217,a105
AR v218,a106
AR v219,a107
AR v220,a108
AR v221,a109
AR v222,a110
AR v223,a111
v_pk_mul_f32 v[216:217],v[216:217],v[164:165] op_sel_hi:[1,0]
v_pk_mul_f32 v[218:219],v[218:219],v[164:165] op_sel_hi:[1,0]
v_pk_mul_f32 v[220:221],v[220:221],v[164:165] op_sel_hi:[1,0]
v_pk_mul_f32 v[222:223],v[222:223],v[164:165] op_sel_hi:[1,0]
CV v244,v216,v217
CV v245,v218,v219
CV v246,v220,v221
CV v247,v222,v223
buffer_store_dwordx4 v[244:247],v2,s[20:23],s53 offen offset:1024 sc1
AR v224,a112
AR v225,a113
AR v226,a114
AR v227,a115
AR v228,a116
AR v229,a117
AR v230,a118
AR v231,a119
v_pk_mul_f32 v[224:225],v[224:225],v[164:165] op_sel_hi:[1,0]
v_pk_mul_f32 v[226:227],v[226:227],v[164:165] op_sel_hi:[1,0]
v_pk_mul_f32 v[228:229],v[228:229],v[164:165] op_sel_hi:[1,0]
v_pk_mul_f32 v[230:231],v[230:231],v[164:165] op_sel_hi:[1,0]
CV v248,v224,v225
CV v249,v226,v227
CV v250,v228,v229
CV v251,v230,v231
buffer_store_dwordx4 v[248:251],v2,s[20:23],s53 offen offset:2048 sc1
AR v232,a120
AR v233,a121
AR v234,a122
AR v235,a123
AR v236,a124
AR v237,a125
AR v238,a126
AR v239,a127
v_pk_mul_f32 v[232:233],v[232:233],v[164:165] op_sel_hi:[1,0]
v_pk_mul_f32 v[234:235],v[234:235],v[164:165] op_sel_hi:[1,0]
v_pk_mul_f32 v[236:237],v[236:237],v[164:165] op_sel_hi:[1,0]
v_pk_mul_f32 v[238:239],v[238:239],v[164:165] op_sel_hi:[1,0]
CV v252,v232,v233
CV v253,v234,v235
CV v254,v236,v237
CV v255,v238,v239
buffer_store_dwordx4 v[252:255],v2,s[20:23],s53 offen offset:3072 sc1
s_cmp_eq_u32 s36,7
s_cbranch_scc1 Lm_SM14
s_lshl_b32 s62,s36,2
s_sub_u32 s62,27,s62
s_lshl_b32 s40,s62,6
s_add_u32 s50,s50,s40
s_sub_u32 s62,s62,1
.p2align 5
Lm_S13:
LW 7
MF a[0:3],a[224:227],v[112:115],a[0:3]
s_barrier
v_exp_f32 v164,v80
MF a[32:35],a[224:227],v[116:119],a[32:35]
LW 6
v_add_u32 v4,0x4000,v5
v_and_b32 v4,0x1ffff,v4
MF a[4:7],a[228:231],v[112:115],a[4:7]
s_add_u32 s48,s48,16384
v_exp_f32 v165,v81
MF a[36:39],a[228:231],v[116:119],a[36:39]
LW 5
s_bfe_u32 m0,s48,0x110000
RD a[192:195],v4,0
MF a[8:11],a[232:235],v[112:115],a[8:11]
RD a[196:199],v4,1024
CV v128,v164,v165
MF a[40:43],a[232:235],v[116:119],a[40:43]
LW 6
v_exp_f32 v166,v82
MF a[12:15],a[236:239],v[112:115],a[12:15]
RD a[200:203],v4,2048
MF a[44:47],a[236:239],v[116:119],a[44:47]
LW 6
v_exp_f32 v167,v83
MF a[16:19],a[240:243],v[112:115],a[16:19]
RD a[204:207],v4,3072
CV v129,v166,v167
MF a[48:51],a[240:243],v[116:119],a[48:51]
LW 6
RD a[208:211],v4,4096
v_or3_b32 v6,v6,v128,v129
MF a[20:23],a[244:247],v[112:115],a[20:23]
v_exp_f32 v168,v84
MF a[52:55],a[244:247],v[116:119],a[52:55]
LW 6
buffer_load_dwordx4 v2,s[16:19],s48 offen sc1 lds
RD a[212:215],v4,5120
MF a[24:27],a[248:251],v[112:115],a[24:27]
v_exp_f32 v169,v85
MF a[56:59],a[248:251],v[116:119],a[56:59]
LW 6
RD a[216:219],v4,6144
CV v130,v168,v169
MF a[28:31],a[252:255],v[112:115],a[28:31]
buffer_load_dwordx4 v2,s[16:19],s48 offen offset:1024 sc1 lds
RD a[220:223],v4,7168
MF a[60:63],a[252:255],v[116:119],a[60:63]
v_exp_f32 v170,v86
MF v[144:147],v[160:163],v[112:115],v[144:147]
v_exp_f32 v171,v87
MF v[148:151],v[160:163],v[116:119],v[148:151]
LW 7
CV v131,v170,v171
v_or3_b32 v6,v6,v130,v131
MF v[48:51],a[192:195],a[128:131],v[16:19]
LW 6
v_exp_f32 v172,v88
MF v[48:51],a[196:199],a[132:135],v[48:51]
LW 5
v_exp_f32 v173,v89
MF v[48:51],a[200:203],a[136:139],v[48:51]
LW 4
RD a[224:227],v5,8192
CV v132,v172,v173
MF v[48:51],a[204:207],a[140:143],v[48:51]
LW 4
v_exp_f32 v174,v90
MF v[52:55],a[208:211],a[128:131],v[16:19]
LW 3
v_exp_f32 v175,v91
MF v[52:55],a[212:215],a[132:135],v[52:55]
LW 2
RD a[228:231],v5,9216
CV v133,v174,v175
MF v[52:55],a[216:219],a[136:139],v[52:55]
LW 2
v_exp_f32 v176,v92
MF v[52:55],a[220:223],a[140:143],v[52:55]
RD a[232:235],v5,10240
v_or3_b32 v6,v6,v132,v133
MF v[56:59],a[192:195],a[144:147],v[20:23]
buffer_load_dwordx4 v2,s[16:19],s48 offen offset:2048 sc1 lds
RD a[236:239],v5,11264
MF v[56:59],a[196:199],a[148:151],v[56:59]
v_exp_f32 v177,v93
MF v[56:59],a[200:203],a[152:155],v[56:59]
v_exp_f32 v178,v94
MF v[56:59],a[204:207],a[156:159],v[56:59]
RD a[240:243],v5,12288
CV v134,v176,v177
MF v[60:63],a[208:211],a[144:147],v[20:23]
v_exp_f32 v179,v95
MF v[60:63],a[212:215],a[148:151],v[60:63]
RD a[244:247],v5,13312
CV v135,v178,v179
MF v[60:63],a[216:219],a[152:155],v[60:63]
RD a[248:251],v5,14336
buffer_load_dwordx4 v2,s[16:19],s48 offen offset:3072 sc1 lds
RD a[252:255],v5,15360
v_or3_b32 v6,v6,v134,v135
v_and_b32 v15,0x40004000,v6
v_cmp_ne_u32 vcc,0,v15
MF v[60:63],a[220:223],a[156:159],v[60:63]
LW 7
s_cbranch_vccnz Lm_fx22
Lm_fx22r:
MF a[0:3],a[224:227],v[128:131],a[0:3]
v_exp_f32 v164,v48
MF a[32:35],a[224:227],v[132:135],a[32:35]
LW 6
v_add_u32 v5,0x4000,v4
v_and_b32 v5,0x1ffff,v5
MF a[4:7],a[228:231],v[128:131],a[4:7]
s_add_u32 s48,s48,16384
v_exp_f32 v165,v49
MF a[36:39],a[228:231],v[132:135],a[36:39]
LW 5
RD a[192:195],v5,0
CV v112,v164,v165
MF a[8:11],a[232:235],v[128:131],a[8:11]
s_bfe_u32 m0,s48,0x110000
v_exp_f32 v166,v50
MF a[40:43],a[232:235],v[132:135],a[40:43]
LW 5
RD a[196:199],v5,1024
MF a[12:15],a[236:239],v[128:131],a[12:15]
v_exp_f32 v167,v51
MF a[44:47],a[236:239],v[132:135],a[44:47]
LW 5
RD a[200:203],v5,2048
CV v113,v166,v167
MF a[16:19],a[240:243],v[128:131],a[16:19]
RD a[204:207],v5,3072
v_or3_b32 v6,v6,v112,v113
MF a[48:51],a[240:243],v[132:135],a[48:51]
LW 6
v_exp_f32 v168,v52
MF a[20:23],a[244:247],v[128:131],a[20:23]
buffer_load_dwordx4 v2,s[16:19],s48 offen sc1 lds
RD a[208:211],v5,4096
MF a[52:55],a[244:247],v[132:135],a[52:55]
LW 6
v_exp_f32 v169,v53
MF a[24:27],a[248:251],v[128:131],a[24:27]
RD a[212:215],v5,5120
CV v114,v168,v169
MF a[56:59],a[248:251],v[132:135],a[56:59]
LW 6
RD a[216:219],v5,6144
MF a[28:31],a[252:255],v[128:131],a[28:31]
v_exp_f32 v170,v54
MF a[60:63],a[252:255],v[132:135],a[60:63]
buffer_load_dwordx4 v2,s[16:19],s48 offen offset:1024 sc1 lds
RD a[220:223],v5,7168
MF v[144:147],v[160:163],v[128:131],v[144:147]
v_exp_f32 v171,v55
MF v[148:151],v[160:163],v[132:135],v[148:151]
LW 7
v_exp_f32 v172,v56
MF v[80:83],a[192:195],a[128:131],v[16:19]
LW 6
CV v115,v170,v171
v_or3_b32 v6,v6,v114,v115
MF v[80:83],a[196:199],a[132:135],v[80:83]
LW 5
v_exp_f32 v173,v57
MF v[80:83],a[200:203],a[136:139],v[80:83]
LW 4
v_exp_f32 v174,v58
MF v[80:83],a[204:207],a[140:143],v[80:83]
LW 3
v_exp_f32 v175,v59
MF v[84:87],a[208:211],a[128:131],v[16:19]
LW 2
v_exp_f32 v176,v60
MF v[84:87],a[212:215],a[132:135],v[84:87]
LW 1
RD a[224:227],v4,8192
CV v116,v172,v173
MF v[84:87],a[216:219],a[136:139],v[84:87]
LW 1
v_exp_f32 v177,v61
MF v[84:87],a[220:223],a[140:143],v[84:87]
v_exp_f32 v178,v62
MF v[88:91],a[192:195],a[144:147],v[20:23]
RD a[228:231],v4,9216
CV v117,v174,v175
MF v[88:91],a[196:199],a[148:151],v[88:91]
v_exp_f32 v179,v63
MF v[88:91],a[200:203],a[152:155],v[88:91]
RD a[232:235],v4,10240
v_or3_b32 v6,v6,v116,v117
MF v[88:91],a[204:207],a[156:159],v[88:91]
RD a[236:239],v4,11264
CV v118,v176,v177
MF v[92:95],a[208:211],a[144:147],v[20:23]
buffer_load_dwordx4 v2,s[16:19],s48 offen offset:2048 sc1 lds
RD a[240:243],v4,12288
MF v[92:95],a[212:215],a[148:151],v[92:95]
RD a[244:247],v4,13312
CV v119,v178,v179
MF v[92:95],a[216:219],a[152:155],v[92:95]
RD a[248:251],v4,14336
buffer_load_dwordx4 v2,s[16:19],s48 offen offset:3072 sc1 lds
RD a[252:255],v4,15360
v_or3_b32 v6,v6,v118,v119
v_and_b32 v15,0x40004000,v6
v_cmp_ne_u32 vcc,0,v15
MF v[92:95],a[220:223],a[156:159],v[92:95]
s_cbranch_vccnz Lm_fx23
Lm_fx23r:
s_waitcnt vmcnt(12)
s_sub_u32 s62,s62,1
s_cbranch_scc0 Lm_S13
LW 7
MF a[0:3],a[224:227],v[112:115],a[0:3]
s_barrier
v_exp_f32 v164,v80
MF a[32:35],a[224:227],v[116:119],a[32:35]
LW 6
v_exp_f32 v165,v81
MF a[4:7],a[228:231],v[112:115],a[4:7]
v_add_u32 v4,0x4000,v5
v_and_b32 v4,0x1ffff,v4
MF a[36:39],a[228:231],v[116:119],a[36:39]
LW 5
RD a[192:195],v4,0
CV v128,v164,v165
MF a[8:11],a[232:235],v[112:115],a[8:11]
s_cmp_gt_i32 s50,0
s_cselect_b32 s55,0xff7fff7f,0
RD a[196:199],v4,1024
MF a[40:43],a[232:235],v[116:119],a[40:43]
LW 6
v_exp_f32 v166,v82
MF a[12:15],a[236:239],v[112:115],a[12:15]
s_cmp_eq_u32 s50,0
s_cselect_b32 s54,-1,0
RD a[200:203],v4,2048
MF a[44:47],a[236:239],v[116:119],a[44:47]
LW 6
v_exp_f32 v167,v83
MF a[16:19],a[240:243],v[112:115],a[16:19]
RD a[204:207],v4,3072
CV v129,v166,v167
MF a[48:51],a[240:243],v[116:119],a[48:51]
LW 6
RD a[208:211],v4,4096
v_mov_b32 v3,s55
MF a[20:23],a[244:247],v[112:115],a[20:23]
v_and_or_b32 v40,v200,s54,v3
v_and_or_b32 v41,v201,s54,v3
MF a[52:55],a[244:247],v[116:119],a[52:55]
LW 6
RD a[212:215],v4,5120
v_and_or_b32 v42,v202,s54,v3
MF a[24:27],a[248:251],v[112:115],a[24:27]
v_exp_f32 v168,v84
MF a[56:59],a[248:251],v[116:119],a[56:59]
LW 6
RD a[216:219],v4,6144
v_and_or_b32 v43,v203,s54,v3
MF a[28:31],a[252:255],v[112:115],a[28:31]
v_or3_b32 v6,v6,v128,v129
v_and_or_b32 v44,v204,s54,v3
MF a[60:63],a[252:255],v[116:119],a[60:63]
RD a[220:223],v4,7168
v_and_or_b32 v45,v205,s54,v3
v_and_or_b32 v46,v206,s54,v3
v_and_or_b32 v47,v207,s54,v3
MF v[144:147],v[160:163],v[112:115],v[144:147]
v_exp_f32 v169,v85
MF v[148:151],v[160:163],v[116:119],v[148:151]
v_exp_f32 v170,v86
MF v[48:51],v[192:195],v[40:43],v[16:19]
LW 7
v_exp_f32 v171,v87
MF v[48:51],a[192:195],a[128:131],v[48:51]
LW 6
CV v130,v168,v169
CV v131,v170,v171
MF v[48:51],a[196:199],a[132:135],v[48:51]
LW 5
v_exp_f32 v172,v88
MF v[48:51],a[200:203],a[136:139],v[48:51]
LW 4
v_exp_f32 v173,v89
MF v[48:51],a[204:207],a[140:143],v[48:51]
RD a[224:227],v5,8192
v_or3_b32 v6,v6,v130,v131
MF v[52:55],v[196:199],v[40:43],v[16:19]
LW 4
v_exp_f32 v174,v90
MF v[52:55],a[208:211],a[128:131],v[52:55]
LW 3
v_exp_f32 v175,v91
MF v[52:55],a[212:215],a[132:135],v[52:55]
LW 2
v_exp_f32 v176,v92
MF v[52:55],a[216:219],a[136:139],v[52:55]
LW 1
CV v132,v172,v173
CV v133,v174,v175
MF v[52:55],a[220:223],a[140:143],v[52:55]
v_exp_f32 v177,v93
MF v[56:59],v[192:195],v[44:47],v[20:23]
v_exp_f32 v178,v94
MF v[56:59],a[192:195],a[144:147],v[56:59]
RD a[228:231],v5,9216
v_or3_b32 v6,v6,v132,v133
MF v[56:59],a[196:199],a[148:151],v[56:59]
RD a[232:235],v5,10240
CV v134,v176,v177
MF v[56:59],a[200:203],a[152:155],v[56:59]
v_exp_f32 v179,v95
MF v[56:59],a[204:207],a[156:159],v[56:59]
RD a[236:239],v5,11264
CV v135,v178,v179
MF v[60:63],v[196:199],v[44:47],v[20:23]
RD a[240:243],v5,12288
v_or3_b32 v6,v6,v134,v135
MF v[60:63],a[208:211],a[144:147],v[60:63]
RD a[244:247],v5,13312
v_and_b32 v15,0x40004000,v6
MF v[60:63],a[212:215],a[148:151],v[60:63]
RD a[248:251],v5,14336
v_cmp_ne_u32 vcc,0,v15
MF v[60:63],a[216:219],a[152:155],v[60:63]
s_add_u32 s50,s50,32
s_add_u32 s51,s51,32
RD a[252:255],v5,15360
MF v[60:63],a[220:223],a[156:159],v[60:63]
LW 7
s_cbranch_vccnz Lm_fx24
Lm_fx24r:
MF a[0:3],a[224:227],v[128:131],a[0:3]
v_exp_f32 v164,v48
MF a[32:35],a[224:227],v[132:135],a[32:35]
LW 6
v_add_u32 v5,0x4000,v4
v_and_b32 v5,0x1ffff,v5
MF a[4:7],a[228:231],v[128:131],a[4:7]
s_cmp_gt_i32 s50,0
s_cselect_b32 s55,0xff7fff7f,0
RD a[192:195],v5,0
MF a[36:39],a[228:231],v[132:135],a[36:39]
LW 6
v_exp_f32 v165,v49
MF a[8:11],a[232:235],v[128:131],a[8:11]
RD a[196:199],v5,1024
CV v112,v164,v165
MF a[40:43],a[232:235],v[132:135],a[40:43]
LW 6
RD a[200:203],v5,2048
MF a[12:15],a[236:239],v[128:131],a[12:15]
s_cmp_eq_u32 s50,0
s_cselect_b32 s54,-1,0
RD a[204:207],v5,3072
MF a[44:47],a[236:239],v[132:135],a[44:47]
LW 7
v_exp_f32 v166,v50
MF a[16:19],a[240:243],v[128:131],a[16:19]
RD a[208:211],v5,4096
v_mov_b32 v3,s55
MF a[48:51],a[240:243],v[132:135],a[48:51]
LW 7
v_exp_f32 v167,v51
MF a[20:23],a[244:247],v[128:131],a[20:23]
CV v113,v166,v167
v_and_or_b32 v40,v200,s54,v3
MF a[52:55],a[244:247],v[132:135],a[52:55]
LW 6
RD a[212:215],v5,5120
v_and_or_b32 v41,v201,s54,v3
MF a[24:27],a[248:251],v[128:131],a[24:27]
v_and_or_b32 v42,v202,s54,v3
v_and_or_b32 v43,v203,s54,v3
MF a[56:59],a[248:251],v[132:135],a[56:59]
LW 6
RD a[216:219],v5,6144
v_and_or_b32 v44,v204,s54,v3
MF a[28:31],a[252:255],v[128:131],a[28:31]
RD a[220:223],v5,7168
v_and_or_b32 v45,v205,s54,v3
MF a[60:63],a[252:255],v[132:135],a[60:63]
v_and_or_b32 v46,v206,s54,v3
v_and_or_b32 v47,v207,s54,v3
v_or3_b32 v6,v6,v112,v113
MF v[144:147],v[160:163],v[128:131],v[144:147]
v_exp_f32 v168,v52
MF v[148:151],v[160:163],v[132:135],v[148:151]
v_exp_f32 v169,v53
MF v[80:83],v[192:195],v[40:43],v[16:19]
LW 7
v_exp_f32 v170,v54
MF v[80:83],a[192:195],a[128:131],v[80:83]
LW 6
RD a[224:227],v4,8192
CV v114,v168,v169
MF v[80:83],a[196:199],a[132:135],v[80:83]
LW 6
v_exp_f32 v171,v55
MF v[80:83],a[200:203],a[136:139],v[80:83]
LW 5
CV v115,v170,v171
v_or3_b32 v6,v6,v114,v115
MF v[80:83],a[204:207],a[140:143],v[80:83]
v_exp_f32 v172,v56
MF v[84:87],v[196:199],v[40:43],v[16:19]
LW 4
v_exp_f32 v173,v57
MF v[84:87],a[208:211],a[128:131],v[84:87]
LW 3
v_exp_f32 v174,v58
MF v[84:87],a[212:215],a[132:135],v[84:87]
LW 2
RD a[228:231],v4,9216
CV v116,v172,v173
MF v[84:87],a[216:219],a[136:139],v[84:87]
LW 2
v_exp_f32 v175,v59
MF v[84:87],a[220:223],a[140:143],v[84:87]
v_exp_f32 v176,v60
MF v[88:91],v[192:195],v[44:47],v[20:23]
RD a[232:235],v4,10240
CV v117,v174,v175
MF v[88:91],a[192:195],a[144:147],v[88:91]
v_exp_f32 v177,v61
MF v[88:91],a[196:199],a[148:151],v[88:91]
RD a[236:239],v4,11264
v_or3_b32 v6,v6,v116,v117
MF v[88:91],a[200:203],a[152:155],v[88:91]
v_exp_f32 v178,v62
MF v[88:91],a[204:207],a[156:159],v[88:91]
v_exp_f32 v179,v63
MF v[92:95],v[196:199],v[44:47],v[20:23]
RD a[240:243],v4,12288
CV v118,v176,v177
MF v[92:95],a[208:211],a[144:147],v[92:95]
RD a[244:247],v4,13312
CV v119,v178,v179
MF v[92:95],a[212:215],a[148:151],v[92:95]
RD a[248:251],v4,14336
v_or3_b32 v6,v6,v118,v119
MF v[92:95],a[216:219],a[152:155],v[92:95]
s_add_u32 s50,s50,32
RD a[252:255],v4,15360
v_and_b32 v15,0x40004000,v6
v_cmp_ne_u32 vcc,0,v15
MF v[92:95],a[220:223],a[156:159],v[92:95]
s_cbranch_vccnz Lm_fx25
Lm_fx25r:
s_add_u32 s51,s51,32
Lm_SM14:
s_waitcnt vmcnt(0)
LW 7
MF a[0:3],a[224:227],v[112:115],a[0:3]
s_barrier
v_exp_f32 v164,v80
MF a[32:35],a[224:227],v[116:119],a[32:35]
LW 6
v_add_u32 v4,0x4000,v5
v_and_b32 v4,0x1ffff,v4
MF a[4:7],a[228:231],v[112:115],a[4:7]
s_lshl_b32 s42,s34,4
s_lshl_b32 s7,s42,4
RD a[192:195],v4,0
MF a[36:39],a[228:231],v[116:119],a[36:39]
LW 6
v_exp_f32 v165,v81
MF a[8:11],a[232:235],v[112:115],a[8:11]
s_add_u32 s7,s7,0x8303000
v_lshl_add_u32 v11,v1,2,s7
CV v128,v164,v165
MF a[40:43],a[232:235],v[116:119],a[40:43]
LW 5
RD a[196:199],v4,1024
global_load_dword v12,v11,s[4:5] sc1
MF a[12:15],a[236:239],v[112:115],a[12:15]
s_cmp_gt_i32 s50,0
s_cselect_b32 s55,0xff7fff7f,0
RD a[200:203],v4,2048
MF a[44:47],a[236:239],v[116:119],a[44:47]
LW 6
v_exp_f32 v166,v82
MF a[16:19],a[240:243],v[112:115],a[16:19]
s_cmp_eq_u32 s50,0
s_cselect_b32 s54,-1,0
v_mov_b32 v3,s55
MF a[48:51],a[240:243],v[116:119],a[48:51]
LW 5
v_exp_f32 v167,v83
MF a[20:23],a[244:247],v[112:115],a[20:23]
v_and_or_b32 v40,v200,s54,v3
CV v129,v166,v167
MF a[52:55],a[244:247],v[116:119],a[52:55]
LW 4
RD a[204:207],v4,3072
v_and_or_b32 v41,v201,s54,v3
MF a[24:27],a[248:251],v[112:115],a[24:27]
s_lshl_b32 s42,s33,4
RD a[208:211],v4,4096
v_and_or_b32 v42,v202,s54,v3
MF a[56:59],a[248:251],v[116:119],a[56:59]
LW 5
RD a[212:215],v4,5120
v_and_or_b32 v43,v203,s54,v3
MF a[28:31],a[252:255],v[112:115],a[28:31]
s_lshl_b32 s7,s42,4
v_exp_f32 v168,v84
MF a[60:63],a[252:255],v[116:119],a[60:63]
s_add_u32 s7,s7,0x8306000
RD a[216:219],v4,6144
RD a[220:223],v4,7168
v_and_or_b32 v44,v204,s54,v3
v_and_or_b32 v45,v205,s54,v3
v_and_or_b32 v46,v206,s54,v3
v_and_or_b32 v47,v207,s54,v3
MF v[144:147],v[160:163],v[112:115],v[144:147]
v_lshl_add_u32 v32,v1,2,s7
v_or3_b32 v6,v6,v128,v129
MF v[148:151],v[160:163],v[116:119],v[148:151]
v_exp_f32 v169,v85
MF v[48:51],v[192:195],v[40:43],v[16:19]
LW 7
v_exp_f32 v170,v86
MF v[48:51],a[192:195],a[128:131],v[48:51]
LW 6
global_load_dword v33,v32,s[4:5] sc1
CV v130,v168,v169
MF v[48:51],a[196:199],a[132:135],v[48:51]
LW 5
v_exp_f32 v171,v87
MF v[48:51],a[200:203],a[136:139],v[48:51]
LW 4
v_exp_f32 v172,v88
MF v[48:51],a[204:207],a[140:143],v[48:51]
s_mov_b32 s46,s45
CV v131,v170,v171
v_or3_b32 v6,v6,v130,v131
MF v[52:55],v[196:199],v[40:43],v[16:19]
LW 3
v_exp_f32 v173,v89
MF v[52:55],a[208:211],a[128:131],v[52:55]
LW 2
v_exp_f32 v174,v90
MF v[52:55],a[212:215],a[132:135],v[52:55]
LW 1
v_exp_f32 v175,v91
MF v[52:55],a[216:219],a[136:139],v[52:55]
LW 0
RD a[224:227],v5,8192
CV v132,v172,v173
MF v[52:55],a[220:223],a[140:143],v[52:55]
s_mov_b32 s47,0
v_exp_f32 v176,v92
MF v[56:59],v[192:195],v[44:47],v[20:23]
s_and_b32 s48,s36,1
v_exp_f32 v177,v93
MF v[56:59],a[192:195],a[144:147],v[56:59]
s_xor_b32 s48,s48,1
RD a[228:231],v5,9216
CV v133,v174,v175
MF v[56:59],a[196:199],a[148:151],v[56:59]
s_mul_i32 s48,s48,73728
v_exp_f32 v178,v94
MF v[56:59],a[200:203],a[152:155],v[56:59]
s_mov_b32 s49,s48
v_exp_f32 v179,v95
MF v[56:59],a[204:207],a[156:159],v[56:59]
s_lshl_b32 s7,s2,4
RD a[232:235],v5,10240
v_or3_b32 v6,v6,v132,v133
MF v[60:63],v[196:199],v[44:47],v[20:23]
s_lshl_b32 s41,s32,2
RD a[236:239],v5,11264
CV v134,v176,v177
MF v[60:63],a[208:211],a[144:147],v[60:63]
s_add_u32 s7,s7,s41
RD a[240:243],v5,12288
CV v135,v178,v179
MF v[60:63],a[212:215],a[148:151],v[60:63]
s_add_u32 s7,s7,0x8308000
RD a[244:247],v5,13312
v_or3_b32 v6,v6,v134,v135
MF v[60:63],a[216:219],a[152:155],v[60:63]
s_add_u32 s50,s50,32
RD a[248:251],v5,14336
RD a[252:255],v5,15360
v_and_b32 v15,0x40004000,v6
v_cmp_ne_u32 vcc,0,v15
v_mov_b32 v13,s7
v_mov_b32 v14,s3
global_store_dword v13,v14,s[4:5] sc1
MF v[60:63],a[220:223],a[156:159],v[60:63]
LW 7
s_cbranch_vccnz Lm_fx29
Lm_fx29r:
s_add_u32 s51,s51,32
MF a[0:3],a[224:227],v[128:131],a[0:3]
s_waitcnt vmcnt(2)
v_cmp_ne_u32 vcc,s3,v12
s_nop 0
s_cbranch_vccnz Lm_pl27
Lm_pl27r:
s_waitcnt vmcnt(1)
v_cmp_ne_u32 vcc,s3,v33
s_nop 0
s_cbranch_vccnz Lm_pl28
Lm_pl28r:
MF a[32:35],a[224:227],v[132:135],a[32:35]
LW 6
v_exp_f32 v164,v48
MF a[4:7],a[228:231],v[128:131],a[4:7]
s_add_u32 s43,s45,s48
v_add_u32 v5,0x4000,v4
v_and_b32 v5,0x1ffff,v5
MF a[36:39],a[228:231],v[132:135],a[36:39]
LW 5
s_add_u32 m0,s43,0
RD a[192:195],v5,0
MF a[8:11],a[232:235],v[128:131],a[8:11]
s_cmp_gt_i32 s50,0
s_cselect_b32 s55,0xff7fff7f,0
RD a[196:199],v5,1024
MF a[40:43],a[232:235],v[132:135],a[40:43]
LW 6
v_exp_f32 v165,v49
MF a[12:15],a[236:239],v[128:131],a[12:15]
RD a[200:203],v5,2048
CV v112,v164,v165
MF a[44:47],a[236:239],v[132:135],a[44:47]
LW 6
buffer_load_dwordx4 v2,s[12:15],s46 offen sc1 lds
RD a[204:207],v5,3072
MF a[16:19],a[240:243],v[128:131],a[16:19]
buffer_load_dwordx4 v2,s[12:15],s46 offen offset:1024 sc1 lds
RD a[208:211],v5,4096
MF a[48:51],a[240:243],v[132:135],a[48:51]
LW 7
v_exp_f32 v166,v50
MF a[20:23],a[244:247],v[128:131],a[20:23]
s_cmp_eq_u32 s50,0
s_cselect_b32 s54,-1,0
RD a[212:215],v5,5120
MF a[52:55],a[244:247],v[132:135],a[52:55]
LW 7
v_exp_f32 v167,v51
MF a[24:27],a[248:251],v[128:131],a[24:27]
CV v113,v166,v167
v_or3_b32 v6,v6,v112,v113
MF a[56:59],a[248:251],v[132:135],a[56:59]
LW 6
RD a[216:219],v5,6144
v_mov_b32 v3,s55
MF a[28:31],a[252:255],v[128:131],a[28:31]
RD a[220:223],v5,7168
v_and_or_b32 v40,v200,s54,v3
MF a[60:63],a[252:255],v[132:135],a[60:63]
buffer_load_dwordx4 v2,s[12:15],s46 offen offset:2048 sc1 lds
v_and_or_b32 v41,v201,s54,v3
v_and_or_b32 v42,v202,s54,v3
v_and_or_b32 v43,v203,s54,v3
v_and_or_b32 v44,v204,s54,v3
v_and_or_b32 v45,v205,s54,v3
v_and_or_b32 v46,v206,s54,v3
v_and_or_b32 v47,v207,s54,v3
MF v[144:147],v[160:163],v[128:131],v[144:147]
v_exp_f32 v168,v52
MF v[148:151],v[160:163],v[132:135],v[148:151]
buffer_load_dwordx4 v2,s[12:15],s46 offen offset:3072 sc1 lds
s_add_u32 m0,s43,4096
MF v[80:83],v[192:195],v[40:43],v[16:19]
LW 7
v_exp_f32 v169,v53
MF v[80:83],a[192:195],a[128:131],v[80:83]
LW 6
buffer_load_dwordx4 v26,s[12:15],s46 offen sc1 lds
CV v114,v168,v169
MF v[80:83],a[196:199],a[132:135],v[80:83]
LW 5
v_exp_f32 v170,v54
MF v[80:83],a[200:203],a[136:139],v[80:83]
LW 4
v_exp_f32 v171,v55
MF v[80:83],a[204:207],a[140:143],v[80:83]
CV v115,v170,v171
v_or3_b32 v6,v6,v114,v115
MF v[84:87],v[196:199],v[40:43],v[16:19]
LW 3
buffer_load_dwordx4 v26,s[12:15],s46 offen offset:1024 sc1 lds
buffer_load_dwordx4 v26,s[12:15],s46 offen offset:2048 sc1 lds
MF v[84:87],a[208:211],a[128:131],v[84:87]
LW 2
v_exp_f32 v172,v56
MF v[84:87],a[212:215],a[132:135],v[84:87]
LW 1
v_exp_f32 v173,v57
MF v[84:87],a[216:219],a[136:139],v[84:87]
LW 0
RD a[224:227],v4,8192
CV v116,v172,v173
MF v[84:87],a[220:223],a[140:143],v[84:87]
buffer_load_dwordx4 v26,s[12:15],s46 offen offset:3072 sc1 lds
RD a[228:231],v4,9216
MF v[88:91],v[192:195],v[44:47],v[20:23]
s_add_u32 m0,s43,8192
v_exp_f32 v174,v58
MF v[88:91],a[192:195],a[144:147],v[88:91]
buffer_load_dwordx4 v27,s[12:15],s46 offen sc1 lds
RD a[232:235],v4,10240
MF v[88:91],a[196:199],a[148:151],v[88:91]
s_add_u32 s46,s46,36864
v_exp_f32 v175,v59
MF v[88:91],a[200:203],a[152:155],v[88:91]
s_add_u32 s48,s48,36864
CV v117,v174,v175
v_or3_b32 v6,v6,v116,v117
MF v[88:91],a[204:207],a[156:159],v[88:91]
v_exp_f32 v176,v60
MF v[92:95],v[196:199],v[44:47],v[20:23]
s_cmp_eq_u32 s48,147456
s_cselect_b32 s48,0,s48
RD a[236:239],v4,11264
MF v[92:95],a[208:211],a[144:147],v[92:95]
RD a[240:243],v4,12288
buffer_load_dwordx4 a[64:67],v24,s[8:11],s47 offen sc1
MF v[92:95],a[212:215],a[148:151],v[92:95]
v_exp_f32 v177,v61
v_exp_f32 v178,v62
v_exp_f32 v179,v63
MF v[92:95],a[216:219],a[152:155],v[92:95]
s_add_u32 s50,s50,32
buffer_load_dwordx4 a[68:71],v25,s[8:11],s47 offen sc1
RD a[244:247],v4,13312
buffer_load_dwordx4 a[72:75],v24,s[8:11],s47 offen offset:1024 sc1
RD a[248:251],v4,14336
buffer_load_dwordx4 a[76:79],v25,s[8:11],s47 offen offset:1024 sc1
RD a[252:255],v4,15360
CV v118,v176,v177
CV v119,v178,v179
v_or3_b32 v6,v6,v118,v119
v_and_b32 v15,0x40004000,v6
v_cmp_ne_u32 vcc,0,v15
MF v[92:95],a[220:223],a[156:159],v[92:95]
LW 7
s_cbranch_vccnz Lm_fx26
Lm_fx26r:
s_add_u32 s51,s51,32
MF a[0:3],a[224:227],v[112:115],a[0:3]
v_exp_f32 v164,v80
MF a[32:35],a[224:227],v[116:119],a[32:35]
LW 6
v_exp_f32 v165,v81
MF a[4:7],a[228:231],v[112:115],a[4:7]
s_add_u32 s43,s45,s48
v_exp_f32 v166,v82
MF a[36:39],a[228:231],v[116:119],a[36:39]
LW 5
v_exp_f32 v167,v83
MF a[8:11],a[232:235],v[112:115],a[8:11]
s_add_u32 m0,s43,0
CV v128,v164,v165
CV v129,v166,v167
MF a[40:43],a[232:235],v[116:119],a[40:43]
LW 4
buffer_load_dwordx4 v2,s[12:15],s46 offen sc1 lds
buffer_load_dwordx4 v2,s[12:15],s46 offen offset:1024 sc1 lds
MF a[12:15],a[236:239],v[112:115],a[12:15]
v_exp_f32 v168,v84
MF a[44:47],a[236:239],v[116:119],a[44:47]
LW 3
v_exp_f32 v169,v85
MF a[16:19],a[240:243],v[112:115],a[16:19]
v_exp_f32 v170,v86
MF a[48:51],a[240:243],v[116:119],a[48:51]
LW 2
v_or3_b32 v6,v6,v128,v129
CV v130,v168,v169
MF a[20:23],a[244:247],v[112:115],a[20:23]
v_exp_f32 v171,v87
MF a[52:55],a[244:247],v[116:119],a[52:55]
LW 1
v_exp_f32 v172,v88
MF a[24:27],a[248:251],v[112:115],a[24:27]
buffer_load_dwordx4 v2,s[12:15],s46 offen offset:2048 sc1 lds
CV v131,v170,v171
MF a[56:59],a[248:251],v[116:119],a[56:59]
LW 0
v_exp_f32 v173,v89
MF a[28:31],a[252:255],v[112:115],a[28:31]
v_or3_b32 v6,v6,v130,v131
CV v132,v172,v173
MF a[60:63],a[252:255],v[116:119],a[60:63]
v_exp_f32 v174,v90
v_exp_f32 v175,v91
v_exp_f32 v176,v92
v_exp_f32 v177,v93
v_exp_f32 v178,v94
v_exp_f32 v179,v95
MF v[144:147],v[160:163],v[112:115],v[144:147]
buffer_load_dwordx4 v2,s[12:15],s46 offen offset:3072 sc1 lds
CV v133,v174,v175
v_or3_b32 v6,v6,v132,v133
CV v134,v176,v177
CV v135,v178,v179
v_or3_b32 v6,v6,v134,v135
v_and_b32 v15,0x40004000,v6
v_cmp_ne_u32 vcc,0,v15
MF v[148:151],v[160:163],v[116:119],v[148:151]
s_cbranch_vccnz Lm_fx30
Lm_fx30r:
RD a[224:227],v5,8192
RD a[228:231],v5,9216
RD a[232:235],v5,10240
RD a[236:239],v5,11264
RD a[240:243],v5,12288
RD a[244:247],v5,13312
RD a[248:251],v5,14336
RD a[252:255],v5,15360
LW 0
s_barrier
MF a[0:3],a[224:227],v[128:131],a[0:3]
s_add_u32 m0,s43,4096
MF a[32:35],a[224:227],v[132:135],a[32:35]
buffer_load_dwordx4 v26,s[12:15],s46 offen sc1 lds
MF a[4:7],a[228:231],v[128:131],a[4:7]
buffer_load_dwordx4 v26,s[12:15],s46 offen offset:1024 sc1 lds
MF a[36:39],a[228:231],v[132:135],a[36:39]
MF a[8:11],a[232:235],v[128:131],a[8:11]
buffer_load_dwordx4 v26,s[12:15],s46 offen offset:2048 sc1 lds
MF a[40:43],a[232:235],v[132:135],a[40:43]
MF a[12:15],a[236:239],v[128:131],a[12:15]
buffer_load_dwordx4 v26,s[12:15],s46 offen offset:3072 sc1 lds
MF a[44:47],a[236:239],v[132:135],a[44:47]
MF a[16:19],a[240:243],v[128:131],a[16:19]
s_add_u32 m0,s43,8192
MF a[48:51],a[240:243],v[132:135],a[48:51]
buffer_load_dwordx4 v27,s[12:15],s46 offen sc1 lds
s_add_u32 s46,s46,36864
MF a[20:23],a[244:247],v[128:131],a[20:23]
s_add_u32 s48,s48,36864
s_cmp_eq_u32 s48,147456
s_cselect_b32 s48,0,s48
MF a[52:55],a[244:247],v[132:135],a[52:55]
buffer_load_dwordx4 a[80:83],v24,s[8:11],s47 offen offset:2048 sc1
MF a[24:27],a[248:251],v[128:131],a[24:27]
buffer_load_dwordx4 a[84:87],v25,s[8:11],s47 offen offset:2048 sc1
MF a[56:59],a[248:251],v[132:135],a[56:59]
MF a[28:31],a[252:255],v[128:131],a[28:31]
buffer_load_dwordx4 a[88:91],v24,s[8:11],s47 offen offset:3072 sc1
MF a[60:63],a[252:255],v[132:135],a[60:63]
MF v[144:147],v[160:163],v[128:131],v[144:147]
buffer_load_dwordx4 a[92:95],v25,s[8:11],s47 offen offset:3072 sc1
s_add_u32 s47,s47,4096
MF v[148:151],v[160:163],v[132:135],v[148:151]
s_nop 7
buffer_load_dwordx4 a[96:99],v24,s[8:11],s47 offen sc1
v_rcp_f32 v164,v144
AR v224,a0
AR v225,a1
AR v226,a2
AR v227,a3
AR v228,a4
AR v229,a5
AR v230,a6
AR v231,a7
v_pk_mul_f32 v[224:225],v[224:225],v[164:165] op_sel_hi:[1,0]
v_pk_mul_f32 v[226:227],v[226:227],v[164:165] op_sel_hi:[1,0]
v_pk_mul_f32 v[228:229],v[228:229],v[164:165] op_sel_hi:[1,0]
v_pk_mul_f32 v[230:231],v[230:231],v[164:165] op_sel_hi:[1,0]
CV v180,v224,v225
CV v181,v226,v227
CV v182,v228,v229
CV v183,v230,v231
buffer_store_dwordx4 v[180:183],v2,s[20:23],s52 offen sc1
AR v232,a8
AR v233,a9
AR v234,a10
AR v235,a11
AR v236,a12
AR v237,a13
AR v238,a14
AR v239,a15
v_pk_mul_f32 v[232:233],v[232:233],v[164:165] op_sel_hi:[1,0]
v_pk_mul_f32 v[234:235],v[234:235],v[164:165] op_sel_hi:[1,0]
v_pk_mul_f32 v[236:237],v[236:237],v[164:165] op_sel_hi:[1,0]
v_pk_mul_f32 v[238:239],v[238:239],v[164:165] op_sel_hi:[1,0]
CV v184,v232,v233
CV v185,v234,v235
CV v186,v236,v237
buffer_load_dwordx4 a[100:103],v25,s[8:11],s47 offen sc1
CV v187,v238,v239
AR v240,a16
AR v241,a17
AR v242,a18
AR v243,a19
AR v244,a20
AR v245,a21
AR v246,a22
AR v247,a23
v_pk_mul_f32 v[240:241],v[240:241],v[164:165] op_sel_hi:[1,0]
v_pk_mul_f32 v[242:243],v[242:243],v[164:165] op_sel_hi:[1,0]
v_pk_mul_f32 v[244:245],v[244:245],v[164:165] op_sel_hi:[1,0]
v_pk_mul_f32 v[246:247],v[246:247],v[164:165] op_sel_hi:[1,0]
CV v188,v240,v241
CV v189,v242,v243
CV v190,v244,v245
CV v191,v246,v247
AR v216,a24
AR v217,a25
AR v218,a26
AR v219,a27
AR v220,a28
AR v221,a29
AR v222,a30
AR v223,a31
v_pk_mul_f32 v[216:217],v[216:217],v[164:165] op_sel_hi:[1,0]
v_pk_mul_f32 v[218:219],v[218:219],v[164:165] op_sel_hi:[1,0]
v_pk_mul_f32 v[220:221],v[220:221],v[164:165] op_sel_hi:[1,0]
v_pk_mul_f32 v[222:223],v[222:223],v[164:165] op_sel_hi:[1,0]
CV v192,v216,v217
CV v193,v218,v219
CV v194,v220,v221
CV v195,v222,v223
buffer_load_dwordx4 a[104:107],v24,s[8:11],s47 offen offset:1024 sc1
s_add_u32 s53,s52,204800
v_rcp_f32 v164,v148
AR v224,a32
AR v225,a33
AR v226,a34
AR v227,a35
AR v228,a36
AR v229,a37
AR v230,a38
AR v231,a39
v_pk_mul_f32 v[224:225],v[224:225],v[164:165] op_sel_hi:[1,0]
v_pk_mul_f32 v[226:227],v[226:227],v[164:165] op_sel_hi:[1,0]
v_pk_mul_f32 v[228:229],v[228:229],v[164:165] op_sel_hi:[1,0]
v_pk_mul_f32 v[230:231],v[230:231],v[164:165] op_sel_hi:[1,0]
CV v196,v224,v225
CV v197,v226,v227
CV v198,v228,v229
CV v199,v230,v231
AR v232,a40
AR v233,a41
AR v234,a42
AR v235,a43
AR v236,a44
AR v237,a45
AR v238,a46
AR v239,a47
v_pk_mul_f32 v[232:233],v[232:233],v[164:165] op_sel_hi:[1,0]
v_pk_mul_f32 v[234:235],v[234:235],v[164:165] op_sel_hi:[1,0]
v_pk_mul_f32 v[236:237],v[236:237],v[164:165] op_sel_hi:[1,0]
v_pk_mul_f32 v[238:239],v[238:239],v[164:165] op_sel_hi:[1,0]
CV v200,v232,v233
CV v201,v234,v235
CV v202,v236,v237
buffer_load_dwordx4 a[108:111],v25,s[8:11],s47 offen offset:1024 sc1
CV v203,v238,v239
AR v240,a48
AR v241,a49
AR v242,a50
AR v243,a51
AR v244,a52
AR v245,a53
AR v246,a54
AR v247,a55
v_pk_mul_f32 v[240:241],v[240:241],v[164:165] op_sel_hi:[1,0]
v_pk_mul_f32 v[242:243],v[242:243],v[164:165] op_sel_hi:[1,0]
v_pk_mul_f32 v[244:245],v[244:245],v[164:165] op_sel_hi:[1,0]
v_pk_mul_f32 v[246:247],v[246:247],v[164:165] op_sel_hi:[1,0]
CV v204,v240,v241
CV v205,v242,v243
CV v206,v244,v245
CV v207,v246,v247
AR v216,a56
AR v217,a57
AR v218,a58
AR v219,a59
AR v220,a60
AR v221,a61
AR v222,a62
AR v223,a63
v_pk_mul_f32 v[216:217],v[216:217],v[164:165] op_sel_hi:[1,0]
v_pk_mul_f32 v[218:219],v[218:219],v[164:165] op_sel_hi:[1,0]
v_pk_mul_f32 v[220:221],v[220:221],v[164:165] op_sel_hi:[1,0]
v_pk_mul_f32 v[222:223],v[222:223],v[164:165] op_sel_hi:[1,0]
CV v208,v216,v217
CV v209,v218,v219
CV v210,v220,v221
CV v211,v222,v223
Lm_sp:
s_waitcnt vmcnt(18)
s_barrier
v_add_u32 v3,s49,v2
s_add_u32 s49,s49,36864
s_cmp_eq_u32 s49,147456
s_cselect_b32 s49,0,s49
RD a[128:131],v3,0
RD a[132:135],v3,1024
RD a[136:139],v3,2048
RD a[140:143],v3,3072
RD a[144:147],v3,4096
RD a[148:151],v3,5120
RD a[152:155],v3,6144
RD a[156:159],v3,7168
RD a[160:163],v3,8192
RD a[164:167],v3,9216
RD a[168:171],v3,10240
RD a[172:175],v3,11264
RD a[176:179],v3,12288
RD a[180:183],v3,13312
RD a[184:187],v3,14336
RD a[188:191],v3,15360
RD a[192:195],v3,16384
RD a[196:199],v3,17408
LW 15
MF v[64:67],a[128:131],a[64:67],0
LW 8
buffer_load_dwordx4 a[112:115],v24,s[8:11],s47 offen offset:2048 sc1
RD a[200:203],v3,18432
MF v[64:67],a[164:167],a[72:75],v[64:67]
LW 8
s_add_u32 s43,s45,s48
s_add_u32 m0,s43,0
MF v[68:71],a[168:171],a[72:75],0
RD a[0:3],v3,27648
buffer_load_dwordx4 v2,s[12:15],s46 offen sc1 lds
MF v[68:71],a[132:135],a[64:67],v[68:71]
buffer_load_dwordx4 a[116:119],v25,s[8:11],s47 offen offset:2048 sc1
buffer_load_dwordx4 v2,s[12:15],s46 offen offset:1024 sc1 lds
MF v[72:75],a[136:139],a[64:67],0
LW 8
buffer_load_dwordx4 a[120:123],v24,s[8:11],s47 offen offset:3072 sc1
RD a[204:207],v3,19456
MF v[72:75],a[172:175],a[72:75],v[72:75]
LW 8
buffer_load_dwordx4 v2,s[12:15],s46 offen offset:2048 sc1 lds
MF v[76:79],a[176:179],a[72:75],0
buffer_load_dwordx4 a[124:127],v25,s[8:11],s47 offen offset:3072 sc1
RD a[4:7],v3,28672
MF v[76:79],a[140:143],a[64:67],v[76:79]
s_add_u32 s47,s47,4096
buffer_load_dwordx4 v2,s[12:15],s46 offen offset:3072 sc1 lds
MF v[80:83],a[144:147],a[64:67],0
LW 8
RD a[208:211],v3,20480
MF v[80:83],a[180:183],a[72:75],v[80:83]
LW 8
s_add_u32 m0,s43,4096
MF v[84:87],a[184:187],a[72:75],0
RD a[8:11],v3,29696
buffer_load_dwordx4 v26,s[12:15],s46 offen sc1 lds
MF v[84:87],a[148:151],a[64:67],v[84:87]
buffer_load_dwordx4 v26,s[12:15],s46 offen offset:1024 sc1 lds
buffer_load_dwordx4 v26,s[12:15],s46 offen offset:2048 sc1 lds
MF v[88:91],a[152:155],a[64:67],0
LW 8
buffer_load_dwordx4 v26,s[12:15],s46 offen offset:3072 sc1 lds
RD a[212:215],v3,21504
MF v[88:91],a[188:191],a[72:75],v[88:91]
LW 8
s_add_u32 m0,s43,8192
MF v[92:95],a[192:195],a[72:75],0
buffer_load_dwordx4 v27,s[12:15],s46 offen sc1 lds
s_add_u32 s46,s46,36864
MF v[92:95],a[156:159],a[64:67],v[92:95]
s_add_u32 s48,s48,36864
s_cmp_eq_u32 s48,147456
s_cselect_b32 s48,0,s48
MF v[96:99],a[160:163],a[64:67],0
LW 7
s_mul_i32 s40,s2,36864
RD a[12:15],v3,30720
MF v[96:99],a[196:199],a[72:75],v[96:99]
s_add_u32 s40,s40,0x2400000
s_add_u32 s24,s4,s40
s_addc_u32 s25,s5,0
MF v[100:103],a[128:131],a[68:71],0
s_mov_b32 s26,0x9000
s_mov_b32 s27,0x20000
s_mov_b32 s28,s82
MF v[100:103],a[164:167],a[76:79],v[100:103]
s_mov_b32 s29,s83
s_mov_b32 s30,0x1000
s_mov_b32 s31,0x20000
MF v[104:107],a[168:171],a[76:79],0
RD a[216:219],v3,22528
v_bfe_u32 v28,v1,2,2
MF v[104:107],a[132:135],a[68:71],v[104:107]
RD a[16:19],v3,31744
v_lshlrev_b32 v28,3,v28
MF v[108:111],a[136:139],a[68:71],0
v_and_b32 v29,3,v1
v_add_u32 v29,v29,v28
MF v[108:111],a[172:175],a[76:79],v[108:111]
s_lshl_b32 s40,s37,4
RD a[220:223],v3,23552
v_add_u32 v29,s40,v29
MF v[112:115],a[176:179],a[76:79],0
RD a[20:23],v3,32768
v_lshlrev_b32 v20,1,v29
MF v[112:115],a[140:143],a[68:71],v[112:115]
s_and_b32 s41,s34,1
s_mul_i32 s40,s41,-4608
RD a[224:227],v3,24576
MF v[116:119],a[144:147],a[68:71],0
s_add_u32 s40,s40,5120
RD a[24:27],v3,33792
MF v[116:119],a[180:183],a[76:79],v[116:119]
v_lshl_add_u32 v21,v1,3,s40
MF v[120:123],a[184:187],a[76:79],0
s_mul_i32 s50,s37,204800
RD a[228:231],v3,25600
MF v[120:123],a[148:151],a[68:71],v[120:123]
s_lshr_b32 s40,s34,3
MF v[124:127],a[152:155],a[68:71],0
s_mul_i32 s40,s40,204800
RD a[28:31],v3,34816
MF v[124:127],a[188:191],a[76:79],v[124:127]
s_add_u32 s41,s50,s40
MF v[128:131],a[192:195],a[76:79],0
RD a[232:235],v3,26624
v_add_u32 v17,s41,v2
MF v[128:131],a[156:159],a[68:71],v[128:131]
v_lshl_add_u32 v14,v1,3,s41
MF v[132:135],a[160:163],a[68:71],0
RD a[32:35],v3,35840
MF v[132:135],a[196:199],a[76:79],v[132:135]
LW 15
s_waitcnt vmcnt(18)
MF v[64:67],a[200:203],a[80:83],v[64:67]
s_barrier
MF v[64:67],a[0:3],a[88:91],v[64:67]
LW 14
buffer_load_dwordx4 a[64:67],v24,s[8:11],s47 offen sc1
v_add_u32 v3,s49,v2
MF v[68:71],a[4:7],a[88:91],v[68:71]
s_add_u32 s49,s49,36864
s_add_u32 s43,s45,s48
s_add_u32 m0,s43,0
MF v[68:71],a[204:207],a[80:83],v[68:71]
LW 13
buffer_load_dwordx4 v2,s[12:15],s46 offen sc1 lds
buffer_load_dwordx4 a[68:71],v25,s[8:11],s47 offen sc1
MF v[72:75],a[208:211],a[80:83],v[72:75]
LW 12
s_cmp_eq_u32 s49,147456
s_cselect_b32 s49,0,s49
MF v[72:75],a[8:11],a[88:91],v[72:75]
LW 10
buffer_load_dwordx4 v2,s[12:15],s46 offen offset:1024 sc1 lds
RD a[128:131],v3,0
MF v[76:79],a[12:15],a[88:91],v[76:79]
RD a[164:167],v3,9216
buffer_load_dwordx4 a[72:75],v24,s[8:11],s47 offen offset:1024 sc1
MF v[76:79],a[212:215],a[80:83],v[76:79]
LW 11
buffer_load_dwordx4 v2,s[12:15],s46 offen offset:2048 sc1 lds
MF v[80:83],a[216:219],a[80:83],v[80:83]
LW 10
buffer_load_dwordx4 a[76:79],v25,s[8:11],s47 offen offset:1024 sc1
RD a[132:135],v3,1024
MF v[80:83],a[16:19],a[88:91],v[80:83]
LW 9
buffer_load_dwordx4 v2,s[12:15],s46 offen offset:3072 sc1 lds
RD a[168:171],v3,10240
MF v[84:87],a[20:23],a[88:91],v[84:87]
MF v[84:87],a[220:223],a[80:83],v[84:87]
LW 9
RD a[136:139],v3,2048
s_add_u32 m0,s43,4096
MF v[88:91],a[224:227],a[80:83],v[88:91]
LW 9
buffer_load_dwordx4 v26,s[12:15],s46 offen sc1 lds
s_sub_u32 s41,s50,s40
MF v[88:91],a[24:27],a[88:91],v[88:91]
LW 7
s_add_u32 s41,s41,204800
RD a[172:175],v3,11264
MF v[92:95],a[28:31],a[88:91],v[92:95]
v_add_u32 v18,s41,v2
MF v[92:95],a[228:231],a[80:83],v[92:95]
LW 7
RD a[140:143],v3,3072
MF v[96:99],a[232:235],a[80:83],v[96:99]
LW 7
RD a[176:179],v3,12288
v_lshl_add_u32 v15,v1,3,s41
MF v[96:99],a[32:35],a[88:91],v[96:99]
s_mul_i32 s40,s34,9
MF v[100:103],a[200:203],a[84:87],v[100:103]
s_add_u32 s40,s40,1
RD a[144:147],v3,4096
MF v[100:103],a[0:3],a[92:95],v[100:103]
s_lshr_b32 s40,s40,1
MF v[104:107],a[4:7],a[92:95],v[104:107]
RD a[180:183],v3,13312
MF v[104:107],a[204:207],a[84:87],v[104:107]
s_add_u32 s40,s40,127
MF v[108:111],a[208:211],a[84:87],v[108:111]
buffer_store_dwordx4 v[184:187],v2,s[20:23],s52 offen offset:1024 sc1
RD a[148:151],v3,5120
MF v[108:111],a[8:11],a[92:95],v[108:111]
s_lshl_b32 s40,s40,10
RD a[184:187],v3,14336
MF v[112:115],a[12:15],a[92:95],v[112:115]
s_add_u32 s50,s50,s40
MF v[112:115],a[212:215],a[84:87],v[112:115]
RD a[152:155],v3,6144
MF v[116:119],a[216:219],a[84:87],v[116:119]
s_add_u32 s51,s50,204800
MF v[116:119],a[16:19],a[92:95],v[116:119]
RD a[188:191],v3,15360
v_add_u32 v22,1024,v2
MF v[120:123],a[20:23],a[92:95],v[120:123]
v_lshlrev_b32 v19,3,v1
MF v[120:123],a[220:223],a[84:87],v[120:123]
s_mul_i32 s40,s32,9216
RD a[156:159],v3,7168
MF v[124:127],a[224:227],a[84:87],v[124:127]
RD a[192:195],v3,16384
MF v[124:127],a[24:27],a[92:95],v[124:127]
v_add_u32 v19,s40,v19
MF v[128:131],a[28:31],a[92:95],v[128:131]
s_lshr_b32 s54,s34,2
RD a[160:163],v3,8192
MF v[128:131],a[228:231],a[84:87],v[128:131]
s_and_b32 s55,s34,3
MF v[132:135],a[232:235],a[84:87],v[132:135]
RD a[196:199],v3,17408
MF v[132:135],a[32:35],a[92:95],v[132:135]
LW 15
s_waitcnt vmcnt(23)
MF v[64:67],a[128:131],a[96:99],v[64:67]
buffer_load_dwordx4 a[80:83],v24,s[8:11],s47 offen offset:2048 sc1
RD a[200:203],v3,18432
MF v[64:67],a[164:167],a[104:107],v[64:67]
LW 15
buffer_load_dwordx4 v26,s[12:15],s46 offen offset:1024 sc1 lds
MF v[68:71],a[168:171],a[104:107],v[68:71]
RD a[0:3],v3,27648
MF v[68:71],a[132:135],a[96:99],v[68:71]
LW 15
buffer_load_dwordx4 a[84:87],v25,s[8:11],s47 offen offset:2048 sc1
MF v[72:75],a[136:139],a[96:99],v[72:75]
LW 14
RD a[204:207],v3,19456
MF v[72:75],a[172:175],a[104:107],v[72:75]
LW 13
buffer_load_dwordx4 v26,s[12:15],s46 offen offset:2048 sc1 lds
MF v[76:79],a[176:179],a[104:107],v[76:79]
RD a[4:7],v3,28672
MF v[76:79],a[140:143],a[96:99],v[76:79]
LW 13
buffer_load_dwordx4 a[88:91],v24,s[8:11],s47 offen offset:3072 sc1
MF v[80:83],a[144:147],a[96:99],v[80:83]
LW 12
buffer_load_dwordx4 v26,s[12:15],s46 offen offset:3072 sc1 lds
RD a[208:211],v3,20480
MF v[80:83],a[180:183],a[104:107],v[80:83]
LW 11
MF v[84:87],a[184:187],a[104:107],v[84:87]
buffer_load_dwordx4 a[92:95],v25,s[8:11],s47 offen offset:3072 sc1
RD a[8:11],v3,29696
MF v[84:87],a[148:151],a[96:99],v[84:87]
LW 11
s_add_u32 s47,s47,4096
MF v[88:91],a[152:155],a[96:99],v[88:91]
LW 10
s_add_u32 m0,s43,8192
RD a[212:215],v3,21504
MF v[88:91],a[188:191],a[104:107],v[88:91]
LW 9
buffer_load_dwordx4 v27,s[12:15],s46 offen sc1 lds
s_add_u32 s46,s46,36864
MF v[92:95],a[192:195],a[104:107],v[92:95]
s_add_u32 s48,s48,36864
s_cmp_eq_u32 s48,147456
s_cselect_b32 s48,0,s48
MF v[92:95],a[156:159],a[96:99],v[92:95]
LW 8
s_movk_i32 s40,0
RD a[12:15],v3,30720
MF v[96:99],a[160:163],a[96:99],v[96:99]
LW 8
buffer_load_dwordx2 v[140:141],v19,s[24:27],s40 offen
s_movk_i32 s40,512
MF v[96:99],a[196:199],a[104:107],v[96:99]
RD a[216:219],v3,22528
buffer_load_dwordx2 v[142:143],v19,s[24:27],s40 offen
MF v[100:103],a[128:131],a[100:103],v[100:103]
s_movk_i32 s40,1024
RD a[16:19],v3,31744
buffer_load_dwordx2 v[144:145],v19,s[24:27],s40 offen
MF v[100:103],a[164:167],a[108:111],v[100:103]
s_movk_i32 s40,1536
buffer_load_dwordx2 v[146:147],v19,s[24:27],s40 offen
MF v[104:107],a[168:171],a[108:111],v[104:107]
RD a[220:223],v3,23552
MF v[104:107],a[132:135],a[100:103],v[104:107]
s_movk_i32 s40,2048
buffer_load_dwordx2 v[148:149],v19,s[24:27],s40 offen
MF v[108:111],a[136:139],a[100:103],v[108:111]
s_movk_i32 s40,2560
buffer_load_dwordx2 v[150:151],v19,s[24:27],s40 offen
RD a[20:23],v3,32768
MF v[108:111],a[172:175],a[108:111],v[108:111]
MF v[112:115],a[176:179],a[108:111],v[112:115]
s_movk_i32 s40,3072
buffer_load_dwordx2 v[152:153],v19,s[24:27],s40 offen
RD a[224:227],v3,24576
MF v[112:115],a[140:143],a[100:103],v[112:115]
MF v[116:119],a[144:147],a[100:103],v[116:119]
s_movk_i32 s40,3584
buffer_load_dwordx2 v[154:155],v19,s[24:27],s40 offen
RD a[24:27],v3,33792
MF v[116:119],a[180:183],a[108:111],v[116:119]
MF v[120:123],a[184:187],a[108:111],v[120:123]
s_movk_i32 s40,4096
buffer_load_dwordx2 v[156:157],v19,s[24:27],s40 offen
RD a[228:231],v3,25600
MF v[120:123],a[148:151],a[100:103],v[120:123]
s_movk_i32 s40,4608
buffer_load_dwordx2 v[158:159],v19,s[24:27],s40 offen
MF v[124:127],a[152:155],a[100:103],v[124:127]
RD a[28:31],v3,34816
MF v[124:127],a[188:191],a[108:111],v[124:127]
s_movk_i32 s40,5120
buffer_load_dwordx2 v[160:161],v19,s[24:27],s40 offen
MF v[128:131],a[192:195],a[108:111],v[128:131]
RD a[232:235],v3,26624
MF v[128:131],a[156:159],a[100:103],v[128:131]
s_movk_i32 s40,5632
buffer_load_dwordx2 v[162:163],v19,s[24:27],s40 offen
MF v[132:135],a[160:163],a[100:103],v[132:135]
RD a[32:35],v3,35840
MF v[132:135],a[196:199],a[108:111],v[132:135]
LW 15
s_waitcnt vmcnt(30)
MF v[64:67],a[200:203],a[112:115],v[64:67]
s_barrier
MF v[64:67],a[0:3],a[120:123],v[64:67]
LW 14
buffer_load_dwordx4 a[96:99],v24,s[8:11],s47 offen sc1
v_add_u32 v3,s49,v2
MF v[68:71],a[4:7],a[120:123],v[68:71]
s_add_u32 s49,s49,36864
s_cmp_eq_u32 s49,147456
s_cselect_b32 s49,0,s49
MF v[68:71],a[204:207],a[112:115],v[68:71]
LW 13
s_add_u32 s43,s45,s48
s_add_u32 m0,s43,0
MF v[72:75],a[208:211],a[112:115],v[72:75]
LW 12
RD a[128:131],v3,0
buffer_load_dwordx4 v2,s[12:15],s46 offen sc1 lds
MF v[72:75],a[8:11],a[120:123],v[72:75]
LW 11
buffer_load_dwordx4 a[100:103],v25,s[8:11],s47 offen sc1
MF v[76:79],a[12:15],a[120:123],v[76:79]
RD a[164:167],v3,9216
MF v[76:79],a[212:215],a[112:115],v[76:79]
LW 11
buffer_load_dwordx4 v2,s[12:15],s46 offen offset:1024 sc1 lds
MF v[80:83],a[216:219],a[112:115],v[80:83]
LW 10
RD a[132:135],v3,1024
MF v[80:83],a[16:19],a[120:123],v[80:83]
LW 9
RD a[168:171],v3,10240
buffer_load_dwordx4 a[104:107],v24,s[8:11],s47 offen offset:1024 sc1
MF v[84:87],a[20:23],a[120:123],v[84:87]
MF v[84:87],a[220:223],a[112:115],v[84:87]
LW 9
buffer_load_dwordx4 v2,s[12:15],s46 offen offset:2048 sc1 lds
RD a[136:139],v3,2048
MF v[88:91],a[224:227],a[112:115],v[88:91]
LW 9
MF v[88:91],a[24:27],a[120:123],v[88:91]
LW 7
buffer_load_dwordx4 a[108:111],v25,s[8:11],s47 offen offset:1024 sc1
RD a[172:175],v3,11264
MF v[92:95],a[28:31],a[120:123],v[92:95]
MF v[92:95],a[228:231],a[112:115],v[92:95]
LW 7
buffer_load_dwordx4 v2,s[12:15],s46 offen offset:3072 sc1 lds
RD a[140:143],v3,3072
MF v[96:99],a[232:235],a[112:115],v[96:99]
LW 7
RD a[176:179],v3,12288
MF v[96:99],a[32:35],a[120:123],v[96:99]
MF v[100:103],a[200:203],a[116:119],v[100:103]
s_add_u32 m0,s43,4096
RD a[144:147],v3,4096
MF v[100:103],a[0:3],a[124:127],v[100:103]
buffer_load_dwordx4 v26,s[12:15],s46 offen sc1 lds
MF v[104:107],a[4:7],a[124:127],v[104:107]
s_movk_i32 s40,6144
RD a[180:183],v3,13312
buffer_load_dwordx2 v[164:165],v19,s[24:27],s40 offen
MF v[104:107],a[204:207],a[116:119],v[104:107]
MF v[108:111],a[208:211],a[116:119],v[108:111]
s_movk_i32 s40,6656
buffer_load_dwordx2 v[166:167],v19,s[24:27],s40 offen
RD a[148:151],v3,5120
MF v[108:111],a[8:11],a[124:127],v[108:111]
RD a[184:187],v3,14336
MF v[112:115],a[12:15],a[124:127],v[112:115]
s_movk_i32 s40,7168
buffer_load_dwordx2 v[168:169],v19,s[24:27],s40 offen
MF v[112:115],a[212:215],a[116:119],v[112:115]
RD a[152:155],v3,6144
MF v[116:119],a[216:219],a[116:119],v[116:119]
s_movk_i32 s40,7680
buffer_load_dwordx2 v[170:171],v19,s[24:27],s40 offen
MF v[116:119],a[16:19],a[124:127],v[116:119]
RD a[188:191],v3,15360
MF v[120:123],a[20:23],a[124:127],v[120:123]
s_movk_i32 s40,8192
buffer_load_dwordx2 v[172:173],v19,s[24:27],s40 offen
MF v[120:123],a[220:223],a[116:119],v[120:123]
RD a[156:159],v3,7168
MF v[124:127],a[224:227],a[116:119],v[124:127]
s_movk_i32 s40,8704
buffer_load_dwordx2 v[174:175],v19,s[24:27],s40 offen
RD a[192:195],v3,16384
MF v[124:127],a[24:27],a[124:127],v[124:127]
MF v[128:131],a[28:31],a[124:127],v[128:131]
buffer_store_dwordx4 v[188:191],v2,s[20:23],s52 offen offset:2048 sc1
RD a[160:163],v3,8192
MF v[128:131],a[228:231],a[116:119],v[128:131]
MF v[132:135],a[232:235],a[116:119],v[132:135]
RD a[196:199],v3,17408
MF v[132:135],a[32:35],a[124:127],v[132:135]
LW 15
s_waitcnt vmcnt(39)
MF v[64:67],a[128:131],a[64:67],v[64:67]
buffer_load_dwordx4 a[112:115],v24,s[8:11],s47 offen offset:2048 sc1
RD a[200:203],v3,18432
MF v[64:67],a[164:167],a[72:75],v[64:67]
LW 15
MF v[68:71],a[168:171],a[72:75],v[68:71]
RD a[0:3],v3,27648
MF v[68:71],a[132:135],a[64:67],v[68:71]
LW 15
MF v[72:75],a[136:139],a[64:67],v[72:75]
LW 14
buffer_load_dwordx4 v26,s[12:15],s46 offen offset:1024 sc1 lds
RD a[204:207],v3,19456
MF v[72:75],a[172:175],a[72:75],v[72:75]
LW 13
MF v[76:79],a[176:179],a[72:75],v[76:79]
RD a[4:7],v3,28672
MF v[76:79],a[140:143],a[64:67],v[76:79]
LW 13
MF v[80:83],a[144:147],a[64:67],v[80:83]
LW 12
buffer_load_dwordx4 a[116:119],v25,s[8:11],s47 offen offset:2048 sc1
RD a[208:211],v3,20480
MF v[80:83],a[180:183],a[72:75],v[80:83]
LW 11
MF v[84:87],a[184:187],a[72:75],v[84:87]
RD a[8:11],v3,29696
MF v[84:87],a[148:151],a[64:67],v[84:87]
LW 11
MF v[88:91],a[152:155],a[64:67],v[88:91]
LW 10
RD a[212:215],v3,21504
MF v[88:91],a[188:191],a[72:75],v[88:91]
LW 9
buffer_load_dwordx4 v26,s[12:15],s46 offen offset:2048 sc1 lds
MF v[92:95],a[192:195],a[72:75],v[92:95]
RD a[12:15],v3,30720
MF v[92:95],a[156:159],a[64:67],v[92:95]
LW 9
MF v[96:99],a[160:163],a[64:67],v[96:99]
LW 8
RD a[216:219],v3,22528
MF v[96:99],a[196:199],a[72:75],v[96:99]
buffer_load_dwordx4 a[120:123],v24,s[8:11],s47 offen offset:3072 sc1
MF v[100:103],a[128:131],a[68:71],v[100:103]
RD a[16:19],v3,31744
MF v[100:103],a[164:167],a[76:79],v[100:103]
MF v[104:107],a[168:171],a[76:79],v[104:107]
RD a[220:223],v3,23552
MF v[104:107],a[132:135],a[68:71],v[104:107]
buffer_load_dwordx4 v26,s[12:15],s46 offen offset:3072 sc1 lds
MF v[108:111],a[136:139],a[68:71],v[108:111]
RD a[20:23],v3,32768
MF v[108:111],a[172:175],a[76:79],v[108:111]
MF v[112:115],a[176:179],a[76:79],v[112:115]
RD a[224:227],v3,24576
MF v[112:115],a[140:143],a[68:71],v[112:115]
MF v[116:119],a[144:147],a[68:71],v[116:119]
buffer_load_dwordx4 a[124:127],v25,s[8:11],s47 offen offset:3072 sc1
RD a[24:27],v3,33792
MF v[116:119],a[180:183],a[76:79],v[116:119]
s_add_u32 s47,s47,4096
MF v[120:123],a[184:187],a[76:79],v[120:123]
RD a[228:231],v3,25600
MF v[120:123],a[148:151],a[68:71],v[120:123]
MF v[124:127],a[152:155],a[68:71],v[124:127]
s_add_u32 m0,s43,8192
RD a[28:31],v3,34816
MF v[124:127],a[188:191],a[76:79],v[124:127]
buffer_load_dwordx4 v27,s[12:15],s46 offen sc1 lds
s_add_u32 s46,s46,36864
MF v[128:131],a[192:195],a[76:79],v[128:131]
s_add_u32 s48,s48,36864
s_cmp_eq_u32 s48,147456
s_cselect_b32 s48,0,s48
MF v[128:131],a[156:159],a[68:71],v[128:131]
RD a[232:235],v3,26624
MF v[132:135],a[160:163],a[68:71],v[132:135]
RD a[32:35],v3,35840
MF v[132:135],a[196:199],a[76:79],v[132:135]
LW 15
s_waitcnt vmcnt(36)
MF v[64:67],a[200:203],a[80:83],v[64:67]
s_barrier
MF v[64:67],a[0:3],a[88:91],v[64:67]
LW 14
buffer_load_dwordx4 a[64:67],v24,s[8:11],s47 offen sc1
v_add_u32 v3,s49,v2
MF v[68:71],a[4:7],a[88:91],v[68:71]
s_add_u32 s49,s49,36864
s_cmp_eq_u32 s49,147456
s_cselect_b32 s49,0,s49
MF v[68:71],a[204:207],a[80:83],v[68:71]
LW 13
MF v[72:75],a[208:211],a[80:83],v[72:75]
LW 12
s_add_u32 s43,s45,s48
s_add_u32 m0,s43,0
MF v[72:75],a[8:11],a[88:91],v[72:75]
LW 10
RD a[128:131],v3,0
buffer_load_dwordx4 v2,s[12:15],s46 offen sc1 lds
MF v[76:79],a[12:15],a[88:91],v[76:79]
RD a[164:167],v3,9216
MF v[76:79],a[212:215],a[80:83],v[76:79]
LW 11
buffer_load_dwordx4 a[68:71],v25,s[8:11],s47 offen sc1
MF v[80:83],a[216:219],a[80:83],v[80:83]
LW 10
RD a[132:135],v3,1024
MF v[80:83],a[16:19],a[88:91],v[80:83]
LW 9
RD a[168:171],v3,10240
MF v[84:87],a[20:23],a[88:91],v[84:87]
MF v[84:87],a[220:223],a[80:83],v[84:87]
LW 9
RD a[136:139],v3,2048
buffer_load_dwordx4 v2,s[12:15],s46 offen offset:1024 sc1 lds
MF v[88:91],a[224:227],a[80:83],v[88:91]
LW 9
MF v[88:91],a[24:27],a[88:91],v[88:91]
LW 7
RD a[172:175],v3,11264
MF v[92:95],a[28:31],a[88:91],v[92:95]
buffer_load_dwordx4 a[72:75],v24,s[8:11],s47 offen offset:1024 sc1
MF v[92:95],a[228:231],a[80:83],v[92:95]
LW 7
RD a[140:143],v3,3072
MF v[96:99],a[232:235],a[80:83],v[96:99]
LW 7
RD a[176:179],v3,12288
MF v[96:99],a[32:35],a[88:91],v[96:99]
MF v[100:103],a[200:203],a[84:87],v[100:103]
RD a[144:147],v3,4096
buffer_load_dwordx4 v2,s[12:15],s46 offen offset:2048 sc1 lds
MF v[100:103],a[0:3],a[92:95],v[100:103]
MF v[104:107],a[4:7],a[92:95],v[104:107]
RD a[180:183],v3,13312
MF v[104:107],a[204:207],a[84:87],v[104:107]
buffer_load_dwordx4 a[76:79],v25,s[8:11],s47 offen offset:1024 sc1
MF v[108:111],a[208:211],a[84:87],v[108:111]
RD a[148:151],v3,5120
MF v[108:111],a[8:11],a[92:95],v[108:111]
RD a[184:187],v3,14336
MF v[112:115],a[12:15],a[92:95],v[112:115]
buffer_load_dwordx4 v2,s[12:15],s46 offen offset:3072 sc1 lds
MF v[112:115],a[212:215],a[84:87],v[112:115]
RD a[152:155],v3,6144
MF v[116:119],a[216:219],a[84:87],v[116:119]
MF v[116:119],a[16:19],a[92:95],v[116:119]
RD a[188:191],v3,15360
MF v[120:123],a[20:23],a[92:95],v[120:123]
s_add_u32 m0,s43,4096
MF v[120:123],a[220:223],a[84:87],v[120:123]
RD a[156:159],v3,7168
buffer_load_dwordx4 v26,s[12:15],s46 offen sc1 lds
MF v[124:127],a[224:227],a[84:87],v[124:127]
RD a[192:195],v3,16384
MF v[124:127],a[24:27],a[92:95],v[124:127]
buffer_store_dwordx4 v[192:195],v2,s[20:23],s52 offen offset:3072 sc1
MF v[128:131],a[28:31],a[92:95],v[128:131]
RD a[160:163],v3,8192
MF v[128:131],a[228:231],a[84:87],v[128:131]
MF v[132:135],a[232:235],a[84:87],v[132:135]
RD a[196:199],v3,17408
MF v[132:135],a[32:35],a[92:95],v[132:135]
LW 15
s_waitcnt vmcnt(27)
MF v[64:67],a[128:131],a[96:99],v[64:67]
buffer_load_dwordx4 a[80:83],v24,s[8:11],s47 offen offset:2048 sc1
RD a[200:203],v3,18432
MF v[64:67],a[164:167],a[104:107],v[64:67]
LW 15
MF v[68:71],a[168:171],a[104:107],v[68:71]
RD a[0:3],v3,27648
MF v[68:71],a[132:135],a[96:99],v[68:71]
LW 15
MF v[72:75],a[136:139],a[96:99],v[72:75]
LW 14
buffer_load_dwordx4 v26,s[12:15],s46 offen offset:1024 sc1 lds
RD a[204:207],v3,19456
MF v[72:75],a[172:175],a[104:107],v[72:75]
LW 13
MF v[76:79],a[176:179],a[104:107],v[76:79]
RD a[4:7],v3,28672
MF v[76:79],a[140:143],a[96:99],v[76:79]
LW 13
MF v[80:83],a[144:147],a[96:99],v[80:83]
LW 12
buffer_load_dwordx4 a[84:87],v25,s[8:11],s47 offen offset:2048 sc1
RD a[208:211],v3,20480
MF v[80:83],a[180:183],a[104:107],v[80:83]
LW 11
MF v[84:87],a[184:187],a[104:107],v[84:87]
RD a[8:11],v3,29696
MF v[84:87],a[148:151],a[96:99],v[84:87]
LW 11
MF v[88:91],a[152:155],a[96:99],v[88:91]
LW 10
RD a[212:215],v3,21504
MF v[88:91],a[188:191],a[104:107],v[88:91]
LW 9
buffer_load_dwordx4 v26,s[12:15],s46 offen offset:2048 sc1 lds
MF v[92:95],a[192:195],a[104:107],v[92:95]
RD a[12:15],v3,30720
MF v[92:95],a[156:159],a[96:99],v[92:95]
LW 9
MF v[96:99],a[160:163],a[96:99],v[96:99]
LW 8
RD a[216:219],v3,22528
MF v[96:99],a[196:199],a[104:107],v[96:99]
buffer_load_dwordx4 a[88:91],v24,s[8:11],s47 offen offset:3072 sc1
MF v[100:103],a[128:131],a[100:103],v[100:103]
RD a[16:19],v3,31744
MF v[100:103],a[164:167],a[108:111],v[100:103]
MF v[104:107],a[168:171],a[108:111],v[104:107]
RD a[220:223],v3,23552
MF v[104:107],a[132:135],a[100:103],v[104:107]
buffer_load_dwordx4 v26,s[12:15],s46 offen offset:3072 sc1 lds
MF v[108:111],a[136:139],a[100:103],v[108:111]
RD a[20:23],v3,32768
MF v[108:111],a[172:175],a[108:111],v[108:111]
MF v[112:115],a[176:179],a[108:111],v[112:115]
RD a[224:227],v3,24576
MF v[112:115],a[140:143],a[100:103],v[112:115]
MF v[116:119],a[144:147],a[100:103],v[116:119]
buffer_load_dwordx4 a[92:95],v25,s[8:11],s47 offen offset:3072 sc1
RD a[24:27],v3,33792
MF v[116:119],a[180:183],a[108:111],v[116:119]
s_add_u32 s47,s47,4096
MF v[120:123],a[184:187],a[108:111],v[120:123]
RD a[228:231],v3,25600
MF v[120:123],a[148:151],a[100:103],v[120:123]
MF v[124:127],a[152:155],a[100:103],v[124:127]
s_add_u32 m0,s43,8192
RD a[28:31],v3,34816
MF v[124:127],a[188:191],a[108:111],v[124:127]
buffer_load_dwordx4 v27,s[12:15],s46 offen sc1 lds
s_add_u32 s46,s46,36864
MF v[128:131],a[192:195],a[108:111],v[128:131]
s_add_u32 s48,s48,36864
s_cmp_eq_u32 s48,147456
s_cselect_b32 s48,0,s48
MF v[128:131],a[156:159],a[100:103],v[128:131]
RD a[232:235],v3,26624
MF v[132:135],a[160:163],a[100:103],v[132:135]
RD a[32:35],v3,35840
MF v[132:135],a[196:199],a[108:111],v[132:135]
LW 15
s_waitcnt vmcnt(18)
MF v[64:67],a[200:203],a[112:115],v[64:67]
s_barrier
MF v[64:67],a[0:3],a[120:123],v[64:67]
LW 14
buffer_load_dwordx4 a[96:99],v24,s[8:11],s47 offen sc1
v_add_u32 v3,s49,v2
MF v[68:71],a[4:7],a[120:123],v[68:71]
s_add_u32 s49,s49,36864
s_cmp_eq_u32 s49,147456
s_cselect_b32 s49,0,s49
MF v[68:71],a[204:207],a[112:115],v[68:71]
LW 13
MF v[72:75],a[208:211],a[112:115],v[72:75]
LW 12
s_add_u32 s43,s45,s48
s_add_u32 m0,s43,0
MF v[72:75],a[8:11],a[120:123],v[72:75]
LW 10
RD a[128:131],v3,0
buffer_load_dwordx4 v2,s[12:15],s46 offen sc1 lds
MF v[76:79],a[12:15],a[120:123],v[76:79]
RD a[164:167],v3,9216
MF v[76:79],a[212:215],a[112:115],v[76:79]
LW 11
buffer_load_dwordx4 a[100:103],v25,s[8:11],s47 offen sc1
MF v[80:83],a[216:219],a[112:115],v[80:83]
LW 10
RD a[132:135],v3,1024
MF v[80:83],a[16:19],a[120:123],v[80:83]
LW 9
RD a[168:171],v3,10240
MF v[84:87],a[20:23],a[120:123],v[84:87]
MF v[84:87],a[220:223],a[112:115],v[84:87]
LW 9
RD a[136:139],v3,2048
buffer_load_dwordx4 v2,s[12:15],s46 offen offset:1024 sc1 lds
MF v[88:91],a[224:227],a[112:115],v[88:91]
LW 9
MF v[88:91],a[24:27],a[120:123],v[88:91]
LW 7
RD a[172:175],v3,11264
MF v[92:95],a[28:31],a[120:123],v[92:95]
buffer_load_dwordx4 a[104:107],v24,s[8:11],s47 offen offset:1024 sc1
MF v[92:95],a[228:231],a[112:115],v[92:95]
LW 7
RD a[140:143],v3,3072
MF v[96:99],a[232:235],a[112:115],v[96:99]
LW 7
RD a[176:179],v3,12288
MF v[96:99],a[32:35],a[120:123],v[96:99]
MF v[100:103],a[200:203],a[116:119],v[100:103]
RD a[144:147],v3,4096
buffer_load_dwordx4 v2,s[12:15],s46 offen offset:2048 sc1 lds
MF v[100:103],a[0:3],a[124:127],v[100:103]
MF v[104:107],a[4:7],a[124:127],v[104:107]
RD a[180:183],v3,13312
MF v[104:107],a[204:207],a[116:119],v[104:107]
buffer_load_dwordx4 a[108:111],v25,s[8:11],s47 offen offset:1024 sc1
MF v[108:111],a[208:211],a[116:119],v[108:111]
RD a[148:151],v3,5120
MF v[108:111],a[8:11],a[124:127],v[108:111]
RD a[184:187],v3,14336
MF v[112:115],a[12:15],a[124:127],v[112:115]
buffer_load_dwordx4 v2,s[12:15],s46 offen offset:3072 sc1 lds
MF v[112:115],a[212:215],a[116:119],v[112:115]
RD a[152:155],v3,6144
MF v[116:119],a[216:219],a[116:119],v[116:119]
MF v[116:119],a[16:19],a[124:127],v[116:119]
RD a[188:191],v3,15360
MF v[120:123],a[20:23],a[124:127],v[120:123]
s_add_u32 m0,s43,4096
MF v[120:123],a[220:223],a[116:119],v[120:123]
RD a[156:159],v3,7168
buffer_load_dwordx4 v26,s[12:15],s46 offen sc1 lds
MF v[124:127],a[224:227],a[116:119],v[124:127]
RD a[192:195],v3,16384
MF v[124:127],a[24:27],a[124:127],v[124:127]
buffer_store_dwordx4 v[196:199],v2,s[20:23],s53 offen sc1
MF v[128:131],a[28:31],a[124:127],v[128:131]
RD a[160:163],v3,8192
MF v[128:131],a[228:231],a[116:119],v[128:131]
MF v[132:135],a[232:235],a[116:119],v[132:135]
RD a[196:199],v3,17408
MF v[132:135],a[32:35],a[124:127],v[132:135]
LW 15
s_waitcnt vmcnt(21)
MF v[64:67],a[128:131],a[64:67],v[64:67]
buffer_load_dwordx4 a[112:115],v24,s[8:11],s47 offen offset:2048 sc1
RD a[200:203],v3,18432
MF v[64:67],a[164:167],a[72:75],v[64:67]
LW 15
MF v[68:71],a[168:171],a[72:75],v[68:71]
RD a[0:3],v3,27648
MF v[68:71],a[132:135],a[64:67],v[68:71]
LW 15
MF v[72:75],a[136:139],a[64:67],v[72:75]
LW 14
buffer_load_dwordx4 v26,s[12:15],s46 offen offset:1024 sc1 lds
RD a[204:207],v3,19456
MF v[72:75],a[172:175],a[72:75],v[72:75]
LW 13
MF v[76:79],a[176:179],a[72:75],v[76:79]
RD a[4:7],v3,28672
MF v[76:79],a[140:143],a[64:67],v[76:79]
LW 13
MF v[80:83],a[144:147],a[64:67],v[80:83]
LW 12
buffer_load_dwordx4 a[116:119],v25,s[8:11],s47 offen offset:2048 sc1
RD a[208:211],v3,20480
MF v[80:83],a[180:183],a[72:75],v[80:83]
LW 11
MF v[84:87],a[184:187],a[72:75],v[84:87]
RD a[8:11],v3,29696
MF v[84:87],a[148:151],a[64:67],v[84:87]
LW 11
MF v[88:91],a[152:155],a[64:67],v[88:91]
LW 10
RD a[212:215],v3,21504
MF v[88:91],a[188:191],a[72:75],v[88:91]
LW 9
buffer_load_dwordx4 v26,s[12:15],s46 offen offset:2048 sc1 lds
MF v[92:95],a[192:195],a[72:75],v[92:95]
RD a[12:15],v3,30720
MF v[92:95],a[156:159],a[64:67],v[92:95]
LW 9
MF v[96:99],a[160:163],a[64:67],v[96:99]
LW 8
RD a[216:219],v3,22528
MF v[96:99],a[196:199],a[72:75],v[96:99]
buffer_load_dwordx4 a[120:123],v24,s[8:11],s47 offen offset:3072 sc1
MF v[100:103],a[128:131],a[68:71],v[100:103]
RD a[16:19],v3,31744
MF v[100:103],a[164:167],a[76:79],v[100:103]
MF v[104:107],a[168:171],a[76:79],v[104:107]
RD a[220:223],v3,23552
MF v[104:107],a[132:135],a[68:71],v[104:107]
buffer_load_dwordx4 v26,s[12:15],s46 offen offset:3072 sc1 lds
MF v[108:111],a[136:139],a[68:71],v[108:111]
RD a[20:23],v3,32768
MF v[108:111],a[172:175],a[76:79],v[108:111]
MF v[112:115],a[176:179],a[76:79],v[112:115]
RD a[224:227],v3,24576
MF v[112:115],a[140:143],a[68:71],v[112:115]
MF v[116:119],a[144:147],a[68:71],v[116:119]
buffer_load_dwordx4 a[124:127],v25,s[8:11],s47 offen offset:3072 sc1
RD a[24:27],v3,33792
MF v[116:119],a[180:183],a[76:79],v[116:119]
s_add_u32 s47,s47,4096
MF v[120:123],a[184:187],a[76:79],v[120:123]
RD a[228:231],v3,25600
MF v[120:123],a[148:151],a[68:71],v[120:123]
MF v[124:127],a[152:155],a[68:71],v[124:127]
s_add_u32 m0,s43,8192
RD a[28:31],v3,34816
MF v[124:127],a[188:191],a[76:79],v[124:127]
buffer_load_dwordx4 v27,s[12:15],s46 offen sc1 lds
s_add_u32 s46,s46,36864
MF v[128:131],a[192:195],a[76:79],v[128:131]
s_add_u32 s48,s48,36864
s_cmp_eq_u32 s48,147456
s_cselect_b32 s48,0,s48
MF v[128:131],a[156:159],a[68:71],v[128:131]
RD a[232:235],v3,26624
MF v[132:135],a[160:163],a[68:71],v[132:135]
RD a[32:35],v3,35840
MF v[132:135],a[196:199],a[76:79],v[132:135]
LW 15
s_waitcnt vmcnt(18)
MF v[64:67],a[200:203],a[80:83],v[64:67]
s_barrier
MF v[64:67],a[0:3],a[88:91],v[64:67]
LW 14
buffer_load_dwordx4 a[64:67],v24,s[8:11],s47 offen sc1
v_add_u32 v3,s49,v2
MF v[68:71],a[4:7],a[88:91],v[68:71]
s_add_u32 s49,s49,36864
s_cmp_eq_u32 s49,147456
s_cselect_b32 s49,0,s49
MF v[68:71],a[204:207],a[80:83],v[68:71]
LW 13
MF v[72:75],a[208:211],a[80:83],v[72:75]
LW 12
s_add_u32 s43,s45,s48
s_add_u32 m0,s43,0
MF v[72:75],a[8:11],a[88:91],v[72:75]
LW 10
RD a[128:131],v3,0
buffer_load_dwordx4 v2,s[12:15],s46 offen sc1 lds
MF v[76:79],a[12:15],a[88:91],v[76:79]
RD a[164:167],v3,9216
MF v[76:79],a[212:215],a[80:83],v[76:79]
LW 11
buffer_load_dwordx4 a[68:71],v25,s[8:11],s47 offen sc1
MF v[80:83],a[216:219],a[80:83],v[80:83]
LW 10
RD a[132:135],v3,1024
MF v[80:83],a[16:19],a[88:91],v[80:83]
LW 9
RD a[168:171],v3,10240
MF v[84:87],a[20:23],a[88:91],v[84:87]
MF v[84:87],a[220:223],a[80:83],v[84:87]
LW 9
RD a[136:139],v3,2048
buffer_load_dwordx4 v2,s[12:15],s46 offen offset:1024 sc1 lds
MF v[88:91],a[224:227],a[80:83],v[88:91]
LW 9
MF v[88:91],a[24:27],a[88:91],v[88:91]
LW 7
RD a[172:175],v3,11264
MF v[92:95],a[28:31],a[88:91],v[92:95]
buffer_load_dwordx4 a[72:75],v24,s[8:11],s47 offen offset:1024 sc1
MF v[92:95],a[228:231],a[80:83],v[92:95]
LW 7
RD a[140:143],v3,3072
MF v[96:99],a[232:235],a[80:83],v[96:99]
LW 7
RD a[176:179],v3,12288
MF v[96:99],a[32:35],a[88:91],v[96:99]
MF v[100:103],a[200:203],a[84:87],v[100:103]
RD a[144:147],v3,4096
buffer_load_dwordx4 v2,s[12:15],s46 offen offset:2048 sc1 lds
MF v[100:103],a[0:3],a[92:95],v[100:103]
MF v[104:107],a[4:7],a[92:95],v[104:107]
RD a[180:183],v3,13312
MF v[104:107],a[204:207],a[84:87],v[104:107]
buffer_load_dwordx4 a[76:79],v25,s[8:11],s47 offen offset:1024 sc1
MF v[108:111],a[208:211],a[84:87],v[108:111]
RD a[148:151],v3,5120
MF v[108:111],a[8:11],a[92:95],v[108:111]
RD a[184:187],v3,14336
MF v[112:115],a[12:15],a[92:95],v[112:115]
buffer_load_dwordx4 v2,s[12:15],s46 offen offset:3072 sc1 lds
MF v[112:115],a[212:215],a[84:87],v[112:115]
RD a[152:155],v3,6144
MF v[116:119],a[216:219],a[84:87],v[116:119]
MF v[116:119],a[16:19],a[92:95],v[116:119]
RD a[188:191],v3,15360
MF v[120:123],a[20:23],a[92:95],v[120:123]
s_add_u32 m0,s43,4096
MF v[120:123],a[220:223],a[84:87],v[120:123]
RD a[156:159],v3,7168
buffer_load_dwordx4 v26,s[12:15],s46 offen sc1 lds
MF v[124:127],a[224:227],a[84:87],v[124:127]
RD a[192:195],v3,16384
MF v[124:127],a[24:27],a[92:95],v[124:127]
buffer_store_dwordx4 v[200:203],v2,s[20:23],s53 offen offset:1024 sc1
MF v[128:131],a[28:31],a[92:95],v[128:131]
RD a[160:163],v3,8192
MF v[128:131],a[228:231],a[84:87],v[128:131]
MF v[132:135],a[232:235],a[84:87],v[132:135]
RD a[196:199],v3,17408
MF v[132:135],a[32:35],a[92:95],v[132:135]
LW 15
s_waitcnt vmcnt(21)
MF v[64:67],a[128:131],a[96:99],v[64:67]
buffer_load_dwordx4 a[80:83],v24,s[8:11],s47 offen offset:2048 sc1
RD a[200:203],v3,18432
MF v[64:67],a[164:167],a[104:107],v[64:67]
LW 15
MF v[68:71],a[168:171],a[104:107],v[68:71]
RD a[0:3],v3,27648
MF v[68:71],a[132:135],a[96:99],v[68:71]
LW 15
MF v[72:75],a[136:139],a[96:99],v[72:75]
LW 14
buffer_load_dwordx4 v26,s[12:15],s46 offen offset:1024 sc1 lds
RD a[204:207],v3,19456
MF v[72:75],a[172:175],a[104:107],v[72:75]
LW 13
MF v[76:79],a[176:179],a[104:107],v[76:79]
RD a[4:7],v3,28672
MF v[76:79],a[140:143],a[96:99],v[76:79]
LW 13
MF v[80:83],a[144:147],a[96:99],v[80:83]
LW 12
buffer_load_dwordx4 a[84:87],v25,s[8:11],s47 offen offset:2048 sc1
RD a[208:211],v3,20480
MF v[80:83],a[180:183],a[104:107],v[80:83]
LW 11
MF v[84:87],a[184:187],a[104:107],v[84:87]
RD a[8:11],v3,29696
MF v[84:87],a[148:151],a[96:99],v[84:87]
LW 11
MF v[88:91],a[152:155],a[96:99],v[88:91]
LW 10
RD a[212:215],v3,21504
MF v[88:91],a[188:191],a[104:107],v[88:91]
LW 9
buffer_load_dwordx4 v26,s[12:15],s46 offen offset:2048 sc1 lds
MF v[92:95],a[192:195],a[104:107],v[92:95]
RD a[12:15],v3,30720
MF v[92:95],a[156:159],a[96:99],v[92:95]
LW 9
MF v[96:99],a[160:163],a[96:99],v[96:99]
LW 8
RD a[216:219],v3,22528
MF v[96:99],a[196:199],a[104:107],v[96:99]
buffer_load_dwordx4 a[88:91],v24,s[8:11],s47 offen offset:3072 sc1
MF v[100:103],a[128:131],a[100:103],v[100:103]
RD a[16:19],v3,31744
MF v[100:103],a[164:167],a[108:111],v[100:103]
MF v[104:107],a[168:171],a[108:111],v[104:107]
RD a[220:223],v3,23552
MF v[104:107],a[132:135],a[100:103],v[104:107]
buffer_load_dwordx4 v26,s[12:15],s46 offen offset:3072 sc1 lds
MF v[108:111],a[136:139],a[100:103],v[108:111]
RD a[20:23],v3,32768
MF v[108:111],a[172:175],a[108:111],v[108:111]
MF v[112:115],a[176:179],a[108:111],v[112:115]
RD a[224:227],v3,24576
MF v[112:115],a[140:143],a[100:103],v[112:115]
MF v[116:119],a[144:147],a[100:103],v[116:119]
buffer_load_dwordx4 a[92:95],v25,s[8:11],s47 offen offset:3072 sc1
RD a[24:27],v3,33792
MF v[116:119],a[180:183],a[108:111],v[116:119]
s_add_u32 s47,s47,4096
MF v[120:123],a[184:187],a[108:111],v[120:123]
RD a[228:231],v3,25600
MF v[120:123],a[148:151],a[100:103],v[120:123]
MF v[124:127],a[152:155],a[100:103],v[124:127]
s_add_u32 m0,s43,8192
RD a[28:31],v3,34816
MF v[124:127],a[188:191],a[108:111],v[124:127]
buffer_load_dwordx4 v27,s[12:15],s46 offen sc1 lds
s_add_u32 s46,s46,36864
MF v[128:131],a[192:195],a[108:111],v[128:131]
s_add_u32 s48,s48,36864
s_cmp_eq_u32 s48,147456
s_cselect_b32 s48,0,s48
MF v[128:131],a[156:159],a[100:103],v[128:131]
RD a[232:235],v3,26624
MF v[132:135],a[160:163],a[100:103],v[132:135]
RD a[32:35],v3,35840
MF v[132:135],a[196:199],a[108:111],v[132:135]
LW 15
s_waitcnt vmcnt(18)
MF v[64:67],a[200:203],a[112:115],v[64:67]
s_barrier
MF v[64:67],a[0:3],a[120:123],v[64:67]
LW 14
buffer_load_dwordx4 a[96:99],v24,s[8:11],s47 offen sc1
v_add_u32 v3,s49,v2
MF v[68:71],a[4:7],a[120:123],v[68:71]
s_add_u32 s49,s49,36864
s_cmp_eq_u32 s49,147456
s_cselect_b32 s49,0,s49
MF v[68:71],a[204:207],a[112:115],v[68:71]
LW 13
MF v[72:75],a[208:211],a[112:115],v[72:75]
LW 12
s_add_u32 s43,s45,s48
s_add_u32 m0,s43,0
MF v[72:75],a[8:11],a[120:123],v[72:75]
LW 10
RD a[128:131],v3,0
buffer_load_dwordx4 v2,s[12:15],s46 offen sc1 lds
MF v[76:79],a[12:15],a[120:123],v[76:79]
RD a[164:167],v3,9216
MF v[76:79],a[212:215],a[112:115],v[76:79]
LW 11
buffer_load_dwordx4 a[100:103],v25,s[8:11],s47 offen sc1
MF v[80:83],a[216:219],a[112:115],v[80:83]
LW 10
RD a[132:135],v3,1024
MF v[80:83],a[16:19],a[120:123],v[80:83]
LW 9
RD a[168:171],v3,10240
MF v[84:87],a[20:23],a[120:123],v[84:87]
MF v[84:87],a[220:223],a[112:115],v[84:87]
LW 9
RD a[136:139],v3,2048
buffer_load_dwordx4 v2,s[12:15],s46 offen offset:1024 sc1 lds
MF v[88:91],a[224:227],a[112:115],v[88:91]
LW 9
MF v[88:91],a[24:27],a[120:123],v[88:91]
LW 7
RD a[172:175],v3,11264
MF v[92:95],a[28:31],a[120:123],v[92:95]
buffer_load_dwordx4 a[104:107],v24,s[8:11],s47 offen offset:1024 sc1
MF v[92:95],a[228:231],a[112:115],v[92:95]
LW 7
RD a[140:143],v3,3072
MF v[96:99],a[232:235],a[112:115],v[96:99]
LW 7
RD a[176:179],v3,12288
MF v[96:99],a[32:35],a[120:123],v[96:99]
MF v[100:103],a[200:203],a[116:119],v[100:103]
RD a[144:147],v3,4096
buffer_load_dwordx4 v2,s[12:15],s46 offen offset:2048 sc1 lds
MF v[100:103],a[0:3],a[124:127],v[100:103]
MF v[104:107],a[4:7],a[124:127],v[104:107]
RD a[180:183],v3,13312
MF v[104:107],a[204:207],a[116:119],v[104:107]
buffer_load_dwordx4 a[108:111],v25,s[8:11],s47 offen offset:1024 sc1
MF v[108:111],a[208:211],a[116:119],v[108:111]
RD a[148:151],v3,5120
MF v[108:111],a[8:11],a[124:127],v[108:111]
RD a[184:187],v3,14336
MF v[112:115],a[12:15],a[124:127],v[112:115]
buffer_load_dwordx4 v2,s[12:15],s46 offen offset:3072 sc1 lds
MF v[112:115],a[212:215],a[116:119],v[112:115]
RD a[152:155],v3,6144
MF v[116:119],a[216:219],a[116:119],v[116:119]
MF v[116:119],a[16:19],a[124:127],v[116:119]
RD a[188:191],v3,15360
MF v[120:123],a[20:23],a[124:127],v[120:123]
s_add_u32 m0,s43,4096
MF v[120:123],a[220:223],a[116:119],v[120:123]
RD a[156:159],v3,7168
buffer_load_dwordx4 v26,s[12:15],s46 offen sc1 lds
MF v[124:127],a[224:227],a[116:119],v[124:127]
RD a[192:195],v3,16384
MF v[124:127],a[24:27],a[124:127],v[124:127]
buffer_store_dwordx4 v[204:207],v2,s[20:23],s53 offen offset:2048 sc1
MF v[128:131],a[28:31],a[124:127],v[128:131]
RD a[160:163],v3,8192
MF v[128:131],a[228:231],a[116:119],v[128:131]
MF v[132:135],a[232:235],a[116:119],v[132:135]
RD a[196:199],v3,17408
MF v[132:135],a[32:35],a[124:127],v[132:135]
LW 15
s_waitcnt vmcnt(21)
MF v[64:67],a[128:131],a[64:67],v[64:67]
buffer_load_dwordx4 a[112:115],v24,s[8:11],s47 offen offset:2048 sc1
RD a[200:203],v3,18432
MF v[64:67],a[164:167],a[72:75],v[64:67]
LW 15
MF v[68:71],a[168:171],a[72:75],v[68:71]
RD a[0:3],v3,27648
MF v[68:71],a[132:135],a[64:67],v[68:71]
LW 15
MF v[72:75],a[136:139],a[64:67],v[72:75]
LW 14
buffer_load_dwordx4 v26,s[12:15],s46 offen offset:1024 sc1 lds
RD a[204:207],v3,19456
MF v[72:75],a[172:175],a[72:75],v[72:75]
LW 13
MF v[76:79],a[176:179],a[72:75],v[76:79]
RD a[4:7],v3,28672
MF v[76:79],a[140:143],a[64:67],v[76:79]
LW 13
MF v[80:83],a[144:147],a[64:67],v[80:83]
LW 12
buffer_load_dwordx4 a[116:119],v25,s[8:11],s47 offen offset:2048 sc1
RD a[208:211],v3,20480
MF v[80:83],a[180:183],a[72:75],v[80:83]
LW 11
MF v[84:87],a[184:187],a[72:75],v[84:87]
RD a[8:11],v3,29696
MF v[84:87],a[148:151],a[64:67],v[84:87]
LW 11
MF v[88:91],a[152:155],a[64:67],v[88:91]
LW 10
RD a[212:215],v3,21504
MF v[88:91],a[188:191],a[72:75],v[88:91]
LW 9
buffer_load_dwordx4 v26,s[12:15],s46 offen offset:2048 sc1 lds
MF v[92:95],a[192:195],a[72:75],v[92:95]
RD a[12:15],v3,30720
MF v[92:95],a[156:159],a[64:67],v[92:95]
LW 9
MF v[96:99],a[160:163],a[64:67],v[96:99]
LW 8
RD a[216:219],v3,22528
MF v[96:99],a[196:199],a[72:75],v[96:99]
buffer_load_dwordx4 a[120:123],v24,s[8:11],s47 offen offset:3072 sc1
MF v[100:103],a[128:131],a[68:71],v[100:103]
RD a[16:19],v3,31744
MF v[100:103],a[164:167],a[76:79],v[100:103]
MF v[104:107],a[168:171],a[76:79],v[104:107]
RD a[220:223],v3,23552
MF v[104:107],a[132:135],a[68:71],v[104:107]
buffer_load_dwordx4 v26,s[12:15],s46 offen offset:3072 sc1 lds
MF v[108:111],a[136:139],a[68:71],v[108:111]
RD a[20:23],v3,32768
MF v[108:111],a[172:175],a[76:79],v[108:111]
MF v[112:115],a[176:179],a[76:79],v[112:115]
RD a[224:227],v3,24576
MF v[112:115],a[140:143],a[68:71],v[112:115]
MF v[116:119],a[144:147],a[68:71],v[116:119]
buffer_load_dwordx4 a[124:127],v25,s[8:11],s47 offen offset:3072 sc1
RD a[24:27],v3,33792
MF v[116:119],a[180:183],a[76:79],v[116:119]
s_add_u32 s47,s47,4096
MF v[120:123],a[184:187],a[76:79],v[120:123]
RD a[228:231],v3,25600
MF v[120:123],a[148:151],a[68:71],v[120:123]
MF v[124:127],a[152:155],a[68:71],v[124:127]
s_add_u32 m0,s43,8192
RD a[28:31],v3,34816
MF v[124:127],a[188:191],a[76:79],v[124:127]
buffer_load_dwordx4 v27,s[12:15],s46 offen sc1 lds
s_add_u32 s46,s46,36864
MF v[128:131],a[192:195],a[76:79],v[128:131]
s_add_u32 s48,s48,36864
s_cmp_eq_u32 s48,147456
s_cselect_b32 s48,0,s48
MF v[128:131],a[156:159],a[68:71],v[128:131]
RD a[232:235],v3,26624
MF v[132:135],a[160:163],a[68:71],v[132:135]
RD a[32:35],v3,35840
MF v[132:135],a[196:199],a[76:79],v[132:135]
LW 15
s_waitcnt vmcnt(18)
MF v[64:67],a[200:203],a[80:83],v[64:67]
s_barrier
MF v[64:67],a[0:3],a[88:91],v[64:67]
LW 14
buffer_load_dwordx4 a[64:67],v24,s[8:11],s47 offen sc1
v_add_u32 v3,s49,v2
MF v[68:71],a[4:7],a[88:91],v[68:71]
s_add_u32 s49,s49,36864
s_cmp_eq_u32 s49,147456
s_cselect_b32 s49,0,s49
MF v[68:71],a[204:207],a[80:83],v[68:71]
LW 13
MF v[72:75],a[208:211],a[80:83],v[72:75]
LW 12
s_add_u32 s43,s45,s48
s_add_u32 m0,s43,0
MF v[72:75],a[8:11],a[88:91],v[72:75]
LW 10
RD a[128:131],v3,0
buffer_load_dwordx4 v2,s[12:15],s46 offen sc1 lds
MF v[76:79],a[12:15],a[88:91],v[76:79]
RD a[164:167],v3,9216
MF v[76:79],a[212:215],a[80:83],v[76:79]
LW 11
buffer_load_dwordx4 a[68:71],v25,s[8:11],s47 offen sc1
MF v[80:83],a[216:219],a[80:83],v[80:83]
LW 10
RD a[132:135],v3,1024
MF v[80:83],a[16:19],a[88:91],v[80:83]
LW 9
RD a[168:171],v3,10240
MF v[84:87],a[20:23],a[88:91],v[84:87]
MF v[84:87],a[220:223],a[80:83],v[84:87]
LW 9
RD a[136:139],v3,2048
buffer_load_dwordx4 v2,s[12:15],s46 offen offset:1024 sc1 lds
MF v[88:91],a[224:227],a[80:83],v[88:91]
LW 9
MF v[88:91],a[24:27],a[88:91],v[88:91]
LW 7
RD a[172:175],v3,11264
MF v[92:95],a[28:31],a[88:91],v[92:95]
buffer_load_dwordx4 a[72:75],v24,s[8:11],s47 offen offset:1024 sc1
MF v[92:95],a[228:231],a[80:83],v[92:95]
LW 7
RD a[140:143],v3,3072
MF v[96:99],a[232:235],a[80:83],v[96:99]
LW 7
RD a[176:179],v3,12288
MF v[96:99],a[32:35],a[88:91],v[96:99]
MF v[100:103],a[200:203],a[84:87],v[100:103]
RD a[144:147],v3,4096
buffer_load_dwordx4 v2,s[12:15],s46 offen offset:2048 sc1 lds
MF v[100:103],a[0:3],a[92:95],v[100:103]
MF v[104:107],a[4:7],a[92:95],v[104:107]
RD a[180:183],v3,13312
MF v[104:107],a[204:207],a[84:87],v[104:107]
buffer_load_dwordx4 a[76:79],v25,s[8:11],s47 offen offset:1024 sc1
MF v[108:111],a[208:211],a[84:87],v[108:111]
RD a[148:151],v3,5120
MF v[108:111],a[8:11],a[92:95],v[108:111]
RD a[184:187],v3,14336
MF v[112:115],a[12:15],a[92:95],v[112:115]
buffer_load_dwordx4 v2,s[12:15],s46 offen offset:3072 sc1 lds
MF v[112:115],a[212:215],a[84:87],v[112:115]
RD a[152:155],v3,6144
MF v[116:119],a[216:219],a[84:87],v[116:119]
MF v[116:119],a[16:19],a[92:95],v[116:119]
RD a[188:191],v3,15360
MF v[120:123],a[20:23],a[92:95],v[120:123]
s_add_u32 m0,s43,4096
MF v[120:123],a[220:223],a[84:87],v[120:123]
RD a[156:159],v3,7168
buffer_load_dwordx4 v26,s[12:15],s46 offen sc1 lds
MF v[124:127],a[224:227],a[84:87],v[124:127]
RD a[192:195],v3,16384
MF v[124:127],a[24:27],a[92:95],v[124:127]
buffer_store_dwordx4 v[208:211],v2,s[20:23],s53 offen offset:3072 sc1
MF v[128:131],a[28:31],a[92:95],v[128:131]
RD a[160:163],v3,8192
MF v[128:131],a[228:231],a[84:87],v[128:131]
MF v[132:135],a[232:235],a[84:87],v[132:135]
RD a[196:199],v3,17408
MF v[132:135],a[32:35],a[92:95],v[132:135]
LW 15
s_waitcnt vmcnt(21)
MF v[64:67],a[128:131],a[96:99],v[64:67]
buffer_load_dwordx4 a[80:83],v24,s[8:11],s47 offen offset:2048 sc1
RD a[200:203],v3,18432
MF v[64:67],a[164:167],a[104:107],v[64:67]
LW 15
MF v[68:71],a[168:171],a[104:107],v[68:71]
RD a[0:3],v3,27648
MF v[68:71],a[132:135],a[96:99],v[68:71]
LW 15
MF v[72:75],a[136:139],a[96:99],v[72:75]
LW 14
buffer_load_dwordx4 v26,s[12:15],s46 offen offset:1024 sc1 lds
RD a[204:207],v3,19456
MF v[72:75],a[172:175],a[104:107],v[72:75]
LW 13
MF v[76:79],a[176:179],a[104:107],v[76:79]
RD a[4:7],v3,28672
MF v[76:79],a[140:143],a[96:99],v[76:79]
LW 13
MF v[80:83],a[144:147],a[96:99],v[80:83]
LW 12
buffer_load_dwordx4 a[84:87],v25,s[8:11],s47 offen offset:2048 sc1
RD a[208:211],v3,20480
MF v[80:83],a[180:183],a[104:107],v[80:83]
LW 11
MF v[84:87],a[184:187],a[104:107],v[84:87]
RD a[8:11],v3,29696
MF v[84:87],a[148:151],a[96:99],v[84:87]
LW 11
MF v[88:91],a[152:155],a[96:99],v[88:91]
LW 10
RD a[212:215],v3,21504
MF v[88:91],a[188:191],a[104:107],v[88:91]
LW 9
buffer_load_dwordx4 v26,s[12:15],s46 offen offset:2048 sc1 lds
MF v[92:95],a[192:195],a[104:107],v[92:95]
RD a[12:15],v3,30720
MF v[92:95],a[156:159],a[96:99],v[92:95]
LW 9
MF v[96:99],a[160:163],a[96:99],v[96:99]
LW 8
RD a[216:219],v3,22528
MF v[96:99],a[196:199],a[104:107],v[96:99]
buffer_load_dwordx4 a[88:91],v24,s[8:11],s47 offen offset:3072 sc1
MF v[100:103],a[128:131],a[100:103],v[100:103]
RD a[16:19],v3,31744
MF v[100:103],a[164:167],a[108:111],v[100:103]
MF v[104:107],a[168:171],a[108:111],v[104:107]
RD a[220:223],v3,23552
MF v[104:107],a[132:135],a[100:103],v[104:107]
buffer_load_dwordx4 v26,s[12:15],s46 offen offset:3072 sc1 lds
MF v[108:111],a[136:139],a[100:103],v[108:111]
RD a[20:23],v3,32768
MF v[108:111],a[172:175],a[108:111],v[108:111]
MF v[112:115],a[176:179],a[108:111],v[112:115]
RD a[224:227],v3,24576
MF v[112:115],a[140:143],a[100:103],v[112:115]
MF v[116:119],a[144:147],a[100:103],v[116:119]
buffer_load_dwordx4 a[92:95],v25,s[8:11],s47 offen offset:3072 sc1
RD a[24:27],v3,33792
MF v[116:119],a[180:183],a[108:111],v[116:119]
s_add_u32 s47,s47,4096
MF v[120:123],a[184:187],a[108:111],v[120:123]
RD a[228:231],v3,25600
MF v[120:123],a[148:151],a[100:103],v[120:123]
MF v[124:127],a[152:155],a[100:103],v[124:127]
s_add_u32 m0,s43,8192
RD a[28:31],v3,34816
MF v[124:127],a[188:191],a[108:111],v[124:127]
buffer_load_dwordx4 v27,s[12:15],s46 offen sc1 lds
s_add_u32 s46,s46,36864
MF v[128:131],a[192:195],a[108:111],v[128:131]
s_add_u32 s48,s48,36864
s_cmp_eq_u32 s48,147456
s_cselect_b32 s48,0,s48
MF v[128:131],a[156:159],a[100:103],v[128:131]
RD a[232:235],v3,26624
MF v[132:135],a[160:163],a[100:103],v[132:135]
RD a[32:35],v3,35840
MF v[132:135],a[196:199],a[108:111],v[132:135]
LW 15
s_waitcnt vmcnt(18)
MF v[64:67],a[200:203],a[112:115],v[64:67]
s_barrier
MF v[64:67],a[0:3],a[120:123],v[64:67]
LW 14
buffer_load_dwordx4 a[96:99],v24,s[8:11],s47 offen sc1
v_add_u32 v3,s49,v2
MF v[68:71],a[4:7],a[120:123],v[68:71]
s_add_u32 s49,s49,36864
s_cmp_eq_u32 s49,147456
s_cselect_b32 s49,0,s49
MF v[68:71],a[204:207],a[112:115],v[68:71]
LW 13
MF v[72:75],a[208:211],a[112:115],v[72:75]
LW 12
s_add_u32 s43,s45,s48
RD a[128:131],v3,0
MF v[72:75],a[8:11],a[120:123],v[72:75]
LW 11
s_add_u32 m0,s43,0
MF v[76:79],a[12:15],a[120:123],v[76:79]
RD a[164:167],v3,9216
buffer_load_dwordx4 v2,s[12:15],s46 offen sc1 lds
MF v[76:79],a[212:215],a[112:115],v[76:79]
LW 11
MF v[80:83],a[216:219],a[112:115],v[80:83]
LW 10
buffer_load_dwordx4 a[100:103],v25,s[8:11],s47 offen sc1
RD a[132:135],v3,1024
MF v[80:83],a[16:19],a[120:123],v[80:83]
LW 9
RD a[168:171],v3,10240
MF v[84:87],a[20:23],a[120:123],v[84:87]
MF v[84:87],a[220:223],a[112:115],v[84:87]
LW 9
RD a[136:139],v3,2048
MF v[88:91],a[224:227],a[112:115],v[88:91]
LW 9
buffer_load_dwordx4 v2,s[12:15],s46 offen offset:1024 sc1 lds
MF v[88:91],a[24:27],a[120:123],v[88:91]
LW 7
RD a[172:175],v3,11264
MF v[92:95],a[28:31],a[120:123],v[92:95]
MF v[92:95],a[228:231],a[112:115],v[92:95]
LW 7
RD a[140:143],v3,3072
MF v[96:99],a[232:235],a[112:115],v[96:99]
LW 7
RD a[176:179],v3,12288
buffer_load_dwordx4 a[104:107],v24,s[8:11],s47 offen offset:1024 sc1
MF v[96:99],a[32:35],a[120:123],v[96:99]
MF v[100:103],a[200:203],a[116:119],v[100:103]
RD a[144:147],v3,4096
MF v[100:103],a[0:3],a[124:127],v[100:103]
buffer_load_dwordx4 v2,s[12:15],s46 offen offset:2048 sc1 lds
MF v[104:107],a[4:7],a[124:127],v[104:107]
RD a[180:183],v3,13312
MF v[104:107],a[204:207],a[116:119],v[104:107]
MF v[108:111],a[208:211],a[116:119],v[108:111]
RD a[148:151],v3,5120
MF v[108:111],a[8:11],a[124:127],v[108:111]
RD a[184:187],v3,14336
buffer_load_dwordx4 a[108:111],v25,s[8:11],s47 offen offset:1024 sc1
MF v[112:115],a[12:15],a[124:127],v[112:115]
MF v[112:115],a[212:215],a[116:119],v[112:115]
RD a[152:155],v3,6144
MF v[116:119],a[216:219],a[116:119],v[116:119]
MF v[116:119],a[16:19],a[124:127],v[116:119]
buffer_load_dwordx4 v2,s[12:15],s46 offen offset:3072 sc1 lds
RD a[188:191],v3,15360
MF v[120:123],a[20:23],a[124:127],v[120:123]
MF v[120:123],a[220:223],a[116:119],v[120:123]
RD a[156:159],v3,7168
MF v[124:127],a[224:227],a[116:119],v[124:127]
RD a[192:195],v3,16384
MF v[124:127],a[24:27],a[124:127],v[124:127]
s_add_u32 m0,s43,4096
MF v[128:131],a[28:31],a[124:127],v[128:131]
RD a[160:163],v3,8192
buffer_load_dwordx4 v26,s[12:15],s46 offen sc1 lds
MF v[128:131],a[228:231],a[116:119],v[128:131]
MF v[132:135],a[232:235],a[116:119],v[132:135]
RD a[196:199],v3,17408
MF v[132:135],a[32:35],a[124:127],v[132:135]
LW 15
s_waitcnt vmcnt(20)
MF v[64:67],a[128:131],a[64:67],v[64:67]
buffer_load_dwordx4 a[112:115],v24,s[8:11],s47 offen offset:2048 sc1
RD a[200:203],v3,18432
MF v[64:67],a[164:167],a[72:75],v[64:67]
LW 15
s_mov_b32 s58,0xbdd2d3e8
v_mov_b32 v232,0xc0135761
MF v[68:71],a[168:171],a[72:75],v[68:71]
RD a[0:3],v3,27648
v_lshlrev_b32 v216,16,v140
MF v[68:71],a[132:135],a[64:67],v[68:71]
LW 15
v_and_b32 v217,0xffff0000,v140
v_mul_f32 v218,v216,v216
MF v[72:75],a[136:139],a[64:67],v[72:75]
LW 14
buffer_load_dwordx4 v26,s[12:15],s46 offen offset:1024 sc1 lds
RD a[204:207],v3,19456
MF v[72:75],a[172:175],a[72:75],v[72:75]
LW 13
v_mul_f32 v219,v217,v217
v_fma_f32 v218,v218,s58,v232
MF v[76:79],a[176:179],a[72:75],v[76:79]
RD a[4:7],v3,28672
v_fma_f32 v219,v219,s58,v232
MF v[76:79],a[140:143],a[64:67],v[76:79]
LW 13
v_mul_f32 v218,v218,v216
MF v[80:83],a[144:147],a[64:67],v[80:83]
LW 12
RD a[208:211],v3,20480
v_mul_f32 v219,v219,v217
MF v[80:83],a[180:183],a[72:75],v[80:83]
LW 11
buffer_load_dwordx4 a[116:119],v25,s[8:11],s47 offen offset:2048 sc1
MF v[84:87],a[184:187],a[72:75],v[84:87]
v_exp_f32 v218,v218
MF v[84:87],a[148:151],a[64:67],v[84:87]
LW 10
RD a[8:11],v3,29696
v_lshlrev_b32 v220,16,v141
MF v[88:91],a[152:155],a[64:67],v[88:91]
LW 10
v_exp_f32 v219,v219
MF v[88:91],a[188:191],a[72:75],v[88:91]
LW 8
RD a[212:215],v3,21504
v_and_b32 v221,0xffff0000,v141
MF v[92:95],a[192:195],a[72:75],v[92:95]
buffer_load_dwordx4 v26,s[12:15],s46 offen offset:2048 sc1 lds
v_add_f32 v218,1.0,v218
MF v[92:95],a[156:159],a[64:67],v[92:95]
LW 8
RD a[12:15],v3,30720
v_mul_f32 v222,v220,v220
MF v[96:99],a[160:163],a[64:67],v[96:99]
LW 8
v_add_f32 v219,1.0,v219
v_mul_f32 v223,v221,v221
MF v[96:99],a[196:199],a[72:75],v[96:99]
buffer_load_dwordx4 a[120:123],v24,s[8:11],s47 offen offset:3072 sc1
RD a[216:219],v3,22528
MF v[100:103],a[128:131],a[68:71],v[100:103]
v_rcp_f32 v218,v218
MF v[100:103],a[164:167],a[76:79],v[100:103]
RD a[16:19],v3,31744
v_fma_f32 v222,v222,s58,v232
MF v[104:107],a[168:171],a[76:79],v[104:107]
v_rcp_f32 v219,v219
MF v[104:107],a[132:135],a[68:71],v[104:107]
RD a[220:223],v3,23552
v_fma_f32 v223,v223,s58,v232
MF v[108:111],a[136:139],a[68:71],v[108:111]
v_mul_f32 v216,v216,v218
v_mul_f32 v222,v222,v220
MF v[108:111],a[172:175],a[76:79],v[108:111]
RD a[20:23],v3,32768
buffer_load_dwordx4 v26,s[12:15],s46 offen offset:3072 sc1 lds
MF v[112:115],a[176:179],a[76:79],v[112:115]
v_mul_f32 v217,v217,v219
v_mul_f32 v223,v223,v221
MF v[112:115],a[140:143],a[68:71],v[112:115]
RD a[224:227],v3,24576
CV v140,v216,v217
MF v[116:119],a[144:147],a[68:71],v[116:119]
v_exp_f32 v222,v222
MF v[116:119],a[180:183],a[76:79],v[116:119]
RD a[24:27],v3,33792
v_lshlrev_b32 v224,16,v142
MF v[120:123],a[184:187],a[76:79],v[120:123]
buffer_load_dwordx4 a[124:127],v25,s[8:11],s47 offen offset:3072 sc1
s_add_u32 s47,s47,4096
MF v[120:123],a[148:151],a[68:71],v[120:123]
v_exp_f32 v223,v223
MF v[124:127],a[152:155],a[68:71],v[124:127]
s_add_u32 m0,s43,8192
RD a[228:231],v3,25600
v_and_b32 v225,0xffff0000,v142
MF v[124:127],a[188:191],a[76:79],v[124:127]
v_add_f32 v222,1.0,v222
v_mul_f32 v226,v224,v224
MF v[128:131],a[192:195],a[76:79],v[128:131]
RD a[28:31],v3,34816
v_add_f32 v223,1.0,v223
MF v[128:131],a[156:159],a[68:71],v[128:131]
buffer_load_dwordx4 v27,s[12:15],s46 offen sc1 lds
s_add_u32 s46,s46,36864
MF v[132:135],a[160:163],a[68:71],v[132:135]
s_add_u32 s48,s48,36864
s_cmp_eq_u32 s48,147456
s_cselect_b32 s48,0,s48
MF v[132:135],a[196:199],a[76:79],v[132:135]
LW 15
s_waitcnt vmcnt(17)
RD a[232:235],v3,26624
RD a[32:35],v3,35840
v_mul_f32 v227,v225,v225
v_rcp_f32 v222,v222
v_fma_f32 v226,v226,s58,v232
v_rcp_f32 v223,v223
MF v[64:67],a[200:203],a[80:83],v[64:67]
LW 15
s_barrier
v_fma_f32 v227,v227,s58,v232
MF v[64:67],a[0:3],a[88:91],v[64:67]
LW 14
v_add_u32 v3,s49,v2
v_mul_f32 v220,v220,v222
MF v[68:71],a[4:7],a[88:91],v[68:71]
s_add_u32 s49,s49,36864
buffer_load_dwordx4 a[64:67],v24,s[8:11],s47 offen sc1
v_mul_f32 v226,v226,v224
MF v[68:71],a[204:207],a[80:83],v[68:71]
LW 13
s_cmp_eq_u32 s49,147456
s_cselect_b32 s49,0,s49
MF v[72:75],a[208:211],a[80:83],v[72:75]
LW 12
v_mul_f32 v221,v221,v223
v_mul_f32 v227,v227,v225
MF v[72:75],a[8:11],a[88:91],v[72:75]
LW 10
s_add_u32 s43,s45,s48
s_add_u32 m0,s43,0
MF v[76:79],a[12:15],a[88:91],v[76:79]
RD a[128:131],v3,0
buffer_load_dwordx4 v2,s[12:15],s46 offen sc1 lds
MF v[76:79],a[212:215],a[80:83],v[76:79]
LW 10
RD a[164:167],v3,9216
CV v141,v220,v221
MF v[80:83],a[216:219],a[80:83],v[80:83]
LW 10
v_exp_f32 v226,v226
MF v[80:83],a[16:19],a[88:91],v[80:83]
LW 8
buffer_load_dwordx4 a[68:71],v25,s[8:11],s47 offen sc1
v_lshlrev_b32 v216,16,v143
MF v[84:87],a[20:23],a[88:91],v[84:87]
v_exp_f32 v227,v227
MF v[84:87],a[220:223],a[80:83],v[84:87]
LW 7
RD a[132:135],v3,1024
v_and_b32 v217,0xffff0000,v143
MF v[88:91],a[224:227],a[80:83],v[88:91]
LW 7
RD a[168:171],v3,10240
v_add_f32 v226,1.0,v226
MF v[88:91],a[24:27],a[88:91],v[88:91]
LW 6
v_mul_f32 v218,v216,v216
v_add_f32 v227,1.0,v227
MF v[92:95],a[28:31],a[88:91],v[92:95]
RD a[136:139],v3,2048
buffer_load_dwordx4 v2,s[12:15],s46 offen offset:1024 sc1 lds
MF v[92:95],a[228:231],a[80:83],v[92:95]
LW 6
RD a[172:175],v3,11264
v_mul_f32 v219,v217,v217
MF v[96:99],a[232:235],a[80:83],v[96:99]
LW 6
v_rcp_f32 v226,v226
MF v[96:99],a[32:35],a[88:91],v[96:99]
buffer_load_dwordx4 a[72:75],v24,s[8:11],s47 offen offset:1024 sc1
v_fma_f32 v218,v218,s58,v232
MF v[100:103],a[200:203],a[84:87],v[100:103]
v_rcp_f32 v227,v227
MF v[100:103],a[0:3],a[92:95],v[100:103]
RD a[140:143],v3,3072
v_fma_f32 v219,v219,s58,v232
MF v[104:107],a[4:7],a[92:95],v[104:107]
RD a[176:179],v3,12288
v_mul_f32 v224,v224,v226
MF v[104:107],a[204:207],a[84:87],v[104:107]
buffer_load_dwordx4 v2,s[12:15],s46 offen offset:2048 sc1 lds
v_mul_f32 v218,v218,v216
MF v[108:111],a[208:211],a[84:87],v[108:111]
RD a[144:147],v3,4096
v_mul_f32 v225,v225,v227
MF v[108:111],a[8:11],a[92:95],v[108:111]
RD a[180:183],v3,13312
v_mul_f32 v219,v219,v217
MF v[112:115],a[12:15],a[92:95],v[112:115]
buffer_load_dwordx4 a[76:79],v25,s[8:11],s47 offen offset:1024 sc1
CV v142,v224,v225
MF v[112:115],a[212:215],a[84:87],v[112:115]
v_exp_f32 v218,v218
MF v[116:119],a[216:219],a[84:87],v[116:119]
RD a[148:151],v3,5120
v_lshlrev_b32 v220,16,v144
MF v[116:119],a[16:19],a[92:95],v[116:119]
v_exp_f32 v219,v219
MF v[120:123],a[20:23],a[92:95],v[120:123]
RD a[184:187],v3,14336
v_and_b32 v221,0xffff0000,v144
MF v[120:123],a[220:223],a[84:87],v[120:123]
buffer_load_dwordx4 v2,s[12:15],s46 offen offset:3072 sc1 lds
v_add_f32 v218,1.0,v218
MF v[124:127],a[224:227],a[84:87],v[124:127]
s_add_u32 m0,s43,4096
RD a[152:155],v3,6144
v_mul_f32 v222,v220,v220
MF v[124:127],a[24:27],a[92:95],v[124:127]
RD a[188:191],v3,15360
v_add_f32 v219,1.0,v219
MF v[128:131],a[28:31],a[92:95],v[128:131]
buffer_load_dwordx4 v26,s[12:15],s46 offen sc1 lds
v_mul_f32 v223,v221,v221
MF v[128:131],a[228:231],a[84:87],v[128:131]
s_lshl_b32 s42,s36,5
v_rcp_f32 v218,v218
MF v[132:135],a[232:235],a[84:87],v[132:135]
s_add_u32 s42,s42,s35
s_lshl_b32 s7,s42,4
s_lshl_b32 s41,s32,2
s_add_u32 s7,s7,s41
s_add_u32 s7,s7,0x8304000
RD a[156:159],v3,7168
v_mov_b32 v28,s7
v_mov_b32 v29,s3
global_store_dword v28,v29,s[4:5] sc1
v_fma_f32 v222,v222,s58,v232
MF v[132:135],a[32:35],a[92:95],v[132:135]
LW 14
s_waitcnt vmcnt(20)
RD a[192:195],v3,16384
RD a[160:163],v3,8192
RD a[196:199],v3,17408
v_rcp_f32 v219,v219
v_fma_f32 v223,v223,s58,v232
v_mul_f32 v216,v216,v218
v_mul_f32 v222,v222,v220
v_mul_f32 v217,v217,v219
MF v[64:67],a[128:131],a[96:99],v[64:67]
LW 15
buffer_load_dwordx4 a[80:83],v24,s[8:11],s47 offen offset:2048 sc1
RD a[200:203],v3,18432
MF v[64:67],a[164:167],a[104:107],v[64:67]
LW 15
v_mul_f32 v223,v223,v221
CV v143,v216,v217
MF v[68:71],a[168:171],a[104:107],v[68:71]
v_exp_f32 v222,v222
MF v[68:71],a[132:135],a[96:99],v[68:71]
LW 14
RD a[0:3],v3,27648
v_lshlrev_b32 v224,16,v145
MF v[72:75],a[136:139],a[96:99],v[72:75]
LW 14
v_exp_f32 v223,v223
MF v[72:75],a[172:175],a[104:107],v[72:75]
LW 12
buffer_load_dwordx4 v26,s[12:15],s46 offen offset:1024 sc1 lds
RD a[204:207],v3,19456
MF v[76:79],a[176:179],a[104:107],v[76:79]
v_and_b32 v225,0xffff0000,v145
v_add_f32 v222,1.0,v222
MF v[76:79],a[140:143],a[96:99],v[76:79]
LW 12
RD a[4:7],v3,28672
v_mul_f32 v226,v224,v224
MF v[80:83],a[144:147],a[96:99],v[80:83]
LW 12
RD a[208:211],v3,20480
v_add_f32 v223,1.0,v223
MF v[80:83],a[180:183],a[104:107],v[80:83]
LW 11
buffer_load_dwordx4 a[84:87],v25,s[8:11],s47 offen offset:2048 sc1
v_mul_f32 v227,v225,v225
MF v[84:87],a[184:187],a[104:107],v[84:87]
v_rcp_f32 v222,v222
MF v[84:87],a[148:151],a[96:99],v[84:87]
LW 10
RD a[8:11],v3,29696
v_fma_f32 v226,v226,s58,v232
MF v[88:91],a[152:155],a[96:99],v[88:91]
LW 10
v_rcp_f32 v223,v223
MF v[88:91],a[188:191],a[104:107],v[88:91]
LW 8
RD a[212:215],v3,21504
v_fma_f32 v227,v227,s58,v232
MF v[92:95],a[192:195],a[104:107],v[92:95]
buffer_load_dwordx4 v26,s[12:15],s46 offen offset:2048 sc1 lds
v_mul_f32 v220,v220,v222
MF v[92:95],a[156:159],a[96:99],v[92:95]
LW 8
RD a[12:15],v3,30720
v_mul_f32 v226,v226,v224
MF v[96:99],a[160:163],a[96:99],v[96:99]
LW 8
v_mul_f32 v221,v221,v223
v_mul_f32 v227,v227,v225
MF v[96:99],a[196:199],a[104:107],v[96:99]
RD a[216:219],v3,22528
CV v144,v220,v221
MF v[100:103],a[128:131],a[100:103],v[100:103]
v_exp_f32 v226,v226
MF v[100:103],a[164:167],a[108:111],v[100:103]
buffer_load_dwordx4 a[88:91],v24,s[8:11],s47 offen offset:3072 sc1
v_lshlrev_b32 v216,16,v146
MF v[104:107],a[168:171],a[108:111],v[104:107]
RD a[16:19],v3,31744
MF v[104:107],a[132:135],a[100:103],v[104:107]
v_exp_f32 v227,v227
MF v[108:111],a[136:139],a[100:103],v[108:111]
RD a[220:223],v3,23552
v_and_b32 v217,0xffff0000,v146
MF v[108:111],a[172:175],a[108:111],v[108:111]
v_add_f32 v226,1.0,v226
v_mul_f32 v218,v216,v216
MF v[112:115],a[176:179],a[108:111],v[112:115]
RD a[20:23],v3,32768
buffer_load_dwordx4 v26,s[12:15],s46 offen offset:3072 sc1 lds
MF v[112:115],a[140:143],a[100:103],v[112:115]
v_add_f32 v227,1.0,v227
v_mul_f32 v219,v217,v217
MF v[116:119],a[144:147],a[100:103],v[116:119]
buffer_load_dwordx4 a[92:95],v25,s[8:11],s47 offen offset:3072 sc1
RD a[224:227],v3,24576
MF v[116:119],a[180:183],a[108:111],v[116:119]
s_add_u32 s47,s47,4096
v_rcp_f32 v226,v226
MF v[120:123],a[184:187],a[108:111],v[120:123]
RD a[24:27],v3,33792
v_fma_f32 v218,v218,s58,v232
MF v[120:123],a[148:151],a[100:103],v[120:123]
v_rcp_f32 v227,v227
MF v[124:127],a[152:155],a[100:103],v[124:127]
s_add_u32 m0,s43,8192
v_fma_f32 v219,v219,s58,v232
v_mul_f32 v224,v224,v226
MF v[124:127],a[188:191],a[108:111],v[124:127]
RD a[228:231],v3,25600
v_mul_f32 v218,v218,v216
MF v[128:131],a[192:195],a[108:111],v[128:131]
RD a[28:31],v3,34816
v_mul_f32 v225,v225,v227
MF v[128:131],a[156:159],a[100:103],v[128:131]
buffer_load_dwordx4 v27,s[12:15],s46 offen sc1 lds
v_mul_f32 v219,v219,v217
MF v[132:135],a[160:163],a[100:103],v[132:135]
s_add_u32 s46,s46,36864
CV v145,v224,v225
s_add_u32 s48,s48,36864
s_cmp_eq_u32 s48,147456
s_cselect_b32 s48,0,s48
MF v[132:135],a[196:199],a[108:111],v[132:135]
LW 15
s_waitcnt vmcnt(18)
RD a[232:235],v3,26624
RD a[32:35],v3,35840
v_exp_f32 v218,v218
v_lshlrev_b32 v220,16,v147
v_exp_f32 v219,v219
MF v[64:67],a[200:203],a[112:115],v[64:67]
LW 15
s_barrier
v_and_b32 v221,0xffff0000,v147
MF v[64:67],a[0:3],a[120:123],v[64:67]
LW 14
v_add_u32 v3,s49,v2
v_add_f32 v218,1.0,v218
MF v[68:71],a[4:7],a[120:123],v[68:71]
s_add_u32 s49,s49,36864
buffer_load_dwordx4 a[96:99],v24,s[8:11],s47 offen sc1
v_mul_f32 v222,v220,v220
MF v[68:71],a[204:207],a[112:115],v[68:71]
LW 13
s_cmp_eq_u32 s49,147456
s_cselect_b32 s49,0,s49
MF v[72:75],a[208:211],a[112:115],v[72:75]
LW 12
v_add_f32 v219,1.0,v219
v_mul_f32 v223,v221,v221
MF v[72:75],a[8:11],a[120:123],v[72:75]
LW 10
s_add_u32 s43,s45,s48
RD a[128:131],v3,0
MF v[76:79],a[12:15],a[120:123],v[76:79]
s_add_u32 m0,s43,0
v_rcp_f32 v218,v218
MF v[76:79],a[212:215],a[112:115],v[76:79]
LW 10
buffer_load_dwordx4 v2,s[12:15],s46 offen sc1 lds
v_fma_f32 v222,v222,s58,v232
MF v[80:83],a[216:219],a[112:115],v[80:83]
LW 9
buffer_load_dwordx4 a[100:103],v25,s[8:11],s47 offen sc1
RD a[164:167],v3,9216
MF v[80:83],a[16:19],a[120:123],v[80:83]
LW 8
v_rcp_f32 v219,v219
MF v[84:87],a[20:23],a[120:123],v[84:87]
RD a[132:135],v3,1024
v_fma_f32 v223,v223,s58,v232
MF v[84:87],a[220:223],a[112:115],v[84:87]
LW 8
v_mul_f32 v216,v216,v218
v_mul_f32 v222,v222,v220
MF v[88:91],a[224:227],a[112:115],v[88:91]
LW 7
RD a[168:171],v3,10240
v_mul_f32 v217,v217,v219
MF v[88:91],a[24:27],a[120:123],v[88:91]
LW 6
RD a[136:139],v3,2048
v_mul_f32 v223,v223,v221
MF v[92:95],a[28:31],a[120:123],v[92:95]
buffer_load_dwordx4 v2,s[12:15],s46 offen offset:1024 sc1 lds
CV v146,v216,v217
MF v[92:95],a[228:231],a[112:115],v[92:95]
LW 6
v_exp_f32 v222,v222
MF v[96:99],a[232:235],a[112:115],v[96:99]
LW 5
RD a[172:175],v3,11264
v_lshlrev_b32 v224,16,v148
MF v[96:99],a[32:35],a[120:123],v[96:99]
v_exp_f32 v223,v223
MF v[100:103],a[200:203],a[116:119],v[100:103]
RD a[140:143],v3,3072
v_and_b32 v225,0xffff0000,v148
MF v[100:103],a[0:3],a[124:127],v[100:103]
buffer_load_dwordx4 a[104:107],v24,s[8:11],s47 offen offset:1024 sc1
v_add_f32 v222,1.0,v222
MF v[104:107],a[4:7],a[124:127],v[104:107]
RD a[176:179],v3,12288
v_mul_f32 v226,v224,v224
MF v[104:107],a[204:207],a[116:119],v[104:107]
RD a[144:147],v3,4096
v_add_f32 v223,1.0,v223
MF v[108:111],a[208:211],a[116:119],v[108:111]
buffer_load_dwordx4 v2,s[12:15],s46 offen offset:2048 sc1 lds
v_mul_f32 v227,v225,v225
MF v[108:111],a[8:11],a[124:127],v[108:111]
buffer_load_dwordx4 a[108:111],v25,s[8:11],s47 offen offset:1024 sc1
RD a[180:183],v3,13312
MF v[112:115],a[12:15],a[124:127],v[112:115]
v_rcp_f32 v222,v222
MF v[112:115],a[212:215],a[116:119],v[112:115]
RD a[148:151],v3,5120
v_fma_f32 v226,v226,s58,v232
MF v[116:119],a[216:219],a[116:119],v[116:119]
v_rcp_f32 v223,v223
MF v[116:119],a[16:19],a[124:127],v[116:119]
RD a[184:187],v3,14336
v_fma_f32 v227,v227,s58,v232
MF v[120:123],a[20:23],a[124:127],v[120:123]
v_mul_f32 v220,v220,v222
v_mul_f32 v226,v226,v224
MF v[120:123],a[220:223],a[116:119],v[120:123]
RD a[152:155],v3,6144
v_mul_f32 v221,v221,v223
MF v[124:127],a[224:227],a[116:119],v[124:127]
RD a[188:191],v3,15360
v_mul_f32 v227,v227,v225
MF v[124:127],a[24:27],a[124:127],v[124:127]
buffer_load_dwordx4 v2,s[12:15],s46 offen offset:3072 sc1 lds
CV v147,v220,v221
MF v[128:131],a[28:31],a[124:127],v[128:131]
s_add_u32 m0,s43,4096
v_exp_f32 v226,v226
MF v[128:131],a[228:231],a[116:119],v[128:131]
RD a[156:159],v3,7168
v_lshlrev_b32 v216,16,v149
MF v[132:135],a[232:235],a[116:119],v[132:135]
buffer_load_dwordx4 v26,s[12:15],s46 offen sc1 lds
v_exp_f32 v227,v227
MF v[132:135],a[32:35],a[124:127],v[132:135]
LW 14
s_waitcnt vmcnt(20)
RD a[192:195],v3,16384
RD a[160:163],v3,8192
RD a[196:199],v3,17408
v_and_b32 v217,0xffff0000,v149
v_add_f32 v226,1.0,v226
v_mul_f32 v218,v216,v216
v_add_f32 v227,1.0,v227
MF v[64:67],a[128:131],a[64:67],v[64:67]
LW 15
buffer_load_dwordx4 a[112:115],v24,s[8:11],s47 offen offset:2048 sc1
RD a[200:203],v3,18432
MF v[64:67],a[164:167],a[72:75],v[64:67]
LW 15
v_mul_f32 v219,v217,v217
MF v[68:71],a[168:171],a[72:75],v[68:71]
v_rcp_f32 v226,v226
MF v[68:71],a[132:135],a[64:67],v[68:71]
LW 14
RD a[0:3],v3,27648
v_fma_f32 v218,v218,s58,v232
MF v[72:75],a[136:139],a[64:67],v[72:75]
LW 14
v_rcp_f32 v227,v227
MF v[72:75],a[172:175],a[72:75],v[72:75]
LW 12
RD a[204:207],v3,19456
v_fma_f32 v219,v219,s58,v232
MF v[76:79],a[176:179],a[72:75],v[76:79]
buffer_load_dwordx4 v26,s[12:15],s46 offen offset:1024 sc1 lds
v_mul_f32 v224,v224,v226
MF v[76:79],a[140:143],a[64:67],v[76:79]
LW 12
RD a[4:7],v3,28672
v_mul_f32 v218,v218,v216
MF v[80:83],a[144:147],a[64:67],v[80:83]
LW 12
v_mul_f32 v225,v225,v227
v_mul_f32 v219,v219,v217
MF v[80:83],a[180:183],a[72:75],v[80:83]
LW 10
RD a[208:211],v3,20480
CV v148,v224,v225
MF v[84:87],a[184:187],a[72:75],v[84:87]
RD a[8:11],v3,29696
buffer_load_dwordx4 a[116:119],v25,s[8:11],s47 offen offset:2048 sc1
MF v[84:87],a[148:151],a[64:67],v[84:87]
LW 11
v_exp_f32 v218,v218
MF v[88:91],a[152:155],a[64:67],v[88:91]
LW 10
RD a[212:215],v3,21504
v_lshlrev_b32 v220,16,v150
MF v[88:91],a[188:191],a[72:75],v[88:91]
LW 9
v_exp_f32 v219,v219
MF v[92:95],a[192:195],a[72:75],v[92:95]
v_and_b32 v221,0xffff0000,v150
v_add_f32 v218,1.0,v218
MF v[92:95],a[156:159],a[64:67],v[92:95]
LW 8
buffer_load_dwordx4 v26,s[12:15],s46 offen offset:2048 sc1 lds
v_mul_f32 v222,v220,v220
MF v[96:99],a[160:163],a[64:67],v[96:99]
LW 7
RD a[12:15],v3,30720
v_add_f32 v219,1.0,v219
MF v[96:99],a[196:199],a[72:75],v[96:99]
RD a[216:219],v3,22528
v_mul_f32 v223,v221,v221
MF v[100:103],a[128:131],a[68:71],v[100:103]
v_rcp_f32 v218,v218
MF v[100:103],a[164:167],a[76:79],v[100:103]
buffer_load_dwordx4 a[120:123],v24,s[8:11],s47 offen offset:3072 sc1
v_fma_f32 v222,v222,s58,v232
MF v[104:107],a[168:171],a[76:79],v[104:107]
RD a[16:19],v3,31744
MF v[104:107],a[132:135],a[68:71],v[104:107]
v_rcp_f32 v219,v219
MF v[108:111],a[136:139],a[68:71],v[108:111]
RD a[220:223],v3,23552
v_fma_f32 v223,v223,s58,v232
MF v[108:111],a[172:175],a[76:79],v[108:111]
v_mul_f32 v216,v216,v218
v_mul_f32 v222,v222,v220
MF v[112:115],a[176:179],a[76:79],v[112:115]
RD a[20:23],v3,32768
buffer_load_dwordx4 v26,s[12:15],s46 offen offset:3072 sc1 lds
MF v[112:115],a[140:143],a[68:71],v[112:115]
v_mul_f32 v217,v217,v219
v_mul_f32 v223,v223,v221
MF v[116:119],a[144:147],a[68:71],v[116:119]
RD a[224:227],v3,24576
CV v149,v216,v217
MF v[116:119],a[180:183],a[76:79],v[116:119]
v_exp_f32 v222,v222
MF v[120:123],a[184:187],a[76:79],v[120:123]
RD a[24:27],v3,33792
v_lshlrev_b32 v224,16,v151
MF v[120:123],a[148:151],a[68:71],v[120:123]
buffer_load_dwordx4 a[124:127],v25,s[8:11],s47 offen offset:3072 sc1
s_add_u32 s47,s47,4096
MF v[124:127],a[152:155],a[68:71],v[124:127]
s_add_u32 m0,s43,8192
v_exp_f32 v223,v223
MF v[124:127],a[188:191],a[76:79],v[124:127]
RD a[228:231],v3,25600
v_and_b32 v225,0xffff0000,v151
MF v[128:131],a[192:195],a[76:79],v[128:131]
v_add_f32 v222,1.0,v222
v_mul_f32 v226,v224,v224
MF v[128:131],a[156:159],a[68:71],v[128:131]
RD a[28:31],v3,34816
v_add_f32 v223,1.0,v223
MF v[132:135],a[160:163],a[68:71],v[132:135]
buffer_load_dwordx4 v27,s[12:15],s46 offen sc1 lds
s_add_u32 s46,s46,36864
s_add_u32 s48,s48,36864
s_cmp_eq_u32 s48,147456
s_cselect_b32 s48,0,s48
MF v[132:135],a[196:199],a[76:79],v[132:135]
LW 15
s_waitcnt vmcnt(17)
RD a[232:235],v3,26624
RD a[32:35],v3,35840
v_mul_f32 v227,v225,v225
v_rcp_f32 v222,v222
v_fma_f32 v226,v226,s58,v232
v_rcp_f32 v223,v223
MF v[64:67],a[200:203],a[80:83],v[64:67]
LW 15
s_barrier
v_fma_f32 v227,v227,s58,v232
MF v[64:67],a[0:3],a[88:91],v[64:67]
LW 14
v_add_u32 v3,s49,v2
v_mul_f32 v220,v220,v222
MF v[68:71],a[4:7],a[88:91],v[68:71]
s_add_u32 s49,s49,36864
buffer_load_dwordx4 a[64:67],v24,s[8:11],s47 offen sc1
v_mul_f32 v226,v226,v224
MF v[68:71],a[204:207],a[80:83],v[68:71]
LW 13
v_mul_f32 v221,v221,v223
v_mul_f32 v227,v227,v225
MF v[72:75],a[208:211],a[80:83],v[72:75]
LW 12
s_cmp_eq_u32 s49,147456
s_cselect_b32 s49,0,s49
MF v[72:75],a[8:11],a[88:91],v[72:75]
LW 10
RD a[128:131],v3,0
CV v150,v220,v221
MF v[76:79],a[12:15],a[88:91],v[76:79]
s_add_u32 s43,s45,s48
RD a[164:167],v3,9216
s_add_u32 m0,s43,0
MF v[76:79],a[212:215],a[80:83],v[76:79]
LW 11
buffer_load_dwordx4 v2,s[12:15],s46 offen sc1 lds
MF v[80:83],a[216:219],a[80:83],v[80:83]
LW 10
v_exp_f32 v226,v226
MF v[80:83],a[16:19],a[88:91],v[80:83]
LW 8
RD a[132:135],v3,1024
v_lshlrev_b32 v216,16,v152
MF v[84:87],a[20:23],a[88:91],v[84:87]
v_exp_f32 v227,v227
MF v[84:87],a[220:223],a[80:83],v[84:87]
LW 8
buffer_load_dwordx4 a[68:71],v25,s[8:11],s47 offen sc1
v_and_b32 v217,0xffff0000,v152
MF v[88:91],a[224:227],a[80:83],v[88:91]
LW 7
RD a[168:171],v3,10240
v_add_f32 v226,1.0,v226
MF v[88:91],a[24:27],a[88:91],v[88:91]
LW 6
v_mul_f32 v218,v216,v216
v_add_f32 v227,1.0,v227
MF v[92:95],a[28:31],a[88:91],v[92:95]
RD a[136:139],v3,2048
v_mul_f32 v219,v217,v217
MF v[92:95],a[228:231],a[80:83],v[92:95]
LW 6
RD a[172:175],v3,11264
buffer_load_dwordx4 v2,s[12:15],s46 offen offset:1024 sc1 lds
MF v[96:99],a[232:235],a[80:83],v[96:99]
LW 6
v_rcp_f32 v226,v226
MF v[96:99],a[32:35],a[88:91],v[96:99]
RD a[140:143],v3,3072
v_fma_f32 v218,v218,s58,v232
MF v[100:103],a[200:203],a[84:87],v[100:103]
v_rcp_f32 v227,v227
MF v[100:103],a[0:3],a[92:95],v[100:103]
buffer_load_dwordx4 a[72:75],v24,s[8:11],s47 offen offset:1024 sc1
v_fma_f32 v219,v219,s58,v232
MF v[104:107],a[4:7],a[92:95],v[104:107]
RD a[176:179],v3,12288
v_mul_f32 v224,v224,v226
MF v[104:107],a[204:207],a[84:87],v[104:107]
v_mul_f32 v218,v218,v216
v_mul_f32 v225,v225,v227
MF v[108:111],a[208:211],a[84:87],v[108:111]
RD a[144:147],v3,4096
v_mul_f32 v219,v219,v217
MF v[108:111],a[8:11],a[92:95],v[108:111]
buffer_load_dwordx4 v2,s[12:15],s46 offen offset:2048 sc1 lds
CV v151,v224,v225
MF v[112:115],a[12:15],a[92:95],v[112:115]
buffer_load_dwordx4 a[76:79],v25,s[8:11],s47 offen offset:1024 sc1
RD a[180:183],v3,13312
MF v[112:115],a[212:215],a[84:87],v[112:115]
v_exp_f32 v218,v218
MF v[116:119],a[216:219],a[84:87],v[116:119]
RD a[148:151],v3,5120
v_lshlrev_b32 v220,16,v153
MF v[116:119],a[16:19],a[92:95],v[116:119]
v_exp_f32 v219,v219
MF v[120:123],a[20:23],a[92:95],v[120:123]
RD a[184:187],v3,14336
v_and_b32 v221,0xffff0000,v153
MF v[120:123],a[220:223],a[84:87],v[120:123]
v_add_f32 v218,1.0,v218
v_mul_f32 v222,v220,v220
MF v[124:127],a[224:227],a[84:87],v[124:127]
RD a[152:155],v3,6144
v_add_f32 v219,1.0,v219
MF v[124:127],a[24:27],a[92:95],v[124:127]
RD a[188:191],v3,15360
v_mul_f32 v223,v221,v221
MF v[128:131],a[28:31],a[92:95],v[128:131]
RD a[156:159],v3,7168
buffer_load_dwordx4 v2,s[12:15],s46 offen offset:3072 sc1 lds
MF v[128:131],a[228:231],a[84:87],v[128:131]
s_add_u32 m0,s43,4096
v_rcp_f32 v218,v218
MF v[132:135],a[232:235],a[84:87],v[132:135]
buffer_load_dwordx4 v26,s[12:15],s46 offen sc1 lds
RD a[192:195],v3,16384
v_fma_f32 v222,v222,s58,v232
MF v[132:135],a[32:35],a[92:95],v[132:135]
LW 15
s_waitcnt vmcnt(19)
RD a[160:163],v3,8192
RD a[196:199],v3,17408
v_rcp_f32 v219,v219
v_fma_f32 v223,v223,s58,v232
v_mul_f32 v216,v216,v218
v_mul_f32 v222,v222,v220
v_mul_f32 v217,v217,v219
v_mul_f32 v223,v223,v221
MF v[64:67],a[128:131],a[96:99],v[64:67]
LW 15
buffer_load_dwordx4 a[80:83],v24,s[8:11],s47 offen offset:2048 sc1
RD a[200:203],v3,18432
MF v[64:67],a[164:167],a[104:107],v[64:67]
LW 15
CV v152,v216,v217
MF v[68:71],a[168:171],a[104:107],v[68:71]
v_exp_f32 v222,v222
MF v[68:71],a[132:135],a[96:99],v[68:71]
LW 14
RD a[0:3],v3,27648
v_lshlrev_b32 v224,16,v154
MF v[72:75],a[136:139],a[96:99],v[72:75]
LW 14
v_exp_f32 v223,v223
MF v[72:75],a[172:175],a[104:107],v[72:75]
LW 12
RD a[204:207],v3,19456
v_and_b32 v225,0xffff0000,v154
MF v[76:79],a[176:179],a[104:107],v[76:79]
buffer_load_dwordx4 v26,s[12:15],s46 offen offset:1024 sc1 lds
v_add_f32 v222,1.0,v222
MF v[76:79],a[140:143],a[96:99],v[76:79]
LW 12
RD a[4:7],v3,28672
v_mul_f32 v226,v224,v224
MF v[80:83],a[144:147],a[96:99],v[80:83]
LW 12
v_add_f32 v223,1.0,v223
v_mul_f32 v227,v225,v225
MF v[80:83],a[180:183],a[104:107],v[80:83]
LW 10
buffer_load_dwordx4 a[84:87],v25,s[8:11],s47 offen offset:2048 sc1
RD a[208:211],v3,20480
MF v[84:87],a[184:187],a[104:107],v[84:87]
v_rcp_f32 v222,v222
MF v[84:87],a[148:151],a[96:99],v[84:87]
LW 10
RD a[8:11],v3,29696
v_fma_f32 v226,v226,s58,v232
MF v[88:91],a[152:155],a[96:99],v[88:91]
LW 10
v_rcp_f32 v223,v223
MF v[88:91],a[188:191],a[104:107],v[88:91]
LW 8
v_fma_f32 v227,v227,s58,v232
v_mul_f32 v220,v220,v222
MF v[92:95],a[192:195],a[104:107],v[92:95]
RD a[212:215],v3,21504
v_mul_f32 v226,v226,v224
MF v[92:95],a[156:159],a[96:99],v[92:95]
LW 8
buffer_load_dwordx4 v26,s[12:15],s46 offen offset:2048 sc1 lds
v_mul_f32 v221,v221,v223
MF v[96:99],a[160:163],a[96:99],v[96:99]
LW 7
RD a[12:15],v3,30720
v_mul_f32 v227,v227,v225
MF v[96:99],a[196:199],a[104:107],v[96:99]
RD a[216:219],v3,22528
CV v153,v220,v221
MF v[100:103],a[128:131],a[100:103],v[100:103]
v_exp_f32 v226,v226
MF v[100:103],a[164:167],a[108:111],v[100:103]
buffer_load_dwordx4 a[88:91],v24,s[8:11],s47 offen offset:3072 sc1
v_lshlrev_b32 v216,16,v155
MF v[104:107],a[168:171],a[108:111],v[104:107]
RD a[16:19],v3,31744
MF v[104:107],a[132:135],a[100:103],v[104:107]
v_exp_f32 v227,v227
MF v[108:111],a[136:139],a[100:103],v[108:111]
RD a[220:223],v3,23552
v_and_b32 v217,0xffff0000,v155
MF v[108:111],a[172:175],a[108:111],v[108:111]
v_add_f32 v226,1.0,v226
v_mul_f32 v218,v216,v216
MF v[112:115],a[176:179],a[108:111],v[112:115]
RD a[20:23],v3,32768
buffer_load_dwordx4 v26,s[12:15],s46 offen offset:3072 sc1 lds
MF v[112:115],a[140:143],a[100:103],v[112:115]
v_add_f32 v227,1.0,v227
v_mul_f32 v219,v217,v217
MF v[116:119],a[144:147],a[100:103],v[116:119]
v_rcp_f32 v226,v226
MF v[116:119],a[180:183],a[108:111],v[116:119]
RD a[224:227],v3,24576
v_fma_f32 v218,v218,s58,v232
MF v[120:123],a[184:187],a[108:111],v[120:123]
v_rcp_f32 v227,v227
MF v[120:123],a[148:151],a[100:103],v[120:123]
buffer_load_dwordx4 a[92:95],v25,s[8:11],s47 offen offset:3072 sc1
RD a[24:27],v3,33792
MF v[124:127],a[152:155],a[100:103],v[124:127]
s_add_u32 s47,s47,4096
v_fma_f32 v219,v219,s58,v232
v_mul_f32 v224,v224,v226
MF v[124:127],a[188:191],a[108:111],v[124:127]
s_add_u32 m0,s43,8192
RD a[228:231],v3,25600
v_mul_f32 v218,v218,v216
MF v[128:131],a[192:195],a[108:111],v[128:131]
RD a[28:31],v3,34816
v_mul_f32 v225,v225,v227
MF v[128:131],a[156:159],a[100:103],v[128:131]
buffer_load_dwordx4 v27,s[12:15],s46 offen sc1 lds
v_mul_f32 v219,v219,v217
MF v[132:135],a[160:163],a[100:103],v[132:135]
s_add_u32 s46,s46,36864
CV v154,v224,v225
s_add_u32 s48,s48,36864
s_cmp_eq_u32 s48,147456
s_cselect_b32 s48,0,s48
MF v[132:135],a[196:199],a[108:111],v[132:135]
LW 15
s_waitcnt vmcnt(17)
RD a[232:235],v3,26624
RD a[32:35],v3,35840
v_exp_f32 v218,v218
v_lshlrev_b32 v220,16,v156
v_exp_f32 v219,v219
MF v[64:67],a[200:203],a[112:115],v[64:67]
LW 15
s_barrier
v_and_b32 v221,0xffff0000,v156
MF v[64:67],a[0:3],a[120:123],v[64:67]
LW 14
v_add_u32 v3,s49,v2
v_add_f32 v218,1.0,v218
MF v[68:71],a[4:7],a[120:123],v[68:71]
s_add_u32 s49,s49,36864
buffer_load_dwordx4 a[96:99],v24,s[8:11],s47 offen sc1
v_mul_f32 v222,v220,v220
MF v[68:71],a[204:207],a[112:115],v[68:71]
LW 13
v_add_f32 v219,1.0,v219
v_mul_f32 v223,v221,v221
MF v[72:75],a[208:211],a[112:115],v[72:75]
LW 12
s_cmp_eq_u32 s49,147456
s_cselect_b32 s49,0,s49
MF v[72:75],a[8:11],a[120:123],v[72:75]
LW 10
v_rcp_f32 v218,v218
MF v[76:79],a[12:15],a[120:123],v[76:79]
s_add_u32 s43,s45,s48
s_add_u32 m0,s43,0
RD a[128:131],v3,0
MF v[76:79],a[212:215],a[112:115],v[76:79]
LW 10
buffer_load_dwordx4 v2,s[12:15],s46 offen sc1 lds
v_fma_f32 v222,v222,s58,v232
MF v[80:83],a[216:219],a[112:115],v[80:83]
LW 9
buffer_load_dwordx4 a[100:103],v25,s[8:11],s47 offen sc1
RD a[164:167],v3,9216
MF v[80:83],a[16:19],a[120:123],v[80:83]
LW 8
v_rcp_f32 v219,v219
MF v[84:87],a[20:23],a[120:123],v[84:87]
RD a[132:135],v3,1024
v_fma_f32 v223,v223,s58,v232
MF v[84:87],a[220:223],a[112:115],v[84:87]
LW 8
v_mul_f32 v216,v216,v218
v_mul_f32 v222,v222,v220
MF v[88:91],a[224:227],a[112:115],v[88:91]
LW 7
RD a[168:171],v3,10240
v_mul_f32 v217,v217,v219
MF v[88:91],a[24:27],a[120:123],v[88:91]
LW 6
RD a[136:139],v3,2048
v_mul_f32 v223,v223,v221
MF v[92:95],a[28:31],a[120:123],v[92:95]
buffer_load_dwordx4 v2,s[12:15],s46 offen offset:1024 sc1 lds
CV v155,v216,v217
MF v[92:95],a[228:231],a[112:115],v[92:95]
LW 6
v_exp_f32 v222,v222
MF v[96:99],a[232:235],a[112:115],v[96:99]
LW 5
RD a[172:175],v3,11264
v_lshlrev_b32 v224,16,v157
MF v[96:99],a[32:35],a[120:123],v[96:99]
v_exp_f32 v223,v223
MF v[100:103],a[200:203],a[116:119],v[100:103]
RD a[140:143],v3,3072
v_and_b32 v225,0xffff0000,v157
MF v[100:103],a[0:3],a[124:127],v[100:103]
buffer_load_dwordx4 a[104:107],v24,s[8:11],s47 offen offset:1024 sc1
v_add_f32 v222,1.0,v222
MF v[104:107],a[4:7],a[124:127],v[104:107]
RD a[176:179],v3,12288
v_mul_f32 v226,v224,v224
MF v[104:107],a[204:207],a[116:119],v[104:107]
RD a[144:147],v3,4096
v_add_f32 v223,1.0,v223
MF v[108:111],a[208:211],a[116:119],v[108:111]
buffer_load_dwordx4 v2,s[12:15],s46 offen offset:2048 sc1 lds
v_mul_f32 v227,v225,v225
MF v[108:111],a[8:11],a[124:127],v[108:111]
v_rcp_f32 v222,v222
MF v[112:115],a[12:15],a[124:127],v[112:115]
RD a[180:183],v3,13312
v_fma_f32 v226,v226,s58,v232
MF v[112:115],a[212:215],a[116:119],v[112:115]
v_rcp_f32 v223,v223
MF v[116:119],a[216:219],a[116:119],v[116:119]
RD a[148:151],v3,5120
v_fma_f32 v227,v227,s58,v232
MF v[116:119],a[16:19],a[124:127],v[116:119]
buffer_load_dwordx4 a[108:111],v25,s[8:11],s47 offen offset:1024 sc1
v_mul_f32 v220,v220,v222
MF v[120:123],a[20:23],a[124:127],v[120:123]
RD a[184:187],v3,14336
v_mul_f32 v226,v226,v224
MF v[120:123],a[220:223],a[116:119],v[120:123]
RD a[152:155],v3,6144
v_mul_f32 v221,v221,v223
MF v[124:127],a[224:227],a[116:119],v[124:127]
v_mul_f32 v227,v227,v225
CV v156,v220,v221
MF v[124:127],a[24:27],a[124:127],v[124:127]
buffer_load_dwordx4 v2,s[12:15],s46 offen offset:3072 sc1 lds
RD a[188:191],v3,15360
MF v[128:131],a[28:31],a[124:127],v[128:131]
s_add_u32 m0,s43,4096
v_exp_f32 v226,v226
MF v[128:131],a[228:231],a[116:119],v[128:131]
RD a[156:159],v3,7168
v_lshlrev_b32 v216,16,v158
MF v[132:135],a[232:235],a[116:119],v[132:135]
buffer_load_dwordx4 v26,s[12:15],s46 offen sc1 lds
v_exp_f32 v227,v227
MF v[132:135],a[32:35],a[124:127],v[132:135]
LW 14
s_waitcnt vmcnt(19)
RD a[192:195],v3,16384
RD a[160:163],v3,8192
RD a[196:199],v3,17408
v_and_b32 v217,0xffff0000,v158
v_add_f32 v226,1.0,v226
v_mul_f32 v218,v216,v216
v_add_f32 v227,1.0,v227
v_mul_f32 v219,v217,v217
MF v[64:67],a[128:131],a[64:67],v[64:67]
LW 15
buffer_load_dwordx4 a[112:115],v24,s[8:11],s47 offen offset:2048 sc1
RD a[200:203],v3,18432
MF v[64:67],a[164:167],a[72:75],v[64:67]
LW 15
v_rcp_f32 v226,v226
MF v[68:71],a[168:171],a[72:75],v[68:71]
RD a[0:3],v3,27648
v_fma_f32 v218,v218,s58,v232
MF v[68:71],a[132:135],a[64:67],v[68:71]
LW 15
v_rcp_f32 v227,v227
MF v[72:75],a[136:139],a[64:67],v[72:75]
LW 14
buffer_load_dwordx4 v26,s[12:15],s46 offen offset:1024 sc1 lds
v_fma_f32 v219,v219,s58,v232
MF v[72:75],a[172:175],a[72:75],v[72:75]
LW 12
RD a[204:207],v3,19456
v_mul_f32 v224,v224,v226
MF v[76:79],a[176:179],a[72:75],v[76:79]
v_mul_f32 v218,v218,v216
v_mul_f32 v225,v225,v227
MF v[76:79],a[140:143],a[64:67],v[76:79]
LW 12
RD a[4:7],v3,28672
v_mul_f32 v219,v219,v217
MF v[80:83],a[144:147],a[64:67],v[80:83]
LW 12
buffer_load_dwordx4 a[116:119],v25,s[8:11],s47 offen offset:2048 sc1
CV v157,v224,v225
MF v[80:83],a[180:183],a[72:75],v[80:83]
LW 10
RD a[208:211],v3,20480
MF v[84:87],a[184:187],a[72:75],v[84:87]
v_exp_f32 v218,v218
MF v[84:87],a[148:151],a[64:67],v[84:87]
LW 10
RD a[8:11],v3,29696
v_lshlrev_b32 v220,16,v159
MF v[88:91],a[152:155],a[64:67],v[88:91]
LW 10
v_exp_f32 v219,v219
MF v[88:91],a[188:191],a[72:75],v[88:91]
LW 8
buffer_load_dwordx4 v26,s[12:15],s46 offen offset:2048 sc1 lds
v_and_b32 v221,0xffff0000,v159
MF v[92:95],a[192:195],a[72:75],v[92:95]
RD a[212:215],v3,21504
v_add_f32 v218,1.0,v218
MF v[92:95],a[156:159],a[64:67],v[92:95]
LW 8
v_mul_f32 v222,v220,v220
v_add_f32 v219,1.0,v219
MF v[96:99],a[160:163],a[64:67],v[96:99]
LW 7
buffer_load_dwordx4 a[120:123],v24,s[8:11],s47 offen offset:3072 sc1
RD a[12:15],v3,30720
MF v[96:99],a[196:199],a[72:75],v[96:99]
RD a[216:219],v3,22528
v_mul_f32 v223,v221,v221
MF v[100:103],a[128:131],a[68:71],v[100:103]
v_rcp_f32 v218,v218
MF v[100:103],a[164:167],a[76:79],v[100:103]
buffer_load_dwordx4 v26,s[12:15],s46 offen offset:3072 sc1 lds
v_fma_f32 v222,v222,s58,v232
MF v[104:107],a[168:171],a[76:79],v[104:107]
v_rcp_f32 v219,v219
MF v[104:107],a[132:135],a[68:71],v[104:107]
RD a[16:19],v3,31744
v_fma_f32 v223,v223,s58,v232
MF v[108:111],a[136:139],a[68:71],v[108:111]
RD a[220:223],v3,23552
v_mul_f32 v216,v216,v218
MF v[108:111],a[172:175],a[76:79],v[108:111]
buffer_load_dwordx4 a[124:127],v25,s[8:11],s47 offen offset:3072 sc1
v_mul_f32 v222,v222,v220
MF v[112:115],a[176:179],a[76:79],v[112:115]
s_add_u32 s47,s47,4096
RD a[20:23],v3,32768
v_mul_f32 v217,v217,v219
MF v[112:115],a[140:143],a[68:71],v[112:115]
s_add_u32 m0,s43,8192
v_mul_f32 v223,v223,v221
CV v158,v216,v217
MF v[116:119],a[144:147],a[68:71],v[116:119]
v_exp_f32 v222,v222
MF v[116:119],a[180:183],a[76:79],v[116:119]
buffer_load_dwordx4 v27,s[12:15],s46 offen sc1 lds
RD a[224:227],v3,24576
MF v[120:123],a[184:187],a[76:79],v[120:123]
s_add_u32 s46,s46,36864
v_lshlrev_b32 v224,16,v160
s_add_u32 s48,s48,36864
MF v[120:123],a[148:151],a[68:71],v[120:123]
s_cmp_eq_u32 s48,147456
s_cselect_b32 s48,0,s48
RD a[24:27],v3,33792
MF v[124:127],a[152:155],a[68:71],v[124:127]
s_mul_i32 s53,s54,18432
v_exp_f32 v223,v223
MF v[124:127],a[188:191],a[76:79],v[124:127]
s_add_u32 s53,s53,131072
v_and_b32 v225,0xffff0000,v160
v_add_f32 v222,1.0,v222
MF v[128:131],a[192:195],a[76:79],v[128:131]
s_lshr_b32 s52,s54,1
s_lshl_b32 s52,s52,16
RD a[228:231],v3,25600
MF v[128:131],a[156:159],a[68:71],v[128:131]
s_and_b32 s57,s54,1
s_mul_i32 s40,s57,32768
s_add_u32 s52,s52,s40
MF v[132:135],a[160:163],a[68:71],v[132:135]
s_mul_i32 s57,s57,0
v_mul_f32 v226,v224,v224
s_add_u32 s57,s57,2
s_lshr_b32 s7,s54,1
s_mul_i32 s7,s7,1792
s_add_u32 s7,s7,0x8308000
v_lshl_add_u32 v8,v1,5,s7
global_load_dwordx4 v[234:237],v8,s[4:5] sc1
global_load_dwordx4 v[238:241],v8,s[4:5] offset:16 sc1
MF v[132:135],a[196:199],a[76:79],v[132:135]
LW 14
s_waitcnt vmcnt(19)
RD a[28:31],v3,34816
RD a[232:235],v3,26624
RD a[32:35],v3,35840
v_add_f32 v223,1.0,v223
v_mul_f32 v227,v225,v225
v_rcp_f32 v222,v222
v_fma_f32 v226,v226,s58,v232
v_rcp_f32 v223,v223
v_fma_f32 v227,v227,s58,v232
MF v[64:67],a[200:203],a[80:83],v[64:67]
LW 15
s_barrier
v_mul_f32 v220,v220,v222
MF v[64:67],a[0:3],a[88:91],v[64:67]
LW 14
v_add_u32 v3,s49,v2
v_mul_f32 v226,v226,v224
MF v[68:71],a[4:7],a[88:91],v[68:71]
s_add_u32 s49,s49,36864
buffer_load_dwordx4 a[64:67],v24,s[8:11],s47 offen sc1
v_mul_f32 v221,v221,v223
MF v[68:71],a[204:207],a[80:83],v[68:71]
LW 13
s_cmp_eq_u32 s49,147456
s_cselect_b32 s49,0,s49
MF v[72:75],a[208:211],a[80:83],v[72:75]
LW 12
v_mul_f32 v227,v227,v225
CV v159,v220,v221
MF v[72:75],a[8:11],a[88:91],v[72:75]
LW 10
s_add_u32 s43,s45,s48
s_add_u32 m0,s43,0
MF v[76:79],a[12:15],a[88:91],v[76:79]
RD a[128:131],v3,0
buffer_load_dwordx4 v2,s[12:15],s46 offen sc1 lds
MF v[76:79],a[212:215],a[80:83],v[76:79]
LW 10
v_exp_f32 v226,v226
MF v[80:83],a[216:219],a[80:83],v[80:83]
LW 9
RD a[164:167],v3,9216
v_lshlrev_b32 v216,16,v161
MF v[80:83],a[16:19],a[88:91],v[80:83]
LW 8
v_exp_f32 v227,v227
MF v[84:87],a[20:23],a[88:91],v[84:87]
buffer_load_dwordx4 a[68:71],v25,s[8:11],s47 offen sc1
v_and_b32 v217,0xffff0000,v161
MF v[84:87],a[220:223],a[80:83],v[84:87]
LW 7
RD a[132:135],v3,1024
v_add_f32 v226,1.0,v226
MF v[88:91],a[224:227],a[80:83],v[88:91]
LW 7
RD a[168:171],v3,10240
v_mul_f32 v218,v216,v216
MF v[88:91],a[24:27],a[88:91],v[88:91]
LW 6
buffer_load_dwordx4 v2,s[12:15],s46 offen offset:1024 sc1 lds
v_add_f32 v227,1.0,v227
MF v[92:95],a[28:31],a[88:91],v[92:95]
RD a[136:139],v3,2048
v_mul_f32 v219,v217,v217
MF v[92:95],a[228:231],a[80:83],v[92:95]
LW 6
v_rcp_f32 v226,v226
MF v[96:99],a[232:235],a[80:83],v[96:99]
LW 5
RD a[172:175],v3,11264
v_fma_f32 v218,v218,s58,v232
MF v[96:99],a[32:35],a[88:91],v[96:99]
RD a[140:143],v3,3072
buffer_load_dwordx4 a[72:75],v24,s[8:11],s47 offen offset:1024 sc1
MF v[100:103],a[200:203],a[84:87],v[100:103]
v_rcp_f32 v227,v227
MF v[100:103],a[0:3],a[92:95],v[100:103]
v_fma_f32 v219,v219,s58,v232
v_mul_f32 v224,v224,v226
MF v[104:107],a[4:7],a[92:95],v[104:107]
buffer_load_dwordx4 v2,s[12:15],s46 offen offset:2048 sc1 lds
v_mul_f32 v218,v218,v216
MF v[104:107],a[204:207],a[84:87],v[104:107]
RD a[176:179],v3,12288
v_mul_f32 v225,v225,v227
MF v[108:111],a[208:211],a[84:87],v[108:111]
RD a[144:147],v3,4096
v_mul_f32 v219,v219,v217
MF v[108:111],a[8:11],a[92:95],v[108:111]
buffer_load_dwordx4 a[76:79],v25,s[8:11],s47 offen offset:1024 sc1
CV v160,v224,v225
MF v[112:115],a[12:15],a[92:95],v[112:115]
buffer_load_dwordx4 v2,s[12:15],s46 offen offset:3072 sc1 lds
RD a[180:183],v3,13312
MF v[112:115],a[212:215],a[84:87],v[112:115]
s_add_u32 m0,s43,4096
v_exp_f32 v218,v218
MF v[116:119],a[216:219],a[84:87],v[116:119]
RD a[148:151],v3,5120
v_lshlrev_b32 v220,16,v162
MF v[116:119],a[16:19],a[92:95],v[116:119]
v_exp_f32 v219,v219
MF v[120:123],a[20:23],a[92:95],v[120:123]
RD a[184:187],v3,14336
v_and_b32 v221,0xffff0000,v162
MF v[120:123],a[220:223],a[84:87],v[120:123]
v_add_f32 v218,1.0,v218
v_mul_f32 v222,v220,v220
MF v[124:127],a[224:227],a[84:87],v[124:127]
buffer_load_dwordx4 v26,s[12:15],s46 offen sc1 lds
RD a[152:155],v3,6144
MF v[124:127],a[24:27],a[92:95],v[124:127]
v_add_f32 v219,1.0,v219
v_mul_f32 v223,v221,v221
MF v[128:131],a[28:31],a[92:95],v[128:131]
s_add_u32 s40,s0,Lm_fin-Lm_pc
s_addc_u32 s41,s1,0
RD a[188:191],v3,15360
MF v[128:131],a[228:231],a[84:87],v[128:131]
s_lshr_b32 s7,s2,3
v_rcp_f32 v218,v218
MF v[132:135],a[232:235],a[84:87],v[132:135]
s_lshl_b32 s7,s7,2
s_add_u32 s7,s7,s32
s_lshl_b32 s7,s7,9
v_and_b32 v28,3,v1
v_lshl_add_u32 v28,v28,7,s7
v_min_u32 v28,Lm_codeend-Lm_fin-4,v28
global_load_dword v29,v28,s[40:41]
s_sub_u32 s42,15,s33
s_min_u32 s42,s42,s33
s_lshl_b32 s42,s42,5
s_lshr_b32 s41,s54,1
s_lshl_b32 s41,s41,4
s_add_u32 s42,s42,s41
s_lshl_b32 s7,s42,4
s_add_u32 s7,s7,0x8304000
v_lshl_add_u32 v30,v1,2,s7
global_load_dword v31,v30,s[4:5] sc1
v_fma_f32 v222,v222,s58,v232
MF v[132:135],a[32:35],a[92:95],v[132:135]
LW 13
s_waitcnt vmcnt(23)
RD a[156:159],v3,7168
RD a[192:195],v3,16384
RD a[160:163],v3,8192
RD a[196:199],v3,17408
v_rcp_f32 v219,v219
v_fma_f32 v223,v223,s58,v232
v_mul_f32 v216,v216,v218
v_mul_f32 v222,v222,v220
v_mul_f32 v217,v217,v219
v_mul_f32 v223,v223,v221
MF v[64:67],a[128:131],a[96:99],v[64:67]
LW 15
buffer_load_dwordx4 a[80:83],v24,s[8:11],s47 offen offset:2048 sc1
RD a[200:203],v3,18432
MF v[64:67],a[164:167],a[104:107],v[64:67]
LW 15
CV v161,v216,v217
MF v[68:71],a[168:171],a[104:107],v[68:71]
v_exp_f32 v222,v222
MF v[68:71],a[132:135],a[96:99],v[68:71]
LW 14
RD a[0:3],v3,27648
v_lshlrev_b32 v224,16,v163
MF v[72:75],a[136:139],a[96:99],v[72:75]
LW 14
v_exp_f32 v223,v223
MF v[72:75],a[172:175],a[104:107],v[72:75]
LW 12
RD a[204:207],v3,19456
v_and_b32 v225,0xffff0000,v163
MF v[76:79],a[176:179],a[104:107],v[76:79]
buffer_load_dwordx4 v26,s[12:15],s46 offen offset:1024 sc1 lds
v_add_f32 v222,1.0,v222
MF v[76:79],a[140:143],a[96:99],v[76:79]
LW 12
RD a[4:7],v3,28672
v_mul_f32 v226,v224,v224
MF v[80:83],a[144:147],a[96:99],v[80:83]
LW 12
v_add_f32 v223,1.0,v223
v_mul_f32 v227,v225,v225
MF v[80:83],a[180:183],a[104:107],v[80:83]
LW 10
buffer_load_dwordx4 a[84:87],v25,s[8:11],s47 offen offset:2048 sc1
RD a[208:211],v3,20480
MF v[84:87],a[184:187],a[104:107],v[84:87]
v_rcp_f32 v222,v222
MF v[84:87],a[148:151],a[96:99],v[84:87]
LW 10
RD a[8:11],v3,29696
v_fma_f32 v226,v226,s58,v232
MF v[88:91],a[152:155],a[96:99],v[88:91]
LW 10
v_rcp_f32 v223,v223
MF v[88:91],a[188:191],a[104:107],v[88:91]
LW 8
v_fma_f32 v227,v227,s58,v232
v_mul_f32 v220,v220,v222
MF v[92:95],a[192:195],a[104:107],v[92:95]
RD a[212:215],v3,21504
v_mul_f32 v226,v226,v224
MF v[92:95],a[156:159],a[96:99],v[92:95]
LW 8
buffer_load_dwordx4 v26,s[12:15],s46 offen offset:2048 sc1 lds
v_mul_f32 v221,v221,v223
MF v[96:99],a[160:163],a[96:99],v[96:99]
LW 7
RD a[12:15],v3,30720
v_mul_f32 v227,v227,v225
MF v[96:99],a[196:199],a[104:107],v[96:99]
RD a[216:219],v3,22528
CV v162,v220,v221
MF v[100:103],a[128:131],a[100:103],v[100:103]
v_exp_f32 v226,v226
MF v[100:103],a[164:167],a[108:111],v[100:103]
buffer_load_dwordx4 a[88:91],v24,s[8:11],s47 offen offset:3072 sc1
v_lshlrev_b32 v216,16,v164
MF v[104:107],a[168:171],a[108:111],v[104:107]
v_exp_f32 v227,v227
MF v[104:107],a[132:135],a[100:103],v[104:107]
RD a[16:19],v3,31744
v_and_b32 v217,0xffff0000,v164
MF v[108:111],a[136:139],a[100:103],v[108:111]
RD a[220:223],v3,23552
v_add_f32 v226,1.0,v226
MF v[108:111],a[172:175],a[108:111],v[108:111]
v_mul_f32 v218,v216,v216
v_add_f32 v227,1.0,v227
MF v[112:115],a[176:179],a[108:111],v[112:115]
RD a[20:23],v3,32768
buffer_load_dwordx4 v26,s[12:15],s46 offen offset:3072 sc1 lds
MF v[112:115],a[140:143],a[100:103],v[112:115]
RD a[224:227],v3,24576
v_mul_f32 v219,v217,v217
MF v[116:119],a[144:147],a[100:103],v[116:119]
v_rcp_f32 v226,v226
MF v[116:119],a[180:183],a[108:111],v[116:119]
RD a[24:27],v3,33792
v_fma_f32 v218,v218,s58,v232
MF v[120:123],a[184:187],a[108:111],v[120:123]
v_rcp_f32 v227,v227
MF v[120:123],a[148:151],a[100:103],v[120:123]
buffer_load_dwordx4 a[92:95],v25,s[8:11],s47 offen offset:3072 sc1
v_fma_f32 v219,v219,s58,v232
MF v[124:127],a[152:155],a[100:103],v[124:127]
s_add_u32 s47,s47,4096
v_mul_f32 v224,v224,v226
v_mul_f32 v218,v218,v216
MF v[124:127],a[188:191],a[108:111],v[124:127]
s_add_u32 m0,s43,8192
RD a[228:231],v3,25600
v_mul_f32 v225,v225,v227
MF v[128:131],a[192:195],a[108:111],v[128:131]
RD a[28:31],v3,34816
v_mul_f32 v219,v219,v217
MF v[128:131],a[156:159],a[100:103],v[128:131]
buffer_load_dwordx4 v27,s[12:15],s46 offen sc1 lds
CV v163,v224,v225
MF v[132:135],a[160:163],a[100:103],v[132:135]
s_add_u32 s46,s46,36864
RD a[232:235],v3,26624
s_add_u32 s48,s48,36864
s_cmp_eq_u32 s48,147456
s_cselect_b32 s48,0,s48
MF v[132:135],a[196:199],a[108:111],v[132:135]
LW 15
s_waitcnt vmcnt(21)
RD a[32:35],v3,35840
v_exp_f32 v218,v218
v_lshlrev_b32 v220,16,v165
v_exp_f32 v219,v219
v_and_b32 v221,0xffff0000,v165
MF v[64:67],a[200:203],a[112:115],v[64:67]
s_barrier
s_waitcnt vmcnt(19)
v_xor_b32 v234,s3,v234
v_bitop3_b32 v234,v235,s3,v234 bitop3:0xbe
v_bitop3_b32 v234,v236,s3,v234 bitop3:0xbe
v_bitop3_b32 v234,v237,s3,v234 bitop3:0xbe
v_bitop3_b32 v234,v238,s3,v234 bitop3:0xbe
v_bitop3_b32 v234,v239,s3,v234 bitop3:0xbe
v_bitop3_b32 v234,v240,s3,v234 bitop3:0xbe
v_bitop3_b32 v234,v241,s3,v234 bitop3:0xbe
v_cmp_ne_u32 vcc,0,v234
s_nop 0
s_cbranch_vccnz Lm_pl31
Lm_pl31r:
MF v[64:67],a[0:3],a[120:123],v[64:67]
LW 14
v_add_f32 v218,1.0,v218
v_mul_f32 v222,v220,v220
MF v[68:71],a[4:7],a[120:123],v[68:71]
buffer_load_dwordx4 a[96:99],v24,s[8:11],s47 offen sc1
v_add_u32 v3,s49,v2
MF v[68:71],a[204:207],a[112:115],v[68:71]
LW 13
s_add_u32 s49,s49,36864
v_add_f32 v219,1.0,v219
MF v[72:75],a[208:211],a[112:115],v[72:75]
LW 12
s_cmp_eq_u32 s49,147456
s_cselect_b32 s49,0,s49
MF v[72:75],a[8:11],a[120:123],v[72:75]
LW 10
RD a[128:131],v3,0
v_mul_f32 v223,v221,v221
MF v[76:79],a[12:15],a[120:123],v[76:79]
s_mul_i32 s40,s34,534528
v_rcp_f32 v218,v218
MF v[76:79],a[212:215],a[112:115],v[76:79]
LW 10
s_add_u32 s40,s40,0x8400000
v_fma_f32 v222,v222,s58,v232
MF v[80:83],a[216:219],a[112:115],v[80:83]
LW 9
s_add_u32 s12,s4,s40
s_addc_u32 s13,s5,0
MF v[80:83],a[16:19],a[120:123],v[80:83]
LW 7
s_mov_b32 s14,0x82800
s_mov_b32 s15,0x20000
MF v[84:87],a[20:23],a[120:123],v[84:87]
s_mov_b32 s46,s45
s_add_u32 s43,s45,s48
s_add_u32 m0,s43,0
MF v[84:87],a[220:223],a[112:115],v[84:87]
LW 6
RD a[164:167],v3,9216
buffer_load_dwordx4 v2,s[12:15],s46 offen sc1 lds
MF v[88:91],a[224:227],a[112:115],v[88:91]
LW 6
v_rcp_f32 v219,v219
MF v[88:91],a[24:27],a[120:123],v[88:91]
LW 4
v_fma_f32 v223,v223,s58,v232
v_mul_f32 v216,v216,v218
MF v[92:95],a[28:31],a[120:123],v[92:95]
RD a[132:135],v3,1024
v_mul_f32 v222,v222,v220
MF v[92:95],a[228:231],a[112:115],v[92:95]
LW 4
buffer_load_dwordx4 a[100:103],v25,s[8:11],s47 offen sc1
v_mul_f32 v217,v217,v219
MF v[96:99],a[232:235],a[112:115],v[96:99]
LW 3
RD a[168:171],v3,10240
v_mul_f32 v223,v223,v221
MF v[96:99],a[32:35],a[120:123],v[96:99]
RD a[136:139],v3,2048
CV v164,v216,v217
MF v[100:103],a[200:203],a[116:119],v[100:103]
v_exp_f32 v222,v222
MF v[100:103],a[0:3],a[124:127],v[100:103]
buffer_load_dwordx4 v2,s[12:15],s46 offen offset:1024 sc1 lds
v_lshlrev_b32 v224,16,v166
MF v[104:107],a[4:7],a[124:127],v[104:107]
buffer_load_dwordx4 a[104:107],v24,s[8:11],s47 offen offset:1024 sc1
RD a[172:175],v3,11264
MF v[104:107],a[204:207],a[116:119],v[104:107]
v_exp_f32 v223,v223
MF v[108:111],a[208:211],a[116:119],v[108:111]
RD a[140:143],v3,3072
v_and_b32 v225,0xffff0000,v166
MF v[108:111],a[8:11],a[124:127],v[108:111]
v_add_f32 v222,1.0,v222
v_mul_f32 v226,v224,v224
MF v[112:115],a[12:15],a[124:127],v[112:115]
RD a[176:179],v3,12288
v_add_f32 v223,1.0,v223
MF v[112:115],a[212:215],a[116:119],v[112:115]
RD a[144:147],v3,4096
v_mul_f32 v227,v225,v225
MF v[116:119],a[216:219],a[116:119],v[116:119]
v_rcp_f32 v222,v222
MF v[116:119],a[16:19],a[124:127],v[116:119]
RD a[180:183],v3,13312
buffer_load_dwordx4 v2,s[12:15],s46 offen offset:2048 sc1 lds
MF v[120:123],a[20:23],a[124:127],v[120:123]
RD a[148:151],v3,5120
v_fma_f32 v226,v226,s58,v232
MF v[120:123],a[220:223],a[116:119],v[120:123]
v_rcp_f32 v223,v223
MF v[124:127],a[224:227],a[116:119],v[124:127]
v_fma_f32 v227,v227,s58,v232
v_mul_f32 v220,v220,v222
MF v[124:127],a[24:27],a[124:127],v[124:127]
RD a[184:187],v3,14336
buffer_load_dwordx4 a[108:111],v25,s[8:11],s47 offen offset:1024 sc1
MF v[128:131],a[28:31],a[124:127],v[128:131]
v_mul_f32 v226,v226,v224
v_mul_f32 v221,v221,v223
MF v[128:131],a[228:231],a[116:119],v[128:131]
RD a[152:155],v3,6144
v_mul_f32 v227,v227,v225
MF v[132:135],a[232:235],a[116:119],v[132:135]
buffer_load_dwordx4 v2,s[12:15],s46 offen offset:3072 sc1 lds
s_add_u32 m0,s43,4096
s_nop 0
buffer_load_dwordx4 v26,s[12:15],s46 offen sc1 lds
RD a[188:191],v3,15360
CV v165,v220,v221
MF v[132:135],a[32:35],a[124:127],v[132:135]
LW 13
s_waitcnt vmcnt(21)
RD a[156:159],v3,7168
RD a[192:195],v3,16384
RD a[160:163],v3,8192
RD a[196:199],v3,17408
v_exp_f32 v226,v226
v_lshlrev_b32 v216,16,v167
v_exp_f32 v227,v227
v_and_b32 v217,0xffff0000,v167
v_add_f32 v226,1.0,v226
v_mul_f32 v218,v216,v216
v_add_f32 v227,1.0,v227
v_mul_f32 v219,v217,v217
MF v[64:67],a[128:131],a[64:67],v[64:67]
LW 15
buffer_load_dwordx4 a[112:115],v24,s[8:11],s47 offen offset:2048 sc1
RD a[200:203],v3,18432
MF v[64:67],a[164:167],a[72:75],v[64:67]
LW 15
v_rcp_f32 v226,v226
MF v[68:71],a[168:171],a[72:75],v[68:71]
RD a[0:3],v3,27648
v_fma_f32 v218,v218,s58,v232
MF v[68:71],a[132:135],a[64:67],v[68:71]
LW 15
v_rcp_f32 v227,v227
MF v[72:75],a[136:139],a[64:67],v[72:75]
LW 14
v_fma_f32 v219,v219,s58,v232
v_mul_f32 v224,v224,v226
MF v[72:75],a[172:175],a[72:75],v[72:75]
LW 12
buffer_load_dwordx4 v26,s[12:15],s46 offen offset:1024 sc1 lds
RD a[204:207],v3,19456
MF v[76:79],a[176:179],a[72:75],v[76:79]
v_mul_f32 v218,v218,v216
v_mul_f32 v225,v225,v227
MF v[76:79],a[140:143],a[64:67],v[76:79]
LW 12
RD a[4:7],v3,28672
v_mul_f32 v219,v219,v217
MF v[80:83],a[144:147],a[64:67],v[80:83]
LW 12
RD a[208:211],v3,20480
CV v166,v224,v225
MF v[80:83],a[180:183],a[72:75],v[80:83]
LW 11
v_exp_f32 v218,v218
MF v[84:87],a[184:187],a[72:75],v[84:87]
buffer_load_dwordx4 a[116:119],v25,s[8:11],s47 offen offset:2048 sc1
v_lshlrev_b32 v220,16,v168
MF v[84:87],a[148:151],a[64:67],v[84:87]
LW 10
RD a[8:11],v3,29696
MF v[88:91],a[152:155],a[64:67],v[88:91]
LW 10
v_exp_f32 v219,v219
MF v[88:91],a[188:191],a[72:75],v[88:91]
LW 8
v_and_b32 v221,0xffff0000,v168
v_add_f32 v218,1.0,v218
MF v[92:95],a[192:195],a[72:75],v[92:95]
RD a[212:215],v3,21504
v_mul_f32 v222,v220,v220
MF v[92:95],a[156:159],a[64:67],v[92:95]
LW 8
buffer_load_dwordx4 v26,s[12:15],s46 offen offset:2048 sc1 lds
v_add_f32 v219,1.0,v219
MF v[96:99],a[160:163],a[64:67],v[96:99]
LW 7
RD a[12:15],v3,30720
v_mul_f32 v223,v221,v221
MF v[96:99],a[196:199],a[72:75],v[96:99]
v_rcp_f32 v218,v218
MF v[100:103],a[128:131],a[68:71],v[100:103]
RD a[216:219],v3,22528
v_fma_f32 v222,v222,s58,v232
MF v[100:103],a[164:167],a[76:79],v[100:103]
RD a[16:19],v3,31744
buffer_load_dwordx4 a[120:123],v24,s[8:11],s47 offen offset:3072 sc1
MF v[104:107],a[168:171],a[76:79],v[104:107]
v_rcp_f32 v219,v219
MF v[104:107],a[132:135],a[68:71],v[104:107]
v_fma_f32 v223,v223,s58,v232
v_mul_f32 v216,v216,v218
MF v[108:111],a[136:139],a[68:71],v[108:111]
RD a[220:223],v3,23552
v_mul_f32 v222,v222,v220
MF v[108:111],a[172:175],a[76:79],v[108:111]
buffer_load_dwordx4 v26,s[12:15],s46 offen offset:3072 sc1 lds
v_mul_f32 v217,v217,v219
MF v[112:115],a[176:179],a[76:79],v[112:115]
RD a[20:23],v3,32768
v_mul_f32 v223,v223,v221
MF v[112:115],a[140:143],a[68:71],v[112:115]
RD a[224:227],v3,24576
CV v167,v216,v217
MF v[116:119],a[144:147],a[68:71],v[116:119]
v_exp_f32 v222,v222
MF v[116:119],a[180:183],a[76:79],v[116:119]
RD a[24:27],v3,33792
v_lshlrev_b32 v224,16,v169
MF v[120:123],a[184:187],a[76:79],v[120:123]
v_exp_f32 v223,v223
MF v[120:123],a[148:151],a[68:71],v[120:123]
buffer_load_dwordx4 a[124:127],v25,s[8:11],s47 offen offset:3072 sc1
s_add_u32 s47,s47,4096
MF v[124:127],a[152:155],a[68:71],v[124:127]
s_add_u32 m0,s43,8192
v_and_b32 v225,0xffff0000,v169
v_add_f32 v222,1.0,v222
MF v[124:127],a[188:191],a[76:79],v[124:127]
RD a[228:231],v3,25600
v_mul_f32 v226,v224,v224
MF v[128:131],a[192:195],a[76:79],v[128:131]
RD a[28:31],v3,34816
v_add_f32 v223,1.0,v223
MF v[128:131],a[156:159],a[68:71],v[128:131]
buffer_load_dwordx4 v27,s[12:15],s46 offen sc1 lds
v_mul_f32 v227,v225,v225
MF v[132:135],a[160:163],a[68:71],v[132:135]
s_add_u32 s46,s46,36864
RD a[232:235],v3,26624
s_add_u32 s48,s48,36864
s_cmp_eq_u32 s48,147456
s_cselect_b32 s48,0,s48
MF v[132:135],a[196:199],a[76:79],v[132:135]
LW 15
s_waitcnt vmcnt(17)
RD a[32:35],v3,35840
v_rcp_f32 v222,v222
v_fma_f32 v226,v226,s58,v232
v_rcp_f32 v223,v223
v_fma_f32 v227,v227,s58,v232
MF v[64:67],a[200:203],a[80:83],v[64:67]
s_barrier
s_waitcnt vmcnt(17)
v_cmp_ne_u32 vcc,s3,v31
s_nop 0
s_cbranch_vccnz Lm_pl32
Lm_pl32r:
MF v[64:67],a[0:3],a[88:91],v[64:67]
LW 14
v_mul_f32 v220,v220,v222
v_mul_f32 v226,v226,v224
MF v[68:71],a[4:7],a[88:91],v[68:71]
s_mov_b32 s47,s52
buffer_load_dwordx4 a[64:67],v17,s[20:23],s47 offen sc1
v_add_u32 v3,s49,v2
MF v[68:71],a[204:207],a[80:83],v[68:71]
LW 13
v_mul_f32 v221,v221,v223
v_mul_f32 v227,v227,v225
MF v[72:75],a[208:211],a[80:83],v[72:75]
LW 12
CV v168,v220,v221
s_add_u32 s49,s49,36864
MF v[72:75],a[8:11],a[88:91],v[72:75]
LW 10
s_cmp_eq_u32 s49,147456
s_cselect_b32 s49,0,s49
MF v[76:79],a[12:15],a[88:91],v[76:79]
s_add_u32 s43,s45,s48
RD a[128:131],v3,0
s_add_u32 m0,s43,0
MF v[76:79],a[212:215],a[80:83],v[76:79]
LW 10
RD a[164:167],v3,9216
buffer_load_dwordx4 v2,s[12:15],s46 offen sc1 lds
MF v[80:83],a[216:219],a[80:83],v[80:83]
LW 10
v_exp_f32 v226,v226
MF v[80:83],a[16:19],a[88:91],v[80:83]
LW 8
buffer_load_dwordx4 a[68:71],v18,s[20:23],s47 offen sc1
v_lshlrev_b32 v216,16,v170
MF v[84:87],a[20:23],a[88:91],v[84:87]
v_exp_f32 v227,v227
MF v[84:87],a[220:223],a[80:83],v[84:87]
LW 7
RD a[132:135],v3,1024
v_and_b32 v217,0xffff0000,v170
MF v[88:91],a[224:227],a[80:83],v[88:91]
LW 7
v_add_f32 v226,1.0,v226
v_mul_f32 v218,v216,v216
MF v[88:91],a[24:27],a[88:91],v[88:91]
LW 5
RD a[168:171],v3,10240
v_add_f32 v227,1.0,v227
MF v[92:95],a[28:31],a[88:91],v[92:95]
buffer_load_dwordx4 v2,s[12:15],s46 offen offset:1024 sc1 lds
v_mul_f32 v219,v217,v217
MF v[92:95],a[228:231],a[80:83],v[92:95]
LW 5
buffer_load_dwordx4 a[72:75],v17,s[20:23],s47 offen offset:1024 sc1
RD a[136:139],v3,2048
MF v[96:99],a[232:235],a[80:83],v[96:99]
LW 5
v_rcp_f32 v226,v226
MF v[96:99],a[32:35],a[88:91],v[96:99]
RD a[172:175],v3,11264
v_fma_f32 v218,v218,s58,v232
MF v[100:103],a[200:203],a[84:87],v[100:103]
v_rcp_f32 v227,v227
MF v[100:103],a[0:3],a[92:95],v[100:103]
RD a[140:143],v3,3072
v_fma_f32 v219,v219,s58,v232
MF v[104:107],a[4:7],a[92:95],v[104:107]
v_mul_f32 v224,v224,v226
v_mul_f32 v218,v218,v216
MF v[104:107],a[204:207],a[84:87],v[104:107]
RD a[176:179],v3,12288
buffer_load_dwordx4 v2,s[12:15],s46 offen offset:2048 sc1 lds
MF v[108:111],a[208:211],a[84:87],v[108:111]
v_mul_f32 v225,v225,v227
v_mul_f32 v219,v219,v217
MF v[108:111],a[8:11],a[92:95],v[108:111]
RD a[144:147],v3,4096
CV v169,v224,v225
MF v[112:115],a[12:15],a[92:95],v[112:115]
RD a[180:183],v3,13312
buffer_load_dwordx4 a[76:79],v18,s[20:23],s47 offen offset:1024 sc1
MF v[112:115],a[212:215],a[84:87],v[112:115]
v_exp_f32 v218,v218
MF v[116:119],a[216:219],a[84:87],v[116:119]
RD a[148:151],v3,5120
v_lshlrev_b32 v220,16,v171
MF v[116:119],a[16:19],a[92:95],v[116:119]
v_exp_f32 v219,v219
MF v[120:123],a[20:23],a[92:95],v[120:123]
buffer_load_dwordx4 v2,s[12:15],s46 offen offset:3072 sc1 lds
v_and_b32 v221,0xffff0000,v171
MF v[120:123],a[220:223],a[84:87],v[120:123]
s_add_u32 m0,s43,4096
RD a[184:187],v3,14336
v_add_f32 v218,1.0,v218
MF v[124:127],a[224:227],a[84:87],v[124:127]
v_mul_f32 v222,v220,v220
v_add_f32 v219,1.0,v219
MF v[124:127],a[24:27],a[92:95],v[124:127]
buffer_load_dwordx4 v26,s[12:15],s46 offen sc1 lds
RD a[152:155],v3,6144
MF v[128:131],a[28:31],a[92:95],v[128:131]
RD a[188:191],v3,15360
v_mul_f32 v223,v221,v221
MF v[128:131],a[228:231],a[84:87],v[128:131]
v_rcp_f32 v218,v218
MF v[132:135],a[232:235],a[84:87],v[132:135]
buffer_load_ushort v176,v20,s[28:31],0 offen
buffer_load_ushort v177,v20,s[28:31],0 offen offset:8
v_fma_f32 v222,v222,s58,v232
MF v[132:135],a[32:35],a[92:95],v[132:135]
LW 13
s_waitcnt vmcnt(21)
RD a[156:159],v3,7168
RD a[192:195],v3,16384
RD a[160:163],v3,8192
RD a[196:199],v3,17408
v_rcp_f32 v219,v219
v_fma_f32 v223,v223,s58,v232
v_mul_f32 v216,v216,v218
v_mul_f32 v222,v222,v220
v_mul_f32 v217,v217,v219
v_mul_f32 v223,v223,v221
CV v170,v216,v217
MF v[64:67],a[128:131],a[96:99],v[64:67]
LW 15
buffer_load_dwordx4 a[80:83],v17,s[20:23],s47 offen offset:2048 sc1
RD a[200:203],v3,18432
MF v[64:67],a[164:167],a[104:107],v[64:67]
LW 15
v_exp_f32 v222,v222
MF v[68:71],a[168:171],a[104:107],v[68:71]
RD a[0:3],v3,27648
v_lshlrev_b32 v224,16,v172
MF v[68:71],a[132:135],a[96:99],v[68:71]
LW 15
v_exp_f32 v223,v223
MF v[72:75],a[136:139],a[96:99],v[72:75]
LW 14
v_and_b32 v225,0xffff0000,v172
v_add_f32 v222,1.0,v222
MF v[72:75],a[172:175],a[104:107],v[72:75]
LW 12
buffer_load_dwordx4 v26,s[12:15],s46 offen offset:1024 sc1 lds
RD a[204:207],v3,19456
MF v[76:79],a[176:179],a[104:107],v[76:79]
v_mul_f32 v226,v224,v224
v_add_f32 v223,1.0,v223
MF v[76:79],a[140:143],a[96:99],v[76:79]
LW 12
RD a[4:7],v3,28672
v_mul_f32 v227,v225,v225
MF v[80:83],a[144:147],a[96:99],v[80:83]
LW 12
v_rcp_f32 v222,v222
MF v[80:83],a[180:183],a[104:107],v[80:83]
LW 10
RD a[208:211],v3,20480
v_fma_f32 v226,v226,s58,v232
MF v[84:87],a[184:187],a[104:107],v[84:87]
RD a[8:11],v3,29696
buffer_load_dwordx4 a[84:87],v18,s[20:23],s47 offen offset:2048 sc1
MF v[84:87],a[148:151],a[96:99],v[84:87]
LW 11
v_rcp_f32 v223,v223
MF v[88:91],a[152:155],a[96:99],v[88:91]
LW 10
v_fma_f32 v227,v227,s58,v232
v_mul_f32 v220,v220,v222
MF v[88:91],a[188:191],a[104:107],v[88:91]
LW 8
RD a[212:215],v3,21504
v_mul_f32 v226,v226,v224
MF v[92:95],a[192:195],a[104:107],v[92:95]
buffer_load_dwordx4 v26,s[12:15],s46 offen offset:2048 sc1 lds
v_mul_f32 v221,v221,v223
MF v[92:95],a[156:159],a[96:99],v[92:95]
LW 8
RD a[12:15],v3,30720
v_mul_f32 v227,v227,v225
MF v[96:99],a[160:163],a[96:99],v[96:99]
LW 8
RD a[216:219],v3,22528
CV v171,v220,v221
MF v[96:99],a[196:199],a[104:107],v[96:99]
v_exp_f32 v226,v226
MF v[100:103],a[128:131],a[100:103],v[100:103]
buffer_load_dwordx4 a[88:91],v17,s[20:23],s47 offen offset:3072 sc1
v_lshlrev_b32 v216,16,v173
MF v[100:103],a[164:167],a[108:111],v[100:103]
v_exp_f32 v227,v227
MF v[104:107],a[168:171],a[108:111],v[104:107]
RD a[16:19],v3,31744
v_and_b32 v217,0xffff0000,v173
MF v[104:107],a[132:135],a[100:103],v[104:107]
RD a[220:223],v3,23552
v_add_f32 v226,1.0,v226
MF v[108:111],a[136:139],a[100:103],v[108:111]
v_mul_f32 v218,v216,v216
v_add_f32 v227,1.0,v227
MF v[108:111],a[172:175],a[108:111],v[108:111]
RD a[20:23],v3,32768
buffer_load_dwordx4 v26,s[12:15],s46 offen offset:3072 sc1 lds
MF v[112:115],a[176:179],a[108:111],v[112:115]
RD a[224:227],v3,24576
v_mul_f32 v219,v217,v217
MF v[112:115],a[140:143],a[100:103],v[112:115]
v_rcp_f32 v226,v226
MF v[116:119],a[144:147],a[100:103],v[116:119]
RD a[24:27],v3,33792
v_fma_f32 v218,v218,s58,v232
MF v[116:119],a[180:183],a[108:111],v[116:119]
v_rcp_f32 v227,v227
MF v[120:123],a[184:187],a[108:111],v[120:123]
buffer_load_dwordx4 a[92:95],v18,s[20:23],s47 offen offset:3072 sc1
v_fma_f32 v219,v219,s58,v232
MF v[120:123],a[148:151],a[100:103],v[120:123]
s_add_u32 s47,s47,4096
v_mul_f32 v224,v224,v226
v_mul_f32 v218,v218,v216
MF v[124:127],a[152:155],a[100:103],v[124:127]
s_add_u32 m0,s43,8192
RD a[228:231],v3,25600
v_mul_f32 v225,v225,v227
MF v[124:127],a[188:191],a[108:111],v[124:127]
RD a[28:31],v3,34816
v_mul_f32 v219,v219,v217
MF v[128:131],a[192:195],a[108:111],v[128:131]
buffer_load_dwordx4 v27,s[12:15],s46 offen sc1 lds
CV v172,v224,v225
MF v[128:131],a[156:159],a[100:103],v[128:131]
s_add_u32 s46,s46,36864
RD a[232:235],v3,26624
s_add_u32 s48,s48,36864
MF v[132:135],a[160:163],a[100:103],v[132:135]
s_cmp_eq_u32 s48,147456
s_cselect_b32 s48,0,s48
RD a[32:35],v3,35840
MF v[132:135],a[196:199],a[108:111],v[132:135]
LW 15
s_waitcnt vmcnt(19)
v_exp_f32 v218,v218
v_lshlrev_b32 v220,16,v174
v_exp_f32 v219,v219
v_and_b32 v221,0xffff0000,v174
MF v[64:67],a[200:203],a[112:115],v[64:67]
s_barrier
v_add_f32 v218,1.0,v218
MF v[64:67],a[0:3],a[120:123],v[64:67]
LW 14
v_add_u32 v3,s49,v2
v_mul_f32 v222,v220,v220
MF v[68:71],a[4:7],a[120:123],v[68:71]
s_add_u32 s49,s49,36864
buffer_load_dwordx4 a[96:99],v17,s[20:23],s47 offen sc1
v_add_f32 v219,1.0,v219
MF v[68:71],a[204:207],a[112:115],v[68:71]
LW 13
v_mul_f32 v223,v221,v221
MF v[72:75],a[208:211],a[112:115],v[72:75]
LW 12
s_cmp_eq_u32 s49,147456
s_cselect_b32 s49,0,s49
MF v[72:75],a[8:11],a[120:123],v[72:75]
LW 10
v_rcp_f32 v218,v218
MF v[76:79],a[12:15],a[120:123],v[76:79]
s_add_u32 s43,s45,s48
RD a[128:131],v3,0
v_fma_f32 v222,v222,s58,v232
MF v[76:79],a[212:215],a[112:115],v[76:79]
LW 10
RD a[164:167],v3,9216
s_add_u32 m0,s43,0
MF v[80:83],a[216:219],a[112:115],v[80:83]
LW 10
RD a[132:135],v3,1024
buffer_load_dwordx4 v2,s[12:15],s46 offen sc1 lds
MF v[80:83],a[16:19],a[120:123],v[80:83]
LW 9
v_rcp_f32 v219,v219
MF v[84:87],a[20:23],a[120:123],v[84:87]
v_fma_f32 v223,v223,s58,v232
v_mul_f32 v216,v216,v218
MF v[84:87],a[220:223],a[112:115],v[84:87]
LW 8
buffer_load_dwordx4 a[100:103],v18,s[20:23],s47 offen sc1
v_mul_f32 v222,v222,v220
MF v[88:91],a[224:227],a[112:115],v[88:91]
LW 7
RD a[168:171],v3,10240
v_mul_f32 v217,v217,v219
MF v[88:91],a[24:27],a[120:123],v[88:91]
LW 6
v_mul_f32 v223,v223,v221
CV v173,v216,v217
MF v[92:95],a[28:31],a[120:123],v[92:95]
buffer_load_dwordx4 v2,s[12:15],s46 offen offset:1024 sc1 lds
RD a[136:139],v3,2048
MF v[92:95],a[228:231],a[112:115],v[92:95]
LW 6
v_exp_f32 v222,v222
MF v[96:99],a[232:235],a[112:115],v[96:99]
LW 5
RD a[172:175],v3,11264
v_lshlrev_b32 v224,16,v175
MF v[96:99],a[32:35],a[120:123],v[96:99]
v_exp_f32 v223,v223
MF v[100:103],a[200:203],a[116:119],v[100:103]
RD a[140:143],v3,3072
v_and_b32 v225,0xffff0000,v175
MF v[100:103],a[0:3],a[124:127],v[100:103]
buffer_load_dwordx4 a[104:107],v17,s[20:23],s47 offen offset:1024 sc1
v_add_f32 v222,1.0,v222
MF v[104:107],a[4:7],a[124:127],v[104:107]
RD a[176:179],v3,12288
v_mul_f32 v226,v224,v224
MF v[104:107],a[204:207],a[116:119],v[104:107]
v_add_f32 v223,1.0,v223
v_mul_f32 v227,v225,v225
MF v[108:111],a[208:211],a[116:119],v[108:111]
buffer_load_dwordx4 v2,s[12:15],s46 offen offset:2048 sc1 lds
RD a[144:147],v3,4096
MF v[108:111],a[8:11],a[124:127],v[108:111]
v_rcp_f32 v222,v222
MF v[112:115],a[12:15],a[124:127],v[112:115]
RD a[180:183],v3,13312
v_fma_f32 v226,v226,s58,v232
MF v[112:115],a[212:215],a[116:119],v[112:115]
v_rcp_f32 v223,v223
MF v[116:119],a[216:219],a[116:119],v[116:119]
RD a[148:151],v3,5120
v_fma_f32 v227,v227,s58,v232
MF v[116:119],a[16:19],a[124:127],v[116:119]
v_mul_f32 v220,v220,v222
v_mul_f32 v226,v226,v224
MF v[120:123],a[20:23],a[124:127],v[120:123]
RD a[184:187],v3,14336
buffer_load_dwordx4 a[108:111],v18,s[20:23],s47 offen offset:1024 sc1
MF v[120:123],a[220:223],a[116:119],v[120:123]
v_mul_f32 v221,v221,v223
v_mul_f32 v227,v227,v225
MF v[124:127],a[224:227],a[116:119],v[124:127]
RD a[152:155],v3,6144
CV v174,v220,v221
MF v[124:127],a[24:27],a[124:127],v[124:127]
v_exp_f32 v226,v226
MF v[128:131],a[28:31],a[124:127],v[128:131]
buffer_load_dwordx4 v2,s[12:15],s46 offen offset:3072 sc1 lds
RD a[188:191],v3,15360
MF v[128:131],a[228:231],a[116:119],v[128:131]
s_add_u32 m0,s43,4096
v_exp_f32 v227,v227
MF v[132:135],a[232:235],a[116:119],v[132:135]
buffer_load_dwordx4 v26,s[12:15],s46 offen sc1 lds
RD a[156:159],v3,7168
v_add_f32 v226,1.0,v226
MF v[132:135],a[32:35],a[124:127],v[132:135]
LW 14
s_waitcnt vmcnt(21)
RD a[192:195],v3,16384
RD a[160:163],v3,8192
RD a[196:199],v3,17408
v_add_f32 v227,1.0,v227
v_rcp_f32 v226,v226
v_rcp_f32 v227,v227
v_mul_f32 v224,v224,v226
v_mul_f32 v225,v225,v227
CV v175,v224,v225
s_waitcnt vmcnt(17)
v_lshlrev_b32 v176,16,v176
v_lshlrev_b32 v177,16,v177
s_nop 4
v_pk_add_f32 v[64:65],v[64:65],v[176:177] op_sel:[0,0] op_sel_hi:[1,0]
v_lshlrev_b32 v216,16,v140
v_and_b32 v217,0xffff0000,v140
v_pk_mul_f32 v[64:65],v[64:65],v[216:217]
v_pk_add_f32 v[66:67],v[66:67],v[176:177] op_sel:[0,0] op_sel_hi:[1,0]
CV v180,v64,v65
v_lshlrev_b32 v218,16,v141
v_and_b32 v219,0xffff0000,v141
v_pk_mul_f32 v[66:67],v[66:67],v[218:219]
v_pk_add_f32 v[68:69],v[68:69],v[176:177] op_sel:[0,0] op_sel_hi:[1,0]
CV v181,v66,v67
v_lshlrev_b32 v220,16,v142
v_and_b32 v221,0xffff0000,v142
v_pk_mul_f32 v[68:69],v[68:69],v[220:221]
v_pk_add_f32 v[70:71],v[70:71],v[176:177] op_sel:[0,0] op_sel_hi:[1,0]
CV v182,v68,v69
v_lshlrev_b32 v222,16,v143
v_and_b32 v223,0xffff0000,v143
v_pk_mul_f32 v[70:71],v[70:71],v[222:223]
v_pk_add_f32 v[72:73],v[72:73],v[176:177] op_sel:[0,0] op_sel_hi:[1,0]
CV v183,v70,v71
v_lshlrev_b32 v224,16,v144
buffer_store_dwordx4 v[180:183],v22,s[20:23],s50 offen sc1
v_and_b32 v225,0xffff0000,v144
v_pk_mul_f32 v[72:73],v[72:73],v[224:225]
v_pk_add_f32 v[74:75],v[74:75],v[176:177] op_sel:[0,0] op_sel_hi:[1,0]
CV v184,v72,v73
v_lshlrev_b32 v226,16,v145
v_and_b32 v227,0xffff0000,v145
v_pk_mul_f32 v[74:75],v[74:75],v[226:227]
v_pk_add_f32 v[76:77],v[76:77],v[176:177] op_sel:[0,0] op_sel_hi:[1,0]
CV v185,v74,v75
v_lshlrev_b32 v228,16,v146
v_and_b32 v229,0xffff0000,v146
v_pk_mul_f32 v[76:77],v[76:77],v[228:229]
v_pk_add_f32 v[78:79],v[78:79],v[176:177] op_sel:[0,0] op_sel_hi:[1,0]
CV v186,v76,v77
v_lshlrev_b32 v230,16,v147
v_and_b32 v231,0xffff0000,v147
v_pk_mul_f32 v[78:79],v[78:79],v[230:231]
v_pk_add_f32 v[80:81],v[80:81],v[176:177] op_sel:[0,0] op_sel_hi:[1,0]
CV v187,v78,v79
v_lshlrev_b32 v216,16,v148
buffer_store_dwordx4 v[184:187],v22,s[20:23],s50 offen offset:1024 sc1
v_and_b32 v217,0xffff0000,v148
v_pk_mul_f32 v[80:81],v[80:81],v[216:217]
v_pk_add_f32 v[82:83],v[82:83],v[176:177] op_sel:[0,0] op_sel_hi:[1,0]
CV v188,v80,v81
v_lshlrev_b32 v218,16,v149
v_and_b32 v219,0xffff0000,v149
v_pk_mul_f32 v[82:83],v[82:83],v[218:219]
v_pk_add_f32 v[84:85],v[84:85],v[176:177] op_sel:[0,0] op_sel_hi:[1,0]
CV v189,v82,v83
v_lshlrev_b32 v220,16,v150
v_and_b32 v221,0xffff0000,v150
v_pk_mul_f32 v[84:85],v[84:85],v[220:221]
v_pk_add_f32 v[86:87],v[86:87],v[176:177] op_sel:[0,0] op_sel_hi:[1,0]
CV v190,v84,v85
v_lshlrev_b32 v222,16,v151
v_and_b32 v223,0xffff0000,v151
v_pk_mul_f32 v[86:87],v[86:87],v[222:223]
v_pk_add_f32 v[88:89],v[88:89],v[176:177] op_sel:[0,0] op_sel_hi:[1,0]
CV v191,v86,v87
v_lshlrev_b32 v224,16,v152
buffer_store_dwordx4 v[188:191],v22,s[20:23],s50 offen offset:2048 sc1
v_and_b32 v225,0xffff0000,v152
v_pk_mul_f32 v[88:89],v[88:89],v[224:225]
v_pk_add_f32 v[90:91],v[90:91],v[176:177] op_sel:[0,0] op_sel_hi:[1,0]
CV v192,v88,v89
v_lshlrev_b32 v226,16,v153
v_and_b32 v227,0xffff0000,v153
v_pk_mul_f32 v[90:91],v[90:91],v[226:227]
v_pk_add_f32 v[92:93],v[92:93],v[176:177] op_sel:[0,0] op_sel_hi:[1,0]
CV v193,v90,v91
v_lshlrev_b32 v228,16,v154
v_and_b32 v229,0xffff0000,v154
v_pk_mul_f32 v[92:93],v[92:93],v[228:229]
v_pk_add_f32 v[94:95],v[94:95],v[176:177] op_sel:[0,0] op_sel_hi:[1,0]
CV v194,v92,v93
v_lshlrev_b32 v230,16,v155
v_and_b32 v231,0xffff0000,v155
v_pk_mul_f32 v[94:95],v[94:95],v[230:231]
v_pk_add_f32 v[96:97],v[96:97],v[176:177] op_sel:[0,0] op_sel_hi:[1,0]
CV v195,v94,v95
v_lshlrev_b32 v216,16,v156
buffer_store_dwordx4 v[192:195],v22,s[20:23],s50 offen offset:3072 sc1
v_and_b32 v217,0xffff0000,v156
v_pk_mul_f32 v[96:97],v[96:97],v[216:217]
v_pk_add_f32 v[98:99],v[98:99],v[176:177] op_sel:[0,0] op_sel_hi:[1,0]
CV v196,v96,v97
v_lshlrev_b32 v218,16,v157
v_and_b32 v219,0xffff0000,v157
v_pk_mul_f32 v[98:99],v[98:99],v[218:219]
v_pk_add_f32 v[100:101],v[100:101],v[176:177] op_sel:[0,1] op_sel_hi:[1,1]
CV v197,v98,v99
v_lshlrev_b32 v220,16,v158
buffer_store_dwordx2 v[196:197],v21,s[20:23],s50 offen sc1
v_and_b32 v221,0xffff0000,v158
v_pk_mul_f32 v[100:101],v[100:101],v[220:221]
v_pk_add_f32 v[102:103],v[102:103],v[176:177] op_sel:[0,1] op_sel_hi:[1,1]
CV v198,v100,v101
v_lshlrev_b32 v222,16,v159
v_and_b32 v223,0xffff0000,v159
v_pk_mul_f32 v[102:103],v[102:103],v[222:223]
v_pk_add_f32 v[104:105],v[104:105],v[176:177] op_sel:[0,1] op_sel_hi:[1,1]
CV v199,v102,v103
v_lshlrev_b32 v224,16,v160
v_and_b32 v225,0xffff0000,v160
v_pk_mul_f32 v[104:105],v[104:105],v[224:225]
v_pk_add_f32 v[106:107],v[106:107],v[176:177] op_sel:[0,1] op_sel_hi:[1,1]
CV v200,v104,v105
v_lshlrev_b32 v226,16,v161
v_and_b32 v227,0xffff0000,v161
v_pk_mul_f32 v[106:107],v[106:107],v[226:227]
v_pk_add_f32 v[108:109],v[108:109],v[176:177] op_sel:[0,1] op_sel_hi:[1,1]
CV v201,v106,v107
v_lshlrev_b32 v228,16,v162
v_and_b32 v229,0xffff0000,v162
v_pk_mul_f32 v[108:109],v[108:109],v[228:229]
v_pk_add_f32 v[110:111],v[110:111],v[176:177] op_sel:[0,1] op_sel_hi:[1,1]
CV v202,v108,v109
v_lshlrev_b32 v230,16,v163
v_and_b32 v231,0xffff0000,v163
v_pk_mul_f32 v[110:111],v[110:111],v[230:231]
v_pk_add_f32 v[112:113],v[112:113],v[176:177] op_sel:[0,1] op_sel_hi:[1,1]
CV v203,v110,v111
v_lshlrev_b32 v216,16,v164
v_and_b32 v217,0xffff0000,v164
v_pk_mul_f32 v[112:113],v[112:113],v[216:217]
v_pk_add_f32 v[114:115],v[114:115],v[176:177] op_sel:[0,1] op_sel_hi:[1,1]
CV v204,v112,v113
v_lshlrev_b32 v218,16,v165
v_and_b32 v219,0xffff0000,v165
v_pk_mul_f32 v[114:115],v[114:115],v[218:219]
v_pk_add_f32 v[116:117],v[116:117],v[176:177] op_sel:[0,1] op_sel_hi:[1,1]
CV v205,v114,v115
v_lshlrev_b32 v220,16,v166
v_and_b32 v221,0xffff0000,v166
v_pk_mul_f32 v[116:117],v[116:117],v[220:221]
v_pk_add_f32 v[118:119],v[118:119],v[176:177] op_sel:[0,1] op_sel_hi:[1,1]
CV v206,v116,v117
v_lshlrev_b32 v222,16,v167
v_and_b32 v223,0xffff0000,v167
v_pk_mul_f32 v[118:119],v[118:119],v[222:223]
v_pk_add_f32 v[120:121],v[120:121],v[176:177] op_sel:[0,1] op_sel_hi:[1,1]
CV v207,v118,v119
v_lshlrev_b32 v224,16,v168
v_and_b32 v225,0xffff0000,v168
v_pk_mul_f32 v[120:121],v[120:121],v[224:225]
v_pk_add_f32 v[122:123],v[122:123],v[176:177] op_sel:[0,1] op_sel_hi:[1,1]
CV v208,v120,v121
v_lshlrev_b32 v226,16,v169
v_and_b32 v227,0xffff0000,v169
v_pk_mul_f32 v[122:123],v[122:123],v[226:227]
v_pk_add_f32 v[124:125],v[124:125],v[176:177] op_sel:[0,1] op_sel_hi:[1,1]
CV v209,v122,v123
v_lshlrev_b32 v228,16,v170
v_and_b32 v229,0xffff0000,v170
v_pk_mul_f32 v[124:125],v[124:125],v[228:229]
v_pk_add_f32 v[126:127],v[126:127],v[176:177] op_sel:[0,1] op_sel_hi:[1,1]
CV v210,v124,v125
v_lshlrev_b32 v230,16,v171
v_and_b32 v231,0xffff0000,v171
v_pk_mul_f32 v[126:127],v[126:127],v[230:231]
v_pk_add_f32 v[128:129],v[128:129],v[176:177] op_sel:[0,1] op_sel_hi:[1,1]
CV v211,v126,v127
v_lshlrev_b32 v216,16,v172
v_and_b32 v217,0xffff0000,v172
v_pk_mul_f32 v[128:129],v[128:129],v[216:217]
v_pk_add_f32 v[130:131],v[130:131],v[176:177] op_sel:[0,1] op_sel_hi:[1,1]
CV v212,v128,v129
v_lshlrev_b32 v218,16,v173
v_and_b32 v219,0xffff0000,v173
v_pk_mul_f32 v[130:131],v[130:131],v[218:219]
v_pk_add_f32 v[132:133],v[132:133],v[176:177] op_sel:[0,1] op_sel_hi:[1,1]
CV v213,v130,v131
v_lshlrev_b32 v220,16,v174
v_and_b32 v221,0xffff0000,v174
v_pk_mul_f32 v[132:133],v[132:133],v[220:221]
v_pk_add_f32 v[134:135],v[134:135],v[176:177] op_sel:[0,1] op_sel_hi:[1,1]
CV v214,v132,v133
v_lshlrev_b32 v222,16,v175
v_and_b32 v223,0xffff0000,v175
v_pk_mul_f32 v[134:135],v[134:135],v[222:223]
CV v215,v134,v135
Lm_fin:
MF v[64:67],a[128:131],a[64:67],0
LW 15
buffer_load_dwordx4 a[112:115],v17,s[20:23],s47 offen offset:2048 sc1
RD a[200:203],v3,18432
MF v[64:67],a[164:167],a[72:75],v[64:67]
LW 15
MF v[68:71],a[168:171],a[72:75],0
RD a[0:3],v3,27648
MF v[68:71],a[132:135],a[64:67],v[68:71]
LW 15
buffer_load_dwordx4 v26,s[12:15],s46 offen offset:1024 sc1 lds
MF v[72:75],a[136:139],a[64:67],0
LW 14
RD a[204:207],v3,19456
MF v[72:75],a[172:175],a[72:75],v[72:75]
LW 13
MF v[76:79],a[176:179],a[72:75],0
RD a[4:7],v3,28672
MF v[76:79],a[140:143],a[64:67],v[76:79]
LW 13
buffer_load_dwordx4 a[116:119],v18,s[20:23],s47 offen offset:2048 sc1
MF v[80:83],a[144:147],a[64:67],0
LW 12
RD a[208:211],v3,20480
MF v[80:83],a[180:183],a[72:75],v[80:83]
LW 11
MF v[84:87],a[184:187],a[72:75],0
buffer_load_dwordx4 v26,s[12:15],s46 offen offset:2048 sc1 lds
RD a[8:11],v3,29696
MF v[84:87],a[148:151],a[64:67],v[84:87]
LW 11
MF v[88:91],a[152:155],a[64:67],0
LW 10
RD a[212:215],v3,21504
MF v[88:91],a[188:191],a[72:75],v[88:91]
LW 9
MF v[92:95],a[192:195],a[72:75],0
buffer_load_dwordx4 a[120:123],v17,s[20:23],s47 offen offset:3072 sc1
RD a[12:15],v3,30720
MF v[92:95],a[156:159],a[64:67],v[92:95]
LW 9
MF v[96:99],a[160:163],a[64:67],0
LW 8
RD a[216:219],v3,22528
MF v[96:99],a[196:199],a[72:75],v[96:99]
buffer_load_dwordx4 v26,s[12:15],s46 offen offset:3072 sc1 lds
MF v[100:103],a[128:131],a[68:71],0
RD a[16:19],v3,31744
MF v[100:103],a[164:167],a[76:79],v[100:103]
MF v[104:107],a[168:171],a[76:79],0
RD a[220:223],v3,23552
MF v[104:107],a[132:135],a[68:71],v[104:107]
buffer_load_dwordx4 a[124:127],v18,s[20:23],s47 offen offset:3072 sc1
s_add_u32 s47,s47,4096
MF v[108:111],a[136:139],a[68:71],0
RD a[20:23],v3,32768
MF v[108:111],a[172:175],a[76:79],v[108:111]
MF v[112:115],a[176:179],a[76:79],0
s_add_u32 m0,s43,8192
RD a[224:227],v3,24576
MF v[112:115],a[140:143],a[68:71],v[112:115]
buffer_load_dwordx4 v27,s[12:15],s46 offen sc1 lds
s_add_u32 s46,s46,36864
MF v[116:119],a[144:147],a[68:71],0
s_add_u32 s48,s48,36864
s_cmp_eq_u32 s48,147456
s_cselect_b32 s48,0,s48
MF v[116:119],a[180:183],a[76:79],v[116:119]
RD a[24:27],v3,33792
MF v[120:123],a[184:187],a[76:79],0
buffer_store_dwordx4 v[198:201],v22,s[20:23],s51 offen sc1
RD a[228:231],v3,25600
MF v[120:123],a[148:151],a[68:71],v[120:123]
MF v[124:127],a[152:155],a[68:71],0
RD a[28:31],v3,34816
MF v[124:127],a[188:191],a[76:79],v[124:127]
s_lshl_b32 s56,s33,2
s_add_u32 s56,s56,s55
s_mul_i32 s40,s56,245760
MF v[128:131],a[192:195],a[76:79],0
s_add_u32 s40,s40,0x72fec00
s_add_u32 s24,s4,s40
s_addc_u32 s25,s5,0
MF v[128:131],a[156:159],a[68:71],v[128:131]
s_mov_b32 s26,0x3d400
s_mov_b32 s27,0x20000
s_mov_b32 s28,s64
MF v[132:135],a[160:163],a[68:71],0
s_mov_b32 s29,s65
s_mov_b32 s30,0x240000
s_mov_b32 s31,0x20000
s_mov_b32 s8,s86
s_mov_b32 s9,s87
s_mov_b32 s10,0x240000
s_mov_b32 s11,0x20000
MF v[132:135],a[196:199],a[76:79],v[132:135]
LW 15
s_waitcnt vmcnt(23)
RD a[232:235],v3,26624
RD a[32:35],v3,35840
MF v[64:67],a[200:203],a[80:83],v[64:67]
LW 15
s_barrier
MF v[64:67],a[0:3],a[88:91],v[64:67]
LW 14
buffer_load_dwordx4 a[64:67],v17,s[20:23],s47 offen sc1
v_add_u32 v3,s49,v2
MF v[68:71],a[4:7],a[88:91],v[68:71]
s_add_u32 s49,s49,36864
s_add_u32 s43,s45,s48
s_add_u32 m0,s43,0
MF v[68:71],a[204:207],a[80:83],v[68:71]
LW 13
buffer_load_dwordx4 v2,s[12:15],s46 offen sc1 lds
buffer_load_dwordx4 a[68:71],v18,s[20:23],s47 offen sc1
MF v[72:75],a[208:211],a[80:83],v[72:75]
LW 12
s_cmp_eq_u32 s49,147456
s_cselect_b32 s49,0,s49
MF v[72:75],a[8:11],a[88:91],v[72:75]
LW 10
buffer_load_dwordx4 v2,s[12:15],s46 offen offset:1024 sc1 lds
buffer_load_dwordx4 a[72:75],v17,s[20:23],s47 offen offset:1024 sc1
MF v[76:79],a[12:15],a[88:91],v[76:79]
buffer_load_dwordx4 v2,s[12:15],s46 offen offset:2048 sc1 lds
RD a[128:131],v3,0
MF v[76:79],a[212:215],a[80:83],v[76:79]
LW 10
RD a[164:167],v3,9216
buffer_load_dwordx4 a[76:79],v18,s[20:23],s47 offen offset:1024 sc1
MF v[80:83],a[216:219],a[80:83],v[80:83]
LW 10
buffer_load_dwordx4 v2,s[12:15],s46 offen offset:3072 sc1 lds
s_add_u32 m0,s43,4096
MF v[80:83],a[16:19],a[88:91],v[80:83]
LW 8
RD a[132:135],v3,1024
buffer_load_dwordx4 v26,s[12:15],s46 offen sc1 lds
MF v[84:87],a[20:23],a[88:91],v[84:87]
v_bfe_u32 v28,v1,2,2
v_lshlrev_b32 v28,3,v28
MF v[84:87],a[220:223],a[80:83],v[84:87]
LW 8
RD a[168:171],v3,10240
v_and_b32 v29,3,v1
MF v[88:91],a[224:227],a[80:83],v[88:91]
LW 8
RD a[136:139],v3,2048
v_add_u32 v29,v29,v28
MF v[88:91],a[24:27],a[88:91],v[88:91]
LW 7
s_lshl_b32 s40,s37,4
v_add_u32 v29,s40,v29
MF v[92:95],a[28:31],a[88:91],v[92:95]
s_movk_i32 s40,1152
RD a[172:175],v3,11264
v_mul_lo_u32 v4,v29,s40
MF v[92:95],a[228:231],a[80:83],v[92:95]
LW 7
RD a[140:143],v3,3072
v_lshrrev_b32 v28,4,v1
MF v[96:99],a[232:235],a[80:83],v[96:99]
LW 7
RD a[176:179],v3,12288
v_lshl_add_u32 v4,v28,3,v4
MF v[96:99],a[32:35],a[88:91],v[96:99]
s_mul_i32 s40,s55,288
MF v[100:103],a[200:203],a[84:87],v[100:103]
s_lshr_b32 s41,s54,1
RD a[144:147],v3,4096
MF v[100:103],a[0:3],a[92:95],v[100:103]
s_mul_i32 s41,s41,4608
MF v[104:107],a[4:7],a[92:95],v[104:107]
s_add_u32 s40,s40,s41
RD a[180:183],v3,13312
MF v[104:107],a[204:207],a[84:87],v[104:107]
s_and_b32 s41,s54,1
s_mul_i32 s41,s41,160
MF v[108:111],a[208:211],a[84:87],v[108:111]
s_add_u32 s40,s40,s41
RD a[148:151],v3,5120
MF v[108:111],a[8:11],a[92:95],v[108:111]
RD a[184:187],v3,14336
v_add_u32 v4,s40,v4
MF v[112:115],a[12:15],a[92:95],v[112:115]
s_mul_i32 s40,s32,5120
MF v[112:115],a[212:215],a[84:87],v[112:115]
RD a[152:155],v3,6144
v_add_u32 v5,s40,v2
MF v[116:119],a[216:219],a[84:87],v[116:119]
v_add_u32 v7,4096,v5
MF v[116:119],a[16:19],a[92:95],v[116:119]
RD a[188:191],v3,15360
v_add_u32 v9,8192,v5
MF v[120:123],a[20:23],a[92:95],v[120:123]
v_mov_b32 v10,0xfffff800
s_and_b32 s60,s3,0x7ff
MF v[120:123],a[220:223],a[84:87],v[120:123]
s_bfe_u32 s61,s3,0xb000b
RD a[156:159],v3,7168
MF v[124:127],a[224:227],a[84:87],v[124:127]
s_lshr_b32 s62,s3,21
RD a[192:195],v3,16384
MF v[124:127],a[24:27],a[92:95],v[124:127]
s_mul_i32 s63,s3,0x9e3779b1
MF v[128:131],a[28:31],a[92:95],v[128:131]
s_lshr_b32 s63,s63,21
RD a[160:163],v3,8192
MF v[128:131],a[228:231],a[84:87],v[128:131]
buffer_store_dwordx4 v[202:205],v22,s[20:23],s51 offen offset:1024 sc1
MF v[132:135],a[232:235],a[84:87],v[132:135]
RD a[196:199],v3,17408
buffer_store_dwordx4 v[206:209],v22,s[20:23],s51 offen offset:2048 sc1
MF v[132:135],a[32:35],a[92:95],v[132:135]
LW 15
s_waitcnt vmcnt(27)
MF v[64:67],a[128:131],a[96:99],v[64:67]
buffer_load_dwordx4 a[80:83],v17,s[20:23],s47 offen offset:2048 sc1
RD a[200:203],v3,18432
MF v[64:67],a[164:167],a[104:107],v[64:67]
LW 15
MF v[68:71],a[168:171],a[104:107],v[68:71]
RD a[0:3],v3,27648
MF v[68:71],a[132:135],a[96:99],v[68:71]
LW 15
buffer_load_dwordx4 v26,s[12:15],s46 offen offset:1024 sc1 lds
MF v[72:75],a[136:139],a[96:99],v[72:75]
LW 14
RD a[204:207],v3,19456
MF v[72:75],a[172:175],a[104:107],v[72:75]
LW 13
MF v[76:79],a[176:179],a[104:107],v[76:79]
RD a[4:7],v3,28672
MF v[76:79],a[140:143],a[96:99],v[76:79]
LW 13
buffer_load_dwordx4 a[84:87],v18,s[20:23],s47 offen offset:2048 sc1
MF v[80:83],a[144:147],a[96:99],v[80:83]
LW 12
RD a[208:211],v3,20480
MF v[80:83],a[180:183],a[104:107],v[80:83]
LW 11
MF v[84:87],a[184:187],a[104:107],v[84:87]
RD a[8:11],v3,29696
MF v[84:87],a[148:151],a[96:99],v[84:87]
LW 11
buffer_load_dwordx4 v26,s[12:15],s46 offen offset:2048 sc1 lds
MF v[88:91],a[152:155],a[96:99],v[88:91]
LW 10
RD a[212:215],v3,21504
MF v[88:91],a[188:191],a[104:107],v[88:91]
LW 9
MF v[92:95],a[192:195],a[104:107],v[92:95]
RD a[12:15],v3,30720
MF v[92:95],a[156:159],a[96:99],v[92:95]
LW 9
buffer_load_dwordx4 a[88:91],v17,s[20:23],s47 offen offset:3072 sc1
MF v[96:99],a[160:163],a[96:99],v[96:99]
LW 8
RD a[216:219],v3,22528
MF v[96:99],a[196:199],a[104:107],v[96:99]
MF v[100:103],a[128:131],a[100:103],v[100:103]
RD a[16:19],v3,31744
MF v[100:103],a[164:167],a[108:111],v[100:103]
buffer_load_dwordx4 v26,s[12:15],s46 offen offset:3072 sc1 lds
MF v[104:107],a[168:171],a[108:111],v[104:107]
RD a[220:223],v3,23552
MF v[104:107],a[132:135],a[100:103],v[104:107]
MF v[108:111],a[136:139],a[100:103],v[108:111]
RD a[20:23],v3,32768
MF v[108:111],a[172:175],a[108:111],v[108:111]
buffer_load_dwordx4 a[92:95],v18,s[20:23],s47 offen offset:3072 sc1
s_add_u32 s47,s47,4096
MF v[112:115],a[176:179],a[108:111],v[112:115]
RD a[224:227],v3,24576
MF v[112:115],a[140:143],a[100:103],v[112:115]
MF v[116:119],a[144:147],a[100:103],v[116:119]
RD a[24:27],v3,33792
MF v[116:119],a[180:183],a[108:111],v[116:119]
s_add_u32 m0,s43,8192
MF v[120:123],a[184:187],a[108:111],v[120:123]
buffer_load_dwordx4 v27,s[12:15],s46 offen sc1 lds
s_add_u32 s46,s46,36864
MF v[120:123],a[148:151],a[100:103],v[120:123]
s_add_u32 s48,s48,36864
s_cmp_eq_u32 s48,147456
s_cselect_b32 s48,0,s48
MF v[124:127],a[152:155],a[100:103],v[124:127]
RD a[228:231],v3,25600
MF v[124:127],a[188:191],a[108:111],v[124:127]
buffer_store_dwordx4 v[210:213],v22,s[20:23],s51 offen offset:3072 sc1
RD a[28:31],v3,34816
MF v[128:131],a[192:195],a[108:111],v[128:131]
RD a[232:235],v3,26624
MF v[128:131],a[156:159],a[100:103],v[128:131]
MF v[132:135],a[160:163],a[100:103],v[132:135]
RD a[32:35],v3,35840
MF v[132:135],a[196:199],a[108:111],v[132:135]
LW 15
s_waitcnt vmcnt(21)
MF v[64:67],a[200:203],a[112:115],v[64:67]
s_barrier
MF v[64:67],a[0:3],a[120:123],v[64:67]
LW 14
buffer_load_dwordx4 a[96:99],v17,s[20:23],s47 offen sc1
v_add_u32 v3,s49,v2
MF v[68:71],a[4:7],a[120:123],v[68:71]
s_add_u32 s49,s49,36864
s_cmp_eq_u32 s49,147456
s_cselect_b32 s49,0,s49
MF v[68:71],a[204:207],a[112:115],v[68:71]
LW 13
MF v[72:75],a[208:211],a[112:115],v[72:75]
LW 12
s_add_u32 s43,s45,s48
s_add_u32 m0,s43,0
MF v[72:75],a[8:11],a[120:123],v[72:75]
LW 10
RD a[128:131],v3,0
buffer_load_dwordx4 v2,s[12:15],s46 offen sc1 lds
MF v[76:79],a[12:15],a[120:123],v[76:79]
RD a[164:167],v3,9216
MF v[76:79],a[212:215],a[112:115],v[76:79]
LW 11
buffer_load_dwordx4 a[100:103],v18,s[20:23],s47 offen sc1
MF v[80:83],a[216:219],a[112:115],v[80:83]
LW 10
RD a[132:135],v3,1024
MF v[80:83],a[16:19],a[120:123],v[80:83]
LW 9
RD a[168:171],v3,10240
MF v[84:87],a[20:23],a[120:123],v[84:87]
MF v[84:87],a[220:223],a[112:115],v[84:87]
LW 9
RD a[136:139],v3,2048
buffer_load_dwordx4 v2,s[12:15],s46 offen offset:1024 sc1 lds
MF v[88:91],a[224:227],a[112:115],v[88:91]
LW 9
MF v[88:91],a[24:27],a[120:123],v[88:91]
LW 7
RD a[172:175],v3,11264
MF v[92:95],a[28:31],a[120:123],v[92:95]
buffer_load_dwordx4 a[104:107],v17,s[20:23],s47 offen offset:1024 sc1
MF v[92:95],a[228:231],a[112:115],v[92:95]
LW 7
RD a[140:143],v3,3072
MF v[96:99],a[232:235],a[112:115],v[96:99]
LW 7
RD a[176:179],v3,12288
MF v[96:99],a[32:35],a[120:123],v[96:99]
MF v[100:103],a[200:203],a[116:119],v[100:103]
RD a[144:147],v3,4096
buffer_load_dwordx4 v2,s[12:15],s46 offen offset:2048 sc1 lds
MF v[100:103],a[0:3],a[124:127],v[100:103]
MF v[104:107],a[4:7],a[124:127],v[104:107]
RD a[180:183],v3,13312
MF v[104:107],a[204:207],a[116:119],v[104:107]
buffer_load_dwordx4 a[108:111],v18,s[20:23],s47 offen offset:1024 sc1
MF v[108:111],a[208:211],a[116:119],v[108:111]
RD a[148:151],v3,5120
MF v[108:111],a[8:11],a[124:127],v[108:111]
RD a[184:187],v3,14336
MF v[112:115],a[12:15],a[124:127],v[112:115]
buffer_load_dwordx4 v2,s[12:15],s46 offen offset:3072 sc1 lds
MF v[112:115],a[212:215],a[116:119],v[112:115]
RD a[152:155],v3,6144
MF v[116:119],a[216:219],a[116:119],v[116:119]
MF v[116:119],a[16:19],a[124:127],v[116:119]
RD a[188:191],v3,15360
MF v[120:123],a[20:23],a[124:127],v[120:123]
s_add_u32 m0,s43,4096
MF v[120:123],a[220:223],a[116:119],v[120:123]
RD a[156:159],v3,7168
buffer_load_dwordx4 v26,s[12:15],s46 offen sc1 lds
MF v[124:127],a[224:227],a[116:119],v[124:127]
RD a[192:195],v3,16384
MF v[124:127],a[24:27],a[124:127],v[124:127]
buffer_store_dwordx2 v[214:215],v21,s[20:23],s51 offen sc1
MF v[128:131],a[28:31],a[124:127],v[128:131]
RD a[160:163],v3,8192
MF v[128:131],a[228:231],a[116:119],v[128:131]
MF v[132:135],a[232:235],a[116:119],v[132:135]
RD a[196:199],v3,17408
MF v[132:135],a[32:35],a[124:127],v[132:135]
LW 15
s_waitcnt vmcnt(23)
MF v[64:67],a[128:131],a[64:67],v[64:67]
buffer_load_dwordx4 a[112:115],v17,s[20:23],s47 offen offset:2048 sc1
RD a[200:203],v3,18432
MF v[64:67],a[164:167],a[72:75],v[64:67]
LW 15
MF v[68:71],a[168:171],a[72:75],v[68:71]
RD a[0:3],v3,27648
MF v[68:71],a[132:135],a[64:67],v[68:71]
LW 15
MF v[72:75],a[136:139],a[64:67],v[72:75]
LW 14
buffer_load_dwordx4 v26,s[12:15],s46 offen offset:1024 sc1 lds
RD a[204:207],v3,19456
MF v[72:75],a[172:175],a[72:75],v[72:75]
LW 13
MF v[76:79],a[176:179],a[72:75],v[76:79]
RD a[4:7],v3,28672
MF v[76:79],a[140:143],a[64:67],v[76:79]
LW 13
MF v[80:83],a[144:147],a[64:67],v[80:83]
LW 12
buffer_load_dwordx4 a[116:119],v18,s[20:23],s47 offen offset:2048 sc1
RD a[208:211],v3,20480
MF v[80:83],a[180:183],a[72:75],v[80:83]
LW 11
MF v[84:87],a[184:187],a[72:75],v[84:87]
RD a[8:11],v3,29696
MF v[84:87],a[148:151],a[64:67],v[84:87]
LW 11
MF v[88:91],a[152:155],a[64:67],v[88:91]
LW 10
RD a[212:215],v3,21504
MF v[88:91],a[188:191],a[72:75],v[88:91]
LW 9
buffer_load_dwordx4 v26,s[12:15],s46 offen offset:2048 sc1 lds
MF v[92:95],a[192:195],a[72:75],v[92:95]
RD a[12:15],v3,30720
MF v[92:95],a[156:159],a[64:67],v[92:95]
LW 9
MF v[96:99],a[160:163],a[64:67],v[96:99]
LW 8
RD a[216:219],v3,22528
MF v[96:99],a[196:199],a[72:75],v[96:99]
buffer_load_dwordx4 a[120:123],v17,s[20:23],s47 offen offset:3072 sc1
MF v[100:103],a[128:131],a[68:71],v[100:103]
RD a[16:19],v3,31744
MF v[100:103],a[164:167],a[76:79],v[100:103]
MF v[104:107],a[168:171],a[76:79],v[104:107]
RD a[220:223],v3,23552
MF v[104:107],a[132:135],a[68:71],v[104:107]
buffer_load_dwordx4 v26,s[12:15],s46 offen offset:3072 sc1 lds
MF v[108:111],a[136:139],a[68:71],v[108:111]
RD a[20:23],v3,32768
MF v[108:111],a[172:175],a[76:79],v[108:111]
MF v[112:115],a[176:179],a[76:79],v[112:115]
RD a[224:227],v3,24576
MF v[112:115],a[140:143],a[68:71],v[112:115]
MF v[116:119],a[144:147],a[68:71],v[116:119]
buffer_load_dwordx4 a[124:127],v18,s[20:23],s47 offen offset:3072 sc1
RD a[24:27],v3,33792
MF v[116:119],a[180:183],a[76:79],v[116:119]
s_add_u32 s47,s47,4096
MF v[120:123],a[184:187],a[76:79],v[120:123]
RD a[228:231],v3,25600
MF v[120:123],a[148:151],a[68:71],v[120:123]
MF v[124:127],a[152:155],a[68:71],v[124:127]
s_add_u32 m0,s43,8192
RD a[28:31],v3,34816
MF v[124:127],a[188:191],a[76:79],v[124:127]
buffer_load_dwordx4 v27,s[12:15],s46 offen sc1 lds
s_add_u32 s46,s46,36864
MF v[128:131],a[192:195],a[76:79],v[128:131]
s_add_u32 s48,s48,36864
s_cmp_eq_u32 s48,147456
s_cselect_b32 s48,0,s48
MF v[128:131],a[156:159],a[68:71],v[128:131]
RD a[232:235],v3,26624
MF v[132:135],a[160:163],a[68:71],v[132:135]
RD a[32:35],v3,35840
MF v[132:135],a[196:199],a[76:79],v[132:135]
LW 15
s_waitcnt vmcnt(19)
MF v[64:67],a[200:203],a[80:83],v[64:67]
s_barrier
MF v[64:67],a[0:3],a[88:91],v[64:67]
LW 14
buffer_load_dwordx4 a[64:67],v17,s[20:23],s47 offen sc1
v_add_u32 v3,s49,v2
MF v[68:71],a[4:7],a[88:91],v[68:71]
s_add_u32 s49,s49,36864
s_cmp_eq_u32 s49,147456
s_cselect_b32 s49,0,s49
MF v[68:71],a[204:207],a[80:83],v[68:71]
LW 13
MF v[72:75],a[208:211],a[80:83],v[72:75]
LW 12
s_add_u32 s43,s45,s48
RD a[128:131],v3,0
MF v[72:75],a[8:11],a[88:91],v[72:75]
LW 11
s_add_u32 m0,s43,0
MF v[76:79],a[12:15],a[88:91],v[76:79]
RD a[164:167],v3,9216
buffer_load_dwordx4 v2,s[12:15],s46 offen sc1 lds
MF v[76:79],a[212:215],a[80:83],v[76:79]
LW 11
MF v[80:83],a[216:219],a[80:83],v[80:83]
LW 10
buffer_load_dwordx4 a[68:71],v18,s[20:23],s47 offen sc1
RD a[132:135],v3,1024
MF v[80:83],a[16:19],a[88:91],v[80:83]
LW 9
RD a[168:171],v3,10240
MF v[84:87],a[20:23],a[88:91],v[84:87]
MF v[84:87],a[220:223],a[80:83],v[84:87]
LW 9
RD a[136:139],v3,2048
MF v[88:91],a[224:227],a[80:83],v[88:91]
LW 9
buffer_load_dwordx4 v2,s[12:15],s46 offen offset:1024 sc1 lds
MF v[88:91],a[24:27],a[88:91],v[88:91]
LW 7
RD a[172:175],v3,11264
MF v[92:95],a[28:31],a[88:91],v[92:95]
MF v[92:95],a[228:231],a[80:83],v[92:95]
LW 7
RD a[140:143],v3,3072
MF v[96:99],a[232:235],a[80:83],v[96:99]
LW 7
RD a[176:179],v3,12288
buffer_load_dwordx4 a[72:75],v17,s[20:23],s47 offen offset:1024 sc1
MF v[96:99],a[32:35],a[88:91],v[96:99]
MF v[100:103],a[200:203],a[84:87],v[100:103]
RD a[144:147],v3,4096
MF v[100:103],a[0:3],a[92:95],v[100:103]
buffer_load_dwordx4 v2,s[12:15],s46 offen offset:2048 sc1 lds
MF v[104:107],a[4:7],a[92:95],v[104:107]
RD a[180:183],v3,13312
MF v[104:107],a[204:207],a[84:87],v[104:107]
MF v[108:111],a[208:211],a[84:87],v[108:111]
RD a[148:151],v3,5120
MF v[108:111],a[8:11],a[92:95],v[108:111]
RD a[184:187],v3,14336
buffer_load_dwordx4 a[76:79],v18,s[20:23],s47 offen offset:1024 sc1
MF v[112:115],a[12:15],a[92:95],v[112:115]
MF v[112:115],a[212:215],a[84:87],v[112:115]
RD a[152:155],v3,6144
MF v[116:119],a[216:219],a[84:87],v[116:119]
MF v[116:119],a[16:19],a[92:95],v[116:119]
buffer_load_dwordx4 v2,s[12:15],s46 offen offset:3072 sc1 lds
RD a[188:191],v3,15360
MF v[120:123],a[20:23],a[92:95],v[120:123]
MF v[120:123],a[220:223],a[84:87],v[120:123]
RD a[156:159],v3,7168
MF v[124:127],a[224:227],a[84:87],v[124:127]
RD a[192:195],v3,16384
MF v[124:127],a[24:27],a[92:95],v[124:127]
s_add_u32 m0,s43,4096
MF v[128:131],a[28:31],a[92:95],v[128:131]
RD a[160:163],v3,8192
buffer_load_dwordx4 v26,s[12:15],s46 offen sc1 lds
MF v[128:131],a[228:231],a[84:87],v[128:131]
MF v[132:135],a[232:235],a[84:87],v[132:135]
RD a[196:199],v3,17408
MF v[132:135],a[32:35],a[92:95],v[132:135]
LW 15
s_waitcnt vmcnt(20)
MF v[64:67],a[128:131],a[96:99],v[64:67]
buffer_load_dwordx4 a[80:83],v17,s[20:23],s47 offen offset:2048 sc1
RD a[200:203],v3,18432
MF v[64:67],a[164:167],a[104:107],v[64:67]
LW 15
MF v[68:71],a[168:171],a[104:107],v[68:71]
RD a[0:3],v3,27648
MF v[68:71],a[132:135],a[96:99],v[68:71]
LW 15
MF v[72:75],a[136:139],a[96:99],v[72:75]
LW 14
buffer_load_dwordx4 v26,s[12:15],s46 offen offset:1024 sc1 lds
RD a[204:207],v3,19456
MF v[72:75],a[172:175],a[104:107],v[72:75]
LW 13
MF v[76:79],a[176:179],a[104:107],v[76:79]
RD a[4:7],v3,28672
MF v[76:79],a[140:143],a[96:99],v[76:79]
LW 13
MF v[80:83],a[144:147],a[96:99],v[80:83]
LW 12
buffer_load_dwordx4 a[84:87],v18,s[20:23],s47 offen offset:2048 sc1
RD a[208:211],v3,20480
MF v[80:83],a[180:183],a[104:107],v[80:83]
LW 11
MF v[84:87],a[184:187],a[104:107],v[84:87]
RD a[8:11],v3,29696
MF v[84:87],a[148:151],a[96:99],v[84:87]
LW 11
MF v[88:91],a[152:155],a[96:99],v[88:91]
LW 10
RD a[212:215],v3,21504
MF v[88:91],a[188:191],a[104:107],v[88:91]
LW 9
buffer_load_dwordx4 v26,s[12:15],s46 offen offset:2048 sc1 lds
MF v[92:95],a[192:195],a[104:107],v[92:95]
RD a[12:15],v3,30720
MF v[92:95],a[156:159],a[96:99],v[92:95]
LW 9
MF v[96:99],a[160:163],a[96:99],v[96:99]
LW 8
RD a[216:219],v3,22528
MF v[96:99],a[196:199],a[104:107],v[96:99]
buffer_load_dwordx4 a[88:91],v17,s[20:23],s47 offen offset:3072 sc1
MF v[100:103],a[128:131],a[100:103],v[100:103]
RD a[16:19],v3,31744
MF v[100:103],a[164:167],a[108:111],v[100:103]
MF v[104:107],a[168:171],a[108:111],v[104:107]
RD a[220:223],v3,23552
MF v[104:107],a[132:135],a[100:103],v[104:107]
buffer_load_dwordx4 v26,s[12:15],s46 offen offset:3072 sc1 lds
MF v[108:111],a[136:139],a[100:103],v[108:111]
RD a[20:23],v3,32768
MF v[108:111],a[172:175],a[108:111],v[108:111]
MF v[112:115],a[176:179],a[108:111],v[112:115]
RD a[224:227],v3,24576
MF v[112:115],a[140:143],a[100:103],v[112:115]
MF v[116:119],a[144:147],a[100:103],v[116:119]
buffer_load_dwordx4 a[92:95],v18,s[20:23],s47 offen offset:3072 sc1
RD a[24:27],v3,33792
MF v[116:119],a[180:183],a[108:111],v[116:119]
s_add_u32 s47,s47,4096
MF v[120:123],a[184:187],a[108:111],v[120:123]
RD a[228:231],v3,25600
MF v[120:123],a[148:151],a[100:103],v[120:123]
MF v[124:127],a[152:155],a[100:103],v[124:127]
s_add_u32 m0,s43,8192
RD a[28:31],v3,34816
MF v[124:127],a[188:191],a[108:111],v[124:127]
buffer_load_dwordx4 v27,s[12:15],s46 offen sc1 lds
s_add_u32 s46,s46,36864
MF v[128:131],a[192:195],a[108:111],v[128:131]
s_add_u32 s48,s48,36864
s_cmp_eq_u32 s48,147456
s_cselect_b32 s48,0,s48
MF v[128:131],a[156:159],a[100:103],v[128:131]
RD a[232:235],v3,26624
MF v[132:135],a[160:163],a[100:103],v[132:135]
RD a[32:35],v3,35840
MF v[132:135],a[196:199],a[108:111],v[132:135]
LW 15
s_waitcnt vmcnt(17)
MF v[64:67],a[200:203],a[112:115],v[64:67]
s_barrier
MF v[64:67],a[0:3],a[120:123],v[64:67]
LW 14
buffer_load_dwordx4 a[96:99],v17,s[20:23],s47 offen sc1
v_add_u32 v3,s49,v2
MF v[68:71],a[4:7],a[120:123],v[68:71]
s_add_u32 s49,s49,36864
s_cmp_eq_u32 s49,147456
s_cselect_b32 s49,0,s49
MF v[68:71],a[204:207],a[112:115],v[68:71]
LW 13
MF v[72:75],a[208:211],a[112:115],v[72:75]
LW 12
s_add_u32 s43,s45,s48
s_add_u32 m0,s43,0
MF v[72:75],a[8:11],a[120:123],v[72:75]
LW 10
RD a[128:131],v3,0
buffer_load_dwordx4 v2,s[12:15],s46 offen sc1 lds
MF v[76:79],a[12:15],a[120:123],v[76:79]
RD a[164:167],v3,9216
MF v[76:79],a[212:215],a[112:115],v[76:79]
LW 11
buffer_load_dwordx4 a[100:103],v18,s[20:23],s47 offen sc1
MF v[80:83],a[216:219],a[112:115],v[80:83]
LW 10
RD a[132:135],v3,1024
MF v[80:83],a[16:19],a[120:123],v[80:83]
LW 9
RD a[168:171],v3,10240
MF v[84:87],a[20:23],a[120:123],v[84:87]
MF v[84:87],a[220:223],a[112:115],v[84:87]
LW 9
RD a[136:139],v3,2048
buffer_load_dwordx4 v2,s[12:15],s46 offen offset:1024 sc1 lds
MF v[88:91],a[224:227],a[112:115],v[88:91]
LW 9
MF v[88:91],a[24:27],a[120:123],v[88:91]
LW 7
RD a[172:175],v3,11264
MF v[92:95],a[28:31],a[120:123],v[92:95]
buffer_load_dwordx4 a[104:107],v17,s[20:23],s47 offen offset:1024 sc1
MF v[92:95],a[228:231],a[112:115],v[92:95]
LW 7
RD a[140:143],v3,3072
MF v[96:99],a[232:235],a[112:115],v[96:99]
LW 7
RD a[176:179],v3,12288
MF v[96:99],a[32:35],a[120:123],v[96:99]
MF v[100:103],a[200:203],a[116:119],v[100:103]
RD a[144:147],v3,4096
buffer_load_dwordx4 v2,s[12:15],s46 offen offset:2048 sc1 lds
MF v[100:103],a[0:3],a[124:127],v[100:103]
MF v[104:107],a[4:7],a[124:127],v[104:107]
RD a[180:183],v3,13312
MF v[104:107],a[204:207],a[116:119],v[104:107]
buffer_load_dwordx4 a[108:111],v18,s[20:23],s47 offen offset:1024 sc1
MF v[108:111],a[208:211],a[116:119],v[108:111]
RD a[148:151],v3,5120
MF v[108:111],a[8:11],a[124:127],v[108:111]
RD a[184:187],v3,14336
MF v[112:115],a[12:15],a[124:127],v[112:115]
buffer_load_dwordx4 v2,s[12:15],s46 offen offset:3072 sc1 lds
MF v[112:115],a[212:215],a[116:119],v[112:115]
RD a[152:155],v3,6144
MF v[116:119],a[216:219],a[116:119],v[116:119]
MF v[116:119],a[16:19],a[124:127],v[116:119]
RD a[188:191],v3,15360
MF v[120:123],a[20:23],a[124:127],v[120:123]
s_add_u32 m0,s43,4096
MF v[120:123],a[220:223],a[116:119],v[120:123]
RD a[156:159],v3,7168
buffer_load_dwordx4 v26,s[12:15],s46 offen sc1 lds
MF v[124:127],a[224:227],a[116:119],v[124:127]
RD a[192:195],v3,16384
MF v[124:127],a[24:27],a[124:127],v[124:127]
s_lshl_b32 s42,s33,4
s_add_u32 s42,s42,s34
s_lshl_b32 s7,s42,4
MF v[128:131],a[28:31],a[124:127],v[128:131]
s_lshl_b32 s41,s32,2
s_add_u32 s7,s7,s41
s_add_u32 s7,s7,0x8305000
MF v[128:131],a[228:231],a[116:119],v[128:131]
v_mov_b32 v28,s7
v_mov_b32 v29,s3
MF v[132:135],a[232:235],a[116:119],v[132:135]
RD a[160:163],v3,8192
global_store_dword v28,v29,s[4:5] sc1
MF v[132:135],a[32:35],a[124:127],v[132:135]
LW 15
s_waitcnt vmcnt(20)
RD a[196:199],v3,17408
MF v[64:67],a[128:131],a[64:67],v[64:67]
buffer_load_dwordx4 a[112:115],v17,s[20:23],s47 offen offset:2048 sc1
RD a[200:203],v3,18432
MF v[64:67],a[164:167],a[72:75],v[64:67]
LW 15
MF v[68:71],a[168:171],a[72:75],v[68:71]
RD a[0:3],v3,27648
MF v[68:71],a[132:135],a[64:67],v[68:71]
LW 15
MF v[72:75],a[136:139],a[64:67],v[72:75]
LW 14
buffer_load_dwordx4 v26,s[12:15],s46 offen offset:1024 sc1 lds
RD a[204:207],v3,19456
MF v[72:75],a[172:175],a[72:75],v[72:75]
LW 13
MF v[76:79],a[176:179],a[72:75],v[76:79]
RD a[4:7],v3,28672
MF v[76:79],a[140:143],a[64:67],v[76:79]
LW 13
MF v[80:83],a[144:147],a[64:67],v[80:83]
LW 12
buffer_load_dwordx4 a[116:119],v18,s[20:23],s47 offen offset:2048 sc1
RD a[208:211],v3,20480
MF v[80:83],a[180:183],a[72:75],v[80:83]
LW 11
MF v[84:87],a[184:187],a[72:75],v[84:87]
RD a[8:11],v3,29696
MF v[84:87],a[148:151],a[64:67],v[84:87]
LW 11
MF v[88:91],a[152:155],a[64:67],v[88:91]
LW 10
RD a[212:215],v3,21504
MF v[88:91],a[188:191],a[72:75],v[88:91]
LW 9
buffer_load_dwordx4 v26,s[12:15],s46 offen offset:2048 sc1 lds
MF v[92:95],a[192:195],a[72:75],v[92:95]
RD a[12:15],v3,30720
MF v[92:95],a[156:159],a[64:67],v[92:95]
LW 9
MF v[96:99],a[160:163],a[64:67],v[96:99]
LW 8
RD a[216:219],v3,22528
MF v[96:99],a[196:199],a[72:75],v[96:99]
buffer_load_dwordx4 a[120:123],v17,s[20:23],s47 offen offset:3072 sc1
MF v[100:103],a[128:131],a[68:71],v[100:103]
RD a[16:19],v3,31744
MF v[100:103],a[164:167],a[76:79],v[100:103]
MF v[104:107],a[168:171],a[76:79],v[104:107]
RD a[220:223],v3,23552
MF v[104:107],a[132:135],a[68:71],v[104:107]
buffer_load_dwordx4 v26,s[12:15],s46 offen offset:3072 sc1 lds
MF v[108:111],a[136:139],a[68:71],v[108:111]
RD a[20:23],v3,32768
MF v[108:111],a[172:175],a[76:79],v[108:111]
MF v[112:115],a[176:179],a[76:79],v[112:115]
RD a[224:227],v3,24576
MF v[112:115],a[140:143],a[68:71],v[112:115]
MF v[116:119],a[144:147],a[68:71],v[116:119]
buffer_load_dwordx4 a[124:127],v18,s[20:23],s47 offen offset:3072 sc1
RD a[24:27],v3,33792
MF v[116:119],a[180:183],a[76:79],v[116:119]
s_add_u32 s47,s47,4096
MF v[120:123],a[184:187],a[76:79],v[120:123]
RD a[228:231],v3,25600
MF v[120:123],a[148:151],a[68:71],v[120:123]
MF v[124:127],a[152:155],a[68:71],v[124:127]
s_add_u32 m0,s43,8192
RD a[28:31],v3,34816
MF v[124:127],a[188:191],a[76:79],v[124:127]
buffer_load_dwordx4 v27,s[12:15],s46 offen sc1 lds
s_add_u32 s46,s46,36864
MF v[128:131],a[192:195],a[76:79],v[128:131]
s_add_u32 s48,s48,36864
s_cmp_eq_u32 s48,147456
s_cselect_b32 s48,0,s48
MF v[128:131],a[156:159],a[68:71],v[128:131]
RD a[232:235],v3,26624
MF v[132:135],a[160:163],a[68:71],v[132:135]
RD a[32:35],v3,35840
MF v[132:135],a[196:199],a[76:79],v[132:135]
LW 15
s_waitcnt vmcnt(18)
MF v[64:67],a[200:203],a[80:83],v[64:67]
s_barrier
MF v[64:67],a[0:3],a[88:91],v[64:67]
LW 14
buffer_load_dwordx4 a[64:67],v17,s[20:23],s47 offen sc1
v_add_u32 v3,s49,v2
MF v[68:71],a[4:7],a[88:91],v[68:71]
s_add_u32 s49,s49,36864
s_cmp_eq_u32 s49,147456
s_cselect_b32 s49,0,s49
MF v[68:71],a[204:207],a[80:83],v[68:71]
LW 13
MF v[72:75],a[208:211],a[80:83],v[72:75]
LW 12
s_add_u32 s43,s45,s48
RD a[128:131],v3,0
MF v[72:75],a[8:11],a[88:91],v[72:75]
LW 11
s_add_u32 m0,s43,0
MF v[76:79],a[12:15],a[88:91],v[76:79]
RD a[164:167],v3,9216
buffer_load_dwordx4 v2,s[12:15],s46 offen sc1 lds
MF v[76:79],a[212:215],a[80:83],v[76:79]
LW 11
MF v[80:83],a[216:219],a[80:83],v[80:83]
LW 10
buffer_load_dwordx4 a[68:71],v18,s[20:23],s47 offen sc1
RD a[132:135],v3,1024
MF v[80:83],a[16:19],a[88:91],v[80:83]
LW 9
RD a[168:171],v3,10240
MF v[84:87],a[20:23],a[88:91],v[84:87]
MF v[84:87],a[220:223],a[80:83],v[84:87]
LW 9
RD a[136:139],v3,2048
MF v[88:91],a[224:227],a[80:83],v[88:91]
LW 9
buffer_load_dwordx4 v2,s[12:15],s46 offen offset:1024 sc1 lds
MF v[88:91],a[24:27],a[88:91],v[88:91]
LW 7
RD a[172:175],v3,11264
MF v[92:95],a[28:31],a[88:91],v[92:95]
MF v[92:95],a[228:231],a[80:83],v[92:95]
LW 7
RD a[140:143],v3,3072
MF v[96:99],a[232:235],a[80:83],v[96:99]
LW 7
RD a[176:179],v3,12288
buffer_load_dwordx4 a[72:75],v17,s[20:23],s47 offen offset:1024 sc1
MF v[96:99],a[32:35],a[88:91],v[96:99]
MF v[100:103],a[200:203],a[84:87],v[100:103]
RD a[144:147],v3,4096
MF v[100:103],a[0:3],a[92:95],v[100:103]
buffer_load_dwordx4 v2,s[12:15],s46 offen offset:2048 sc1 lds
MF v[104:107],a[4:7],a[92:95],v[104:107]
RD a[180:183],v3,13312
MF v[104:107],a[204:207],a[84:87],v[104:107]
MF v[108:111],a[208:211],a[84:87],v[108:111]
RD a[148:151],v3,5120
MF v[108:111],a[8:11],a[92:95],v[108:111]
RD a[184:187],v3,14336
buffer_load_dwordx4 a[76:79],v18,s[20:23],s47 offen offset:1024 sc1
MF v[112:115],a[12:15],a[92:95],v[112:115]
MF v[112:115],a[212:215],a[84:87],v[112:115]
RD a[152:155],v3,6144
MF v[116:119],a[216:219],a[84:87],v[116:119]
MF v[116:119],a[16:19],a[92:95],v[116:119]
buffer_load_dwordx4 v2,s[12:15],s46 offen offset:3072 sc1 lds
RD a[188:191],v3,15360
MF v[120:123],a[20:23],a[92:95],v[120:123]
MF v[120:123],a[220:223],a[84:87],v[120:123]
RD a[156:159],v3,7168
MF v[124:127],a[224:227],a[84:87],v[124:127]
RD a[192:195],v3,16384
MF v[124:127],a[24:27],a[92:95],v[124:127]
s_add_u32 m0,s43,4096
MF v[128:131],a[28:31],a[92:95],v[128:131]
RD a[160:163],v3,8192
buffer_load_dwordx4 v26,s[12:15],s46 offen sc1 lds
MF v[128:131],a[228:231],a[84:87],v[128:131]
MF v[132:135],a[232:235],a[84:87],v[132:135]
RD a[196:199],v3,17408
MF v[132:135],a[32:35],a[92:95],v[132:135]
LW 15
s_waitcnt vmcnt(20)
MF v[64:67],a[128:131],a[96:99],v[64:67]
buffer_load_dwordx4 a[80:83],v17,s[20:23],s47 offen offset:2048 sc1
RD a[200:203],v3,18432
MF v[64:67],a[164:167],a[104:107],v[64:67]
LW 15
MF v[68:71],a[168:171],a[104:107],v[68:71]
RD a[0:3],v3,27648
MF v[68:71],a[132:135],a[96:99],v[68:71]
LW 15
MF v[72:75],a[136:139],a[96:99],v[72:75]
LW 14
buffer_load_dwordx4 v26,s[12:15],s46 offen offset:1024 sc1 lds
RD a[204:207],v3,19456
MF v[72:75],a[172:175],a[104:107],v[72:75]
LW 13
MF v[76:79],a[176:179],a[104:107],v[76:79]
RD a[4:7],v3,28672
MF v[76:79],a[140:143],a[96:99],v[76:79]
LW 13
MF v[80:83],a[144:147],a[96:99],v[80:83]
LW 12
buffer_load_dwordx4 a[84:87],v18,s[20:23],s47 offen offset:2048 sc1
RD a[208:211],v3,20480
MF v[80:83],a[180:183],a[104:107],v[80:83]
LW 11
MF v[84:87],a[184:187],a[104:107],v[84:87]
RD a[8:11],v3,29696
MF v[84:87],a[148:151],a[96:99],v[84:87]
LW 11
MF v[88:91],a[152:155],a[96:99],v[88:91]
LW 10
RD a[212:215],v3,21504
MF v[88:91],a[188:191],a[104:107],v[88:91]
LW 9
buffer_load_dwordx4 v26,s[12:15],s46 offen offset:2048 sc1 lds
MF v[92:95],a[192:195],a[104:107],v[92:95]
RD a[12:15],v3,30720
MF v[92:95],a[156:159],a[96:99],v[92:95]
LW 9
MF v[96:99],a[160:163],a[96:99],v[96:99]
LW 8
RD a[216:219],v3,22528
MF v[96:99],a[196:199],a[104:107],v[96:99]
buffer_load_dwordx4 a[88:91],v17,s[20:23],s47 offen offset:3072 sc1
MF v[100:103],a[128:131],a[100:103],v[100:103]
RD a[16:19],v3,31744
MF v[100:103],a[164:167],a[108:111],v[100:103]
MF v[104:107],a[168:171],a[108:111],v[104:107]
RD a[220:223],v3,23552
MF v[104:107],a[132:135],a[100:103],v[104:107]
buffer_load_dwordx4 v26,s[12:15],s46 offen offset:3072 sc1 lds
MF v[108:111],a[136:139],a[100:103],v[108:111]
RD a[20:23],v3,32768
MF v[108:111],a[172:175],a[108:111],v[108:111]
MF v[112:115],a[176:179],a[108:111],v[112:115]
RD a[224:227],v3,24576
MF v[112:115],a[140:143],a[100:103],v[112:115]
MF v[116:119],a[144:147],a[100:103],v[116:119]
buffer_load_dwordx4 a[92:95],v18,s[20:23],s47 offen offset:3072 sc1
RD a[24:27],v3,33792
MF v[116:119],a[180:183],a[108:111],v[116:119]
s_add_u32 s47,s47,4096
MF v[120:123],a[184:187],a[108:111],v[120:123]
RD a[228:231],v3,25600
MF v[120:123],a[148:151],a[100:103],v[120:123]
MF v[124:127],a[152:155],a[100:103],v[124:127]
s_add_u32 m0,s43,8192
RD a[28:31],v3,34816
MF v[124:127],a[188:191],a[108:111],v[124:127]
buffer_load_dwordx4 v27,s[12:15],s46 offen sc1 lds
s_add_u32 s46,s46,36864
MF v[128:131],a[192:195],a[108:111],v[128:131]
s_add_u32 s48,s48,36864
s_cmp_eq_u32 s48,147456
s_cselect_b32 s48,0,s48
MF v[128:131],a[156:159],a[100:103],v[128:131]
RD a[232:235],v3,26624
MF v[132:135],a[160:163],a[100:103],v[132:135]
RD a[32:35],v3,35840
MF v[132:135],a[196:199],a[108:111],v[132:135]
LW 15
s_waitcnt vmcnt(17)
MF v[64:67],a[200:203],a[112:115],v[64:67]
s_barrier
MF v[64:67],a[0:3],a[120:123],v[64:67]
LW 14
buffer_load_dwordx4 a[96:99],v17,s[20:23],s47 offen sc1
v_add_u32 v3,s49,v2
MF v[68:71],a[4:7],a[120:123],v[68:71]
s_add_u32 s49,s49,36864
s_cmp_eq_u32 s49,147456
s_cselect_b32 s49,0,s49
MF v[68:71],a[204:207],a[112:115],v[68:71]
LW 13
MF v[72:75],a[208:211],a[112:115],v[72:75]
LW 12
s_add_u32 s43,s45,s48
RD a[128:131],v3,0
MF v[72:75],a[8:11],a[120:123],v[72:75]
LW 11
s_add_u32 m0,s43,0
MF v[76:79],a[12:15],a[120:123],v[76:79]
RD a[164:167],v3,9216
buffer_load_dwordx4 v2,s[12:15],s46 offen sc1 lds
MF v[76:79],a[212:215],a[112:115],v[76:79]
LW 11
MF v[80:83],a[216:219],a[112:115],v[80:83]
LW 10
buffer_load_dwordx4 a[100:103],v18,s[20:23],s47 offen sc1
RD a[132:135],v3,1024
MF v[80:83],a[16:19],a[120:123],v[80:83]
LW 9
RD a[168:171],v3,10240
MF v[84:87],a[20:23],a[120:123],v[84:87]
MF v[84:87],a[220:223],a[112:115],v[84:87]
LW 9
RD a[136:139],v3,2048
MF v[88:91],a[224:227],a[112:115],v[88:91]
LW 9
buffer_load_dwordx4 v2,s[12:15],s46 offen offset:1024 sc1 lds
MF v[88:91],a[24:27],a[120:123],v[88:91]
LW 7
RD a[172:175],v3,11264
MF v[92:95],a[28:31],a[120:123],v[92:95]
MF v[92:95],a[228:231],a[112:115],v[92:95]
LW 7
RD a[140:143],v3,3072
MF v[96:99],a[232:235],a[112:115],v[96:99]
LW 7
RD a[176:179],v3,12288
buffer_load_dwordx4 a[104:107],v17,s[20:23],s47 offen offset:1024 sc1
MF v[96:99],a[32:35],a[120:123],v[96:99]
MF v[100:103],a[200:203],a[116:119],v[100:103]
RD a[144:147],v3,4096
MF v[100:103],a[0:3],a[124:127],v[100:103]
buffer_load_dwordx4 v2,s[12:15],s46 offen offset:2048 sc1 lds
MF v[104:107],a[4:7],a[124:127],v[104:107]
RD a[180:183],v3,13312
MF v[104:107],a[204:207],a[116:119],v[104:107]
MF v[108:111],a[208:211],a[116:119],v[108:111]
RD a[148:151],v3,5120
MF v[108:111],a[8:11],a[124:127],v[108:111]
RD a[184:187],v3,14336
buffer_load_dwordx4 a[108:111],v18,s[20:23],s47 offen offset:1024 sc1
MF v[112:115],a[12:15],a[124:127],v[112:115]
MF v[112:115],a[212:215],a[116:119],v[112:115]
RD a[152:155],v3,6144
MF v[116:119],a[216:219],a[116:119],v[116:119]
MF v[116:119],a[16:19],a[124:127],v[116:119]
buffer_load_dwordx4 v2,s[12:15],s46 offen offset:3072 sc1 lds
RD a[188:191],v3,15360
MF v[120:123],a[20:23],a[124:127],v[120:123]
MF v[120:123],a[220:223],a[116:119],v[120:123]
RD a[156:159],v3,7168
MF v[124:127],a[224:227],a[116:119],v[124:127]
RD a[192:195],v3,16384
MF v[124:127],a[24:27],a[124:127],v[124:127]
s_add_u32 m0,s43,4096
MF v[128:131],a[28:31],a[124:127],v[128:131]
RD a[160:163],v3,8192
buffer_load_dwordx4 v26,s[12:15],s46 offen sc1 lds
MF v[128:131],a[228:231],a[116:119],v[128:131]
MF v[132:135],a[232:235],a[116:119],v[132:135]
RD a[196:199],v3,17408
MF v[132:135],a[32:35],a[124:127],v[132:135]
LW 15
s_waitcnt vmcnt(19)
MF v[64:67],a[128:131],a[64:67],v[64:67]
buffer_load_dwordx4 a[112:115],v17,s[20:23],s47 offen offset:2048 sc1
RD a[200:203],v3,18432
MF v[64:67],a[164:167],a[72:75],v[64:67]
LW 15
MF v[68:71],a[168:171],a[72:75],v[68:71]
RD a[0:3],v3,27648
MF v[68:71],a[132:135],a[64:67],v[68:71]
LW 15
buffer_load_dwordx4 v26,s[12:15],s46 offen offset:1024 sc1 lds
MF v[72:75],a[136:139],a[64:67],v[72:75]
LW 14
RD a[204:207],v3,19456
MF v[72:75],a[172:175],a[72:75],v[72:75]
LW 13
MF v[76:79],a[176:179],a[72:75],v[76:79]
RD a[4:7],v3,28672
MF v[76:79],a[140:143],a[64:67],v[76:79]
LW 13
buffer_load_dwordx4 a[116:119],v18,s[20:23],s47 offen offset:2048 sc1
MF v[80:83],a[144:147],a[64:67],v[80:83]
LW 12
RD a[208:211],v3,20480
MF v[80:83],a[180:183],a[72:75],v[80:83]
LW 11
MF v[84:87],a[184:187],a[72:75],v[84:87]
RD a[8:11],v3,29696
MF v[84:87],a[148:151],a[64:67],v[84:87]
LW 11
buffer_load_dwordx4 v26,s[12:15],s46 offen offset:2048 sc1 lds
MF v[88:91],a[152:155],a[64:67],v[88:91]
LW 10
RD a[212:215],v3,21504
MF v[88:91],a[188:191],a[72:75],v[88:91]
LW 9
MF v[92:95],a[192:195],a[72:75],v[92:95]
RD a[12:15],v3,30720
MF v[92:95],a[156:159],a[64:67],v[92:95]
LW 9
buffer_load_dwordx4 a[120:123],v17,s[20:23],s47 offen offset:3072 sc1
MF v[96:99],a[160:163],a[64:67],v[96:99]
LW 8
RD a[216:219],v3,22528
MF v[96:99],a[196:199],a[72:75],v[96:99]
MF v[100:103],a[128:131],a[68:71],v[100:103]
RD a[16:19],v3,31744
MF v[100:103],a[164:167],a[76:79],v[100:103]
buffer_load_dwordx4 v26,s[12:15],s46 offen offset:3072 sc1 lds
MF v[104:107],a[168:171],a[76:79],v[104:107]
RD a[220:223],v3,23552
MF v[104:107],a[132:135],a[68:71],v[104:107]
MF v[108:111],a[136:139],a[68:71],v[108:111]
RD a[20:23],v3,32768
MF v[108:111],a[172:175],a[76:79],v[108:111]
buffer_load_dwordx4 a[124:127],v18,s[20:23],s47 offen offset:3072 sc1
s_add_u32 s47,s47,4096
MF v[112:115],a[176:179],a[76:79],v[112:115]
RD a[224:227],v3,24576
MF v[112:115],a[140:143],a[68:71],v[112:115]
MF v[116:119],a[144:147],a[68:71],v[116:119]
RD a[24:27],v3,33792
MF v[116:119],a[180:183],a[76:79],v[116:119]
s_add_u32 m0,s43,8192
MF v[120:123],a[184:187],a[76:79],v[120:123]
buffer_load_dwordx4 v27,s[12:15],s46 offen sc1 lds
s_add_u32 s46,s46,36864
MF v[120:123],a[148:151],a[68:71],v[120:123]
s_add_u32 s48,s48,36864
s_cmp_eq_u32 s48,147456
s_cselect_b32 s48,0,s48
MF v[124:127],a[152:155],a[68:71],v[124:127]
RD a[228:231],v3,25600
MF v[124:127],a[188:191],a[76:79],v[124:127]
s_lshl_b32 s42,s33,4
s_lshl_b32 s41,s54,2
RD a[28:31],v3,34816
MF v[128:131],a[192:195],a[76:79],v[128:131]
s_add_u32 s42,s42,s41
s_lshl_b32 s7,s42,4
s_add_u32 s7,s7,0x8305000
MF v[128:131],a[156:159],a[68:71],v[128:131]
v_and_b32 v23,15,v1
v_lshl_add_u32 v23,v23,2,s7
MF v[132:135],a[160:163],a[68:71],v[132:135]
RD a[232:235],v3,26624
global_load_dword v24,v23,s[4:5] sc1
MF v[132:135],a[196:199],a[76:79],v[132:135]
LW 15
s_waitcnt vmcnt(18)
RD a[32:35],v3,35840
MF v[64:67],a[200:203],a[80:83],v[64:67]
s_barrier
s_waitcnt vmcnt(0)
v_cmp_ne_u32 vcc,s3,v24
s_nop 0
s_cbranch_vccnz Lm_pl33
Lm_pl33r:
MF v[64:67],a[0:3],a[88:91],v[64:67]
LW 14
s_mov_b32 s47,s53
v_add_u32 v3,s49,v2
MF v[68:71],a[4:7],a[88:91],v[68:71]
s_add_u32 s49,s49,36864
buffer_load_dwordx4 a[64:67],v17,s[20:23],s47 offen sc1
MF v[68:71],a[204:207],a[80:83],v[68:71]
LW 13
s_cmp_eq_u32 s49,147456
s_cselect_b32 s49,0,s49
MF v[72:75],a[208:211],a[80:83],v[72:75]
LW 12
s_add_u32 s43,s45,s48
RD a[128:131],v3,0
MF v[72:75],a[8:11],a[88:91],v[72:75]
LW 11
s_add_u32 m0,s43,0
MF v[76:79],a[12:15],a[88:91],v[76:79]
RD a[164:167],v3,9216
buffer_load_dwordx4 v2,s[12:15],s46 offen sc1 lds
MF v[76:79],a[212:215],a[80:83],v[76:79]
LW 11
MF v[80:83],a[216:219],a[80:83],v[80:83]
LW 10
buffer_load_dwordx4 a[68:71],v18,s[20:23],s47 offen sc1
RD a[132:135],v3,1024
MF v[80:83],a[16:19],a[88:91],v[80:83]
LW 9
RD a[168:171],v3,10240
MF v[84:87],a[20:23],a[88:91],v[84:87]
MF v[84:87],a[220:223],a[80:83],v[84:87]
LW 9
RD a[136:139],v3,2048
MF v[88:91],a[224:227],a[80:83],v[88:91]
LW 9
buffer_load_dwordx4 v2,s[12:15],s46 offen offset:1024 sc1 lds
MF v[88:91],a[24:27],a[88:91],v[88:91]
LW 7
RD a[172:175],v3,11264
MF v[92:95],a[28:31],a[88:91],v[92:95]
MF v[92:95],a[228:231],a[80:83],v[92:95]
LW 7
RD a[140:143],v3,3072
MF v[96:99],a[232:235],a[80:83],v[96:99]
LW 7
RD a[176:179],v3,12288
buffer_load_dwordx4 a[72:75],v17,s[20:23],s47 offen offset:1024 sc1
MF v[96:99],a[32:35],a[88:91],v[96:99]
MF v[100:103],a[200:203],a[84:87],v[100:103]
RD a[144:147],v3,4096
MF v[100:103],a[0:3],a[92:95],v[100:103]
buffer_load_dwordx4 v2,s[12:15],s46 offen offset:2048 sc1 lds
MF v[104:107],a[4:7],a[92:95],v[104:107]
RD a[180:183],v3,13312
MF v[104:107],a[204:207],a[84:87],v[104:107]
MF v[108:111],a[208:211],a[84:87],v[108:111]
RD a[148:151],v3,5120
MF v[108:111],a[8:11],a[92:95],v[108:111]
RD a[184:187],v3,14336
buffer_load_dwordx4 a[76:79],v18,s[20:23],s47 offen offset:1024 sc1
MF v[112:115],a[12:15],a[92:95],v[112:115]
MF v[112:115],a[212:215],a[84:87],v[112:115]
RD a[152:155],v3,6144
MF v[116:119],a[216:219],a[84:87],v[116:119]
MF v[116:119],a[16:19],a[92:95],v[116:119]
buffer_load_dwordx4 v2,s[12:15],s46 offen offset:3072 sc1 lds
RD a[188:191],v3,15360
MF v[120:123],a[20:23],a[92:95],v[120:123]
MF v[120:123],a[220:223],a[84:87],v[120:123]
RD a[156:159],v3,7168
MF v[124:127],a[224:227],a[84:87],v[124:127]
RD a[192:195],v3,16384
MF v[124:127],a[24:27],a[92:95],v[124:127]
s_add_u32 m0,s43,4096
MF v[128:131],a[28:31],a[92:95],v[128:131]
RD a[160:163],v3,8192
buffer_load_dwordx4 v26,s[12:15],s46 offen sc1 lds
MF v[128:131],a[228:231],a[84:87],v[128:131]
MF v[132:135],a[232:235],a[84:87],v[132:135]
RD a[196:199],v3,17408
MF v[132:135],a[32:35],a[92:95],v[132:135]
LW 15
s_waitcnt vmcnt(9)
MF v[64:67],a[128:131],a[96:99],v[64:67]
buffer_load_dwordx4 a[80:83],v17,s[20:23],s47 offen offset:2048 sc1
RD a[200:203],v3,18432
MF v[64:67],a[164:167],a[104:107],v[64:67]
LW 15
MF v[68:71],a[168:171],a[104:107],v[68:71]
RD a[0:3],v3,27648
MF v[68:71],a[132:135],a[96:99],v[68:71]
LW 15
buffer_load_dwordx4 v26,s[12:15],s46 offen offset:1024 sc1 lds
MF v[72:75],a[136:139],a[96:99],v[72:75]
LW 14
RD a[204:207],v3,19456
MF v[72:75],a[172:175],a[104:107],v[72:75]
LW 13
MF v[76:79],a[176:179],a[104:107],v[76:79]
RD a[4:7],v3,28672
MF v[76:79],a[140:143],a[96:99],v[76:79]
LW 13
buffer_load_dwordx4 a[84:87],v18,s[20:23],s47 offen offset:2048 sc1
MF v[80:83],a[144:147],a[96:99],v[80:83]
LW 12
RD a[208:211],v3,20480
MF v[80:83],a[180:183],a[104:107],v[80:83]
LW 11
MF v[84:87],a[184:187],a[104:107],v[84:87]
buffer_load_dwordx4 v26,s[12:15],s46 offen offset:2048 sc1 lds
RD a[8:11],v3,29696
MF v[84:87],a[148:151],a[96:99],v[84:87]
LW 11
MF v[88:91],a[152:155],a[96:99],v[88:91]
LW 10
RD a[212:215],v3,21504
MF v[88:91],a[188:191],a[104:107],v[88:91]
LW 9
MF v[92:95],a[192:195],a[104:107],v[92:95]
buffer_load_dwordx4 a[88:91],v17,s[20:23],s47 offen offset:3072 sc1
RD a[12:15],v3,30720
MF v[92:95],a[156:159],a[96:99],v[92:95]
LW 9
MF v[96:99],a[160:163],a[96:99],v[96:99]
LW 8
RD a[216:219],v3,22528
MF v[96:99],a[196:199],a[104:107],v[96:99]
buffer_load_dwordx4 v26,s[12:15],s46 offen offset:3072 sc1 lds
MF v[100:103],a[128:131],a[100:103],v[100:103]
RD a[16:19],v3,31744
MF v[100:103],a[164:167],a[108:111],v[100:103]
MF v[104:107],a[168:171],a[108:111],v[104:107]
RD a[220:223],v3,23552
MF v[104:107],a[132:135],a[100:103],v[104:107]
buffer_load_dwordx4 a[92:95],v18,s[20:23],s47 offen offset:3072 sc1
s_add_u32 s47,s47,4096
MF v[108:111],a[136:139],a[100:103],v[108:111]
RD a[20:23],v3,32768
MF v[108:111],a[172:175],a[108:111],v[108:111]
MF v[112:115],a[176:179],a[108:111],v[112:115]
s_add_u32 m0,s43,8192
RD a[224:227],v3,24576
MF v[112:115],a[140:143],a[100:103],v[112:115]
buffer_load_dwordx4 v27,s[12:15],s46 offen sc1 lds
s_add_u32 s46,s46,36864
MF v[116:119],a[144:147],a[100:103],v[116:119]
s_add_u32 s48,s48,36864
s_cmp_eq_u32 s48,147456
s_cselect_b32 s48,0,s48
MF v[116:119],a[180:183],a[108:111],v[116:119]
RD a[24:27],v3,33792
MF v[120:123],a[184:187],a[108:111],v[120:123]
s_add_u32 s57,s53,12288
buffer_load_dwordx4 v[164:167],v17,s[20:23],s57 offen sc1
RD a[228:231],v3,25600
MF v[120:123],a[148:151],a[100:103],v[120:123]
MF v[124:127],a[152:155],a[100:103],v[124:127]
RD a[28:31],v3,34816
MF v[124:127],a[188:191],a[108:111],v[124:127]
buffer_load_dwordx4 v[168:171],v18,s[20:23],s57 offen sc1
MF v[128:131],a[192:195],a[108:111],v[128:131]
RD a[232:235],v3,26624
MF v[128:131],a[156:159],a[100:103],v[128:131]
MF v[132:135],a[160:163],a[100:103],v[132:135]
RD a[32:35],v3,35840
MF v[132:135],a[196:199],a[108:111],v[132:135]
LW 15
s_waitcnt vmcnt(19)
MF v[64:67],a[200:203],a[112:115],v[64:67]
s_barrier
MF v[64:67],a[0:3],a[120:123],v[64:67]
LW 14
buffer_load_dwordx2 a[96:97],v14,s[20:23],s47 offen sc1
v_add_u32 v3,s49,v2
MF v[68:71],a[4:7],a[120:123],v[68:71]
s_add_u32 s49,s49,36864
buffer_load_dwordx2 a[98:99],v14,s[20:23],s47 offen offset:512 sc1
MF v[68:71],a[204:207],a[112:115],v[68:71]
LW 13
s_cmp_eq_u32 s49,147456
s_cselect_b32 s49,0,s49
MF v[72:75],a[208:211],a[112:115],v[72:75]
LW 12
s_add_u32 s43,s45,s48
s_add_u32 m0,s43,0
MF v[72:75],a[8:11],a[120:123],v[72:75]
LW 10
RD a[128:131],v3,0
buffer_load_dwordx4 v2,s[12:15],s46 offen sc1 lds
MF v[76:79],a[12:15],a[120:123],v[76:79]
RD a[164:167],v3,9216
MF v[76:79],a[212:215],a[112:115],v[76:79]
LW 11
buffer_load_dwordx2 a[100:101],v15,s[20:23],s47 offen sc1
buffer_load_dwordx2 a[102:103],v15,s[20:23],s47 offen offset:512 sc1
MF v[80:83],a[216:219],a[112:115],v[80:83]
LW 10
RD a[132:135],v3,1024
MF v[80:83],a[16:19],a[120:123],v[80:83]
LW 9
RD a[168:171],v3,10240
MF v[84:87],a[20:23],a[120:123],v[84:87]
buffer_load_dwordx4 v2,s[12:15],s46 offen offset:1024 sc1 lds
MF v[84:87],a[220:223],a[112:115],v[84:87]
LW 9
RD a[136:139],v3,2048
MF v[88:91],a[224:227],a[112:115],v[88:91]
LW 9
MF v[88:91],a[24:27],a[120:123],v[88:91]
LW 7
buffer_load_dwordx4 a[104:107],v17,s[20:23],s47 offen offset:1024 sc1
RD a[172:175],v3,11264
MF v[92:95],a[28:31],a[120:123],v[92:95]
MF v[92:95],a[228:231],a[112:115],v[92:95]
LW 7
RD a[140:143],v3,3072
MF v[96:99],a[232:235],a[112:115],v[96:99]
LW 7
RD a[176:179],v3,12288
buffer_load_dwordx4 v2,s[12:15],s46 offen offset:2048 sc1 lds
MF v[96:99],a[32:35],a[120:123],v[96:99]
MF v[100:103],a[200:203],a[116:119],v[100:103]
RD a[144:147],v3,4096
MF v[100:103],a[0:3],a[124:127],v[100:103]
buffer_load_dwordx4 a[108:111],v18,s[20:23],s47 offen offset:1024 sc1
MF v[104:107],a[4:7],a[124:127],v[104:107]
RD a[180:183],v3,13312
MF v[104:107],a[204:207],a[116:119],v[104:107]
MF v[108:111],a[208:211],a[116:119],v[108:111]
buffer_load_dwordx4 v2,s[12:15],s46 offen offset:3072 sc1 lds
RD a[148:151],v3,5120
MF v[108:111],a[8:11],a[124:127],v[108:111]
RD a[184:187],v3,14336
MF v[112:115],a[12:15],a[124:127],v[112:115]
MF v[112:115],a[212:215],a[116:119],v[112:115]
s_add_u32 s57,s53,12288
buffer_load_dwordx2 v[172:173],v14,s[20:23],s57 offen offset:1024 sc1
RD a[152:155],v3,6144
MF v[116:119],a[216:219],a[116:119],v[116:119]
buffer_load_dwordx2 v[174:175],v14,s[20:23],s57 offen offset:1536 sc1
MF v[116:119],a[16:19],a[124:127],v[116:119]
RD a[188:191],v3,15360
MF v[120:123],a[20:23],a[124:127],v[120:123]
s_add_u32 m0,s43,4096
MF v[120:123],a[220:223],a[116:119],v[120:123]
RD a[156:159],v3,7168
buffer_load_dwordx4 v26,s[12:15],s46 offen sc1 lds
MF v[124:127],a[224:227],a[116:119],v[124:127]
RD a[192:195],v3,16384
MF v[124:127],a[24:27],a[124:127],v[124:127]
buffer_load_dwordx2 v[176:177],v15,s[20:23],s57 offen offset:1024 sc1
buffer_load_dwordx2 v[178:179],v15,s[20:23],s57 offen offset:1536 sc1
MF v[128:131],a[28:31],a[124:127],v[128:131]
RD a[160:163],v3,8192
MF v[128:131],a[228:231],a[116:119],v[128:131]
MF v[132:135],a[232:235],a[116:119],v[132:135]
RD a[196:199],v3,17408
MF v[132:135],a[32:35],a[124:127],v[132:135]
LW 15
s_waitcnt vmcnt(27)
MF v[64:67],a[128:131],a[64:67],v[64:67]
buffer_load_dwordx4 a[112:115],v17,s[20:23],s47 offen offset:2048 sc1
RD a[200:203],v3,18432
MF v[64:67],a[164:167],a[72:75],v[64:67]
LW 15
MF v[68:71],a[168:171],a[72:75],v[68:71]
RD a[0:3],v3,27648
MF v[68:71],a[132:135],a[64:67],v[68:71]
LW 15
buffer_load_dwordx4 v26,s[12:15],s46 offen offset:1024 sc1 lds
MF v[72:75],a[136:139],a[64:67],v[72:75]
LW 14
RD a[204:207],v3,19456
MF v[72:75],a[172:175],a[72:75],v[72:75]
LW 13
MF v[76:79],a[176:179],a[72:75],v[76:79]
RD a[4:7],v3,28672
MF v[76:79],a[140:143],a[64:67],v[76:79]
LW 13
buffer_load_dwordx4 a[116:119],v18,s[20:23],s47 offen offset:2048 sc1
MF v[80:83],a[144:147],a[64:67],v[80:83]
LW 12
RD a[208:211],v3,20480
MF v[80:83],a[180:183],a[72:75],v[80:83]
LW 11
MF v[84:87],a[184:187],a[72:75],v[84:87]
buffer_load_dwordx4 v26,s[12:15],s46 offen offset:2048 sc1 lds
RD a[8:11],v3,29696
MF v[84:87],a[148:151],a[64:67],v[84:87]
LW 11
MF v[88:91],a[152:155],a[64:67],v[88:91]
LW 10
RD a[212:215],v3,21504
MF v[88:91],a[188:191],a[72:75],v[88:91]
LW 9
MF v[92:95],a[192:195],a[72:75],v[92:95]
buffer_load_dwordx4 a[120:123],v17,s[20:23],s47 offen offset:3072 sc1
RD a[12:15],v3,30720
MF v[92:95],a[156:159],a[64:67],v[92:95]
LW 9
MF v[96:99],a[160:163],a[64:67],v[96:99]
LW 8
RD a[216:219],v3,22528
MF v[96:99],a[196:199],a[72:75],v[96:99]
buffer_load_dwordx4 v26,s[12:15],s46 offen offset:3072 sc1 lds
MF v[100:103],a[128:131],a[68:71],v[100:103]
RD a[16:19],v3,31744
MF v[100:103],a[164:167],a[76:79],v[100:103]
MF v[104:107],a[168:171],a[76:79],v[104:107]
RD a[220:223],v3,23552
MF v[104:107],a[132:135],a[68:71],v[104:107]
buffer_load_dwordx4 a[124:127],v18,s[20:23],s47 offen offset:3072 sc1
s_add_u32 s47,s47,4096
MF v[108:111],a[136:139],a[68:71],v[108:111]
RD a[20:23],v3,32768
MF v[108:111],a[172:175],a[76:79],v[108:111]
MF v[112:115],a[176:179],a[76:79],v[112:115]
s_add_u32 m0,s43,8192
RD a[224:227],v3,24576
MF v[112:115],a[140:143],a[68:71],v[112:115]
buffer_load_dwordx4 v27,s[12:15],s46 offen sc1 lds
s_add_u32 s46,s46,36864
MF v[116:119],a[144:147],a[68:71],v[116:119]
s_add_u32 s48,s48,36864
s_cmp_eq_u32 s48,147456
s_cselect_b32 s48,0,s48
MF v[116:119],a[180:183],a[76:79],v[116:119]
RD a[24:27],v3,33792
MF v[120:123],a[184:187],a[76:79],v[120:123]
s_add_u32 s57,s53,12288
buffer_load_dwordx4 v[180:183],v17,s[20:23],s57 offen offset:2048 sc1
RD a[228:231],v3,25600
MF v[120:123],a[148:151],a[68:71],v[120:123]
MF v[124:127],a[152:155],a[68:71],v[124:127]
RD a[28:31],v3,34816
MF v[124:127],a[188:191],a[76:79],v[124:127]
buffer_load_dwordx4 v[184:187],v18,s[20:23],s57 offen offset:2048 sc1
MF v[128:131],a[192:195],a[76:79],v[128:131]
RD a[232:235],v3,26624
MF v[128:131],a[156:159],a[68:71],v[128:131]
MF v[132:135],a[160:163],a[68:71],v[132:135]
RD a[32:35],v3,35840
MF v[132:135],a[196:199],a[76:79],v[132:135]
LW 15
s_waitcnt vmcnt(27)
MF v[64:67],a[200:203],a[80:83],v[64:67]
s_barrier
MF v[64:67],a[0:3],a[88:91],v[64:67]
LW 14
buffer_load_dwordx4 a[64:67],v17,s[20:23],s47 offen sc1
v_add_u32 v3,s49,v2
MF v[68:71],a[4:7],a[88:91],v[68:71]
s_add_u32 s49,s49,36864
s_cmp_eq_u32 s49,147456
s_cselect_b32 s49,0,s49
MF v[68:71],a[204:207],a[80:83],v[68:71]
LW 13
MF v[72:75],a[208:211],a[80:83],v[72:75]
LW 12
s_add_u32 s43,s45,s48
s_add_u32 m0,s43,0
MF v[72:75],a[8:11],a[88:91],v[72:75]
LW 10
RD a[128:131],v3,0
buffer_load_dwordx4 v2,s[12:15],s46 offen sc1 lds
MF v[76:79],a[12:15],a[88:91],v[76:79]
RD a[164:167],v3,9216
MF v[76:79],a[212:215],a[80:83],v[76:79]
LW 11
buffer_load_dwordx4 a[68:71],v18,s[20:23],s47 offen sc1
MF v[80:83],a[216:219],a[80:83],v[80:83]
LW 10
RD a[132:135],v3,1024
MF v[80:83],a[16:19],a[88:91],v[80:83]
LW 9
RD a[168:171],v3,10240
MF v[84:87],a[20:23],a[88:91],v[84:87]
buffer_load_dwordx4 v2,s[12:15],s46 offen offset:1024 sc1 lds
MF v[84:87],a[220:223],a[80:83],v[84:87]
LW 9
RD a[136:139],v3,2048
MF v[88:91],a[224:227],a[80:83],v[88:91]
LW 9
MF v[88:91],a[24:27],a[88:91],v[88:91]
LW 7
buffer_load_dwordx4 a[72:75],v17,s[20:23],s47 offen offset:1024 sc1
RD a[172:175],v3,11264
MF v[92:95],a[28:31],a[88:91],v[92:95]
MF v[92:95],a[228:231],a[80:83],v[92:95]
LW 7
RD a[140:143],v3,3072
MF v[96:99],a[232:235],a[80:83],v[96:99]
LW 7
RD a[176:179],v3,12288
buffer_load_dwordx4 v2,s[12:15],s46 offen offset:2048 sc1 lds
MF v[96:99],a[32:35],a[88:91],v[96:99]
MF v[100:103],a[200:203],a[84:87],v[100:103]
RD a[144:147],v3,4096
MF v[100:103],a[0:3],a[92:95],v[100:103]
buffer_load_dwordx4 a[76:79],v18,s[20:23],s47 offen offset:1024 sc1
MF v[104:107],a[4:7],a[92:95],v[104:107]
RD a[180:183],v3,13312
MF v[104:107],a[204:207],a[84:87],v[104:107]
MF v[108:111],a[208:211],a[84:87],v[108:111]
buffer_load_dwordx4 v2,s[12:15],s46 offen offset:3072 sc1 lds
RD a[148:151],v3,5120
MF v[108:111],a[8:11],a[92:95],v[108:111]
RD a[184:187],v3,14336
MF v[112:115],a[12:15],a[92:95],v[112:115]
MF v[112:115],a[212:215],a[84:87],v[112:115]
s_add_u32 s57,s53,12288
buffer_load_dwordx4 v[188:191],v17,s[20:23],s57 offen offset:3072 sc1
RD a[152:155],v3,6144
MF v[116:119],a[216:219],a[84:87],v[116:119]
MF v[116:119],a[16:19],a[92:95],v[116:119]
RD a[188:191],v3,15360
MF v[120:123],a[20:23],a[92:95],v[120:123]
s_add_u32 m0,s43,4096
MF v[120:123],a[220:223],a[84:87],v[120:123]
RD a[156:159],v3,7168
buffer_load_dwordx4 v26,s[12:15],s46 offen sc1 lds
MF v[124:127],a[224:227],a[84:87],v[124:127]
RD a[192:195],v3,16384
MF v[124:127],a[24:27],a[92:95],v[124:127]
buffer_load_dwordx4 v[192:195],v18,s[20:23],s57 offen offset:3072 sc1
MF v[128:131],a[28:31],a[92:95],v[128:131]
RD a[160:163],v3,8192
MF v[128:131],a[228:231],a[84:87],v[128:131]
MF v[132:135],a[232:235],a[84:87],v[132:135]
RD a[196:199],v3,17408
MF v[132:135],a[32:35],a[92:95],v[132:135]
LW 15
s_waitcnt vmcnt(27)
MF v[64:67],a[128:131],a[96:99],v[64:67]
s_barrier
MF v[64:67],a[164:167],a[104:107],v[64:67]
LW 14
buffer_load_dwordx4 a[80:83],v17,s[20:23],s47 offen offset:2048 sc1
RD a[200:203],v3,18432
MF v[68:71],a[168:171],a[104:107],v[68:71]
RD a[0:3],v3,27648
MF v[68:71],a[132:135],a[96:99],v[68:71]
LW 15
buffer_load_dwordx4 v26,s[12:15],s46 offen offset:1024 sc1 lds
MF v[72:75],a[136:139],a[96:99],v[72:75]
LW 14
RD a[204:207],v3,19456
MF v[72:75],a[172:175],a[104:107],v[72:75]
LW 13
buffer_load_dwordx4 a[84:87],v18,s[20:23],s47 offen offset:2048 sc1
MF v[76:79],a[176:179],a[104:107],v[76:79]
RD a[4:7],v3,28672
MF v[76:79],a[140:143],a[96:99],v[76:79]
LW 13
MF v[80:83],a[144:147],a[96:99],v[80:83]
LW 12
RD a[208:211],v3,20480
buffer_load_dwordx4 v26,s[12:15],s46 offen offset:2048 sc1 lds
MF v[80:83],a[180:183],a[104:107],v[80:83]
LW 11
MF v[84:87],a[184:187],a[104:107],v[84:87]
RD a[8:11],v3,29696
buffer_load_dwordx4 a[88:91],v17,s[20:23],s47 offen offset:3072 sc1
MF v[84:87],a[148:151],a[96:99],v[84:87]
LW 11
MF v[88:91],a[152:155],a[96:99],v[88:91]
LW 10
RD a[212:215],v3,21504
MF v[88:91],a[188:191],a[104:107],v[88:91]
LW 9
buffer_load_dwordx4 v26,s[12:15],s46 offen offset:3072 sc1 lds
MF v[92:95],a[192:195],a[104:107],v[92:95]
RD a[12:15],v3,30720
MF v[92:95],a[156:159],a[96:99],v[92:95]
LW 9
buffer_load_dwordx4 a[92:95],v18,s[20:23],s47 offen offset:3072 sc1
s_add_u32 s47,s47,4096
MF v[96:99],a[160:163],a[96:99],v[96:99]
LW 8
RD a[216:219],v3,22528
MF v[96:99],a[196:199],a[104:107],v[96:99]
MF v[100:103],a[128:131],a[100:103],v[100:103]
s_add_u32 m0,s43,8192
RD a[16:19],v3,31744
MF v[100:103],a[164:167],a[108:111],v[100:103]
buffer_load_dwordx4 v27,s[12:15],s46 offen sc1 lds
s_add_u32 s46,s46,36864
MF v[104:107],a[168:171],a[108:111],v[104:107]
s_add_u32 s48,s48,36864
s_cmp_eq_u32 s48,147456
s_cselect_b32 s48,0,s48
MF v[104:107],a[132:135],a[100:103],v[104:107]
s_lshr_b32 s40,s32,1
s_mul_i32 s40,s40,9216
s_and_b32 s41,s32,1
MF v[108:111],a[136:139],a[100:103],v[108:111]
s_mul_i32 s41,s41,5120
s_add_u32 s40,s40,s41
s_sub_u32 s46,s46,s45
MF v[108:111],a[172:175],a[108:111],v[108:111]
s_add_u32 s46,s46,s40
RD a[220:223],v3,23552
s_mov_b32 s45,s40
MF v[112:115],a[176:179],a[108:111],v[112:115]
s_add_u32 s43,s45,s48
s_add_u32 m0,s43,0
RD a[20:23],v3,32768
MF v[112:115],a[140:143],a[100:103],v[112:115]
RD a[224:227],v3,24576
buffer_load_dwordx4 v2,s[12:15],s46 offen sc1 lds
MF v[116:119],a[144:147],a[100:103],v[116:119]
RD a[24:27],v3,33792
buffer_load_dwordx4 v2,s[12:15],s46 offen offset:1024 sc1 lds
MF v[116:119],a[180:183],a[108:111],v[116:119]
buffer_load_dwordx4 v2,s[12:15],s46 offen offset:2048 sc1 lds
MF v[120:123],a[184:187],a[108:111],v[120:123]
RD a[228:231],v3,25600
MF v[120:123],a[148:151],a[100:103],v[120:123]
MF v[124:127],a[152:155],a[100:103],v[124:127]
RD a[28:31],v3,34816
buffer_load_dwordx4 v2,s[12:15],s46 offen offset:3072 sc1 lds
MF v[124:127],a[188:191],a[108:111],v[124:127]
MF v[128:131],a[192:195],a[108:111],v[128:131]
s_add_u32 m0,s43,4096
RD a[232:235],v3,26624
MF v[128:131],a[156:159],a[100:103],v[128:131]
buffer_load_dwordx4 v26,s[12:15],s46 offen sc1 lds
MF v[132:135],a[160:163],a[100:103],v[132:135]
RD a[32:35],v3,35840
MF v[132:135],a[196:199],a[108:111],v[132:135]
LW 15
s_waitcnt vmcnt(26)
MF v[64:67],a[200:203],a[112:115],v[64:67]
s_barrier
MF v[64:67],a[0:3],a[120:123],v[64:67]
LW 14
s_add_u32 s57,s53,16384
v_add_u32 v3,s49,v2
MF v[68:71],a[4:7],a[120:123],v[68:71]
buffer_load_dwordx4 v[196:199],v17,s[20:23],s57 offen sc1
buffer_load_dwordx4 v[200:203],v18,s[20:23],s57 offen sc1
MF v[68:71],a[204:207],a[112:115],v[68:71]
LW 13
s_add_u32 s57,s53,16384
s_add_u32 s49,s49,36864
MF v[72:75],a[208:211],a[112:115],v[72:75]
LW 12
s_cmp_eq_u32 s49,147456
s_cselect_b32 s49,0,s49
MF v[72:75],a[8:11],a[120:123],v[72:75]
LW 10
buffer_load_dwordx4 v[204:207],v17,s[20:23],s57 offen offset:1024 sc1
buffer_load_dwordx4 v[208:211],v18,s[20:23],s57 offen offset:1024 sc1
MF v[76:79],a[12:15],a[120:123],v[76:79]
s_and_b32 s7,s54,1
v_add_u32 v12,s49,v2
MF v[76:79],a[212:215],a[112:115],v[76:79]
LW 9
s_lshl_b32 s7,s7,10
s_add_u32 s49,s49,36864
MF v[80:83],a[216:219],a[112:115],v[80:83]
LW 8
s_cmp_eq_u32 s49,147456
s_cselect_b32 s49,0,s49
MF v[80:83],a[16:19],a[120:123],v[80:83]
LW 6
v_add_u32 v13,s49,v2
s_xor_b32 s40,s54,1
MF v[84:87],a[20:23],a[120:123],v[84:87]
s_mul_i32 s40,s40,61440
MF v[84:87],a[220:223],a[112:115],v[84:87]
LW 5
s_add_u32 s40,s40,s7
s_add_u32 s49,s49,36864
MF v[88:91],a[224:227],a[112:115],v[88:91]
LW 4
s_cmp_eq_u32 s49,147456
s_cselect_b32 s49,0,s49
MF v[88:91],a[24:27],a[120:123],v[88:91]
LW 2
RD a[128:131],v3,4096
s_xor_b32 s41,s54,2
MF v[92:95],a[28:31],a[120:123],v[92:95]
s_mul_i32 s41,s41,61440
MF v[92:95],a[228:231],a[112:115],v[92:95]
LW 2
s_add_u32 s41,s41,25600
RD a[132:135],v3,13312
MF v[96:99],a[232:235],a[112:115],v[96:99]
LW 2
MF v[96:99],a[32:35],a[120:123],v[96:99]
s_xor_b32 s42,s54,3
RD a[136:139],v3,22528
MF v[100:103],a[200:203],a[116:119],v[100:103]
s_mul_i32 s42,s42,61440
MF v[100:103],a[0:3],a[124:127],v[100:103]
RD a[140:143],v3,31744
MF v[104:107],a[4:7],a[124:127],v[104:107]
s_add_u32 s42,s42,40960
MF v[104:107],a[204:207],a[116:119],v[104:107]
s_add_u32 s42,s42,s7
RD a[144:147],v3,5120
MF v[108:111],a[208:211],a[116:119],v[108:111]
s_mul_i32 s43,s54,61440
MF v[108:111],a[8:11],a[124:127],v[108:111]
RD a[148:151],v3,14336
MF v[112:115],a[12:15],a[124:127],v[112:115]
s_add_u32 s43,s43,5120
MF v[112:115],a[212:215],a[116:119],v[112:115]
s_add_u32 s44,s43,20480
RD a[152:155],v3,23552
MF v[116:119],a[216:219],a[116:119],v[116:119]
s_add_u32 s45,s43,40960
MF v[116:119],a[16:19],a[124:127],v[116:119]
RD a[156:159],v3,32768
MF v[120:123],a[20:23],a[124:127],v[120:123]
s_sub_u32 s7,4096,s7
MF v[120:123],a[220:223],a[116:119],v[120:123]
v_add_u32 v11,s7,v5
MF v[124:127],a[224:227],a[116:119],v[124:127]
s_bitcmp1_b32 s54,0
s_cselect_b32 s58,s40,0x70000000
s_cselect_b32 s59,s42,s41
MF v[124:127],a[24:27],a[124:127],v[124:127]
MF v[128:131],a[28:31],a[124:127],v[128:131]
MF v[128:131],a[228:231],a[116:119],v[128:131]
MF v[132:135],a[232:235],a[116:119],v[132:135]
MF v[132:135],a[32:35],a[124:127],v[132:135]
LW 7
s_waitcnt vmcnt(4)
MF v[116:119],a[128:131],a[68:71],v[116:119]
LW 6
s_barrier
MF v[116:119],a[132:135],a[76:79],v[116:119]
LW 5
RD a[160:163],v12,4096
MF v[116:119],a[136:139],a[84:87],v[116:119]
LW 5
RD a[164:167],v12,13312
MF v[116:119],a[140:143],a[92:95],v[116:119]
RD a[168:171],v12,22528
MF v[80:83],a[128:131],a[64:67],v[80:83]
RD a[172:175],v12,31744
MF v[80:83],a[132:135],a[72:75],v[80:83]
RD a[176:179],v13,4096
MF v[80:83],a[136:139],a[80:83],v[80:83]
RD a[180:183],v13,13312
MF v[80:83],a[140:143],a[88:91],v[80:83]
LW 5
RD a[184:187],v12,5120
MF v[80:83],a[160:163],v[164:167],v[80:83]
LW 5
s_waitcnt vmcnt(0)
RD a[188:191],v12,14336
MF v[80:83],a[164:167],v[172:175],v[80:83]
LW 5
RD a[192:195],v12,23552
MF v[80:83],a[168:171],v[180:183],v[80:83]
LW 5
buffer_load_dwordx2 v[140:141],v4,s[28:31],0 offen offset:0
RD a[196:199],v12,32768
MF v[80:83],a[172:175],v[188:191],v[80:83]
LW 5
RD a[200:203],v13,5120
MF v[80:83],a[176:179],v[196:199],v[80:83]
LW 5
RD a[204:207],v13,14336
MF v[80:83],a[180:183],v[204:207],v[80:83]
RD a[208:211],v3,6144
MF v[116:119],a[160:163],v[168:171],v[116:119]
buffer_load_dwordx2 v[142:143],v4,s[28:31],0 offen offset:32
MF v[116:119],a[164:167],v[176:179],v[116:119]
RD a[212:215],v3,15360
MF v[116:119],a[168:171],v[184:187],v[116:119]
MF v[116:119],a[172:175],v[192:195],v[116:119]
RD a[216:219],v3,24576
MF v[116:119],a[176:179],v[200:203],v[116:119]
buffer_load_dwordx2 v[144:145],v4,s[28:31],0 offen offset:64
MF v[116:119],a[180:183],v[208:211],v[116:119]
RD a[220:223],v3,33792
MF v[120:123],a[144:147],a[68:71],v[120:123]
MF v[120:123],a[148:151],a[76:79],v[120:123]
RD a[224:227],v12,6144
v_and_or_b32 v80,v80,v10,s60
MF v[120:123],a[152:155],a[84:87],v[120:123]
v_and_or_b32 v81,v81,v10,s61
v_and_or_b32 v82,v82,v10,s62
MF v[120:123],a[156:159],a[92:95],v[120:123]
LW 10
buffer_load_dwordx2 v[146:147],v4,s[28:31],0 offen offset:96
v_and_or_b32 v83,v83,v10,s63
MF v[120:123],a[184:187],v[168:171],v[120:123]
LW 9
RD a[228:231],v12,15360
buffer_store_dwordx4 v[80:83],v7,s[24:27],s58 offen sc1
MF v[120:123],a[188:191],v[176:179],v[120:123]
LW 9
RD a[232:235],v12,24576
MF v[120:123],a[192:195],v[184:187],v[120:123]
LW 9
buffer_load_dwordx2 v[148:149],v4,s[28:31],0 offen offset:128
MF v[120:123],a[196:199],v[192:195],v[120:123]
LW 8
RD a[0:3],v12,33792
v_and_or_b32 v116,v116,v10,s60
MF v[120:123],a[200:203],v[200:203],v[120:123]
LW 8
v_and_or_b32 v117,v117,v10,s61
v_and_or_b32 v118,v118,v10,s62
MF v[120:123],a[204:207],v[208:211],v[120:123]
RD a[4:7],v13,6144
v_and_or_b32 v119,v119,v10,s63
MF v[84:87],a[144:147],a[64:67],v[84:87]
buffer_store_dwordx4 v[116:119],v7,s[24:27],s59 offen sc1
MF v[84:87],a[148:151],a[72:75],v[84:87]
RD a[8:11],v13,15360
MF v[84:87],a[152:155],a[80:83],v[84:87]
MF v[84:87],a[156:159],a[88:91],v[84:87]
RD a[12:15],v3,7168
MF v[84:87],a[184:187],v[164:167],v[84:87]
MF v[84:87],a[188:191],v[172:175],v[84:87]
RD a[16:19],v3,16384
MF v[84:87],a[192:195],v[180:183],v[84:87]
MF v[84:87],a[196:199],v[188:191],v[84:87]
RD a[20:23],v3,25600
v_and_or_b32 v120,v120,v10,s60
MF v[84:87],a[200:203],v[196:199],v[84:87]
v_and_or_b32 v121,v121,v10,s61
v_and_or_b32 v122,v122,v10,s62
MF v[84:87],a[204:207],v[204:207],v[84:87]
LW 12
RD a[24:27],v3,34816
v_and_or_b32 v123,v123,v10,s63
MF v[124:127],a[208:211],a[68:71],v[124:127]
LW 12
buffer_store_dwordx4 v[120:123],v7,s[24:27],s42 offen offset:1024 sc1
MF v[124:127],a[212:215],a[76:79],v[124:127]
LW 11
RD a[28:31],v12,7168
MF v[124:127],a[216:219],a[84:87],v[124:127]
LW 11
MF v[124:127],a[220:223],a[92:95],v[124:127]
LW 10
RD a[32:35],v12,16384
MF v[124:127],a[224:227],v[168:171],v[124:127]
LW 10
MF v[124:127],a[228:231],v[176:179],v[124:127]
LW 9
RD a[128:131],v12,25600
MF v[124:127],a[232:235],v[184:187],v[124:127]
LW 9
MF v[124:127],a[0:3],v[192:195],v[124:127]
LW 8
RD a[132:135],v12,34816
v_and_or_b32 v84,v84,v10,s60
MF v[124:127],a[4:7],v[200:203],v[124:127]
LW 8
v_and_or_b32 v85,v85,v10,s61
v_and_or_b32 v86,v86,v10,s62
MF v[124:127],a[8:11],v[208:211],v[124:127]
RD a[136:139],v13,7168
v_and_or_b32 v87,v87,v10,s63
MF v[88:91],a[208:211],a[64:67],v[88:91]
buffer_store_dwordx4 v[84:87],v7,s[24:27],s40 offen offset:1024 sc1
MF v[88:91],a[212:215],a[72:75],v[88:91]
RD a[140:143],v13,16384
MF v[88:91],a[216:219],a[80:83],v[88:91]
MF v[88:91],a[220:223],a[88:91],v[88:91]
RD a[144:147],v3,8192
MF v[88:91],a[224:227],v[164:167],v[88:91]
MF v[88:91],a[228:231],v[172:175],v[88:91]
RD a[148:151],v3,17408
MF v[88:91],a[232:235],v[180:183],v[88:91]
MF v[88:91],a[0:3],v[188:191],v[88:91]
RD a[152:155],v3,26624
v_and_or_b32 v124,v124,v10,s60
MF v[88:91],a[4:7],v[196:199],v[88:91]
v_and_or_b32 v125,v125,v10,s61
v_and_or_b32 v126,v126,v10,s62
MF v[88:91],a[8:11],v[204:207],v[88:91]
LW 12
RD a[156:159],v3,35840
v_and_or_b32 v127,v127,v10,s63
MF v[128:131],a[12:15],a[68:71],v[128:131]
LW 12
buffer_store_dwordx4 v[124:127],v7,s[24:27],s42 offen offset:2048 sc1
MF v[128:131],a[16:19],a[76:79],v[128:131]
LW 11
RD a[160:163],v12,8192
MF v[128:131],a[20:23],a[84:87],v[128:131]
LW 11
MF v[128:131],a[24:27],a[92:95],v[128:131]
LW 10
RD a[164:167],v12,17408
MF v[128:131],a[28:31],v[168:171],v[128:131]
LW 10
MF v[128:131],a[32:35],v[176:179],v[128:131]
LW 9
RD a[168:171],v12,26624
MF v[128:131],a[128:131],v[184:187],v[128:131]
LW 9
MF v[128:131],a[132:135],v[192:195],v[128:131]
LW 8
RD a[172:175],v12,35840
v_and_or_b32 v88,v88,v10,s60
MF v[128:131],a[136:139],v[200:203],v[128:131]
LW 8
v_and_or_b32 v89,v89,v10,s61
v_and_or_b32 v90,v90,v10,s62
MF v[128:131],a[140:143],v[208:211],v[128:131]
RD a[176:179],v13,8192
v_and_or_b32 v91,v91,v10,s63
MF v[92:95],a[12:15],a[64:67],v[92:95]
buffer_store_dwordx4 v[88:91],v7,s[24:27],s40 offen offset:2048 sc1
MF v[92:95],a[16:19],a[72:75],v[92:95]
RD a[180:183],v13,17408
MF v[92:95],a[20:23],a[80:83],v[92:95]
MF v[92:95],a[24:27],a[88:91],v[92:95]
RD a[184:187],v3,0
MF v[92:95],a[28:31],v[164:167],v[92:95]
MF v[92:95],a[32:35],v[172:175],v[92:95]
RD a[188:191],v3,9216
MF v[92:95],a[128:131],v[180:183],v[92:95]
MF v[92:95],a[132:135],v[188:191],v[92:95]
RD a[192:195],v3,18432
v_and_or_b32 v128,v128,v10,s60
MF v[92:95],a[136:139],v[196:199],v[92:95]
v_and_or_b32 v129,v129,v10,s61
v_and_or_b32 v130,v130,v10,s62
MF v[92:95],a[140:143],v[204:207],v[92:95]
LW 12
RD a[196:199],v3,27648
v_and_or_b32 v131,v131,v10,s63
MF v[132:135],a[144:147],a[68:71],v[132:135]
LW 12
buffer_store_dwordx4 v[128:131],v7,s[24:27],s42 offen offset:3072 sc1
MF v[132:135],a[148:151],a[76:79],v[132:135]
LW 11
RD a[200:203],v12,0
MF v[132:135],a[152:155],a[84:87],v[132:135]
LW 11
MF v[132:135],a[156:159],a[92:95],v[132:135]
LW 10
RD a[204:207],v12,9216
MF v[132:135],a[160:163],v[168:171],v[132:135]
LW 10
MF v[132:135],a[164:167],v[176:179],v[132:135]
LW 9
RD a[208:211],v12,18432
MF v[132:135],a[168:171],v[184:187],v[132:135]
LW 9
MF v[132:135],a[172:175],v[192:195],v[132:135]
LW 8
RD a[212:215],v12,27648
v_and_or_b32 v92,v92,v10,s60
MF v[132:135],a[176:179],v[200:203],v[132:135]
LW 8
v_and_or_b32 v93,v93,v10,s61
v_and_or_b32 v94,v94,v10,s62
MF v[132:135],a[180:183],v[208:211],v[132:135]
RD a[216:219],v13,0
v_and_or_b32 v95,v95,v10,s63
MF v[96:99],a[144:147],a[64:67],v[96:99]
buffer_store_dwordx4 v[92:95],v7,s[24:27],s40 offen offset:3072 sc1
MF v[96:99],a[148:151],a[72:75],v[96:99]
RD a[220:223],v13,9216
MF v[96:99],a[152:155],a[80:83],v[96:99]
MF v[96:99],a[156:159],a[88:91],v[96:99]
RD a[224:227],v3,1024
MF v[96:99],a[160:163],v[164:167],v[96:99]
MF v[96:99],a[164:167],v[172:175],v[96:99]
RD a[228:231],v3,10240
MF v[96:99],a[168:171],v[180:183],v[96:99]
MF v[96:99],a[172:175],v[188:191],v[96:99]
RD a[232:235],v3,19456
v_and_or_b32 v132,v132,v10,s60
MF v[96:99],a[176:179],v[196:199],v[96:99]
v_and_or_b32 v133,v133,v10,s61
v_and_or_b32 v134,v134,v10,s62
MF v[96:99],a[180:183],v[204:207],v[96:99]
LW 12
RD a[0:3],v3,28672
v_and_or_b32 v135,v135,v10,s63
MF v[100:103],a[184:187],a[68:71],v[100:103]
LW 12
buffer_store_dwordx4 v[132:135],v9,s[24:27],s42 offen sc1
MF v[100:103],a[188:191],a[76:79],v[100:103]
LW 11
RD a[4:7],v12,1024
MF v[100:103],a[192:195],a[84:87],v[100:103]
LW 11
MF v[100:103],a[196:199],a[92:95],v[100:103]
LW 10
RD a[8:11],v12,10240
MF v[100:103],a[200:203],v[168:171],v[100:103]
LW 10
MF v[100:103],a[204:207],v[176:179],v[100:103]
LW 9
RD a[12:15],v12,19456
MF v[100:103],a[208:211],v[184:187],v[100:103]
LW 9
MF v[100:103],a[212:215],v[192:195],v[100:103]
LW 8
RD a[16:19],v12,28672
v_and_or_b32 v96,v96,v10,s60
MF v[100:103],a[216:219],v[200:203],v[100:103]
LW 8
v_and_or_b32 v97,v97,v10,s61
v_and_or_b32 v98,v98,v10,s62
MF v[100:103],a[220:223],v[208:211],v[100:103]
RD a[20:23],v13,1024
v_and_or_b32 v99,v99,v10,s63
MF v[64:67],a[184:187],a[64:67],v[64:67]
buffer_store_dwordx4 v[96:99],v9,s[24:27],s40 offen sc1
MF v[64:67],a[188:191],a[72:75],v[64:67]
RD a[24:27],v13,10240
MF v[64:67],a[192:195],a[80:83],v[64:67]
MF v[64:67],a[196:199],a[88:91],v[64:67]
RD a[28:31],v3,2048
MF v[64:67],a[200:203],v[164:167],v[64:67]
MF v[64:67],a[204:207],v[172:175],v[64:67]
RD a[32:35],v3,11264
MF v[64:67],a[208:211],v[180:183],v[64:67]
MF v[64:67],a[212:215],v[188:191],v[64:67]
RD a[128:131],v3,20480
v_and_or_b32 v100,v100,v10,s60
MF v[64:67],a[216:219],v[196:199],v[64:67]
v_and_or_b32 v101,v101,v10,s61
v_and_or_b32 v102,v102,v10,s62
MF v[64:67],a[220:223],v[204:207],v[64:67]
LW 12
RD a[132:135],v3,29696
v_and_or_b32 v103,v103,v10,s63
MF v[104:107],a[224:227],a[68:71],v[104:107]
LW 12
buffer_store_dwordx4 v[100:103],v5,s[24:27],s41 offen sc1
MF v[104:107],a[228:231],a[76:79],v[104:107]
LW 11
RD a[136:139],v12,2048
MF v[104:107],a[232:235],a[84:87],v[104:107]
LW 11
MF v[104:107],a[0:3],a[92:95],v[104:107]
LW 10
RD a[140:143],v12,11264
MF v[104:107],a[4:7],v[168:171],v[104:107]
LW 10
MF v[104:107],a[8:11],v[176:179],v[104:107]
LW 9
RD a[144:147],v12,20480
MF v[104:107],a[12:15],v[184:187],v[104:107]
LW 9
MF v[104:107],a[16:19],v[192:195],v[104:107]
LW 8
RD a[148:151],v12,29696
MF v[104:107],a[20:23],v[200:203],v[104:107]
LW 8
MF v[104:107],a[24:27],v[208:211],v[104:107]
RD a[152:155],v13,2048
MF v[68:71],a[224:227],a[64:67],v[68:71]
MF v[68:71],a[228:231],a[72:75],v[68:71]
RD a[156:159],v13,11264
MF v[68:71],a[232:235],a[80:83],v[68:71]
MF v[68:71],a[0:3],a[88:91],v[68:71]
RD a[160:163],v3,3072
MF v[68:71],a[4:7],v[164:167],v[68:71]
MF v[68:71],a[8:11],v[172:175],v[68:71]
RD a[164:167],v3,12288
MF v[68:71],a[12:15],v[180:183],v[68:71]
MF v[68:71],a[16:19],v[188:191],v[68:71]
RD a[168:171],v3,21504
v_and_or_b32 v104,v104,v10,s60
MF v[68:71],a[20:23],v[196:199],v[68:71]
v_and_or_b32 v105,v105,v10,s61
v_and_or_b32 v106,v106,v10,s62
MF v[68:71],a[24:27],v[204:207],v[68:71]
LW 12
RD a[172:175],v3,30720
v_and_or_b32 v107,v107,v10,s63
MF v[108:111],a[28:31],a[68:71],v[108:111]
LW 12
buffer_store_dwordx4 v[104:107],v5,s[24:27],s41 offen offset:1024 sc1
MF v[108:111],a[32:35],a[76:79],v[108:111]
LW 11
RD a[176:179],v12,3072
MF v[108:111],a[128:131],a[84:87],v[108:111]
LW 11
MF v[108:111],a[132:135],a[92:95],v[108:111]
LW 10
RD a[180:183],v12,12288
MF v[108:111],a[136:139],v[168:171],v[108:111]
LW 10
MF v[108:111],a[140:143],v[176:179],v[108:111]
LW 9
RD a[184:187],v12,21504
MF v[108:111],a[144:147],v[184:187],v[108:111]
LW 9
MF v[108:111],a[148:151],v[192:195],v[108:111]
LW 8
RD a[188:191],v12,30720
MF v[108:111],a[152:155],v[200:203],v[108:111]
LW 8
MF v[108:111],a[156:159],v[208:211],v[108:111]
RD a[192:195],v13,3072
MF v[72:75],a[28:31],a[64:67],v[72:75]
MF v[72:75],a[32:35],a[72:75],v[72:75]
RD a[196:199],v13,12288
MF v[72:75],a[128:131],a[80:83],v[72:75]
MF v[72:75],a[132:135],a[88:91],v[72:75]
MF v[72:75],a[136:139],v[164:167],v[72:75]
MF v[72:75],a[140:143],v[172:175],v[72:75]
MF v[72:75],a[144:147],v[180:183],v[72:75]
MF v[72:75],a[148:151],v[188:191],v[72:75]
v_and_or_b32 v108,v108,v10,s60
v_and_or_b32 v109,v109,v10,s61
MF v[72:75],a[152:155],v[196:199],v[72:75]
v_and_or_b32 v110,v110,v10,s62
v_and_or_b32 v111,v111,v10,s63
MF v[72:75],a[156:159],v[204:207],v[72:75]
LW 9
buffer_store_dwordx4 v[108:111],v5,s[24:27],s41 offen offset:2048 sc1
MF v[112:115],a[160:163],a[68:71],v[112:115]
LW 8
MF v[112:115],a[164:167],a[76:79],v[112:115]
LW 7
MF v[112:115],a[168:171],a[84:87],v[112:115]
LW 6
MF v[112:115],a[172:175],a[92:95],v[112:115]
LW 5
MF v[112:115],a[176:179],v[168:171],v[112:115]
LW 4
MF v[112:115],a[180:183],v[176:179],v[112:115]
LW 3
MF v[112:115],a[184:187],v[184:187],v[112:115]
LW 2
MF v[112:115],a[188:191],v[192:195],v[112:115]
LW 1
MF v[112:115],a[192:195],v[200:203],v[112:115]
LW 0
MF v[112:115],a[196:199],v[208:211],v[112:115]
MF v[76:79],a[160:163],a[64:67],v[76:79]
MF v[76:79],a[164:167],a[72:75],v[76:79]
MF v[76:79],a[168:171],a[80:83],v[76:79]
MF v[76:79],a[172:175],a[88:91],v[76:79]
MF v[76:79],a[176:179],v[164:167],v[76:79]
MF v[76:79],a[180:183],v[172:175],v[76:79]
MF v[76:79],a[184:187],v[180:183],v[76:79]
MF v[76:79],a[188:191],v[188:191],v[76:79]
v_and_or_b32 v112,v112,v10,s60
v_and_or_b32 v113,v113,v10,s61
MF v[76:79],a[192:195],v[196:199],v[76:79]
v_and_or_b32 v114,v114,v10,s62
v_and_or_b32 v115,v115,v10,s63
MF v[76:79],a[196:199],v[204:207],v[76:79]
buffer_store_dwordx4 v[112:115],v5,s[24:27],s41 offen offset:3072 sc1
v_xor_b32 v80,s60,v80
v_xor_b32 v81,s61,v81
v_xor_b32 v82,s62,v82
v_xor_b32 v83,s63,v83
s_mov_b32 s7,0x40000
Lm_ex34:
buffer_load_dwordx4 v[168:171],v11,s[24:27],s43 offen sc1
buffer_load_dwordx4 v[188:191],v11,s[24:27],s44 offen sc1
buffer_load_dwordx4 v[208:211],v11,s[24:27],s45 offen sc1
s_sub_u32 s7,s7,1
s_cbranch_scc1 Lm_ey35
s_waitcnt vmcnt(0)
v_xor_b32 v168,s60,v168
v_xor_b32 v169,s61,v169
v_xor_b32 v170,s62,v170
v_xor_b32 v171,s63,v171
v_xor_b32 v188,s60,v188
v_xor_b32 v189,s61,v189
v_xor_b32 v190,s62,v190
v_xor_b32 v191,s63,v191
v_xor_b32 v208,s60,v208
v_xor_b32 v209,s61,v209
v_xor_b32 v210,s62,v210
v_xor_b32 v211,s63,v211
v_or_b32 v28,v168,v169
v_or_b32 v29,v170,v171
v_or3_b32 v28,v28,v188,v189
v_or3_b32 v29,v29,v190,v191
v_or3_b32 v28,v28,v208,v209
v_or3_b32 v29,v29,v210,v211
v_or_b32 v28,v28,v29
v_and_b32 v28,0x7ff,v28
v_cmp_ne_u32 vcc,0,v28
s_nop 0
s_cbranch_vccnz Lm_ex34
Lm_ey35:
buffer_load_dwordx4 v[152:155],v5,s[24:27],s43 offen sc1
buffer_load_dwordx4 v[156:159],v5,s[24:27],s43 offen offset:1024 sc1
buffer_load_dwordx4 v[160:163],v5,s[24:27],s43 offen offset:2048 sc1
buffer_load_dwordx4 v[164:167],v5,s[24:27],s43 offen offset:3072 sc1
buffer_load_dwordx4 v[168:171],v11,s[24:27],s43 offen sc1
buffer_load_dwordx4 v[172:175],v5,s[24:27],s44 offen sc1
buffer_load_dwordx4 v[176:179],v5,s[24:27],s44 offen offset:1024 sc1
buffer_load_dwordx4 v[180:183],v5,s[24:27],s44 offen offset:2048 sc1
buffer_load_dwordx4 v[184:187],v5,s[24:27],s44 offen offset:3072 sc1
buffer_load_dwordx4 v[188:191],v11,s[24:27],s44 offen sc1
buffer_load_dwordx4 v[192:195],v5,s[24:27],s45 offen sc1
buffer_load_dwordx4 v[196:199],v5,s[24:27],s45 offen offset:1024 sc1
buffer_load_dwordx4 v[200:203],v5,s[24:27],s45 offen offset:2048 sc1
buffer_load_dwordx4 v[204:207],v5,s[24:27],s45 offen offset:3072 sc1
buffer_load_dwordx4 v[208:211],v11,s[24:27],s45 offen sc1
s_sub_u32 s7,s7,1
s_cbranch_scc1 Lm_ez36
s_waitcnt vmcnt(0)
v_xor_b32 v152,s60,v152
v_xor_b32 v153,s61,v153
v_xor_b32 v154,s62,v154
v_xor_b32 v155,s63,v155
v_xor_b32 v156,s60,v156
v_xor_b32 v157,s61,v157
v_xor_b32 v158,s62,v158
v_xor_b32 v159,s63,v159
v_xor_b32 v160,s60,v160
v_xor_b32 v161,s61,v161
v_xor_b32 v162,s62,v162
v_xor_b32 v163,s63,v163
v_xor_b32 v164,s60,v164
v_xor_b32 v165,s61,v165
v_xor_b32 v166,s62,v166
v_xor_b32 v167,s63,v167
v_xor_b32 v168,s60,v168
v_xor_b32 v169,s61,v169
v_xor_b32 v170,s62,v170
v_xor_b32 v171,s63,v171
v_xor_b32 v172,s60,v172
v_xor_b32 v173,s61,v173
v_xor_b32 v174,s62,v174
v_xor_b32 v175,s63,v175
v_xor_b32 v176,s60,v176
v_xor_b32 v177,s61,v177
v_xor_b32 v178,s62,v178
v_xor_b32 v179,s63,v179
v_xor_b32 v180,s60,v180
v_xor_b32 v181,s61,v181
v_xor_b32 v182,s62,v182
v_xor_b32 v183,s63,v183
v_xor_b32 v184,s60,v184
v_xor_b32 v185,s61,v185
v_xor_b32 v186,s62,v186
v_xor_b32 v187,s63,v187
v_xor_b32 v188,s60,v188
v_xor_b32 v189,s61,v189
v_xor_b32 v190,s62,v190
v_xor_b32 v191,s63,v191
v_xor_b32 v192,s60,v192
v_xor_b32 v193,s61,v193
v_xor_b32 v194,s62,v194
v_xor_b32 v195,s63,v195
v_xor_b32 v196,s60,v196
v_xor_b32 v197,s61,v197
v_xor_b32 v198,s62,v198
v_xor_b32 v199,s63,v199
v_xor_b32 v200,s60,v200
v_xor_b32 v201,s61,v201
v_xor_b32 v202,s62,v202
v_xor_b32 v203,s63,v203
v_xor_b32 v204,s60,v204
v_xor_b32 v205,s61,v205
v_xor_b32 v206,s62,v206
v_xor_b32 v207,s63,v207
v_xor_b32 v208,s60,v208
v_xor_b32 v209,s61,v209
v_xor_b32 v210,s62,v210
v_xor_b32 v211,s63,v211
v_or_b32 v28,v152,v153
v_or_b32 v29,v154,v155
v_or3_b32 v28,v28,v156,v157
v_or3_b32 v29,v29,v158,v159
v_or3_b32 v28,v28,v160,v161
v_or3_b32 v29,v29,v162,v163
v_or3_b32 v28,v28,v164,v165
v_or3_b32 v29,v29,v166,v167
v_or3_b32 v28,v28,v168,v169
v_or3_b32 v29,v29,v170,v171
v_or3_b32 v28,v28,v172,v173
v_or3_b32 v29,v29,v174,v175
v_or3_b32 v28,v28,v176,v177
v_or3_b32 v29,v29,v178,v179
v_or3_b32 v28,v28,v180,v181
v_or3_b32 v29,v29,v182,v183
v_or3_b32 v28,v28,v184,v185
v_or3_b32 v29,v29,v186,v187
v_or3_b32 v28,v28,v188,v189
v_or3_b32 v29,v29,v190,v191
v_or3_b32 v28,v28,v192,v193
v_or3_b32 v29,v29,v194,v195
v_or3_b32 v28,v28,v196,v197
v_or3_b32 v29,v29,v198,v199
v_or3_b32 v28,v28,v200,v201
v_or3_b32 v29,v29,v202,v203
v_or3_b32 v28,v28,v204,v205
v_or3_b32 v29,v29,v206,v207
v_or3_b32 v28,v28,v208,v209
v_or3_b32 v29,v29,v210,v211
v_or_b32 v28,v28,v29
v_and_b32 v28,0x7ff,v28
v_cmp_ne_u32 vcc,0,v28
s_nop 0
s_cbranch_vccnz Lm_ey35
Lm_ez36:
s_waitcnt vmcnt(0)
s_and_b32 s41,s54,1
s_lshl_b32 s41,s41,31
v_add_u32 v6,s41,v4
v_lshlrev_b32 v220,16,v140
v_and_b32 v221,0xffff0000,v140
v_lshlrev_b32 v222,16,v141
v_and_b32 v223,0xffff0000,v141
v_pk_add_f32 v[64:65],v[64:65],v[152:153]
v_pk_add_f32 v[66:67],v[66:67],v[154:155]
v_pk_add_f32 v[64:65],v[64:65],v[172:173]
v_pk_add_f32 v[66:67],v[66:67],v[174:175]
v_pk_add_f32 v[64:65],v[64:65],v[192:193]
v_pk_add_f32 v[66:67],v[66:67],v[194:195]
v_pk_add_f32 v[64:65],v[64:65],v[220:221]
v_pk_add_f32 v[66:67],v[66:67],v[222:223]
CV v64,v64,v65
CV v65,v66,v67
buffer_store_dwordx2 v[64:65],v4,s[8:11],0 offen sc1
v_lshlrev_b32 v224,16,v142
v_and_b32 v225,0xffff0000,v142
v_lshlrev_b32 v226,16,v143
v_and_b32 v227,0xffff0000,v143
v_pk_add_f32 v[68:69],v[68:69],v[156:157]
v_pk_add_f32 v[70:71],v[70:71],v[158:159]
v_pk_add_f32 v[68:69],v[68:69],v[176:177]
v_pk_add_f32 v[70:71],v[70:71],v[178:179]
v_pk_add_f32 v[68:69],v[68:69],v[196:197]
v_pk_add_f32 v[70:71],v[70:71],v[198:199]
v_pk_add_f32 v[68:69],v[68:69],v[224:225]
v_pk_add_f32 v[70:71],v[70:71],v[226:227]
CV v68,v68,v69
CV v69,v70,v71
buffer_store_dwordx2 v[68:69],v4,s[8:11],0 offen offset:32 sc1
v_lshlrev_b32 v228,16,v144
v_and_b32 v229,0xffff0000,v144
v_lshlrev_b32 v230,16,v145
v_and_b32 v231,0xffff0000,v145
v_pk_add_f32 v[72:73],v[72:73],v[160:161]
v_pk_add_f32 v[74:75],v[74:75],v[162:163]
v_pk_add_f32 v[72:73],v[72:73],v[180:181]
v_pk_add_f32 v[74:75],v[74:75],v[182:183]
v_pk_add_f32 v[72:73],v[72:73],v[200:201]
v_pk_add_f32 v[74:75],v[74:75],v[202:203]
v_pk_add_f32 v[72:73],v[72:73],v[228:229]
v_pk_add_f32 v[74:75],v[74:75],v[230:231]
CV v72,v72,v73
CV v73,v74,v75
buffer_store_dwordx2 v[72:73],v4,s[8:11],0 offen offset:64 sc1
v_lshlrev_b32 v232,16,v146
v_and_b32 v233,0xffff0000,v146
v_lshlrev_b32 v234,16,v147
v_and_b32 v235,0xffff0000,v147
v_pk_add_f32 v[76:77],v[76:77],v[164:165]
v_pk_add_f32 v[78:79],v[78:79],v[166:167]
v_pk_add_f32 v[76:77],v[76:77],v[184:185]
v_pk_add_f32 v[78:79],v[78:79],v[186:187]
v_pk_add_f32 v[76:77],v[76:77],v[204:205]
v_pk_add_f32 v[78:79],v[78:79],v[206:207]
v_pk_add_f32 v[76:77],v[76:77],v[232:233]
v_pk_add_f32 v[78:79],v[78:79],v[234:235]
CV v76,v76,v77
CV v77,v78,v79
buffer_store_dwordx2 v[76:77],v4,s[8:11],0 offen offset:96 sc1
v_lshlrev_b32 v236,16,v148
v_and_b32 v237,0xffff0000,v148
v_lshlrev_b32 v238,16,v149
v_and_b32 v239,0xffff0000,v149
v_pk_add_f32 v[80:81],v[80:81],v[168:169]
v_pk_add_f32 v[82:83],v[82:83],v[170:171]
v_pk_add_f32 v[80:81],v[80:81],v[188:189]
v_pk_add_f32 v[82:83],v[82:83],v[190:191]
v_pk_add_f32 v[80:81],v[80:81],v[208:209]
v_pk_add_f32 v[82:83],v[82:83],v[210:211]
v_pk_add_f32 v[80:81],v[80:81],v[236:237]
v_pk_add_f32 v[82:83],v[82:83],v[238:239]
CV v80,v80,v81
CV v81,v82,v83
buffer_store_dwordx2 v[80:81],v6,s[8:11],0 offen offset:128 sc1
s_add_u32 s40,s2,s32
s_cmp_lg_u32 s40,0
s_cbranch_scc1 Lm_noep
v_mov_b32 v28,0x8380000
v_mov_b32 v29,s3
global_store_dword v28,v29,s[4:5]
Lm_noep:
Lm_end:
s_endpgm
Lm_fx10:
s_call_b64 s[38:39],Lm_fix04
s_branch Lm_fx10r
Lm_fx16:
s_call_b64 s[38:39],Lm_fix14
s_branch Lm_fx16r
Lm_fx17:
s_call_b64 s[38:39],Lm_fix04
s_branch Lm_fx17r
Lm_fx18:
s_call_b64 s[38:39],Lm_fix14
s_branch Lm_fx18r
Lm_fx19:
s_call_b64 s[38:39],Lm_fix04
s_branch Lm_fx19r
Lm_fx20:
s_call_b64 s[38:39],Lm_fix14
s_branch Lm_fx20r
Lm_fx21:
s_call_b64 s[38:39],Lm_fix02
s_branch Lm_fx21r
Lm_fx22:
s_call_b64 s[38:39],Lm_fix12
s_branch Lm_fx22r
Lm_fx23:
s_call_b64 s[38:39],Lm_fix02
s_branch Lm_fx23r
Lm_fx24:
s_call_b64 s[38:39],Lm_fix12
s_branch Lm_fx24r
Lm_fx25:
s_call_b64 s[38:39],Lm_fix02
s_branch Lm_fx25r
Lm_fx26:
s_call_b64 s[38:39],Lm_fix02
s_branch Lm_fx26r
Lm_fx29:
s_call_b64 s[38:39],Lm_fix12
s_branch Lm_fx29r
Lm_fx30:
s_call_b64 s[38:39],Lm_fix12
s_branch Lm_fx30r
Lm_fix02:
s_nop 15
v_max3_f32 v164,v48,v49,v50
v_max3_f32 v165,v51,v52,v53
v_max3_f32 v164,v164,v54,v55
v_max_f32 v164,v164,v165
v_mov_b32 v165,v164
s_nop 1
v_permlane16_swap_b32 v164,v165
s_nop 1
v_max_f32 v164,v164,v165
v_mov_b32 v165,v164
s_nop 1
v_permlane32_swap_b32 v164,v165
s_nop 1
v_max_f32 v164,v164,v165
v_add_f32 v164,0x41c00000,v164
v_max_f32 v164,0,v164
v_sub_f32 v165,0,v164
v_exp_f32 v165,v165
v_sub_f32 v16,v16,v164
v_sub_f32 v17,v17,v164
v_sub_f32 v18,v18,v164
v_sub_f32 v19,v19,v164
v_sub_f32 v48,v48,v164
v_sub_f32 v49,v49,v164
v_sub_f32 v50,v50,v164
v_sub_f32 v51,v51,v164
v_sub_f32 v52,v52,v164
v_sub_f32 v53,v53,v164
v_sub_f32 v54,v54,v164
v_sub_f32 v55,v55,v164
v_sub_f32 v80,v80,v164
v_sub_f32 v81,v81,v164
v_sub_f32 v82,v82,v164
v_sub_f32 v83,v83,v164
v_sub_f32 v84,v84,v164
v_sub_f32 v85,v85,v164
v_sub_f32 v86,v86,v164
v_sub_f32 v87,v87,v164
v_mul_f32 v144,v144,v165
v_mul_f32 v145,v145,v165
v_mul_f32 v146,v146,v165
v_mul_f32 v147,v147,v165
AR v166,a0
AR v167,a1
AR v168,a2
AR v169,a3
v_mul_f32 v166,v166,v165
v_mul_f32 v167,v167,v165
v_mul_f32 v168,v168,v165
v_mul_f32 v169,v169,v165
AW a0,v166
AW a1,v167
AW a2,v168
AW a3,v169
AR v166,a4
AR v167,a5
AR v168,a6
AR v169,a7
v_mul_f32 v166,v166,v165
v_mul_f32 v167,v167,v165
v_mul_f32 v168,v168,v165
v_mul_f32 v169,v169,v165
AW a4,v166
AW a5,v167
AW a6,v168
AW a7,v169
AR v166,a8
AR v167,a9
AR v168,a10
AR v169,a11
v_mul_f32 v166,v166,v165
v_mul_f32 v167,v167,v165
v_mul_f32 v168,v168,v165
v_mul_f32 v169,v169,v165
AW a8,v166
AW a9,v167
AW a10,v168
AW a11,v169
AR v166,a12
AR v167,a13
AR v168,a14
AR v169,a15
v_mul_f32 v166,v166,v165
v_mul_f32 v167,v167,v165
v_mul_f32 v168,v168,v165
v_mul_f32 v169,v169,v165
AW a12,v166
AW a13,v167
AW a14,v168
AW a15,v169
AR v166,a16
AR v167,a17
AR v168,a18
AR v169,a19
v_mul_f32 v166,v166,v165
v_mul_f32 v167,v167,v165
v_mul_f32 v168,v168,v165
v_mul_f32 v169,v169,v165
AW a16,v166
AW a17,v167
AW a18,v168
AW a19,v169
AR v166,a20
AR v167,a21
AR v168,a22
AR v169,a23
v_mul_f32 v166,v166,v165
v_mul_f32 v167,v167,v165
v_mul_f32 v168,v168,v165
v_mul_f32 v169,v169,v165
AW a20,v166
AW a21,v167
AW a22,v168
AW a23,v169
AR v166,a24
AR v167,a25
AR v168,a26
AR v169,a27
v_mul_f32 v166,v166,v165
v_mul_f32 v167,v167,v165
v_mul_f32 v168,v168,v165
v_mul_f32 v169,v169,v165
AW a24,v166
AW a25,v167
AW a26,v168
AW a27,v169
AR v166,a28
AR v167,a29
AR v168,a30
AR v169,a31
v_mul_f32 v166,v166,v165
v_mul_f32 v167,v167,v165
v_mul_f32 v168,v168,v165
v_mul_f32 v169,v169,v165
AW a28,v166
AW a29,v167
AW a30,v168
AW a31,v169
v_exp_f32 v166,v48
v_exp_f32 v167,v49
s_nop 0
CV v112,v166,v167
v_exp_f32 v166,v50
v_exp_f32 v167,v51
s_nop 0
CV v113,v166,v167
v_exp_f32 v166,v52
v_exp_f32 v167,v53
s_nop 0
CV v114,v166,v167
v_exp_f32 v166,v54
v_exp_f32 v167,v55
s_nop 0
CV v115,v166,v167
v_max3_f32 v164,v56,v57,v58
v_max3_f32 v165,v59,v60,v61
v_max3_f32 v164,v164,v62,v63
v_max_f32 v164,v164,v165
v_mov_b32 v165,v164
s_nop 1
v_permlane16_swap_b32 v164,v165
s_nop 1
v_max_f32 v164,v164,v165
v_mov_b32 v165,v164
s_nop 1
v_permlane32_swap_b32 v164,v165
s_nop 1
v_max_f32 v164,v164,v165
v_add_f32 v164,0x41c00000,v164
v_max_f32 v164,0,v164
v_sub_f32 v165,0,v164
v_exp_f32 v165,v165
v_sub_f32 v20,v20,v164
v_sub_f32 v21,v21,v164
v_sub_f32 v22,v22,v164
v_sub_f32 v23,v23,v164
v_sub_f32 v56,v56,v164
v_sub_f32 v57,v57,v164
v_sub_f32 v58,v58,v164
v_sub_f32 v59,v59,v164
v_sub_f32 v60,v60,v164
v_sub_f32 v61,v61,v164
v_sub_f32 v62,v62,v164
v_sub_f32 v63,v63,v164
v_sub_f32 v88,v88,v164
v_sub_f32 v89,v89,v164
v_sub_f32 v90,v90,v164
v_sub_f32 v91,v91,v164
v_sub_f32 v92,v92,v164
v_sub_f32 v93,v93,v164
v_sub_f32 v94,v94,v164
v_sub_f32 v95,v95,v164
v_mul_f32 v148,v148,v165
v_mul_f32 v149,v149,v165
v_mul_f32 v150,v150,v165
v_mul_f32 v151,v151,v165
AR v166,a32
AR v167,a33
AR v168,a34
AR v169,a35
v_mul_f32 v166,v166,v165
v_mul_f32 v167,v167,v165
v_mul_f32 v168,v168,v165
v_mul_f32 v169,v169,v165
AW a32,v166
AW a33,v167
AW a34,v168
AW a35,v169
AR v166,a36
AR v167,a37
AR v168,a38
AR v169,a39
v_mul_f32 v166,v166,v165
v_mul_f32 v167,v167,v165
v_mul_f32 v168,v168,v165
v_mul_f32 v169,v169,v165
AW a36,v166
AW a37,v167
AW a38,v168
AW a39,v169
AR v166,a40
AR v167,a41
AR v168,a42
AR v169,a43
v_mul_f32 v166,v166,v165
v_mul_f32 v167,v167,v165
v_mul_f32 v168,v168,v165
v_mul_f32 v169,v169,v165
AW a40,v166
AW a41,v167
AW a42,v168
AW a43,v169
AR v166,a44
AR v167,a45
AR v168,a46
AR v169,a47
v_mul_f32 v166,v166,v165
v_mul_f32 v167,v167,v165
v_mul_f32 v168,v168,v165
v_mul_f32 v169,v169,v165
AW a44,v166
AW a45,v167
AW a46,v168
AW a47,v169
AR v166,a48
AR v167,a49
AR v168,a50
AR v169,a51
v_mul_f32 v166,v166,v165
v_mul_f32 v167,v167,v165
v_mul_f32 v168,v168,v165
v_mul_f32 v169,v169,v165
AW a48,v166
AW a49,v167
AW a50,v168
AW a51,v169
AR v166,a52
AR v167,a53
AR v168,a54
AR v169,a55
v_mul_f32 v166,v166,v165
v_mul_f32 v167,v167,v165
v_mul_f32 v168,v168,v165
v_mul_f32 v169,v169,v165
AW a52,v166
AW a53,v167
AW a54,v168
AW a55,v169
AR v166,a56
AR v167,a57
AR v168,a58
AR v169,a59
v_mul_f32 v166,v166,v165
v_mul_f32 v167,v167,v165
v_mul_f32 v168,v168,v165
v_mul_f32 v169,v169,v165
AW a56,v166
AW a57,v167
AW a58,v168
AW a59,v169
AR v166,a60
AR v167,a61
AR v168,a62
AR v169,a63
v_mul_f32 v166,v166,v165
v_mul_f32 v167,v167,v165
v_mul_f32 v168,v168,v165
v_mul_f32 v169,v169,v165
AW a60,v166
AW a61,v167
AW a62,v168
AW a63,v169
v_exp_f32 v166,v56
v_exp_f32 v167,v57
s_nop 0
CV v116,v166,v167
v_exp_f32 v166,v58
v_exp_f32 v167,v59
s_nop 0
CV v117,v166,v167
v_exp_f32 v166,v60
v_exp_f32 v167,v61
s_nop 0
CV v118,v166,v167
v_exp_f32 v166,v62
v_exp_f32 v167,v63
s_nop 0
CV v119,v166,v167
v_mov_b32 v6,0
s_nop 1
s_setpc_b64 s[38:39]
Lm_fix04:
s_nop 15
v_max3_f32 v164,v48,v49,v50
v_max3_f32 v165,v51,v52,v53
v_max3_f32 v164,v164,v54,v55
v_max_f32 v164,v164,v165
v_mov_b32 v165,v164
s_nop 1
v_permlane16_swap_b32 v164,v165
s_nop 1
v_max_f32 v164,v164,v165
v_mov_b32 v165,v164
s_nop 1
v_permlane32_swap_b32 v164,v165
s_nop 1
v_max_f32 v164,v164,v165
v_add_f32 v164,0x41c00000,v164
v_max_f32 v164,0,v164
v_sub_f32 v165,0,v164
v_exp_f32 v165,v165
v_sub_f32 v16,v16,v164
v_sub_f32 v17,v17,v164
v_sub_f32 v18,v18,v164
v_sub_f32 v19,v19,v164
v_sub_f32 v48,v48,v164
v_sub_f32 v49,v49,v164
v_sub_f32 v50,v50,v164
v_sub_f32 v51,v51,v164
v_sub_f32 v52,v52,v164
v_sub_f32 v53,v53,v164
v_sub_f32 v54,v54,v164
v_sub_f32 v55,v55,v164
v_sub_f32 v80,v80,v164
v_sub_f32 v81,v81,v164
v_sub_f32 v82,v82,v164
v_sub_f32 v83,v83,v164
v_sub_f32 v84,v84,v164
v_sub_f32 v85,v85,v164
v_sub_f32 v86,v86,v164
v_sub_f32 v87,v87,v164
v_mul_f32 v144,v144,v165
v_mul_f32 v145,v145,v165
v_mul_f32 v146,v146,v165
v_mul_f32 v147,v147,v165
AR v166,a0
AR v167,a1
AR v168,a2
AR v169,a3
v_mul_f32 v166,v166,v165
v_mul_f32 v167,v167,v165
v_mul_f32 v168,v168,v165
v_mul_f32 v169,v169,v165
AW a0,v166
AW a1,v167
AW a2,v168
AW a3,v169
AR v166,a4
AR v167,a5
AR v168,a6
AR v169,a7
v_mul_f32 v166,v166,v165
v_mul_f32 v167,v167,v165
v_mul_f32 v168,v168,v165
v_mul_f32 v169,v169,v165
AW a4,v166
AW a5,v167
AW a6,v168
AW a7,v169
AR v166,a8
AR v167,a9
AR v168,a10
AR v169,a11
v_mul_f32 v166,v166,v165
v_mul_f32 v167,v167,v165
v_mul_f32 v168,v168,v165
v_mul_f32 v169,v169,v165
AW a8,v166
AW a9,v167
AW a10,v168
AW a11,v169
AR v166,a12
AR v167,a13
AR v168,a14
AR v169,a15
v_mul_f32 v166,v166,v165
v_mul_f32 v167,v167,v165
v_mul_f32 v168,v168,v165
v_mul_f32 v169,v169,v165
AW a12,v166
AW a13,v167
AW a14,v168
AW a15,v169
AR v166,a16
AR v167,a17
AR v168,a18
AR v169,a19
v_mul_f32 v166,v166,v165
v_mul_f32 v167,v167,v165
v_mul_f32 v168,v168,v165
v_mul_f32 v169,v169,v165
AW a16,v166
AW a17,v167
AW a18,v168
AW a19,v169
AR v166,a20
AR v167,a21
AR v168,a22
AR v169,a23
v_mul_f32 v166,v166,v165
v_mul_f32 v167,v167,v165
v_mul_f32 v168,v168,v165
v_mul_f32 v169,v169,v165
AW a20,v166
AW a21,v167
AW a22,v168
AW a23,v169
AR v166,a24
AR v167,a25
AR v168,a26
AR v169,a27
v_mul_f32 v166,v166,v165
v_mul_f32 v167,v167,v165
v_mul_f32 v168,v168,v165
v_mul_f32 v169,v169,v165
AW a24,v166
AW a25,v167
AW a26,v168
AW a27,v169
AR v166,a28
AR v167,a29
AR v168,a30
AR v169,a31
v_mul_f32 v166,v166,v165
v_mul_f32 v167,v167,v165
v_mul_f32 v168,v168,v165
v_mul_f32 v169,v169,v165
AW a28,v166
AW a29,v167
AW a30,v168
AW a31,v169
v_exp_f32 v166,v48
v_exp_f32 v167,v49
s_nop 0
CV v112,v166,v167
v_exp_f32 v166,v50
v_exp_f32 v167,v51
s_nop 0
CV v113,v166,v167
v_exp_f32 v166,v52
v_exp_f32 v167,v53
s_nop 0
CV v114,v166,v167
v_exp_f32 v166,v54
v_exp_f32 v167,v55
s_nop 0
CV v115,v166,v167
v_max3_f32 v164,v56,v57,v58
v_max3_f32 v165,v59,v60,v61
v_max3_f32 v164,v164,v62,v63
v_max_f32 v164,v164,v165
v_mov_b32 v165,v164
s_nop 1
v_permlane16_swap_b32 v164,v165
s_nop 1
v_max_f32 v164,v164,v165
v_mov_b32 v165,v164
s_nop 1
v_permlane32_swap_b32 v164,v165
s_nop 1
v_max_f32 v164,v164,v165
v_add_f32 v164,0x41c00000,v164
v_max_f32 v164,0,v164
v_sub_f32 v165,0,v164
v_exp_f32 v165,v165
v_sub_f32 v20,v20,v164
v_sub_f32 v21,v21,v164
v_sub_f32 v22,v22,v164
v_sub_f32 v23,v23,v164
v_sub_f32 v56,v56,v164
v_sub_f32 v57,v57,v164
v_sub_f32 v58,v58,v164
v_sub_f32 v59,v59,v164
v_sub_f32 v60,v60,v164
v_sub_f32 v61,v61,v164
v_sub_f32 v62,v62,v164
v_sub_f32 v63,v63,v164
v_sub_f32 v88,v88,v164
v_sub_f32 v89,v89,v164
v_sub_f32 v90,v90,v164
v_sub_f32 v91,v91,v164
v_sub_f32 v92,v92,v164
v_sub_f32 v93,v93,v164
v_sub_f32 v94,v94,v164
v_sub_f32 v95,v95,v164
v_mul_f32 v148,v148,v165
v_mul_f32 v149,v149,v165
v_mul_f32 v150,v150,v165
v_mul_f32 v151,v151,v165
AR v166,a32
AR v167,a33
AR v168,a34
AR v169,a35
v_mul_f32 v166,v166,v165
v_mul_f32 v167,v167,v165
v_mul_f32 v168,v168,v165
v_mul_f32 v169,v169,v165
AW a32,v166
AW a33,v167
AW a34,v168
AW a35,v169
AR v166,a36
AR v167,a37
AR v168,a38
AR v169,a39
v_mul_f32 v166,v166,v165
v_mul_f32 v167,v167,v165
v_mul_f32 v168,v168,v165
v_mul_f32 v169,v169,v165
AW a36,v166
AW a37,v167
AW a38,v168
AW a39,v169
AR v166,a40
AR v167,a41
AR v168,a42
AR v169,a43
v_mul_f32 v166,v166,v165
v_mul_f32 v167,v167,v165
v_mul_f32 v168,v168,v165
v_mul_f32 v169,v169,v165
AW a40,v166
AW a41,v167
AW a42,v168
AW a43,v169
AR v166,a44
AR v167,a45
AR v168,a46
AR v169,a47
v_mul_f32 v166,v166,v165
v_mul_f32 v167,v167,v165
v_mul_f32 v168,v168,v165
v_mul_f32 v169,v169,v165
AW a44,v166
AW a45,v167
AW a46,v168
AW a47,v169
AR v166,a48
AR v167,a49
AR v168,a50
AR v169,a51
v_mul_f32 v166,v166,v165
v_mul_f32 v167,v167,v165
v_mul_f32 v168,v168,v165
v_mul_f32 v169,v169,v165
AW a48,v166
AW a49,v167
AW a50,v168
AW a51,v169
AR v166,a52
AR v167,a53
AR v168,a54
AR v169,a55
v_mul_f32 v166,v166,v165
v_mul_f32 v167,v167,v165
v_mul_f32 v168,v168,v165
v_mul_f32 v169,v169,v165
AW a52,v166
AW a53,v167
AW a54,v168
AW a55,v169
AR v166,a56
AR v167,a57
AR v168,a58
AR v169,a59
v_mul_f32 v166,v166,v165
v_mul_f32 v167,v167,v165
v_mul_f32 v168,v168,v165
v_mul_f32 v169,v169,v165
AW a56,v166
AW a57,v167
AW a58,v168
AW a59,v169
AR v166,a60
AR v167,a61
AR v168,a62
AR v169,a63
v_mul_f32 v166,v166,v165
v_mul_f32 v167,v167,v165
v_mul_f32 v168,v168,v165
v_mul_f32 v169,v169,v165
AW a60,v166
AW a61,v167
AW a62,v168
AW a63,v169
v_exp_f32 v166,v56
v_exp_f32 v167,v57
s_nop 0
CV v116,v166,v167
v_exp_f32 v166,v58
v_exp_f32 v167,v59
s_nop 0
CV v117,v166,v167
v_exp_f32 v166,v60
v_exp_f32 v167,v61
s_nop 0
CV v118,v166,v167
v_exp_f32 v166,v62
v_exp_f32 v167,v63
s_nop 0
CV v119,v166,v167
v_max3_f32 v164,v64,v65,v66
v_max3_f32 v165,v67,v68,v69
v_max3_f32 v164,v164,v70,v71
v_max_f32 v164,v164,v165
v_mov_b32 v165,v164
s_nop 1
v_permlane16_swap_b32 v164,v165
s_nop 1
v_max_f32 v164,v164,v165
v_mov_b32 v165,v164
s_nop 1
v_permlane32_swap_b32 v164,v165
s_nop 1
v_max_f32 v164,v164,v165
v_add_f32 v164,0x41c00000,v164
v_max_f32 v164,0,v164
v_sub_f32 v165,0,v164
v_exp_f32 v165,v165
v_sub_f32 v24,v24,v164
v_sub_f32 v25,v25,v164
v_sub_f32 v26,v26,v164
v_sub_f32 v27,v27,v164
v_sub_f32 v64,v64,v164
v_sub_f32 v65,v65,v164
v_sub_f32 v66,v66,v164
v_sub_f32 v67,v67,v164
v_sub_f32 v68,v68,v164
v_sub_f32 v69,v69,v164
v_sub_f32 v70,v70,v164
v_sub_f32 v71,v71,v164
v_sub_f32 v96,v96,v164
v_sub_f32 v97,v97,v164
v_sub_f32 v98,v98,v164
v_sub_f32 v99,v99,v164
v_sub_f32 v100,v100,v164
v_sub_f32 v101,v101,v164
v_sub_f32 v102,v102,v164
v_sub_f32 v103,v103,v164
v_mul_f32 v152,v152,v165
v_mul_f32 v153,v153,v165
v_mul_f32 v154,v154,v165
v_mul_f32 v155,v155,v165
AR v166,a64
AR v167,a65
AR v168,a66
AR v169,a67
v_mul_f32 v166,v166,v165
v_mul_f32 v167,v167,v165
v_mul_f32 v168,v168,v165
v_mul_f32 v169,v169,v165
AW a64,v166
AW a65,v167
AW a66,v168
AW a67,v169
AR v166,a68
AR v167,a69
AR v168,a70
AR v169,a71
v_mul_f32 v166,v166,v165
v_mul_f32 v167,v167,v165
v_mul_f32 v168,v168,v165
v_mul_f32 v169,v169,v165
AW a68,v166
AW a69,v167
AW a70,v168
AW a71,v169
AR v166,a72
AR v167,a73
AR v168,a74
AR v169,a75
v_mul_f32 v166,v166,v165
v_mul_f32 v167,v167,v165
v_mul_f32 v168,v168,v165
v_mul_f32 v169,v169,v165
AW a72,v166
AW a73,v167
AW a74,v168
AW a75,v169
AR v166,a76
AR v167,a77
AR v168,a78
AR v169,a79
v_mul_f32 v166,v166,v165
v_mul_f32 v167,v167,v165
v_mul_f32 v168,v168,v165
v_mul_f32 v169,v169,v165
AW a76,v166
AW a77,v167
AW a78,v168
AW a79,v169
AR v166,a80
AR v167,a81
AR v168,a82
AR v169,a83
v_mul_f32 v166,v166,v165
v_mul_f32 v167,v167,v165
v_mul_f32 v168,v168,v165
v_mul_f32 v169,v169,v165
AW a80,v166
AW a81,v167
AW a82,v168
AW a83,v169
AR v166,a84
AR v167,a85
AR v168,a86
AR v169,a87
v_mul_f32 v166,v166,v165
v_mul_f32 v167,v167,v165
v_mul_f32 v168,v168,v165
v_mul_f32 v169,v169,v165
AW a84,v166
AW a85,v167
AW a86,v168
AW a87,v169
AR v166,a88
AR v167,a89
AR v168,a90
AR v169,a91
v_mul_f32 v166,v166,v165
v_mul_f32 v167,v167,v165
v_mul_f32 v168,v168,v165
v_mul_f32 v169,v169,v165
AW a88,v166
AW a89,v167
AW a90,v168
AW a91,v169
AR v166,a92
AR v167,a93
AR v168,a94
AR v169,a95
v_mul_f32 v166,v166,v165
v_mul_f32 v167,v167,v165
v_mul_f32 v168,v168,v165
v_mul_f32 v169,v169,v165
AW a92,v166
AW a93,v167
AW a94,v168
AW a95,v169
v_exp_f32 v166,v64
v_exp_f32 v167,v65
s_nop 0
CV v120,v166,v167
v_exp_f32 v166,v66
v_exp_f32 v167,v67
s_nop 0
CV v121,v166,v167
v_exp_f32 v166,v68
v_exp_f32 v167,v69
s_nop 0
CV v122,v166,v167
v_exp_f32 v166,v70
v_exp_f32 v167,v71
s_nop 0
CV v123,v166,v167
v_max3_f32 v164,v72,v73,v74
v_max3_f32 v165,v75,v76,v77
v_max3_f32 v164,v164,v78,v79
v_max_f32 v164,v164,v165
v_mov_b32 v165,v164
s_nop 1
v_permlane16_swap_b32 v164,v165
s_nop 1
v_max_f32 v164,v164,v165
v_mov_b32 v165,v164
s_nop 1
v_permlane32_swap_b32 v164,v165
s_nop 1
v_max_f32 v164,v164,v165
v_add_f32 v164,0x41c00000,v164
v_max_f32 v164,0,v164
v_sub_f32 v165,0,v164
v_exp_f32 v165,v165
v_sub_f32 v28,v28,v164
v_sub_f32 v29,v29,v164
v_sub_f32 v30,v30,v164
v_sub_f32 v31,v31,v164
v_sub_f32 v72,v72,v164
v_sub_f32 v73,v73,v164
v_sub_f32 v74,v74,v164
v_sub_f32 v75,v75,v164
v_sub_f32 v76,v76,v164
v_sub_f32 v77,v77,v164
v_sub_f32 v78,v78,v164
v_sub_f32 v79,v79,v164
v_sub_f32 v104,v104,v164
v_sub_f32 v105,v105,v164
v_sub_f32 v106,v106,v164
v_sub_f32 v107,v107,v164
v_sub_f32 v108,v108,v164
v_sub_f32 v109,v109,v164
v_sub_f32 v110,v110,v164
v_sub_f32 v111,v111,v164
v_mul_f32 v156,v156,v165
v_mul_f32 v157,v157,v165
v_mul_f32 v158,v158,v165
v_mul_f32 v159,v159,v165
AR v166,a96
AR v167,a97
AR v168,a98
AR v169,a99
v_mul_f32 v166,v166,v165
v_mul_f32 v167,v167,v165
v_mul_f32 v168,v168,v165
v_mul_f32 v169,v169,v165
AW a96,v166
AW a97,v167
AW a98,v168
AW a99,v169
AR v166,a100
AR v167,a101
AR v168,a102
AR v169,a103
v_mul_f32 v166,v166,v165
v_mul_f32 v167,v167,v165
v_mul_f32 v168,v168,v165
v_mul_f32 v169,v169,v165
AW a100,v166
AW a101,v167
AW a102,v168
AW a103,v169
AR v166,a104
AR v167,a105
AR v168,a106
AR v169,a107
v_mul_f32 v166,v166,v165
v_mul_f32 v167,v167,v165
v_mul_f32 v168,v168,v165
v_mul_f32 v169,v169,v165
AW a104,v166
AW a105,v167
AW a106,v168
AW a107,v169
AR v166,a108
AR v167,a109
AR v168,a110
AR v169,a111
v_mul_f32 v166,v166,v165
v_mul_f32 v167,v167,v165
v_mul_f32 v168,v168,v165
v_mul_f32 v169,v169,v165
AW a108,v166
AW a109,v167
AW a110,v168
AW a111,v169
AR v166,a112
AR v167,a113
AR v168,a114
AR v169,a115
v_mul_f32 v166,v166,v165
v_mul_f32 v167,v167,v165
v_mul_f32 v168,v168,v165
v_mul_f32 v169,v169,v165
AW a112,v166
AW a113,v167
AW a114,v168
AW a115,v169
AR v166,a116
AR v167,a117
AR v168,a118
AR v169,a119
v_mul_f32 v166,v166,v165
v_mul_f32 v167,v167,v165
v_mul_f32 v168,v168,v165
v_mul_f32 v169,v169,v165
AW a116,v166
AW a117,v167
AW a118,v168
AW a119,v169
AR v166,a120
AR v167,a121
AR v168,a122
AR v169,a123
v_mul_f32 v166,v166,v165
v_mul_f32 v167,v167,v165
v_mul_f32 v168,v168,v165
v_mul_f32 v169,v169,v165
AW a120,v166
AW a121,v167
AW a122,v168
AW a123,v169
AR v166,a124
AR v167,a125
AR v168,a126
AR v169,a127
v_mul_f32 v166,v166,v165
v_mul_f32 v167,v167,v165
v_mul_f32 v168,v168,v165
v_mul_f32 v169,v169,v165
AW a124,v166
AW a125,v167
AW a126,v168
AW a127,v169
v_exp_f32 v166,v72
v_exp_f32 v167,v73
s_nop 0
CV v124,v166,v167
v_exp_f32 v166,v74
v_exp_f32 v167,v75
s_nop 0
CV v125,v166,v167
v_exp_f32 v166,v76
v_exp_f32 v167,v77
s_nop 0
CV v126,v166,v167
v_exp_f32 v166,v78
v_exp_f32 v167,v79
s_nop 0
CV v127,v166,v167
v_mov_b32 v6,0
s_nop 1
s_setpc_b64 s[38:39]
Lm_fix12:
s_nop 15
v_max3_f32 v164,v80,v81,v82
v_max3_f32 v165,v83,v84,v85
v_max3_f32 v164,v164,v86,v87
v_max_f32 v164,v164,v165
v_mov_b32 v165,v164
s_nop 1
v_permlane16_swap_b32 v164,v165
s_nop 1
v_max_f32 v164,v164,v165
v_mov_b32 v165,v164
s_nop 1
v_permlane32_swap_b32 v164,v165
s_nop 1
v_max_f32 v164,v164,v165
v_add_f32 v164,0x41c00000,v164
v_max_f32 v164,0,v164
v_sub_f32 v165,0,v164
v_exp_f32 v165,v165
v_sub_f32 v16,v16,v164
v_sub_f32 v17,v17,v164
v_sub_f32 v18,v18,v164
v_sub_f32 v19,v19,v164
v_sub_f32 v80,v80,v164
v_sub_f32 v81,v81,v164
v_sub_f32 v82,v82,v164
v_sub_f32 v83,v83,v164
v_sub_f32 v84,v84,v164
v_sub_f32 v85,v85,v164
v_sub_f32 v86,v86,v164
v_sub_f32 v87,v87,v164
v_sub_f32 v48,v48,v164
v_sub_f32 v49,v49,v164
v_sub_f32 v50,v50,v164
v_sub_f32 v51,v51,v164
v_sub_f32 v52,v52,v164
v_sub_f32 v53,v53,v164
v_sub_f32 v54,v54,v164
v_sub_f32 v55,v55,v164
v_mul_f32 v144,v144,v165
v_mul_f32 v145,v145,v165
v_mul_f32 v146,v146,v165
v_mul_f32 v147,v147,v165
AR v166,a0
AR v167,a1
AR v168,a2
AR v169,a3
v_mul_f32 v166,v166,v165
v_mul_f32 v167,v167,v165
v_mul_f32 v168,v168,v165
v_mul_f32 v169,v169,v165
AW a0,v166
AW a1,v167
AW a2,v168
AW a3,v169
AR v166,a4
AR v167,a5
AR v168,a6
AR v169,a7
v_mul_f32 v166,v166,v165
v_mul_f32 v167,v167,v165
v_mul_f32 v168,v168,v165
v_mul_f32 v169,v169,v165
AW a4,v166
AW a5,v167
AW a6,v168
AW a7,v169
AR v166,a8
AR v167,a9
AR v168,a10
AR v169,a11
v_mul_f32 v166,v166,v165
v_mul_f32 v167,v167,v165
v_mul_f32 v168,v168,v165
v_mul_f32 v169,v169,v165
AW a8,v166
AW a9,v167
AW a10,v168
AW a11,v169
AR v166,a12
AR v167,a13
AR v168,a14
AR v169,a15
v_mul_f32 v166,v166,v165
v_mul_f32 v167,v167,v165
v_mul_f32 v168,v168,v165
v_mul_f32 v169,v169,v165
AW a12,v166
AW a13,v167
AW a14,v168
AW a15,v169
AR v166,a16
AR v167,a17
AR v168,a18
AR v169,a19
v_mul_f32 v166,v166,v165
v_mul_f32 v167,v167,v165
v_mul_f32 v168,v168,v165
v_mul_f32 v169,v169,v165
AW a16,v166
AW a17,v167
AW a18,v168
AW a19,v169
AR v166,a20
AR v167,a21
AR v168,a22
AR v169,a23
v_mul_f32 v166,v166,v165
v_mul_f32 v167,v167,v165
v_mul_f32 v168,v168,v165
v_mul_f32 v169,v169,v165
AW a20,v166
AW a21,v167
AW a22,v168
AW a23,v169
AR v166,a24
AR v167,a25
AR v168,a26
AR v169,a27
v_mul_f32 v166,v166,v165
v_mul_f32 v167,v167,v165
v_mul_f32 v168,v168,v165
v_mul_f32 v169,v169,v165
AW a24,v166
AW a25,v167
AW a26,v168
AW a27,v169
AR v166,a28
AR v167,a29
AR v168,a30
AR v169,a31
v_mul_f32 v166,v166,v165
v_mul_f32 v167,v167,v165
v_mul_f32 v168,v168,v165
v_mul_f32 v169,v169,v165
AW a28,v166
AW a29,v167
AW a30,v168
AW a31,v169
v_exp_f32 v166,v80
v_exp_f32 v167,v81
s_nop 0
CV v128,v166,v167
v_exp_f32 v166,v82
v_exp_f32 v167,v83
s_nop 0
CV v129,v166,v167
v_exp_f32 v166,v84
v_exp_f32 v167,v85
s_nop 0
CV v130,v166,v167
v_exp_f32 v166,v86
v_exp_f32 v167,v87
s_nop 0
CV v131,v166,v167
v_max3_f32 v164,v88,v89,v90
v_max3_f32 v165,v91,v92,v93
v_max3_f32 v164,v164,v94,v95
v_max_f32 v164,v164,v165
v_mov_b32 v165,v164
s_nop 1
v_permlane16_swap_b32 v164,v165
s_nop 1
v_max_f32 v164,v164,v165
v_mov_b32 v165,v164
s_nop 1
v_permlane32_swap_b32 v164,v165
s_nop 1
v_max_f32 v164,v164,v165
v_add_f32 v164,0x41c00000,v164
v_max_f32 v164,0,v164
v_sub_f32 v165,0,v164
v_exp_f32 v165,v165
v_sub_f32 v20,v20,v164
v_sub_f32 v21,v21,v164
v_sub_f32 v22,v22,v164
v_sub_f32 v23,v23,v164
v_sub_f32 v88,v88,v164
v_sub_f32 v89,v89,v164
v_sub_f32 v90,v90,v164
v_sub_f32 v91,v91,v164
v_sub_f32 v92,v92,v164
v_sub_f32 v93,v93,v164
v_sub_f32 v94,v94,v164
v_sub_f32 v95,v95,v164
v_sub_f32 v56,v56,v164
v_sub_f32 v57,v57,v164
v_sub_f32 v58,v58,v164
v_sub_f32 v59,v59,v164
v_sub_f32 v60,v60,v164
v_sub_f32 v61,v61,v164
v_sub_f32 v62,v62,v164
v_sub_f32 v63,v63,v164
v_mul_f32 v148,v148,v165
v_mul_f32 v149,v149,v165
v_mul_f32 v150,v150,v165
v_mul_f32 v151,v151,v165
AR v166,a32
AR v167,a33
AR v168,a34
AR v169,a35
v_mul_f32 v166,v166,v165
v_mul_f32 v167,v167,v165
v_mul_f32 v168,v168,v165
v_mul_f32 v169,v169,v165
AW a32,v166
AW a33,v167
AW a34,v168
AW a35,v169
AR v166,a36
AR v167,a37
AR v168,a38
AR v169,a39
v_mul_f32 v166,v166,v165
v_mul_f32 v167,v167,v165
v_mul_f32 v168,v168,v165
v_mul_f32 v169,v169,v165
AW a36,v166
AW a37,v167
AW a38,v168
AW a39,v169
AR v166,a40
AR v167,a41
AR v168,a42
AR v169,a43
v_mul_f32 v166,v166,v165
v_mul_f32 v167,v167,v165
v_mul_f32 v168,v168,v165
v_mul_f32 v169,v169,v165
AW a40,v166
AW a41,v167
AW a42,v168
AW a43,v169
AR v166,a44
AR v167,a45
AR v168,a46
AR v169,a47
v_mul_f32 v166,v166,v165
v_mul_f32 v167,v167,v165
v_mul_f32 v168,v168,v165
v_mul_f32 v169,v169,v165
AW a44,v166
AW a45,v167
AW a46,v168
AW a47,v169
AR v166,a48
AR v167,a49
AR v168,a50
AR v169,a51
v_mul_f32 v166,v166,v165
v_mul_f32 v167,v167,v165
v_mul_f32 v168,v168,v165
v_mul_f32 v169,v169,v165
AW a48,v166
AW a49,v167
AW a50,v168
AW a51,v169
AR v166,a52
AR v167,a53
AR v168,a54
AR v169,a55
v_mul_f32 v166,v166,v165
v_mul_f32 v167,v167,v165
v_mul_f32 v168,v168,v165
v_mul_f32 v169,v169,v165
AW a52,v166
AW a53,v167
AW a54,v168
AW a55,v169
AR v166,a56
AR v167,a57
AR v168,a58
AR v169,a59
v_mul_f32 v166,v166,v165
v_mul_f32 v167,v167,v165
v_mul_f32 v168,v168,v165
v_mul_f32 v169,v169,v165
AW a56,v166
AW a57,v167
AW a58,v168
AW a59,v169
AR v166,a60
AR v167,a61
AR v168,a62
AR v169,a63
v_mul_f32 v166,v166,v165
v_mul_f32 v167,v167,v165
v_mul_f32 v168,v168,v165
v_mul_f32 v169,v169,v165
AW a60,v166
AW a61,v167
AW a62,v168
AW a63,v169
v_exp_f32 v166,v88
v_exp_f32 v167,v89
s_nop 0
CV v132,v166,v167
v_exp_f32 v166,v90
v_exp_f32 v167,v91
s_nop 0
CV v133,v166,v167
v_exp_f32 v166,v92
v_exp_f32 v167,v93
s_nop 0
CV v134,v166,v167
v_exp_f32 v166,v94
v_exp_f32 v167,v95
s_nop 0
CV v135,v166,v167
v_mov_b32 v6,0
s_nop 1
s_setpc_b64 s[38:39]
Lm_fix14:
s_nop 15
v_max3_f32 v164,v80,v81,v82
v_max3_f32 v165,v83,v84,v85
v_max3_f32 v164,v164,v86,v87
v_max_f32 v164,v164,v165
v_mov_b32 v165,v164
s_nop 1
v_permlane16_swap_b32 v164,v165
s_nop 1
v_max_f32 v164,v164,v165
v_mov_b32 v165,v164
s_nop 1
v_permlane32_swap_b32 v164,v165
s_nop 1
v_max_f32 v164,v164,v165
v_add_f32 v164,0x41c00000,v164
v_max_f32 v164,0,v164
v_sub_f32 v165,0,v164
v_exp_f32 v165,v165
v_sub_f32 v16,v16,v164
v_sub_f32 v17,v17,v164
v_sub_f32 v18,v18,v164
v_sub_f32 v19,v19,v164
v_sub_f32 v80,v80,v164
v_sub_f32 v81,v81,v164
v_sub_f32 v82,v82,v164
v_sub_f32 v83,v83,v164
v_sub_f32 v84,v84,v164
v_sub_f32 v85,v85,v164
v_sub_f32 v86,v86,v164
v_sub_f32 v87,v87,v164
v_sub_f32 v48,v48,v164
v_sub_f32 v49,v49,v164
v_sub_f32 v50,v50,v164
v_sub_f32 v51,v51,v164
v_sub_f32 v52,v52,v164
v_sub_f32 v53,v53,v164
v_sub_f32 v54,v54,v164
v_sub_f32 v55,v55,v164
v_mul_f32 v144,v144,v165
v_mul_f32 v145,v145,v165
v_mul_f32 v146,v146,v165
v_mul_f32 v147,v147,v165
AR v166,a0
AR v167,a1
AR v168,a2
AR v169,a3
v_mul_f32 v166,v166,v165
v_mul_f32 v167,v167,v165
v_mul_f32 v168,v168,v165
v_mul_f32 v169,v169,v165
AW a0,v166
AW a1,v167
AW a2,v168
AW a3,v169
AR v166,a4
AR v167,a5
AR v168,a6
AR v169,a7
v_mul_f32 v166,v166,v165
v_mul_f32 v167,v167,v165
v_mul_f32 v168,v168,v165
v_mul_f32 v169,v169,v165
AW a4,v166
AW a5,v167
AW a6,v168
AW a7,v169
AR v166,a8
AR v167,a9
AR v168,a10
AR v169,a11
v_mul_f32 v166,v166,v165
v_mul_f32 v167,v167,v165
v_mul_f32 v168,v168,v165
v_mul_f32 v169,v169,v165
AW a8,v166
AW a9,v167
AW a10,v168
AW a11,v169
AR v166,a12
AR v167,a13
AR v168,a14
AR v169,a15
v_mul_f32 v166,v166,v165
v_mul_f32 v167,v167,v165
v_mul_f32 v168,v168,v165
v_mul_f32 v169,v169,v165
AW a12,v166
AW a13,v167
AW a14,v168
AW a15,v169
AR v166,a16
AR v167,a17
AR v168,a18
AR v169,a19
v_mul_f32 v166,v166,v165
v_mul_f32 v167,v167,v165
v_mul_f32 v168,v168,v165
v_mul_f32 v169,v169,v165
AW a16,v166
AW a17,v167
AW a18,v168
AW a19,v169
AR v166,a20
AR v167,a21
AR v168,a22
AR v169,a23
v_mul_f32 v166,v166,v165
v_mul_f32 v167,v167,v165
v_mul_f32 v168,v168,v165
v_mul_f32 v169,v169,v165
AW a20,v166
AW a21,v167
AW a22,v168
AW a23,v169
AR v166,a24
AR v167,a25
AR v168,a26
AR v169,a27
v_mul_f32 v166,v166,v165
v_mul_f32 v167,v167,v165
v_mul_f32 v168,v168,v165
v_mul_f32 v169,v169,v165
AW a24,v166
AW a25,v167
AW a26,v168
AW a27,v169
AR v166,a28
AR v167,a29
AR v168,a30
AR v169,a31
v_mul_f32 v166,v166,v165
v_mul_f32 v167,v167,v165
v_mul_f32 v168,v168,v165
v_mul_f32 v169,v169,v165
AW a28,v166
AW a29,v167
AW a30,v168
AW a31,v169
v_exp_f32 v166,v80
v_exp_f32 v167,v81
s_nop 0
CV v128,v166,v167
v_exp_f32 v166,v82
v_exp_f32 v167,v83
s_nop 0
CV v129,v166,v167
v_exp_f32 v166,v84
v_exp_f32 v167,v85
s_nop 0
CV v130,v166,v167
v_exp_f32 v166,v86
v_exp_f32 v167,v87
s_nop 0
CV v131,v166,v167
v_max3_f32 v164,v88,v89,v90
v_max3_f32 v165,v91,v92,v93
v_max3_f32 v164,v164,v94,v95
v_max_f32 v164,v164,v165
v_mov_b32 v165,v164
s_nop 1
v_permlane16_swap_b32 v164,v165
s_nop 1
v_max_f32 v164,v164,v165
v_mov_b32 v165,v164
s_nop 1
v_permlane32_swap_b32 v164,v165
s_nop 1
v_max_f32 v164,v164,v165
v_add_f32 v164,0x41c00000,v164
v_max_f32 v164,0,v164
v_sub_f32 v165,0,v164
v_exp_f32 v165,v165
v_sub_f32 v20,v20,v164
v_sub_f32 v21,v21,v164
v_sub_f32 v22,v22,v164
v_sub_f32 v23,v23,v164
v_sub_f32 v88,v88,v164
v_sub_f32 v89,v89,v164
v_sub_f32 v90,v90,v164
v_sub_f32 v91,v91,v164
v_sub_f32 v92,v92,v164
v_sub_f32 v93,v93,v164
v_sub_f32 v94,v94,v164
v_sub_f32 v95,v95,v164
v_sub_f32 v56,v56,v164
v_sub_f32 v57,v57,v164
v_sub_f32 v58,v58,v164
v_sub_f32 v59,v59,v164
v_sub_f32 v60,v60,v164
v_sub_f32 v61,v61,v164
v_sub_f32 v62,v62,v164
v_sub_f32 v63,v63,v164
v_mul_f32 v148,v148,v165
v_mul_f32 v149,v149,v165
v_mul_f32 v150,v150,v165
v_mul_f32 v151,v151,v165
AR v166,a32
AR v167,a33
AR v168,a34
AR v169,a35
v_mul_f32 v166,v166,v165
v_mul_f32 v167,v167,v165
v_mul_f32 v168,v168,v165
v_mul_f32 v169,v169,v165
AW a32,v166
AW a33,v167
AW a34,v168
AW a35,v169
AR v166,a36
AR v167,a37
AR v168,a38
AR v169,a39
v_mul_f32 v166,v166,v165
v_mul_f32 v167,v167,v165
v_mul_f32 v168,v168,v165
v_mul_f32 v169,v169,v165
AW a36,v166
AW a37,v167
AW a38,v168
AW a39,v169
AR v166,a40
AR v167,a41
AR v168,a42
AR v169,a43
v_mul_f32 v166,v166,v165
v_mul_f32 v167,v167,v165
v_mul_f32 v168,v168,v165
v_mul_f32 v169,v169,v165
AW a40,v166
AW a41,v167
AW a42,v168
AW a43,v169
AR v166,a44
AR v167,a45
AR v168,a46
AR v169,a47
v_mul_f32 v166,v166,v165
v_mul_f32 v167,v167,v165
v_mul_f32 v168,v168,v165
v_mul_f32 v169,v169,v165
AW a44,v166
AW a45,v167
AW a46,v168
AW a47,v169
AR v166,a48
AR v167,a49
AR v168,a50
AR v169,a51
v_mul_f32 v166,v166,v165
v_mul_f32 v167,v167,v165
v_mul_f32 v168,v168,v165
v_mul_f32 v169,v169,v165
AW a48,v166
AW a49,v167
AW a50,v168
AW a51,v169
AR v166,a52
AR v167,a53
AR v168,a54
AR v169,a55
v_mul_f32 v166,v166,v165
v_mul_f32 v167,v167,v165
v_mul_f32 v168,v168,v165
v_mul_f32 v169,v169,v165
AW a52,v166
AW a53,v167
AW a54,v168
AW a55,v169
AR v166,a56
AR v167,a57
AR v168,a58
AR v169,a59
v_mul_f32 v166,v166,v165
v_mul_f32 v167,v167,v165
v_mul_f32 v168,v168,v165
v_mul_f32 v169,v169,v165
AW a56,v166
AW a57,v167
AW a58,v168
AW a59,v169
AR v166,a60
AR v167,a61
AR v168,a62
AR v169,a63
v_mul_f32 v166,v166,v165
v_mul_f32 v167,v167,v165
v_mul_f32 v168,v168,v165
v_mul_f32 v169,v169,v165
AW a60,v166
AW a61,v167
AW a62,v168
AW a63,v169
v_exp_f32 v166,v88
v_exp_f32 v167,v89
s_nop 0
CV v132,v166,v167
v_exp_f32 v166,v90
v_exp_f32 v167,v91
s_nop 0
CV v133,v166,v167
v_exp_f32 v166,v92
v_exp_f32 v167,v93
s_nop 0
CV v134,v166,v167
v_exp_f32 v166,v94
v_exp_f32 v167,v95
s_nop 0
CV v135,v166,v167
v_max3_f32 v164,v96,v97,v98
v_max3_f32 v165,v99,v100,v101
v_max3_f32 v164,v164,v102,v103
v_max_f32 v164,v164,v165
v_mov_b32 v165,v164
s_nop 1
v_permlane16_swap_b32 v164,v165
s_nop 1
v_max_f32 v164,v164,v165
v_mov_b32 v165,v164
s_nop 1
v_permlane32_swap_b32 v164,v165
s_nop 1
v_max_f32 v164,v164,v165
v_add_f32 v164,0x41c00000,v164
v_max_f32 v164,0,v164
v_sub_f32 v165,0,v164
v_exp_f32 v165,v165
v_sub_f32 v24,v24,v164
v_sub_f32 v25,v25,v164
v_sub_f32 v26,v26,v164
v_sub_f32 v27,v27,v164
v_sub_f32 v96,v96,v164
v_sub_f32 v97,v97,v164
v_sub_f32 v98,v98,v164
v_sub_f32 v99,v99,v164
v_sub_f32 v100,v100,v164
v_sub_f32 v101,v101,v164
v_sub_f32 v102,v102,v164
v_sub_f32 v103,v103,v164
v_sub_f32 v64,v64,v164
v_sub_f32 v65,v65,v164
v_sub_f32 v66,v66,v164
v_sub_f32 v67,v67,v164
v_sub_f32 v68,v68,v164
v_sub_f32 v69,v69,v164
v_sub_f32 v70,v70,v164
v_sub_f32 v71,v71,v164
v_mul_f32 v152,v152,v165
v_mul_f32 v153,v153,v165
v_mul_f32 v154,v154,v165
v_mul_f32 v155,v155,v165
AR v166,a64
AR v167,a65
AR v168,a66
AR v169,a67
v_mul_f32 v166,v166,v165
v_mul_f32 v167,v167,v165
v_mul_f32 v168,v168,v165
v_mul_f32 v169,v169,v165
AW a64,v166
AW a65,v167
AW a66,v168
AW a67,v169
AR v166,a68
AR v167,a69
AR v168,a70
AR v169,a71
v_mul_f32 v166,v166,v165
v_mul_f32 v167,v167,v165
v_mul_f32 v168,v168,v165
v_mul_f32 v169,v169,v165
AW a68,v166
AW a69,v167
AW a70,v168
AW a71,v169
AR v166,a72
AR v167,a73
AR v168,a74
AR v169,a75
v_mul_f32 v166,v166,v165
v_mul_f32 v167,v167,v165
v_mul_f32 v168,v168,v165
v_mul_f32 v169,v169,v165
AW a72,v166
AW a73,v167
AW a74,v168
AW a75,v169
AR v166,a76
AR v167,a77
AR v168,a78
AR v169,a79
v_mul_f32 v166,v166,v165
v_mul_f32 v167,v167,v165
v_mul_f32 v168,v168,v165
v_mul_f32 v169,v169,v165
AW a76,v166
AW a77,v167
AW a78,v168
AW a79,v169
AR v166,a80
AR v167,a81
AR v168,a82
AR v169,a83
v_mul_f32 v166,v166,v165
v_mul_f32 v167,v167,v165
v_mul_f32 v168,v168,v165
v_mul_f32 v169,v169,v165
AW a80,v166
AW a81,v167
AW a82,v168
AW a83,v169
AR v166,a84
AR v167,a85
AR v168,a86
AR v169,a87
v_mul_f32 v166,v166,v165
v_mul_f32 v167,v167,v165
v_mul_f32 v168,v168,v165
v_mul_f32 v169,v169,v165
AW a84,v166
AW a85,v167
AW a86,v168
AW a87,v169
AR v166,a88
AR v167,a89
AR v168,a90
AR v169,a91
v_mul_f32 v166,v166,v165
v_mul_f32 v167,v167,v165
v_mul_f32 v168,v168,v165
v_mul_f32 v169,v169,v165
AW a88,v166
AW a89,v167
AW a90,v168
AW a91,v169
AR v166,a92
AR v167,a93
AR v168,a94
AR v169,a95
v_mul_f32 v166,v166,v165
v_mul_f32 v167,v167,v165
v_mul_f32 v168,v168,v165
v_mul_f32 v169,v169,v165
AW a92,v166
AW a93,v167
AW a94,v168
AW a95,v169
v_exp_f32 v166,v96
v_exp_f32 v167,v97
s_nop 0
CV v136,v166,v167
v_exp_f32 v166,v98
v_exp_f32 v167,v99
s_nop 0
CV v137,v166,v167
v_exp_f32 v166,v100
v_exp_f32 v167,v101
s_nop 0
CV v138,v166,v167
v_exp_f32 v166,v102
v_exp_f32 v167,v103
s_nop 0
CV v139,v166,v167
v_max3_f32 v164,v104,v105,v106
v_max3_f32 v165,v107,v108,v109
v_max3_f32 v164,v164,v110,v111
v_max_f32 v164,v164,v165
v_mov_b32 v165,v164
s_nop 1
v_permlane16_swap_b32 v164,v165
s_nop 1
v_max_f32 v164,v164,v165
v_mov_b32 v165,v164
s_nop 1
v_permlane32_swap_b32 v164,v165
s_nop 1
v_max_f32 v164,v164,v165
v_add_f32 v164,0x41c00000,v164
v_max_f32 v164,0,v164
v_sub_f32 v165,0,v164
v_exp_f32 v165,v165
v_sub_f32 v28,v28,v164
v_sub_f32 v29,v29,v164
v_sub_f32 v30,v30,v164
v_sub_f32 v31,v31,v164
v_sub_f32 v104,v104,v164
v_sub_f32 v105,v105,v164
v_sub_f32 v106,v106,v164
v_sub_f32 v107,v107,v164
v_sub_f32 v108,v108,v164
v_sub_f32 v109,v109,v164
v_sub_f32 v110,v110,v164
v_sub_f32 v111,v111,v164
v_sub_f32 v72,v72,v164
v_sub_f32 v73,v73,v164
v_sub_f32 v74,v74,v164
v_sub_f32 v75,v75,v164
v_sub_f32 v76,v76,v164
v_sub_f32 v77,v77,v164
v_sub_f32 v78,v78,v164
v_sub_f32 v79,v79,v164
v_mul_f32 v156,v156,v165
v_mul_f32 v157,v157,v165
v_mul_f32 v158,v158,v165
v_mul_f32 v159,v159,v165
AR v166,a96
AR v167,a97
AR v168,a98
AR v169,a99
v_mul_f32 v166,v166,v165
v_mul_f32 v167,v167,v165
v_mul_f32 v168,v168,v165
v_mul_f32 v169,v169,v165
AW a96,v166
AW a97,v167
AW a98,v168
AW a99,v169
AR v166,a100
AR v167,a101
AR v168,a102
AR v169,a103
v_mul_f32 v166,v166,v165
v_mul_f32 v167,v167,v165
v_mul_f32 v168,v168,v165
v_mul_f32 v169,v169,v165
AW a100,v166
AW a101,v167
AW a102,v168
AW a103,v169
AR v166,a104
AR v167,a105
AR v168,a106
AR v169,a107
v_mul_f32 v166,v166,v165
v_mul_f32 v167,v167,v165
v_mul_f32 v168,v168,v165
v_mul_f32 v169,v169,v165
AW a104,v166
AW a105,v167
AW a106,v168
AW a107,v169
AR v166,a108
AR v167,a109
AR v168,a110
AR v169,a111
v_mul_f32 v166,v166,v165
v_mul_f32 v167,v167,v165
v_mul_f32 v168,v168,v165
v_mul_f32 v169,v169,v165
AW a108,v166
AW a109,v167
AW a110,v168
AW a111,v169
AR v166,a112
AR v167,a113
AR v168,a114
AR v169,a115
v_mul_f32 v166,v166,v165
v_mul_f32 v167,v167,v165
v_mul_f32 v168,v168,v165
v_mul_f32 v169,v169,v165
AW a112,v166
AW a113,v167
AW a114,v168
AW a115,v169
AR v166,a116
AR v167,a117
AR v168,a118
AR v169,a119
v_mul_f32 v166,v166,v165
v_mul_f32 v167,v167,v165
v_mul_f32 v168,v168,v165
v_mul_f32 v169,v169,v165
AW a116,v166
AW a117,v167
AW a118,v168
AW a119,v169
AR v166,a120
AR v167,a121
AR v168,a122
AR v169,a123
v_mul_f32 v166,v166,v165
v_mul_f32 v167,v167,v165
v_mul_f32 v168,v168,v165
v_mul_f32 v169,v169,v165
AW a120,v166
AW a121,v167
AW a122,v168
AW a123,v169
AR v166,a124
AR v167,a125
AR v168,a126
AR v169,a127
v_mul_f32 v166,v166,v165
v_mul_f32 v167,v167,v165
v_mul_f32 v168,v168,v165
v_mul_f32 v169,v169,v165
AW a124,v166
AW a125,v167
AW a126,v168
AW a127,v169
v_exp_f32 v166,v104
v_exp_f32 v167,v105
s_nop 0
CV v140,v166,v167
v_exp_f32 v166,v106
v_exp_f32 v167,v107
s_nop 0
CV v141,v166,v167
v_exp_f32 v166,v108
v_exp_f32 v167,v109
s_nop 0
CV v142,v166,v167
v_exp_f32 v166,v110
v_exp_f32 v167,v111
s_nop 0
CV v143,v166,v167
v_mov_b32 v6,0
s_nop 1
s_setpc_b64 s[38:39]
Lm_pl31:
s_mov_b32 s7,0x40000
Lm_pl31s:
s_sleep 1
global_load_dwordx4 v[234:237],v8,s[4:5] sc1
global_load_dwordx4 v[238:241],v8,s[4:5] offset:16 sc1
s_sub_u32 s7,s7,1
s_cmp_eq_u32 s7,0
s_cbranch_scc1 Lm_pl31x
s_waitcnt vmcnt(0)
v_xor_b32 v234,s3,v234
v_bitop3_b32 v234,v235,s3,v234 bitop3:0xbe
v_bitop3_b32 v234,v236,s3,v234 bitop3:0xbe
v_bitop3_b32 v234,v237,s3,v234 bitop3:0xbe
v_bitop3_b32 v234,v238,s3,v234 bitop3:0xbe
v_bitop3_b32 v234,v239,s3,v234 bitop3:0xbe
v_bitop3_b32 v234,v240,s3,v234 bitop3:0xbe
v_bitop3_b32 v234,v241,s3,v234 bitop3:0xbe
v_cmp_ne_u32 vcc,0,v234
s_nop 0
s_cbranch_vccnz Lm_pl31s
Lm_pl31x:
s_waitcnt vmcnt(0)
s_branch Lm_pl31r
Lm_pl5:
s_mov_b32 s7,0x40000
Lm_pl5s:
s_sleep 1
global_load_dword v9,v8,s[4:5] sc1
s_sub_u32 s7,s7,1
s_cmp_eq_u32 s7,0
s_cbranch_scc1 Lm_pl5x
s_waitcnt vmcnt(0)
v_cmp_ne_u32 vcc,s3,v9
s_nop 1
s_cbranch_vccnz Lm_pl5s
Lm_pl5x:
s_waitcnt vmcnt(0)
s_branch Lm_pl5r
Lm_pl6:
s_mov_b32 s7,0x40000
Lm_pl6s:
s_sleep 1
global_load_dword v11,v10,s[4:5] sc1
s_sub_u32 s7,s7,1
s_cmp_eq_u32 s7,0
s_cbranch_scc1 Lm_pl6x
s_waitcnt vmcnt(0)
v_cmp_ne_u32 vcc,s3,v11
s_nop 1
s_cbranch_vccnz Lm_pl6s
Lm_pl6x:
s_waitcnt vmcnt(0)
s_branch Lm_pl6r
Lm_pl8:
s_mov_b32 s7,0x40000
Lm_pl8s:
s_sleep 1
global_load_dword v51,v50,s[4:5] sc1
s_sub_u32 s7,s7,1
s_cmp_eq_u32 s7,0
s_cbranch_scc1 Lm_pl8x
s_waitcnt vmcnt(0)
v_cmp_ne_u32 vcc,s3,v51
s_nop 1
s_cbranch_vccnz Lm_pl8s
Lm_pl8x:
s_waitcnt vmcnt(0)
s_branch Lm_pl8r
Lm_pl9:
s_mov_b32 s7,0x40000
Lm_pl9s:
s_sleep 1
global_load_dword v51,v50,s[4:5] sc1
s_sub_u32 s7,s7,1
s_cmp_eq_u32 s7,0
s_cbranch_scc1 Lm_pl9x
s_waitcnt vmcnt(0)
v_cmp_ne_u32 vcc,s3,v51
s_nop 1
s_cbranch_vccnz Lm_pl9s
Lm_pl9x:
s_waitcnt vmcnt(0)
s_branch Lm_pl9r
Lm_pl27:
s_mov_b32 s7,0x40000
Lm_pl27s:
s_sleep 1
global_load_dword v12,v11,s[4:5] sc1
s_sub_u32 s7,s7,1
s_cmp_eq_u32 s7,0
s_cbranch_scc1 Lm_pl27x
s_waitcnt vmcnt(0)
v_cmp_ne_u32 vcc,s3,v12
s_nop 1
s_cbranch_vccnz Lm_pl27s
Lm_pl27x:
s_waitcnt vmcnt(0)
s_branch Lm_pl27r
Lm_pl28:
s_mov_b32 s7,0x40000
Lm_pl28s:
s_sleep 1
global_load_dword v33,v32,s[4:5] sc1
s_sub_u32 s7,s7,1
s_cmp_eq_u32 s7,0
s_cbranch_scc1 Lm_pl28x
s_waitcnt vmcnt(0)
v_cmp_ne_u32 vcc,s3,v33
s_nop 1
s_cbranch_vccnz Lm_pl28s
Lm_pl28x:
s_waitcnt vmcnt(0)
s_branch Lm_pl28r
Lm_pl32:
s_mov_b32 s7,0x40000
Lm_pl32s:
s_sleep 1
global_load_dword v31,v30,s[4:5] sc1
s_sub_u32 s7,s7,1
s_cmp_eq_u32 s7,0
s_cbranch_scc1 Lm_pl32x
s_waitcnt vmcnt(0)
v_cmp_ne_u32 vcc,s3,v31
s_nop 1
s_cbranch_vccnz Lm_pl32s
Lm_pl32x:
s_waitcnt vmcnt(0)
s_branch Lm_pl32r
Lm_pl33:
s_mov_b32 s7,0x40000
Lm_pl33s:
s_sleep 1
global_load_dword v24,v23,s[4:5] sc1
s_sub_u32 s7,s7,1
s_cmp_eq_u32 s7,0
s_cbranch_scc1 Lm_pl33x
s_waitcnt vmcnt(0)
v_cmp_ne_u32 vcc,s3,v24
s_nop 1
s_cbranch_vccnz Lm_pl33s
Lm_pl33x:
s_waitcnt vmcnt(0)
s_branch Lm_pl33r
Lm_wb7:
buffer_wbl2 sc1
s_waitcnt vmcnt(0)
s_branch Lm_wb7r
Lm_codeend:
.section .rodata,"a"
.p2align 6
.amdhsa_kernel parallel_sum__compressed_kv_cla__mixer_gmlp__prompt_kernel
  .amdhsa_next_free_vgpr 512
  .amdhsa_next_free_sgpr 102
  .amdhsa_accum_offset 256
  .amdhsa_group_segment_fixed_size 0
  .amdhsa_kernarg_size 112
  .amdhsa_user_sgpr_count 2
  .amdhsa_user_sgpr_kernarg_segment_ptr 1
  .amdhsa_system_sgpr_workgroup_id_x 1
  .amdhsa_float_denorm_mode_32 3
.end_amdhsa_kernel
```
